```python
import torch

def _softmax(x, axis=-1):
    return torch.softmax(x, dim=axis)
def _gelu(x):
    return torch.nn.functional.gelu(x, approximate="tanh")
def _silu(x):
    return torch.nn.functional.silu(x)
def _sigmoid(x):
    return torch.sigmoid(x)
def _layernorm(x, axis=-1, eps=1e-5):
    m = x.mean(dim=axis, keepdim=True)
    v = x.var(dim=axis, keepdim=True, unbiased=False)
    return (x - m) / torch.sqrt(v + eps)
def _scatter_add(tgt, idx, src, axis=0):
    return tgt.clone().index_add_(axis, idx, src)
def _segment_sum(src, seg, n):
    out = torch.zeros((n,) + src.shape[1:], dtype=src.dtype)
    return out.index_add_(0, seg, src)
def _pad(x, pw):
    flat = tuple(v for pair in reversed(pw) for v in pair)
    return torch.nn.functional.pad(x, flat)

kernel_name = 'standalone__mha_block_cached__near_ridge'

def setup_inputs():

    _w = (lambda a: (lambda t: t.to(torch.bfloat16) if t.is_floating_point() else t)(torch.as_tensor(a)))
    B, Sq, D = 32, 160, 576
    H, Sk, Dh = 32, 512, 128
    return {
        "x": _w((lambda *s: torch.randn(*s, dtype=torch.bfloat16) * 0.8)(B, Sq, D)),
        "k_cache": _w((lambda *s: torch.randn(*s, dtype=torch.bfloat16) * 0.8)(B, H, Sk, Dh)),
        "v_cache": _w((lambda *s: torch.randn(*s, dtype=torch.bfloat16) * 0.05)(B, H, Sk, Dh)),
        "wq": _w((lambda *s: torch.randn(*s, dtype=torch.bfloat16) * 0.8)(D, H * Dh) * (D ** -0.5)),
        "wo": _w((lambda *s: torch.randn(*s, dtype=torch.bfloat16) * 0.05)(H * Dh, D) * ((H * Dh) ** -0.5)),
    }

def reference(x, k_cache, v_cache, wq, wo):
    B, Sq, D = x.shape
    H, Dh = 32, 128
    q = (lambda x, *d: x.permute(*d))((x @ wq).reshape(B, Sq, H, Dh), 0, 2, 1, 3)
    scores = torch.einsum("bhqd,bhkd->bhqk", q, k_cache) * (Dh ** -0.5)
    p = _softmax(scores, axis=-1)
    o = torch.einsum("bhqk,bhkd->bhqd", p, v_cache)
    return (lambda x, *d: x.permute(*d))(o, 0, 2, 1, 3).reshape(B, Sq, H * Dh) @ wo
```

```asm
; @launch kernel=attn_kernel grid=(1024,1,1) block=(256,1,1) lds=65536
; @launch kernel=oproj_kernel grid=(256,1,1) block=(256,1,1) lds=143360
.amdgcn_target "amdgcn-amd-amdhsa--gfx950"
.text
.globl attn_kernel
.p2align 8
.type attn_kernel,@function
attn_kernel:
    s_cmp_ge_u32 s2, 1024
    s_cbranch_scc1 attn_kernel_done
    s_load_dwordx16 s[4:19], s[0:1], 0

    v_lshrrev_b32 v1, 6, v0
    v_and_b32 v0, 63, v0
    s_getreg_b32 s61, hwreg(HW_REG_HW_ID)
    v_readfirstlane_b32 s60, v1
    s_mov_b32 s43, 0
    s_bfe_u32 s62, s61, 0x20004
    s_and_b32 s61, s61, 1
    s_lshl_b32 s61, s61, 1
    s_xor_b32 s62, s62, s61
    s_lshl_b32 s63, 1, s62
    v_mov_b32 v2, s63
    v_mov_b32 v3, 49152
    v_lshl_add_u32 v1, v1, 2, v3
    ds_write_b32 v1, v2
    s_waitcnt lgkmcnt(0)
    s_barrier
    ds_read_b128 v[4:7], v3
    s_waitcnt lgkmcnt(0)
    v_or3_b32 v4, v4, v5, v6
    v_or_b32 v4, v4, v7
    s_nop 0
    v_readfirstlane_b32 s63, v4
    s_nop 1
    s_cmp_eq_u32 s63, 15
    s_cselect_b32 s60, s62, s60

attn_kernel_restart:
    s_and_b32 s61, s2, 7
    s_lshr_b32 s62, s2, 3
    s_and_b32 s63, s62, 7
    s_lshr_b32 s62, s62, 3
    s_mul_i32 s94, s63, 1
    s_add_u32 s94, s94, s62
    s_and_b32 s64, s61, 3
    s_lshr_b32 s65, s61, 2
    s_lshl_b32 s61, s64, 3
    s_add_u32 s61, s61, s63
    s_lshl_b32 s65, s65, 4
    s_add_u32 s62, s65, s62
    s_lshl_b32 s79, s60, 2
    s_lshl_b32 s41, s60, 11
    s_mov_b32 s42, 0x53800000
    s_mov_b32 s49, 0x2b800000
    s_mov_b32 s44, 0x3e0293ee
    s_mov_b32 s45, 0x3e0293ee

    s_mul_i32 s64, s60, 3
    s_lshl_b32 s65, s60, 1
    s_add_u32 s65, s65, 2
    s_min_u32 s64, s64, s65
    s_mul_i32 s46, s64, 18432
    s_add_u32 s47, s46, 18432
    s_add_u32 s48, s46, 36864
    s_lshl_b32 s50, s64, 17
    s_add_u32 s51, s50, 131072
    s_add_u32 s52, s50, 262144
    v_lshrrev_b32 v22, 4, v0
    s_and_b32 s65, s60, 1
    s_lshl_b32 s65, s65, 2
    v_or_b32 v23, s65, v22
    v_lshlrev_b32 v23, 1, v23
    v_and_b32 v24, 15, v0
    v_xor_b32 v23, v23, v24
    v_lshlrev_b32 v23, 4, v23
    s_lshl_b32 s65, s60, 3
    v_add_u32 v25, s65, v22
    v_lshl_add_u32 v1, v25, 8, v23
    v_lshl_add_u32 v2, v25, 13, v23
    v_lshrrev_b32 v25, 2, v0
    v_and_b32 v26, 3, v0
    v_mul_u32_u24 v3, 1152, v25
    v_lshl_add_u32 v3, v26, 4, v3
    v_lshl_add_u32 v16, v24, 2, v22
    v_lshlrev_b32 v16, 2, v16

    v_lshrrev_b32 v25, 2, v24
    v_lshlrev_b32 v25, 3, v25
    v_and_b32 v26, 3, v24
    v_add_u32 v25, v25, v26
    v_lshlrev_b32 v25, 8, v25
    v_and_b32 v26, 1, v22
    v_lshl_add_u32 v25, v26, 4, v25
    v_lshrrev_b32 v26, 1, v22
    v_and_b32 v27, 7, v24
    v_xor_b32 v26, v26, v27
    v_lshl_add_u32 v4, v26, 5, v25

    v_xor_b32 v5, 64, v4
    v_xor_b32 v6, 0x80, v4
    v_xor_b32 v7, 0xc0, v4
    v_bfe_u32 v25, v0, 2, 2
    v_lshl_add_u32 v26, v22, 3, v25
    v_lshlrev_b32 v26, 8, v26
    v_and_b32 v27, 3, v0
    v_lshl_add_u32 v26, v27, 3, v26
    v_and_b32 v27, 1, v22
    v_lshl_or_b32 v25, v27, 2, v25
    v_lshl_add_u32 v8, v25, 5, v26
    v_xor_b32 v9, 32, v8
    v_xor_b32 v10, 64, v8
    v_xor_b32 v11, 96, v8
    v_xor_b32 v12, 128, v8
    v_xor_b32 v13, 160, v8
    v_xor_b32 v14, 192, v8
    v_xor_b32 v15, 224, v8
    s_waitcnt lgkmcnt(0)
    s_mul_i32 s66, s61, 184320
    s_add_u32 s20, s4, s66
    s_addc_u32 s21, s5, 0
    s_mov_b32 s22, 184320
    s_mov_b32 s23, 0x20000
    s_lshl_b32 s66, s61, 5
    s_add_u32 s66, s66, s62
    s_lshl_b32 s66, s66, 17

    s_add_u32 s24, s6, s66
    s_addc_u32 s25, s7, 0
    s_mov_b32 s26, 131072
    s_mov_b32 s27, 0x20000
    s_add_u32 s28, s8, s66
    s_addc_u32 s29, s9, 0
    s_mov_b32 s30, 131072
    s_mov_b32 s31, 0x20000
    s_lshl_b32 s66, s62, 8
    s_add_u32 s32, s10, s66
    s_addc_u32 s33, s11, 0
    s_sub_u32 s34, 4718592, s66
    s_mov_b32 s35, 0x20000
    s_mul_i32 s66, s61, 1310720
    s_lshl_b32 s67, s62, 12
    s_add_u32 s66, s66, s67
    s_add_u32 s36, s18, s66
    s_addc_u32 s37, s19, 0
    s_mov_b32 s38, 1310720
    s_mov_b32 s39, 0x20000

    s_mov_b32 s68, s12
    s_mov_b32 s69, s13
    s_mov_b32 s70, 4718592
    s_mov_b32 s71, 0x20000
    s_add_u32 s72, s18, 50331648
    s_addc_u32 s73, s19, 0
    s_mov_b32 s74, 6422528
    s_mov_b32 s75, 0x20000
    s_lshl_b32 s66, s2, 1

    s_and_b32 s67, s60, 1
    s_add_u32 s66, s66, s67

    s_lshl_b32 s77, s66, 10
    s_and_b32 s67, s66, 127
    s_mul_i32 s67, s67, 36864
    s_lshr_b32 s66, s66, 7
    s_lshl_b32 s66, s66, 5
    s_add_u32 s76, s66, s67
    s_mul_i32 s67, s61, 0
    s_add_u32 s67, s67, s62
    s_lshl_b32 s67, s67, 13
    s_cmp_ge_u32 s60, 2
    s_cbranch_scc1 attn_kernel_nt2
    buffer_load_dwordx4 v[124:127], v3, s[20:23], s46 offen offset:0
    buffer_load_dwordx4 v[136:139], v3, s[20:23], s46 offen offset:64
    buffer_load_dwordx4 v[128:131], v3, s[20:23], s47 offen offset:0
    buffer_load_dwordx4 v[140:143], v3, s[20:23], s47 offen offset:64
    buffer_load_dwordx4 v[132:135], v3, s[20:23], s48 offen offset:0
    buffer_load_dwordx4 v[144:147], v3, s[20:23], s48 offen offset:64
    buffer_load_dwordx4 v[148:151], v3, s[20:23], s46 offen offset:128
    buffer_load_dwordx4 v[160:163], v3, s[20:23], s46 offen offset:192
    buffer_load_dwordx4 v[152:155], v3, s[20:23], s47 offen offset:128
    buffer_load_dwordx4 v[164:167], v3, s[20:23], s47 offen offset:192
    buffer_load_dwordx4 v[156:159], v3, s[20:23], s48 offen offset:128
    buffer_load_dwordx4 v[168:171], v3, s[20:23], s48 offen offset:192
    buffer_load_dwordx4 v[172:175], v3, s[20:23], s46 offen offset:256
    buffer_load_dwordx4 v[184:187], v3, s[20:23], s46 offen offset:320
    buffer_load_dwordx4 v[176:179], v3, s[20:23], s47 offen offset:256
    buffer_load_dwordx4 v[188:191], v3, s[20:23], s47 offen offset:320
    buffer_load_dwordx4 v[180:183], v3, s[20:23], s48 offen offset:256
    buffer_load_dwordx4 v[192:195], v3, s[20:23], s48 offen offset:320
    s_waitcnt vmcnt(17)
    ds_bpermute_b32 v196, v16, v124
    ds_bpermute_b32 v197, v16, v125
    ds_bpermute_b32 v198, v16, v126
    ds_bpermute_b32 v199, v16, v127
    s_waitcnt vmcnt(15)
    ds_bpermute_b32 v200, v16, v128
    ds_bpermute_b32 v201, v16, v129
    ds_bpermute_b32 v202, v16, v130
    ds_bpermute_b32 v203, v16, v131
    s_waitcnt vmcnt(13)
    ds_bpermute_b32 v204, v16, v132
    ds_bpermute_b32 v205, v16, v133
    ds_bpermute_b32 v206, v16, v134
    ds_bpermute_b32 v207, v16, v135
    s_waitcnt lgkmcnt(0)
    s_barrier
    ds_read_b64_tr_b16 v[224:225], v8 offset:0
    ds_read_b64_tr_b16 v[226:227], v8 offset:1024
    ds_read_b64_tr_b16 v[228:229], v9 offset:0
    ds_read_b64_tr_b16 v[230:231], v9 offset:1024
    ds_read_b64_tr_b16 v[232:233], v10 offset:0
    ds_read_b64_tr_b16 v[234:235], v10 offset:1024
    ds_read_b64_tr_b16 v[236:237], v11 offset:0
    ds_read_b64_tr_b16 v[238:239], v11 offset:1024
    ds_read_b64_tr_b16 v[240:241], v12 offset:0
    ds_read_b64_tr_b16 v[242:243], v12 offset:1024
    ds_read_b64_tr_b16 v[244:245], v13 offset:0
    ds_read_b64_tr_b16 v[246:247], v13 offset:1024
    ds_read_b64_tr_b16 v[248:249], v14 offset:0
    ds_read_b64_tr_b16 v[250:251], v14 offset:1024
    ds_read_b64_tr_b16 v[252:253], v15 offset:0
    ds_read_b64_tr_b16 v[254:255], v15 offset:1024
    s_waitcnt lgkmcnt(14)
    v_mfma_f32_16x16x32_bf16 v[28:31], v[224:227], v[196:199], 0
    v_mfma_f32_16x16x32_bf16 v[32:35], v[224:227], v[200:203], 0
    v_mfma_f32_16x16x32_bf16 v[36:39], v[224:227], v[204:207], 0
    ds_read_b64_tr_b16 v[224:225], v8 offset:8192
    ds_read_b64_tr_b16 v[226:227], v8 offset:9216
    s_waitcnt lgkmcnt(14)
    v_mfma_f32_16x16x32_bf16 v[40:43], v[228:231], v[196:199], 0
    ds_bpermute_b32 v208, v16, v136
    v_mfma_f32_16x16x32_bf16 v[44:47], v[228:231], v[200:203], 0
    ds_bpermute_b32 v209, v16, v137
    v_mfma_f32_16x16x32_bf16 v[48:51], v[228:231], v[204:207], 0
    ds_read_b64_tr_b16 v[228:229], v9 offset:8192
    ds_read_b64_tr_b16 v[230:231], v9 offset:9216
    ds_bpermute_b32 v210, v16, v138
    s_waitcnt lgkmcnt(15)
    v_mfma_f32_16x16x32_bf16 v[52:55], v[232:235], v[196:199], 0
    ds_bpermute_b32 v211, v16, v139
    v_mfma_f32_16x16x32_bf16 v[56:59], v[232:235], v[200:203], 0
    ds_bpermute_b32 v212, v16, v140
    v_mfma_f32_16x16x32_bf16 v[60:63], v[232:235], v[204:207], 0
    ds_read_b64_tr_b16 v[232:233], v10 offset:8192
    ds_read_b64_tr_b16 v[234:235], v10 offset:9216
    ds_bpermute_b32 v213, v16, v141
    v_mfma_f32_16x16x32_bf16 v[64:67], v[236:239], v[196:199], 0
    ds_bpermute_b32 v214, v16, v142
    v_mfma_f32_16x16x32_bf16 v[68:71], v[236:239], v[200:203], 0
    ds_bpermute_b32 v215, v16, v143
    v_mfma_f32_16x16x32_bf16 v[72:75], v[236:239], v[204:207], 0
    ds_read_b64_tr_b16 v[236:237], v11 offset:8192
    ds_read_b64_tr_b16 v[238:239], v11 offset:9216
    s_waitcnt vmcnt(12)
    ds_bpermute_b32 v216, v16, v144
    s_waitcnt lgkmcnt(15)
    v_mfma_f32_16x16x32_bf16 v[76:79], v[240:243], v[196:199], 0
    ds_bpermute_b32 v217, v16, v145
    v_mfma_f32_16x16x32_bf16 v[80:83], v[240:243], v[200:203], 0
    ds_bpermute_b32 v218, v16, v146
    v_mfma_f32_16x16x32_bf16 v[84:87], v[240:243], v[204:207], 0
    ds_read_b64_tr_b16 v[240:241], v12 offset:8192
    ds_read_b64_tr_b16 v[242:243], v12 offset:9216
    ds_bpermute_b32 v219, v16, v147
    v_mfma_f32_16x16x32_bf16 v[88:91], v[244:247], v[196:199], 0
    buffer_load_dwordx4 v[124:127], v3, s[20:23], s46 offen offset:384
    v_mfma_f32_16x16x32_bf16 v[92:95], v[244:247], v[200:203], 0
    buffer_load_dwordx4 v[136:139], v3, s[20:23], s46 offen offset:448
    v_mfma_f32_16x16x32_bf16 v[96:99], v[244:247], v[204:207], 0
    ds_read_b64_tr_b16 v[244:245], v13 offset:8192
    ds_read_b64_tr_b16 v[246:247], v13 offset:9216
    buffer_load_dwordx4 v[128:131], v3, s[20:23], s47 offen offset:384
    v_mfma_f32_16x16x32_bf16 v[100:103], v[248:251], v[196:199], 0
    buffer_load_dwordx4 v[140:143], v3, s[20:23], s47 offen offset:448
    v_mfma_f32_16x16x32_bf16 v[104:107], v[248:251], v[200:203], 0
    buffer_load_dwordx4 v[132:135], v3, s[20:23], s48 offen offset:384
    v_mfma_f32_16x16x32_bf16 v[108:111], v[248:251], v[204:207], 0
    ds_read_b64_tr_b16 v[248:249], v14 offset:8192
    ds_read_b64_tr_b16 v[250:251], v14 offset:9216
    buffer_load_dwordx4 v[144:147], v3, s[20:23], s48 offen offset:448
    v_mfma_f32_16x16x32_bf16 v[112:115], v[252:255], v[196:199], 0
    v_mfma_f32_16x16x32_bf16 v[116:119], v[252:255], v[200:203], 0
    v_mfma_f32_16x16x32_bf16 v[120:123], v[252:255], v[204:207], 0
    ds_read_b64_tr_b16 v[252:253], v15 offset:8192
    ds_read_b64_tr_b16 v[254:255], v15 offset:9216
    s_waitcnt lgkmcnt(15)
    v_mfma_f32_16x16x32_bf16 v[28:31], v[224:227], v[208:211], v[28:31]
    s_waitcnt lgkmcnt(14)
    v_mfma_f32_16x16x32_bf16 v[32:35], v[224:227], v[212:215], v[32:35]
    s_waitcnt lgkmcnt(6)
    v_mfma_f32_16x16x32_bf16 v[36:39], v[224:227], v[216:219], v[36:39]
    v_mfma_f32_16x16x32_bf16 v[40:43], v[228:231], v[208:211], v[40:43]
    s_waitcnt vmcnt(17)
    ds_bpermute_b32 v196, v16, v148
    v_mfma_f32_16x16x32_bf16 v[44:47], v[228:231], v[212:215], v[44:47]
    ds_bpermute_b32 v197, v16, v149
    v_mfma_f32_16x16x32_bf16 v[48:51], v[228:231], v[216:219], v[48:51]
    ds_bpermute_b32 v198, v16, v150
    v_mfma_f32_16x16x32_bf16 v[52:55], v[232:235], v[208:211], v[52:55]
    ds_bpermute_b32 v199, v16, v151
    v_mfma_f32_16x16x32_bf16 v[56:59], v[232:235], v[212:215], v[56:59]
    s_waitcnt vmcnt(15)
    ds_bpermute_b32 v200, v16, v152
    v_mfma_f32_16x16x32_bf16 v[60:63], v[232:235], v[216:219], v[60:63]
    ds_bpermute_b32 v201, v16, v153
    v_mfma_f32_16x16x32_bf16 v[64:67], v[236:239], v[208:211], v[64:67]
    ds_bpermute_b32 v202, v16, v154
    v_mfma_f32_16x16x32_bf16 v[68:71], v[236:239], v[212:215], v[68:71]
    ds_bpermute_b32 v203, v16, v155
    v_mfma_f32_16x16x32_bf16 v[72:75], v[236:239], v[216:219], v[72:75]
    s_waitcnt vmcnt(13)
    ds_bpermute_b32 v204, v16, v156
    v_mfma_f32_16x16x32_bf16 v[76:79], v[240:243], v[208:211], v[76:79]
    ds_bpermute_b32 v205, v16, v157
    v_mfma_f32_16x16x32_bf16 v[80:83], v[240:243], v[212:215], v[80:83]
    ds_bpermute_b32 v206, v16, v158
    v_mfma_f32_16x16x32_bf16 v[84:87], v[240:243], v[216:219], v[84:87]
    s_waitcnt lgkmcnt(0)
    s_barrier
    ds_read_b64_tr_b16 v[224:225], v8 offset:16384
    ds_read_b64_tr_b16 v[226:227], v8 offset:17408
    ds_bpermute_b32 v207, v16, v159
    v_mfma_f32_16x16x32_bf16 v[88:91], v[244:247], v[208:211], v[88:91]
    ds_read_b64_tr_b16 v[228:229], v9 offset:16384
    ds_read_b64_tr_b16 v[230:231], v9 offset:17408
    v_mfma_f32_16x16x32_bf16 v[92:95], v[244:247], v[212:215], v[92:95]
    ds_read_b64_tr_b16 v[232:233], v10 offset:16384
    ds_read_b64_tr_b16 v[234:235], v10 offset:17408
    v_mfma_f32_16x16x32_bf16 v[96:99], v[244:247], v[216:219], v[96:99]
    ds_read_b64_tr_b16 v[236:237], v11 offset:16384
    ds_read_b64_tr_b16 v[238:239], v11 offset:17408
    v_mfma_f32_16x16x32_bf16 v[100:103], v[248:251], v[208:211], v[100:103]
    ds_read_b64_tr_b16 v[240:241], v12 offset:16384
    ds_read_b64_tr_b16 v[242:243], v12 offset:17408
    v_mfma_f32_16x16x32_bf16 v[104:107], v[248:251], v[212:215], v[104:107]
    ds_read_b64_tr_b16 v[244:245], v13 offset:16384
    ds_read_b64_tr_b16 v[246:247], v13 offset:17408
    v_mfma_f32_16x16x32_bf16 v[108:111], v[248:251], v[216:219], v[108:111]
    ds_read_b64_tr_b16 v[248:249], v14 offset:16384
    ds_read_b64_tr_b16 v[250:251], v14 offset:17408
    v_mfma_f32_16x16x32_bf16 v[112:115], v[252:255], v[208:211], v[112:115]
    v_mfma_f32_16x16x32_bf16 v[116:119], v[252:255], v[212:215], v[116:119]
    v_mfma_f32_16x16x32_bf16 v[120:123], v[252:255], v[216:219], v[120:123]
    ds_read_b64_tr_b16 v[252:253], v15 offset:16384
    ds_read_b64_tr_b16 v[254:255], v15 offset:17408
    s_waitcnt lgkmcnt(15)
    v_mfma_f32_16x16x32_bf16 v[28:31], v[224:227], v[196:199], v[28:31]
    v_mfma_f32_16x16x32_bf16 v[32:35], v[224:227], v[200:203], v[32:35]
    s_waitcnt lgkmcnt(14)
    v_mfma_f32_16x16x32_bf16 v[36:39], v[224:227], v[204:207], v[36:39]
    ds_read_b64_tr_b16 v[224:225], v8 offset:24576
    ds_read_b64_tr_b16 v[226:227], v8 offset:25600
    s_waitcnt lgkmcnt(14)
    v_mfma_f32_16x16x32_bf16 v[40:43], v[228:231], v[196:199], v[40:43]
    ds_bpermute_b32 v208, v16, v160
    v_mfma_f32_16x16x32_bf16 v[44:47], v[228:231], v[200:203], v[44:47]
    ds_bpermute_b32 v209, v16, v161
    v_mfma_f32_16x16x32_bf16 v[48:51], v[228:231], v[204:207], v[48:51]
    ds_read_b64_tr_b16 v[228:229], v9 offset:24576
    ds_read_b64_tr_b16 v[230:231], v9 offset:25600
    ds_bpermute_b32 v210, v16, v162
    s_waitcnt lgkmcnt(15)
    v_mfma_f32_16x16x32_bf16 v[52:55], v[232:235], v[196:199], v[52:55]
    ds_bpermute_b32 v211, v16, v163
    v_mfma_f32_16x16x32_bf16 v[56:59], v[232:235], v[200:203], v[56:59]
    ds_bpermute_b32 v212, v16, v164
    v_mfma_f32_16x16x32_bf16 v[60:63], v[232:235], v[204:207], v[60:63]
    ds_read_b64_tr_b16 v[232:233], v10 offset:24576
    ds_read_b64_tr_b16 v[234:235], v10 offset:25600
    ds_bpermute_b32 v213, v16, v165
    v_mfma_f32_16x16x32_bf16 v[64:67], v[236:239], v[196:199], v[64:67]
    ds_bpermute_b32 v214, v16, v166
    v_mfma_f32_16x16x32_bf16 v[68:71], v[236:239], v[200:203], v[68:71]
    ds_bpermute_b32 v215, v16, v167
    v_mfma_f32_16x16x32_bf16 v[72:75], v[236:239], v[204:207], v[72:75]
    ds_read_b64_tr_b16 v[236:237], v11 offset:24576
    ds_read_b64_tr_b16 v[238:239], v11 offset:25600
    s_waitcnt vmcnt(12)
    ds_bpermute_b32 v216, v16, v168
    s_waitcnt lgkmcnt(15)
    v_mfma_f32_16x16x32_bf16 v[76:79], v[240:243], v[196:199], v[76:79]
    ds_bpermute_b32 v217, v16, v169
    v_mfma_f32_16x16x32_bf16 v[80:83], v[240:243], v[200:203], v[80:83]
    ds_bpermute_b32 v218, v16, v170
    v_mfma_f32_16x16x32_bf16 v[84:87], v[240:243], v[204:207], v[84:87]
    ds_read_b64_tr_b16 v[240:241], v12 offset:24576
    ds_read_b64_tr_b16 v[242:243], v12 offset:25600
    ds_bpermute_b32 v219, v16, v171
    v_mfma_f32_16x16x32_bf16 v[88:91], v[244:247], v[196:199], v[88:91]
    buffer_load_dwordx4 v[148:151], v3, s[20:23], s46 offen offset:512
    v_mfma_f32_16x16x32_bf16 v[92:95], v[244:247], v[200:203], v[92:95]
    buffer_load_dwordx4 v[160:163], v3, s[20:23], s46 offen offset:576
    v_mfma_f32_16x16x32_bf16 v[96:99], v[244:247], v[204:207], v[96:99]
    ds_read_b64_tr_b16 v[244:245], v13 offset:24576
    ds_read_b64_tr_b16 v[246:247], v13 offset:25600
    buffer_load_dwordx4 v[152:155], v3, s[20:23], s47 offen offset:512
    v_mfma_f32_16x16x32_bf16 v[100:103], v[248:251], v[196:199], v[100:103]
    buffer_load_dwordx4 v[164:167], v3, s[20:23], s47 offen offset:576
    v_mfma_f32_16x16x32_bf16 v[104:107], v[248:251], v[200:203], v[104:107]
    buffer_load_dwordx4 v[156:159], v3, s[20:23], s48 offen offset:512
    v_mfma_f32_16x16x32_bf16 v[108:111], v[248:251], v[204:207], v[108:111]
    ds_read_b64_tr_b16 v[248:249], v14 offset:24576
    ds_read_b64_tr_b16 v[250:251], v14 offset:25600
    buffer_load_dwordx4 v[168:171], v3, s[20:23], s48 offen offset:576
    v_mfma_f32_16x16x32_bf16 v[112:115], v[252:255], v[196:199], v[112:115]
    v_mfma_f32_16x16x32_bf16 v[116:119], v[252:255], v[200:203], v[116:119]
    v_mfma_f32_16x16x32_bf16 v[120:123], v[252:255], v[204:207], v[120:123]
    ds_read_b64_tr_b16 v[252:253], v15 offset:24576
    ds_read_b64_tr_b16 v[254:255], v15 offset:25600
    s_waitcnt lgkmcnt(15)
    v_mfma_f32_16x16x32_bf16 v[28:31], v[224:227], v[208:211], v[28:31]
    s_waitcnt lgkmcnt(14)
    v_mfma_f32_16x16x32_bf16 v[32:35], v[224:227], v[212:215], v[32:35]
    s_waitcnt lgkmcnt(6)
    v_mfma_f32_16x16x32_bf16 v[36:39], v[224:227], v[216:219], v[36:39]
    v_mfma_f32_16x16x32_bf16 v[40:43], v[228:231], v[208:211], v[40:43]
    s_waitcnt vmcnt(17)
    ds_bpermute_b32 v196, v16, v172
    v_mfma_f32_16x16x32_bf16 v[44:47], v[228:231], v[212:215], v[44:47]
    ds_bpermute_b32 v197, v16, v173
    v_mfma_f32_16x16x32_bf16 v[48:51], v[228:231], v[216:219], v[48:51]
    ds_bpermute_b32 v198, v16, v174
    v_mfma_f32_16x16x32_bf16 v[52:55], v[232:235], v[208:211], v[52:55]
    ds_bpermute_b32 v199, v16, v175
    v_mfma_f32_16x16x32_bf16 v[56:59], v[232:235], v[212:215], v[56:59]
    s_waitcnt vmcnt(15)
    ds_bpermute_b32 v200, v16, v176
    v_mfma_f32_16x16x32_bf16 v[60:63], v[232:235], v[216:219], v[60:63]
    ds_bpermute_b32 v201, v16, v177
    v_mfma_f32_16x16x32_bf16 v[64:67], v[236:239], v[208:211], v[64:67]
    ds_bpermute_b32 v202, v16, v178
    v_mfma_f32_16x16x32_bf16 v[68:71], v[236:239], v[212:215], v[68:71]
    ds_bpermute_b32 v203, v16, v179
    v_mfma_f32_16x16x32_bf16 v[72:75], v[236:239], v[216:219], v[72:75]
    s_waitcnt vmcnt(13)
    ds_bpermute_b32 v204, v16, v180
    v_mfma_f32_16x16x32_bf16 v[76:79], v[240:243], v[208:211], v[76:79]
    ds_bpermute_b32 v205, v16, v181
    v_mfma_f32_16x16x32_bf16 v[80:83], v[240:243], v[212:215], v[80:83]
    ds_bpermute_b32 v206, v16, v182
    v_mfma_f32_16x16x32_bf16 v[84:87], v[240:243], v[216:219], v[84:87]
    s_waitcnt lgkmcnt(0)
    s_barrier
    ds_read_b64_tr_b16 v[224:225], v8 offset:32768
    ds_read_b64_tr_b16 v[226:227], v8 offset:33792
    ds_bpermute_b32 v207, v16, v183
    v_mfma_f32_16x16x32_bf16 v[88:91], v[244:247], v[208:211], v[88:91]
    ds_read_b64_tr_b16 v[228:229], v9 offset:32768
    ds_read_b64_tr_b16 v[230:231], v9 offset:33792
    v_mfma_f32_16x16x32_bf16 v[92:95], v[244:247], v[212:215], v[92:95]
    ds_read_b64_tr_b16 v[232:233], v10 offset:32768
    ds_read_b64_tr_b16 v[234:235], v10 offset:33792
    v_mfma_f32_16x16x32_bf16 v[96:99], v[244:247], v[216:219], v[96:99]
    ds_read_b64_tr_b16 v[236:237], v11 offset:32768
    ds_read_b64_tr_b16 v[238:239], v11 offset:33792
    v_mfma_f32_16x16x32_bf16 v[100:103], v[248:251], v[208:211], v[100:103]
    ds_read_b64_tr_b16 v[240:241], v12 offset:32768
    ds_read_b64_tr_b16 v[242:243], v12 offset:33792
    v_mfma_f32_16x16x32_bf16 v[104:107], v[248:251], v[212:215], v[104:107]
    ds_read_b64_tr_b16 v[244:245], v13 offset:32768
    ds_read_b64_tr_b16 v[246:247], v13 offset:33792
    v_mfma_f32_16x16x32_bf16 v[108:111], v[248:251], v[216:219], v[108:111]
    ds_read_b64_tr_b16 v[248:249], v14 offset:32768
    ds_read_b64_tr_b16 v[250:251], v14 offset:33792
    v_mfma_f32_16x16x32_bf16 v[112:115], v[252:255], v[208:211], v[112:115]
    v_mfma_f32_16x16x32_bf16 v[116:119], v[252:255], v[212:215], v[116:119]
    v_mfma_f32_16x16x32_bf16 v[120:123], v[252:255], v[216:219], v[120:123]
    ds_read_b64_tr_b16 v[252:253], v15 offset:32768
    ds_read_b64_tr_b16 v[254:255], v15 offset:33792
    s_waitcnt lgkmcnt(15)
    v_mfma_f32_16x16x32_bf16 v[28:31], v[224:227], v[196:199], v[28:31]
    v_mfma_f32_16x16x32_bf16 v[32:35], v[224:227], v[200:203], v[32:35]
    s_waitcnt lgkmcnt(14)
    v_mfma_f32_16x16x32_bf16 v[36:39], v[224:227], v[204:207], v[36:39]
    ds_read_b64_tr_b16 v[224:225], v8 offset:40960
    ds_read_b64_tr_b16 v[226:227], v8 offset:41984
    s_waitcnt lgkmcnt(14)
    v_mfma_f32_16x16x32_bf16 v[40:43], v[228:231], v[196:199], v[40:43]
    ds_bpermute_b32 v208, v16, v184
    v_mfma_f32_16x16x32_bf16 v[44:47], v[228:231], v[200:203], v[44:47]
    ds_bpermute_b32 v209, v16, v185
    v_mfma_f32_16x16x32_bf16 v[48:51], v[228:231], v[204:207], v[48:51]
    ds_read_b64_tr_b16 v[228:229], v9 offset:40960
    ds_read_b64_tr_b16 v[230:231], v9 offset:41984
    ds_bpermute_b32 v210, v16, v186
    s_waitcnt lgkmcnt(15)
    v_mfma_f32_16x16x32_bf16 v[52:55], v[232:235], v[196:199], v[52:55]
    ds_bpermute_b32 v211, v16, v187
    v_mfma_f32_16x16x32_bf16 v[56:59], v[232:235], v[200:203], v[56:59]
    ds_bpermute_b32 v212, v16, v188
    v_mfma_f32_16x16x32_bf16 v[60:63], v[232:235], v[204:207], v[60:63]
    ds_read_b64_tr_b16 v[232:233], v10 offset:40960
    ds_read_b64_tr_b16 v[234:235], v10 offset:41984
    ds_bpermute_b32 v213, v16, v189
    v_mfma_f32_16x16x32_bf16 v[64:67], v[236:239], v[196:199], v[64:67]
    ds_bpermute_b32 v214, v16, v190
    v_mfma_f32_16x16x32_bf16 v[68:71], v[236:239], v[200:203], v[68:71]
    ds_bpermute_b32 v215, v16, v191
    v_mfma_f32_16x16x32_bf16 v[72:75], v[236:239], v[204:207], v[72:75]
    ds_read_b64_tr_b16 v[236:237], v11 offset:40960
    ds_read_b64_tr_b16 v[238:239], v11 offset:41984
    s_waitcnt vmcnt(12)
    ds_bpermute_b32 v216, v16, v192
    s_waitcnt lgkmcnt(15)
    v_mfma_f32_16x16x32_bf16 v[76:79], v[240:243], v[196:199], v[76:79]
    ds_bpermute_b32 v217, v16, v193
    v_mfma_f32_16x16x32_bf16 v[80:83], v[240:243], v[200:203], v[80:83]
    ds_bpermute_b32 v218, v16, v194
    v_mfma_f32_16x16x32_bf16 v[84:87], v[240:243], v[204:207], v[84:87]
    ds_read_b64_tr_b16 v[240:241], v12 offset:40960
    ds_read_b64_tr_b16 v[242:243], v12 offset:41984
    ds_bpermute_b32 v219, v16, v195
    v_mfma_f32_16x16x32_bf16 v[88:91], v[244:247], v[196:199], v[88:91]
    buffer_load_dwordx4 v[172:175], v3, s[20:23], s46 offen offset:640
    v_mfma_f32_16x16x32_bf16 v[92:95], v[244:247], v[200:203], v[92:95]
    buffer_load_dwordx4 v[184:187], v3, s[20:23], s46 offen offset:704
    v_mfma_f32_16x16x32_bf16 v[96:99], v[244:247], v[204:207], v[96:99]
    ds_read_b64_tr_b16 v[244:245], v13 offset:40960
    ds_read_b64_tr_b16 v[246:247], v13 offset:41984
    buffer_load_dwordx4 v[176:179], v3, s[20:23], s47 offen offset:640
    v_mfma_f32_16x16x32_bf16 v[100:103], v[248:251], v[196:199], v[100:103]
    buffer_load_dwordx4 v[188:191], v3, s[20:23], s47 offen offset:704
    v_mfma_f32_16x16x32_bf16 v[104:107], v[248:251], v[200:203], v[104:107]
    buffer_load_dwordx4 v[180:183], v3, s[20:23], s48 offen offset:640
    v_mfma_f32_16x16x32_bf16 v[108:111], v[248:251], v[204:207], v[108:111]
    ds_read_b64_tr_b16 v[248:249], v14 offset:40960
    ds_read_b64_tr_b16 v[250:251], v14 offset:41984
    buffer_load_dwordx4 v[192:195], v3, s[20:23], s48 offen offset:704
    v_mfma_f32_16x16x32_bf16 v[112:115], v[252:255], v[196:199], v[112:115]
    v_mfma_f32_16x16x32_bf16 v[116:119], v[252:255], v[200:203], v[116:119]
    v_mfma_f32_16x16x32_bf16 v[120:123], v[252:255], v[204:207], v[120:123]
    ds_read_b64_tr_b16 v[252:253], v15 offset:40960
    ds_read_b64_tr_b16 v[254:255], v15 offset:41984
    s_waitcnt lgkmcnt(15)
    v_mfma_f32_16x16x32_bf16 v[28:31], v[224:227], v[208:211], v[28:31]
    s_waitcnt lgkmcnt(14)
    v_mfma_f32_16x16x32_bf16 v[32:35], v[224:227], v[212:215], v[32:35]
    s_waitcnt lgkmcnt(6)
    v_mfma_f32_16x16x32_bf16 v[36:39], v[224:227], v[216:219], v[36:39]
    v_mfma_f32_16x16x32_bf16 v[40:43], v[228:231], v[208:211], v[40:43]
    s_waitcnt vmcnt(17)
    ds_bpermute_b32 v196, v16, v124
    v_mfma_f32_16x16x32_bf16 v[44:47], v[228:231], v[212:215], v[44:47]
    ds_bpermute_b32 v197, v16, v125
    v_mfma_f32_16x16x32_bf16 v[48:51], v[228:231], v[216:219], v[48:51]
    ds_bpermute_b32 v198, v16, v126
    v_mfma_f32_16x16x32_bf16 v[52:55], v[232:235], v[208:211], v[52:55]
    ds_bpermute_b32 v199, v16, v127
    v_mfma_f32_16x16x32_bf16 v[56:59], v[232:235], v[212:215], v[56:59]
    s_waitcnt vmcnt(15)
    ds_bpermute_b32 v200, v16, v128
    v_mfma_f32_16x16x32_bf16 v[60:63], v[232:235], v[216:219], v[60:63]
    ds_bpermute_b32 v201, v16, v129
    v_mfma_f32_16x16x32_bf16 v[64:67], v[236:239], v[208:211], v[64:67]
    ds_bpermute_b32 v202, v16, v130
    v_mfma_f32_16x16x32_bf16 v[68:71], v[236:239], v[212:215], v[68:71]
    ds_bpermute_b32 v203, v16, v131
    v_mfma_f32_16x16x32_bf16 v[72:75], v[236:239], v[216:219], v[72:75]
    s_waitcnt vmcnt(13)
    ds_bpermute_b32 v204, v16, v132
    v_mfma_f32_16x16x32_bf16 v[76:79], v[240:243], v[208:211], v[76:79]
    ds_bpermute_b32 v205, v16, v133
    v_mfma_f32_16x16x32_bf16 v[80:83], v[240:243], v[212:215], v[80:83]
    ds_bpermute_b32 v206, v16, v134
    v_mfma_f32_16x16x32_bf16 v[84:87], v[240:243], v[216:219], v[84:87]
    s_waitcnt lgkmcnt(0)
    s_barrier
    ds_read_b64_tr_b16 v[224:225], v8 offset:49152
    ds_read_b64_tr_b16 v[226:227], v8 offset:50176
    ds_bpermute_b32 v207, v16, v135
    v_mfma_f32_16x16x32_bf16 v[88:91], v[244:247], v[208:211], v[88:91]
    ds_read_b64_tr_b16 v[228:229], v9 offset:49152
    ds_read_b64_tr_b16 v[230:231], v9 offset:50176
    v_mfma_f32_16x16x32_bf16 v[92:95], v[244:247], v[212:215], v[92:95]
    ds_read_b64_tr_b16 v[232:233], v10 offset:49152
    ds_read_b64_tr_b16 v[234:235], v10 offset:50176
    v_mfma_f32_16x16x32_bf16 v[96:99], v[244:247], v[216:219], v[96:99]
    ds_read_b64_tr_b16 v[236:237], v11 offset:49152
    ds_read_b64_tr_b16 v[238:239], v11 offset:50176
    v_mfma_f32_16x16x32_bf16 v[100:103], v[248:251], v[208:211], v[100:103]
    ds_read_b64_tr_b16 v[240:241], v12 offset:49152
    ds_read_b64_tr_b16 v[242:243], v12 offset:50176
    v_mfma_f32_16x16x32_bf16 v[104:107], v[248:251], v[212:215], v[104:107]
    ds_read_b64_tr_b16 v[244:245], v13 offset:49152
    ds_read_b64_tr_b16 v[246:247], v13 offset:50176
    v_mfma_f32_16x16x32_bf16 v[108:111], v[248:251], v[216:219], v[108:111]
    ds_read_b64_tr_b16 v[248:249], v14 offset:49152
    ds_read_b64_tr_b16 v[250:251], v14 offset:50176
    v_mfma_f32_16x16x32_bf16 v[112:115], v[252:255], v[208:211], v[112:115]
    v_mfma_f32_16x16x32_bf16 v[116:119], v[252:255], v[212:215], v[116:119]
    v_mfma_f32_16x16x32_bf16 v[120:123], v[252:255], v[216:219], v[120:123]
    ds_read_b64_tr_b16 v[252:253], v15 offset:49152
    ds_read_b64_tr_b16 v[254:255], v15 offset:50176
    s_waitcnt lgkmcnt(15)
    v_mfma_f32_16x16x32_bf16 v[28:31], v[224:227], v[196:199], v[28:31]
    v_mfma_f32_16x16x32_bf16 v[32:35], v[224:227], v[200:203], v[32:35]
    s_waitcnt lgkmcnt(14)
    v_mfma_f32_16x16x32_bf16 v[36:39], v[224:227], v[204:207], v[36:39]
    ds_read_b64_tr_b16 v[224:225], v8 offset:57344
    ds_read_b64_tr_b16 v[226:227], v8 offset:58368
    s_waitcnt lgkmcnt(14)
    v_mfma_f32_16x16x32_bf16 v[40:43], v[228:231], v[196:199], v[40:43]
    ds_bpermute_b32 v208, v16, v136
    v_mfma_f32_16x16x32_bf16 v[44:47], v[228:231], v[200:203], v[44:47]
    ds_bpermute_b32 v209, v16, v137
    v_mfma_f32_16x16x32_bf16 v[48:51], v[228:231], v[204:207], v[48:51]
    ds_read_b64_tr_b16 v[228:229], v9 offset:57344
    ds_read_b64_tr_b16 v[230:231], v9 offset:58368
    ds_bpermute_b32 v210, v16, v138
    s_waitcnt lgkmcnt(15)
    v_mfma_f32_16x16x32_bf16 v[52:55], v[232:235], v[196:199], v[52:55]
    ds_bpermute_b32 v211, v16, v139
    v_mfma_f32_16x16x32_bf16 v[56:59], v[232:235], v[200:203], v[56:59]
    ds_bpermute_b32 v212, v16, v140
    v_mfma_f32_16x16x32_bf16 v[60:63], v[232:235], v[204:207], v[60:63]
    ds_read_b64_tr_b16 v[232:233], v10 offset:57344
    ds_read_b64_tr_b16 v[234:235], v10 offset:58368
    ds_bpermute_b32 v213, v16, v141
    v_mfma_f32_16x16x32_bf16 v[64:67], v[236:239], v[196:199], v[64:67]
    ds_bpermute_b32 v214, v16, v142
    v_mfma_f32_16x16x32_bf16 v[68:71], v[236:239], v[200:203], v[68:71]
    ds_bpermute_b32 v215, v16, v143
    v_mfma_f32_16x16x32_bf16 v[72:75], v[236:239], v[204:207], v[72:75]
    ds_read_b64_tr_b16 v[236:237], v11 offset:57344
    ds_read_b64_tr_b16 v[238:239], v11 offset:58368
    s_waitcnt vmcnt(12)
    ds_bpermute_b32 v216, v16, v144
    s_waitcnt lgkmcnt(15)
    v_mfma_f32_16x16x32_bf16 v[76:79], v[240:243], v[196:199], v[76:79]
    ds_bpermute_b32 v217, v16, v145
    v_mfma_f32_16x16x32_bf16 v[80:83], v[240:243], v[200:203], v[80:83]
    ds_bpermute_b32 v218, v16, v146
    v_mfma_f32_16x16x32_bf16 v[84:87], v[240:243], v[204:207], v[84:87]
    ds_read_b64_tr_b16 v[240:241], v12 offset:57344
    ds_read_b64_tr_b16 v[242:243], v12 offset:58368
    ds_bpermute_b32 v219, v16, v147
    v_mfma_f32_16x16x32_bf16 v[88:91], v[244:247], v[196:199], v[88:91]
    buffer_load_dwordx4 v[124:127], v3, s[20:23], s46 offen offset:768
    v_mfma_f32_16x16x32_bf16 v[92:95], v[244:247], v[200:203], v[92:95]
    buffer_load_dwordx4 v[136:139], v3, s[20:23], s46 offen offset:832
    v_mfma_f32_16x16x32_bf16 v[96:99], v[244:247], v[204:207], v[96:99]
    ds_read_b64_tr_b16 v[244:245], v13 offset:57344
    ds_read_b64_tr_b16 v[246:247], v13 offset:58368
    buffer_load_dwordx4 v[128:131], v3, s[20:23], s47 offen offset:768
    v_mfma_f32_16x16x32_bf16 v[100:103], v[248:251], v[196:199], v[100:103]
    buffer_load_dwordx4 v[140:143], v3, s[20:23], s47 offen offset:832
    v_mfma_f32_16x16x32_bf16 v[104:107], v[248:251], v[200:203], v[104:107]
    buffer_load_dwordx4 v[132:135], v3, s[20:23], s48 offen offset:768
    v_mfma_f32_16x16x32_bf16 v[108:111], v[248:251], v[204:207], v[108:111]
    ds_read_b64_tr_b16 v[248:249], v14 offset:57344
    ds_read_b64_tr_b16 v[250:251], v14 offset:58368
    buffer_load_dwordx4 v[144:147], v3, s[20:23], s48 offen offset:832
    v_mfma_f32_16x16x32_bf16 v[112:115], v[252:255], v[196:199], v[112:115]
    v_mfma_f32_16x16x32_bf16 v[116:119], v[252:255], v[200:203], v[116:119]
    v_mfma_f32_16x16x32_bf16 v[120:123], v[252:255], v[204:207], v[120:123]
    ds_read_b64_tr_b16 v[252:253], v15 offset:57344
    ds_read_b64_tr_b16 v[254:255], v15 offset:58368
    s_waitcnt lgkmcnt(15)
    v_mfma_f32_16x16x32_bf16 v[28:31], v[224:227], v[208:211], v[28:31]
    s_waitcnt lgkmcnt(14)
    v_mfma_f32_16x16x32_bf16 v[32:35], v[224:227], v[212:215], v[32:35]
    s_waitcnt lgkmcnt(6)
    v_mfma_f32_16x16x32_bf16 v[36:39], v[224:227], v[216:219], v[36:39]
    v_mfma_f32_16x16x32_bf16 v[40:43], v[228:231], v[208:211], v[40:43]
    s_waitcnt vmcnt(17)
    ds_bpermute_b32 v196, v16, v148
    v_mfma_f32_16x16x32_bf16 v[44:47], v[228:231], v[212:215], v[44:47]
    ds_bpermute_b32 v197, v16, v149
    v_mfma_f32_16x16x32_bf16 v[48:51], v[228:231], v[216:219], v[48:51]
    ds_bpermute_b32 v198, v16, v150
    v_mfma_f32_16x16x32_bf16 v[52:55], v[232:235], v[208:211], v[52:55]
    ds_bpermute_b32 v199, v16, v151
    v_mfma_f32_16x16x32_bf16 v[56:59], v[232:235], v[212:215], v[56:59]
    s_waitcnt vmcnt(15)
    ds_bpermute_b32 v200, v16, v152
    v_mfma_f32_16x16x32_bf16 v[60:63], v[232:235], v[216:219], v[60:63]
    ds_bpermute_b32 v201, v16, v153
    v_mfma_f32_16x16x32_bf16 v[64:67], v[236:239], v[208:211], v[64:67]
    ds_bpermute_b32 v202, v16, v154
    v_mfma_f32_16x16x32_bf16 v[68:71], v[236:239], v[212:215], v[68:71]
    ds_bpermute_b32 v203, v16, v155
    v_mfma_f32_16x16x32_bf16 v[72:75], v[236:239], v[216:219], v[72:75]
    s_waitcnt vmcnt(13)
    ds_bpermute_b32 v204, v16, v156
    v_mfma_f32_16x16x32_bf16 v[76:79], v[240:243], v[208:211], v[76:79]
    ds_bpermute_b32 v205, v16, v157
    v_mfma_f32_16x16x32_bf16 v[80:83], v[240:243], v[212:215], v[80:83]
    ds_bpermute_b32 v206, v16, v158
    v_mfma_f32_16x16x32_bf16 v[84:87], v[240:243], v[216:219], v[84:87]
    s_waitcnt lgkmcnt(0)
    s_barrier
    ds_read_b64_tr_b16 v[224:225], v8 offset:0
    ds_read_b64_tr_b16 v[226:227], v8 offset:1024
    ds_bpermute_b32 v207, v16, v159
    v_mfma_f32_16x16x32_bf16 v[88:91], v[244:247], v[208:211], v[88:91]
    ds_read_b64_tr_b16 v[228:229], v9 offset:0
    ds_read_b64_tr_b16 v[230:231], v9 offset:1024
    v_mfma_f32_16x16x32_bf16 v[92:95], v[244:247], v[212:215], v[92:95]
    ds_read_b64_tr_b16 v[232:233], v10 offset:0
    ds_read_b64_tr_b16 v[234:235], v10 offset:1024
    v_mfma_f32_16x16x32_bf16 v[96:99], v[244:247], v[216:219], v[96:99]
    ds_read_b64_tr_b16 v[236:237], v11 offset:0
    ds_read_b64_tr_b16 v[238:239], v11 offset:1024
    v_mfma_f32_16x16x32_bf16 v[100:103], v[248:251], v[208:211], v[100:103]
    ds_read_b64_tr_b16 v[240:241], v12 offset:0
    ds_read_b64_tr_b16 v[242:243], v12 offset:1024
    v_mfma_f32_16x16x32_bf16 v[104:107], v[248:251], v[212:215], v[104:107]
    ds_read_b64_tr_b16 v[244:245], v13 offset:0
    ds_read_b64_tr_b16 v[246:247], v13 offset:1024
    v_mfma_f32_16x16x32_bf16 v[108:111], v[248:251], v[216:219], v[108:111]
    ds_read_b64_tr_b16 v[248:249], v14 offset:0
    ds_read_b64_tr_b16 v[250:251], v14 offset:1024
    v_mfma_f32_16x16x32_bf16 v[112:115], v[252:255], v[208:211], v[112:115]
    v_mfma_f32_16x16x32_bf16 v[116:119], v[252:255], v[212:215], v[116:119]
    v_mfma_f32_16x16x32_bf16 v[120:123], v[252:255], v[216:219], v[120:123]
    ds_read_b64_tr_b16 v[252:253], v15 offset:0
    ds_read_b64_tr_b16 v[254:255], v15 offset:1024
    s_waitcnt lgkmcnt(15)
    v_mfma_f32_16x16x32_bf16 v[28:31], v[224:227], v[196:199], v[28:31]
    v_mfma_f32_16x16x32_bf16 v[32:35], v[224:227], v[200:203], v[32:35]
    s_waitcnt lgkmcnt(14)
    v_mfma_f32_16x16x32_bf16 v[36:39], v[224:227], v[204:207], v[36:39]
    ds_read_b64_tr_b16 v[224:225], v8 offset:8192
    ds_read_b64_tr_b16 v[226:227], v8 offset:9216
    s_waitcnt lgkmcnt(14)
    v_mfma_f32_16x16x32_bf16 v[40:43], v[228:231], v[196:199], v[40:43]
    ds_bpermute_b32 v208, v16, v160
    v_mfma_f32_16x16x32_bf16 v[44:47], v[228:231], v[200:203], v[44:47]
    ds_bpermute_b32 v209, v16, v161
    v_mfma_f32_16x16x32_bf16 v[48:51], v[228:231], v[204:207], v[48:51]
    ds_read_b64_tr_b16 v[228:229], v9 offset:8192
    ds_read_b64_tr_b16 v[230:231], v9 offset:9216
    ds_bpermute_b32 v210, v16, v162
    s_waitcnt lgkmcnt(15)
    v_mfma_f32_16x16x32_bf16 v[52:55], v[232:235], v[196:199], v[52:55]
    ds_bpermute_b32 v211, v16, v163
    v_mfma_f32_16x16x32_bf16 v[56:59], v[232:235], v[200:203], v[56:59]
    ds_bpermute_b32 v212, v16, v164
    v_mfma_f32_16x16x32_bf16 v[60:63], v[232:235], v[204:207], v[60:63]
    ds_read_b64_tr_b16 v[232:233], v10 offset:8192
    ds_read_b64_tr_b16 v[234:235], v10 offset:9216
    ds_bpermute_b32 v213, v16, v165
    v_mfma_f32_16x16x32_bf16 v[64:67], v[236:239], v[196:199], v[64:67]
    ds_bpermute_b32 v214, v16, v166
    v_mfma_f32_16x16x32_bf16 v[68:71], v[236:239], v[200:203], v[68:71]
    ds_bpermute_b32 v215, v16, v167
    v_mfma_f32_16x16x32_bf16 v[72:75], v[236:239], v[204:207], v[72:75]
    ds_read_b64_tr_b16 v[236:237], v11 offset:8192
    ds_read_b64_tr_b16 v[238:239], v11 offset:9216
    s_waitcnt vmcnt(12)
    ds_bpermute_b32 v216, v16, v168
    s_waitcnt lgkmcnt(15)
    v_mfma_f32_16x16x32_bf16 v[76:79], v[240:243], v[196:199], v[76:79]
    ds_bpermute_b32 v217, v16, v169
    v_mfma_f32_16x16x32_bf16 v[80:83], v[240:243], v[200:203], v[80:83]
    ds_bpermute_b32 v218, v16, v170
    v_mfma_f32_16x16x32_bf16 v[84:87], v[240:243], v[204:207], v[84:87]
    ds_read_b64_tr_b16 v[240:241], v12 offset:8192
    ds_read_b64_tr_b16 v[242:243], v12 offset:9216
    ds_bpermute_b32 v219, v16, v171
    v_mfma_f32_16x16x32_bf16 v[88:91], v[244:247], v[196:199], v[88:91]
    buffer_load_dwordx4 v[148:151], v3, s[20:23], s46 offen offset:896
    v_mfma_f32_16x16x32_bf16 v[92:95], v[244:247], v[200:203], v[92:95]
    buffer_load_dwordx4 v[160:163], v3, s[20:23], s46 offen offset:960
    v_mfma_f32_16x16x32_bf16 v[96:99], v[244:247], v[204:207], v[96:99]
    ds_read_b64_tr_b16 v[244:245], v13 offset:8192
    ds_read_b64_tr_b16 v[246:247], v13 offset:9216
    buffer_load_dwordx4 v[152:155], v3, s[20:23], s47 offen offset:896
    v_mfma_f32_16x16x32_bf16 v[100:103], v[248:251], v[196:199], v[100:103]
    buffer_load_dwordx4 v[164:167], v3, s[20:23], s47 offen offset:960
    v_mfma_f32_16x16x32_bf16 v[104:107], v[248:251], v[200:203], v[104:107]
    buffer_load_dwordx4 v[156:159], v3, s[20:23], s48 offen offset:896
    v_mfma_f32_16x16x32_bf16 v[108:111], v[248:251], v[204:207], v[108:111]
    ds_read_b64_tr_b16 v[248:249], v14 offset:8192
    ds_read_b64_tr_b16 v[250:251], v14 offset:9216
    buffer_load_dwordx4 v[168:171], v3, s[20:23], s48 offen offset:960
    v_mfma_f32_16x16x32_bf16 v[112:115], v[252:255], v[196:199], v[112:115]
    v_mfma_f32_16x16x32_bf16 v[116:119], v[252:255], v[200:203], v[116:119]
    v_mfma_f32_16x16x32_bf16 v[120:123], v[252:255], v[204:207], v[120:123]
    ds_read_b64_tr_b16 v[252:253], v15 offset:8192
    ds_read_b64_tr_b16 v[254:255], v15 offset:9216
    s_waitcnt lgkmcnt(15)
    v_mfma_f32_16x16x32_bf16 v[28:31], v[224:227], v[208:211], v[28:31]
    s_waitcnt lgkmcnt(14)
    v_mfma_f32_16x16x32_bf16 v[32:35], v[224:227], v[212:215], v[32:35]
    s_waitcnt lgkmcnt(6)
    v_mfma_f32_16x16x32_bf16 v[36:39], v[224:227], v[216:219], v[36:39]
    v_mfma_f32_16x16x32_bf16 v[40:43], v[228:231], v[208:211], v[40:43]
    s_waitcnt vmcnt(17)
    ds_bpermute_b32 v196, v16, v172
    v_mfma_f32_16x16x32_bf16 v[44:47], v[228:231], v[212:215], v[44:47]
    ds_bpermute_b32 v197, v16, v173
    v_mfma_f32_16x16x32_bf16 v[48:51], v[228:231], v[216:219], v[48:51]
    ds_bpermute_b32 v198, v16, v174
    v_mfma_f32_16x16x32_bf16 v[52:55], v[232:235], v[208:211], v[52:55]
    ds_bpermute_b32 v199, v16, v175
    v_mfma_f32_16x16x32_bf16 v[56:59], v[232:235], v[212:215], v[56:59]
    s_waitcnt vmcnt(15)
    ds_bpermute_b32 v200, v16, v176
    v_mfma_f32_16x16x32_bf16 v[60:63], v[232:235], v[216:219], v[60:63]
    ds_bpermute_b32 v201, v16, v177
    v_mfma_f32_16x16x32_bf16 v[64:67], v[236:239], v[208:211], v[64:67]
    ds_bpermute_b32 v202, v16, v178
    v_mfma_f32_16x16x32_bf16 v[68:71], v[236:239], v[212:215], v[68:71]
    ds_bpermute_b32 v203, v16, v179
    v_mfma_f32_16x16x32_bf16 v[72:75], v[236:239], v[216:219], v[72:75]
    s_waitcnt vmcnt(13)
    ds_bpermute_b32 v204, v16, v180
    v_mfma_f32_16x16x32_bf16 v[76:79], v[240:243], v[208:211], v[76:79]
    ds_bpermute_b32 v205, v16, v181
    v_mfma_f32_16x16x32_bf16 v[80:83], v[240:243], v[212:215], v[80:83]
    ds_bpermute_b32 v206, v16, v182
    v_mfma_f32_16x16x32_bf16 v[84:87], v[240:243], v[216:219], v[84:87]
    s_waitcnt lgkmcnt(0)
    s_barrier
    ds_read_b64_tr_b16 v[224:225], v8 offset:16384
    ds_read_b64_tr_b16 v[226:227], v8 offset:17408
    ds_bpermute_b32 v207, v16, v183
    v_mfma_f32_16x16x32_bf16 v[88:91], v[244:247], v[208:211], v[88:91]
    ds_read_b64_tr_b16 v[228:229], v9 offset:16384
    ds_read_b64_tr_b16 v[230:231], v9 offset:17408
    v_mfma_f32_16x16x32_bf16 v[92:95], v[244:247], v[212:215], v[92:95]
    ds_read_b64_tr_b16 v[232:233], v10 offset:16384
    ds_read_b64_tr_b16 v[234:235], v10 offset:17408
    v_mfma_f32_16x16x32_bf16 v[96:99], v[244:247], v[216:219], v[96:99]
    ds_read_b64_tr_b16 v[236:237], v11 offset:16384
    ds_read_b64_tr_b16 v[238:239], v11 offset:17408
    v_mfma_f32_16x16x32_bf16 v[100:103], v[248:251], v[208:211], v[100:103]
    ds_read_b64_tr_b16 v[240:241], v12 offset:16384
    ds_read_b64_tr_b16 v[242:243], v12 offset:17408
    v_mfma_f32_16x16x32_bf16 v[104:107], v[248:251], v[212:215], v[104:107]
    ds_read_b64_tr_b16 v[244:245], v13 offset:16384
    ds_read_b64_tr_b16 v[246:247], v13 offset:17408
    v_mfma_f32_16x16x32_bf16 v[108:111], v[248:251], v[216:219], v[108:111]
    ds_read_b64_tr_b16 v[248:249], v14 offset:16384
    ds_read_b64_tr_b16 v[250:251], v14 offset:17408
    v_mfma_f32_16x16x32_bf16 v[112:115], v[252:255], v[208:211], v[112:115]
    v_mfma_f32_16x16x32_bf16 v[116:119], v[252:255], v[212:215], v[116:119]
    v_mfma_f32_16x16x32_bf16 v[120:123], v[252:255], v[216:219], v[120:123]
    ds_read_b64_tr_b16 v[252:253], v15 offset:16384
    ds_read_b64_tr_b16 v[254:255], v15 offset:17408
    s_waitcnt lgkmcnt(15)
    v_mfma_f32_16x16x32_bf16 v[28:31], v[224:227], v[196:199], v[28:31]
    v_mfma_f32_16x16x32_bf16 v[32:35], v[224:227], v[200:203], v[32:35]
    s_waitcnt lgkmcnt(14)
    v_mfma_f32_16x16x32_bf16 v[36:39], v[224:227], v[204:207], v[36:39]
    ds_read_b64_tr_b16 v[224:225], v8 offset:24576
    ds_read_b64_tr_b16 v[226:227], v8 offset:25600
    s_waitcnt lgkmcnt(14)
    v_mfma_f32_16x16x32_bf16 v[40:43], v[228:231], v[196:199], v[40:43]
    ds_bpermute_b32 v208, v16, v184
    v_mfma_f32_16x16x32_bf16 v[44:47], v[228:231], v[200:203], v[44:47]
    ds_bpermute_b32 v209, v16, v185
    v_mfma_f32_16x16x32_bf16 v[48:51], v[228:231], v[204:207], v[48:51]
    ds_read_b64_tr_b16 v[228:229], v9 offset:24576
    ds_read_b64_tr_b16 v[230:231], v9 offset:25600
    ds_bpermute_b32 v210, v16, v186
    s_waitcnt lgkmcnt(15)
    v_mfma_f32_16x16x32_bf16 v[52:55], v[232:235], v[196:199], v[52:55]
    ds_bpermute_b32 v211, v16, v187
    v_mfma_f32_16x16x32_bf16 v[56:59], v[232:235], v[200:203], v[56:59]
    ds_bpermute_b32 v212, v16, v188
    v_mfma_f32_16x16x32_bf16 v[60:63], v[232:235], v[204:207], v[60:63]
    ds_read_b64_tr_b16 v[232:233], v10 offset:24576
    ds_read_b64_tr_b16 v[234:235], v10 offset:25600
    ds_bpermute_b32 v213, v16, v189
    v_mfma_f32_16x16x32_bf16 v[64:67], v[236:239], v[196:199], v[64:67]
    ds_bpermute_b32 v214, v16, v190
    v_mfma_f32_16x16x32_bf16 v[68:71], v[236:239], v[200:203], v[68:71]
    ds_bpermute_b32 v215, v16, v191
    v_mfma_f32_16x16x32_bf16 v[72:75], v[236:239], v[204:207], v[72:75]
    ds_read_b64_tr_b16 v[236:237], v11 offset:24576
    ds_read_b64_tr_b16 v[238:239], v11 offset:25600
    s_waitcnt vmcnt(12)
    ds_bpermute_b32 v216, v16, v192
    s_waitcnt lgkmcnt(15)
    v_mfma_f32_16x16x32_bf16 v[76:79], v[240:243], v[196:199], v[76:79]
    ds_bpermute_b32 v217, v16, v193
    v_mfma_f32_16x16x32_bf16 v[80:83], v[240:243], v[200:203], v[80:83]
    ds_bpermute_b32 v218, v16, v194
    v_mfma_f32_16x16x32_bf16 v[84:87], v[240:243], v[204:207], v[84:87]
    ds_read_b64_tr_b16 v[240:241], v12 offset:24576
    ds_read_b64_tr_b16 v[242:243], v12 offset:25600
    ds_bpermute_b32 v219, v16, v195
    v_mfma_f32_16x16x32_bf16 v[88:91], v[244:247], v[196:199], v[88:91]
    buffer_load_dwordx4 v[172:175], v3, s[20:23], s46 offen offset:1024
    v_mfma_f32_16x16x32_bf16 v[92:95], v[244:247], v[200:203], v[92:95]
    buffer_load_dwordx4 v[184:187], v3, s[20:23], s46 offen offset:1088
    v_mfma_f32_16x16x32_bf16 v[96:99], v[244:247], v[204:207], v[96:99]
    ds_read_b64_tr_b16 v[244:245], v13 offset:24576
    ds_read_b64_tr_b16 v[246:247], v13 offset:25600
    buffer_load_dwordx4 v[176:179], v3, s[20:23], s47 offen offset:1024
    v_mfma_f32_16x16x32_bf16 v[100:103], v[248:251], v[196:199], v[100:103]
    buffer_load_dwordx4 v[188:191], v3, s[20:23], s47 offen offset:1088
    v_mfma_f32_16x16x32_bf16 v[104:107], v[248:251], v[200:203], v[104:107]
    buffer_load_dwordx4 v[180:183], v3, s[20:23], s48 offen offset:1024
    v_mfma_f32_16x16x32_bf16 v[108:111], v[248:251], v[204:207], v[108:111]
    ds_read_b64_tr_b16 v[248:249], v14 offset:24576
    ds_read_b64_tr_b16 v[250:251], v14 offset:25600
    buffer_load_dwordx4 v[192:195], v3, s[20:23], s48 offen offset:1088
    v_mfma_f32_16x16x32_bf16 v[112:115], v[252:255], v[196:199], v[112:115]
    v_mfma_f32_16x16x32_bf16 v[116:119], v[252:255], v[200:203], v[116:119]
    v_mfma_f32_16x16x32_bf16 v[120:123], v[252:255], v[204:207], v[120:123]
    ds_read_b64_tr_b16 v[252:253], v15 offset:24576
    ds_read_b64_tr_b16 v[254:255], v15 offset:25600
    s_waitcnt lgkmcnt(15)
    v_mfma_f32_16x16x32_bf16 v[28:31], v[224:227], v[208:211], v[28:31]
    s_waitcnt lgkmcnt(14)
    v_mfma_f32_16x16x32_bf16 v[32:35], v[224:227], v[212:215], v[32:35]
    s_waitcnt lgkmcnt(6)
    v_mfma_f32_16x16x32_bf16 v[36:39], v[224:227], v[216:219], v[36:39]
    v_mfma_f32_16x16x32_bf16 v[40:43], v[228:231], v[208:211], v[40:43]
    s_waitcnt vmcnt(17)
    ds_bpermute_b32 v196, v16, v124
    v_mfma_f32_16x16x32_bf16 v[44:47], v[228:231], v[212:215], v[44:47]
    ds_bpermute_b32 v197, v16, v125
    v_mfma_f32_16x16x32_bf16 v[48:51], v[228:231], v[216:219], v[48:51]
    ds_bpermute_b32 v198, v16, v126
    v_mfma_f32_16x16x32_bf16 v[52:55], v[232:235], v[208:211], v[52:55]
    ds_bpermute_b32 v199, v16, v127
    v_mfma_f32_16x16x32_bf16 v[56:59], v[232:235], v[212:215], v[56:59]
    s_waitcnt vmcnt(15)
    ds_bpermute_b32 v200, v16, v128
    v_mfma_f32_16x16x32_bf16 v[60:63], v[232:235], v[216:219], v[60:63]
    ds_bpermute_b32 v201, v16, v129
    v_mfma_f32_16x16x32_bf16 v[64:67], v[236:239], v[208:211], v[64:67]
    ds_bpermute_b32 v202, v16, v130
    v_mfma_f32_16x16x32_bf16 v[68:71], v[236:239], v[212:215], v[68:71]
    ds_bpermute_b32 v203, v16, v131
    v_mfma_f32_16x16x32_bf16 v[72:75], v[236:239], v[216:219], v[72:75]
    s_waitcnt vmcnt(13)
    ds_bpermute_b32 v204, v16, v132
    v_mfma_f32_16x16x32_bf16 v[76:79], v[240:243], v[208:211], v[76:79]
    ds_bpermute_b32 v205, v16, v133
    v_mfma_f32_16x16x32_bf16 v[80:83], v[240:243], v[212:215], v[80:83]
    ds_bpermute_b32 v206, v16, v134
    v_mfma_f32_16x16x32_bf16 v[84:87], v[240:243], v[216:219], v[84:87]
    s_waitcnt lgkmcnt(0)
    s_barrier
    ds_read_b64_tr_b16 v[224:225], v8 offset:32768
    ds_read_b64_tr_b16 v[226:227], v8 offset:33792
    ds_bpermute_b32 v207, v16, v135
    v_mfma_f32_16x16x32_bf16 v[88:91], v[244:247], v[208:211], v[88:91]
    ds_read_b64_tr_b16 v[228:229], v9 offset:32768
    ds_read_b64_tr_b16 v[230:231], v9 offset:33792
    v_mfma_f32_16x16x32_bf16 v[92:95], v[244:247], v[212:215], v[92:95]
    ds_read_b64_tr_b16 v[232:233], v10 offset:32768
    ds_read_b64_tr_b16 v[234:235], v10 offset:33792
    v_mfma_f32_16x16x32_bf16 v[96:99], v[244:247], v[216:219], v[96:99]
    ds_read_b64_tr_b16 v[236:237], v11 offset:32768
    ds_read_b64_tr_b16 v[238:239], v11 offset:33792
    v_mfma_f32_16x16x32_bf16 v[100:103], v[248:251], v[208:211], v[100:103]
    ds_read_b64_tr_b16 v[240:241], v12 offset:32768
    ds_read_b64_tr_b16 v[242:243], v12 offset:33792
    v_mfma_f32_16x16x32_bf16 v[104:107], v[248:251], v[212:215], v[104:107]
    ds_read_b64_tr_b16 v[244:245], v13 offset:32768
    ds_read_b64_tr_b16 v[246:247], v13 offset:33792
    v_mfma_f32_16x16x32_bf16 v[108:111], v[248:251], v[216:219], v[108:111]
    ds_read_b64_tr_b16 v[248:249], v14 offset:32768
    ds_read_b64_tr_b16 v[250:251], v14 offset:33792
    v_mfma_f32_16x16x32_bf16 v[112:115], v[252:255], v[208:211], v[112:115]
    v_mfma_f32_16x16x32_bf16 v[116:119], v[252:255], v[212:215], v[116:119]
    v_mfma_f32_16x16x32_bf16 v[120:123], v[252:255], v[216:219], v[120:123]
    ds_read_b64_tr_b16 v[252:253], v15 offset:32768
    ds_read_b64_tr_b16 v[254:255], v15 offset:33792
    s_waitcnt lgkmcnt(15)
    v_mfma_f32_16x16x32_bf16 v[28:31], v[224:227], v[196:199], v[28:31]
    v_mfma_f32_16x16x32_bf16 v[32:35], v[224:227], v[200:203], v[32:35]
    s_waitcnt lgkmcnt(14)
    v_mfma_f32_16x16x32_bf16 v[36:39], v[224:227], v[204:207], v[36:39]
    ds_read_b64_tr_b16 v[224:225], v8 offset:40960
    ds_read_b64_tr_b16 v[226:227], v8 offset:41984
    s_waitcnt lgkmcnt(14)
    v_mfma_f32_16x16x32_bf16 v[40:43], v[228:231], v[196:199], v[40:43]
    ds_bpermute_b32 v208, v16, v136
    v_mfma_f32_16x16x32_bf16 v[44:47], v[228:231], v[200:203], v[44:47]
    ds_bpermute_b32 v209, v16, v137
    v_mfma_f32_16x16x32_bf16 v[48:51], v[228:231], v[204:207], v[48:51]
    ds_read_b64_tr_b16 v[228:229], v9 offset:40960
    ds_read_b64_tr_b16 v[230:231], v9 offset:41984
    ds_bpermute_b32 v210, v16, v138
    s_waitcnt lgkmcnt(15)
    v_mfma_f32_16x16x32_bf16 v[52:55], v[232:235], v[196:199], v[52:55]
    ds_bpermute_b32 v211, v16, v139
    v_mfma_f32_16x16x32_bf16 v[56:59], v[232:235], v[200:203], v[56:59]
    ds_bpermute_b32 v212, v16, v140
    v_mfma_f32_16x16x32_bf16 v[60:63], v[232:235], v[204:207], v[60:63]
    ds_read_b64_tr_b16 v[232:233], v10 offset:40960
    ds_read_b64_tr_b16 v[234:235], v10 offset:41984
    ds_bpermute_b32 v213, v16, v141
    v_mfma_f32_16x16x32_bf16 v[64:67], v[236:239], v[196:199], v[64:67]
    ds_bpermute_b32 v214, v16, v142
    v_mfma_f32_16x16x32_bf16 v[68:71], v[236:239], v[200:203], v[68:71]
    ds_bpermute_b32 v215, v16, v143
    v_mfma_f32_16x16x32_bf16 v[72:75], v[236:239], v[204:207], v[72:75]
    ds_read_b64_tr_b16 v[236:237], v11 offset:40960
    ds_read_b64_tr_b16 v[238:239], v11 offset:41984
    s_waitcnt vmcnt(12)
    ds_bpermute_b32 v216, v16, v144
    s_waitcnt lgkmcnt(15)
    v_mfma_f32_16x16x32_bf16 v[76:79], v[240:243], v[196:199], v[76:79]
    ds_bpermute_b32 v217, v16, v145
    v_mfma_f32_16x16x32_bf16 v[80:83], v[240:243], v[200:203], v[80:83]
    ds_bpermute_b32 v218, v16, v146
    v_mfma_f32_16x16x32_bf16 v[84:87], v[240:243], v[204:207], v[84:87]
    ds_read_b64_tr_b16 v[240:241], v12 offset:40960
    ds_read_b64_tr_b16 v[242:243], v12 offset:41984
    ds_bpermute_b32 v219, v16, v147
    v_mfma_f32_16x16x32_bf16 v[88:91], v[244:247], v[196:199], v[88:91]
    v_mfma_f32_16x16x32_bf16 v[92:95], v[244:247], v[200:203], v[92:95]
    v_mfma_f32_16x16x32_bf16 v[96:99], v[244:247], v[204:207], v[96:99]
    ds_read_b64_tr_b16 v[244:245], v13 offset:40960
    ds_read_b64_tr_b16 v[246:247], v13 offset:41984
    v_mfma_f32_16x16x32_bf16 v[100:103], v[248:251], v[196:199], v[100:103]
    v_mfma_f32_16x16x32_bf16 v[104:107], v[248:251], v[200:203], v[104:107]
    v_mfma_f32_16x16x32_bf16 v[108:111], v[248:251], v[204:207], v[108:111]
    ds_read_b64_tr_b16 v[248:249], v14 offset:40960
    ds_read_b64_tr_b16 v[250:251], v14 offset:41984
    v_mfma_f32_16x16x32_bf16 v[112:115], v[252:255], v[196:199], v[112:115]
    v_mfma_f32_16x16x32_bf16 v[116:119], v[252:255], v[200:203], v[116:119]
    v_mfma_f32_16x16x32_bf16 v[120:123], v[252:255], v[204:207], v[120:123]
    ds_read_b64_tr_b16 v[252:253], v15 offset:40960
    ds_read_b64_tr_b16 v[254:255], v15 offset:41984
    s_waitcnt lgkmcnt(15)
    v_mfma_f32_16x16x32_bf16 v[28:31], v[224:227], v[208:211], v[28:31]
    s_waitcnt lgkmcnt(14)
    v_mfma_f32_16x16x32_bf16 v[32:35], v[224:227], v[212:215], v[32:35]
    s_waitcnt lgkmcnt(6)
    v_mfma_f32_16x16x32_bf16 v[36:39], v[224:227], v[216:219], v[36:39]
    v_mfma_f32_16x16x32_bf16 v[40:43], v[228:231], v[208:211], v[40:43]
    s_waitcnt vmcnt(11)
    ds_bpermute_b32 v196, v16, v148
    v_mfma_f32_16x16x32_bf16 v[44:47], v[228:231], v[212:215], v[44:47]
    ds_bpermute_b32 v197, v16, v149
    v_mfma_f32_16x16x32_bf16 v[48:51], v[228:231], v[216:219], v[48:51]
    ds_bpermute_b32 v198, v16, v150
    v_mfma_f32_16x16x32_bf16 v[52:55], v[232:235], v[208:211], v[52:55]
    ds_bpermute_b32 v199, v16, v151
    v_mfma_f32_16x16x32_bf16 v[56:59], v[232:235], v[212:215], v[56:59]
    s_waitcnt vmcnt(9)
    ds_bpermute_b32 v200, v16, v152
    v_mfma_f32_16x16x32_bf16 v[60:63], v[232:235], v[216:219], v[60:63]
    ds_bpermute_b32 v201, v16, v153
    v_mfma_f32_16x16x32_bf16 v[64:67], v[236:239], v[208:211], v[64:67]
    ds_bpermute_b32 v202, v16, v154
    v_mfma_f32_16x16x32_bf16 v[68:71], v[236:239], v[212:215], v[68:71]
    ds_bpermute_b32 v203, v16, v155
    v_mfma_f32_16x16x32_bf16 v[72:75], v[236:239], v[216:219], v[72:75]
    s_waitcnt vmcnt(7)
    ds_bpermute_b32 v204, v16, v156
    v_mfma_f32_16x16x32_bf16 v[76:79], v[240:243], v[208:211], v[76:79]
    ds_bpermute_b32 v205, v16, v157
    v_mfma_f32_16x16x32_bf16 v[80:83], v[240:243], v[212:215], v[80:83]
    ds_bpermute_b32 v206, v16, v158
    v_mfma_f32_16x16x32_bf16 v[84:87], v[240:243], v[216:219], v[84:87]
    s_waitcnt lgkmcnt(0)
    s_barrier
    ds_read_b64_tr_b16 v[224:225], v8 offset:49152
    ds_read_b64_tr_b16 v[226:227], v8 offset:50176
    ds_bpermute_b32 v207, v16, v159
    v_mfma_f32_16x16x32_bf16 v[88:91], v[244:247], v[208:211], v[88:91]
    ds_read_b64_tr_b16 v[228:229], v9 offset:49152
    ds_read_b64_tr_b16 v[230:231], v9 offset:50176
    v_mfma_f32_16x16x32_bf16 v[92:95], v[244:247], v[212:215], v[92:95]
    ds_read_b64_tr_b16 v[232:233], v10 offset:49152
    ds_read_b64_tr_b16 v[234:235], v10 offset:50176
    v_mfma_f32_16x16x32_bf16 v[96:99], v[244:247], v[216:219], v[96:99]
    ds_read_b64_tr_b16 v[236:237], v11 offset:49152
    ds_read_b64_tr_b16 v[238:239], v11 offset:50176
    v_mfma_f32_16x16x32_bf16 v[100:103], v[248:251], v[208:211], v[100:103]
    ds_read_b64_tr_b16 v[240:241], v12 offset:49152
    ds_read_b64_tr_b16 v[242:243], v12 offset:50176
    v_mfma_f32_16x16x32_bf16 v[104:107], v[248:251], v[212:215], v[104:107]
    ds_read_b64_tr_b16 v[244:245], v13 offset:49152
    ds_read_b64_tr_b16 v[246:247], v13 offset:50176
    v_mfma_f32_16x16x32_bf16 v[108:111], v[248:251], v[216:219], v[108:111]
    ds_read_b64_tr_b16 v[248:249], v14 offset:49152
    ds_read_b64_tr_b16 v[250:251], v14 offset:50176
    v_mfma_f32_16x16x32_bf16 v[112:115], v[252:255], v[208:211], v[112:115]
    v_mfma_f32_16x16x32_bf16 v[116:119], v[252:255], v[212:215], v[116:119]
    v_mfma_f32_16x16x32_bf16 v[120:123], v[252:255], v[216:219], v[120:123]
    ds_read_b64_tr_b16 v[252:253], v15 offset:49152
    ds_read_b64_tr_b16 v[254:255], v15 offset:50176
    s_waitcnt lgkmcnt(15)
    v_mfma_f32_16x16x32_bf16 v[28:31], v[224:227], v[196:199], v[28:31]
    v_mfma_f32_16x16x32_bf16 v[32:35], v[224:227], v[200:203], v[32:35]
    s_waitcnt lgkmcnt(14)
    v_mfma_f32_16x16x32_bf16 v[36:39], v[224:227], v[204:207], v[36:39]
    ds_read_b64_tr_b16 v[224:225], v8 offset:57344
    ds_read_b64_tr_b16 v[226:227], v8 offset:58368
    s_waitcnt lgkmcnt(14)
    v_mfma_f32_16x16x32_bf16 v[40:43], v[228:231], v[196:199], v[40:43]
    ds_bpermute_b32 v208, v16, v160
    v_mfma_f32_16x16x32_bf16 v[44:47], v[228:231], v[200:203], v[44:47]
    ds_bpermute_b32 v209, v16, v161
    v_mfma_f32_16x16x32_bf16 v[48:51], v[228:231], v[204:207], v[48:51]
    ds_read_b64_tr_b16 v[228:229], v9 offset:57344
    ds_read_b64_tr_b16 v[230:231], v9 offset:58368
    ds_bpermute_b32 v210, v16, v162
    s_waitcnt lgkmcnt(15)
    v_mfma_f32_16x16x32_bf16 v[52:55], v[232:235], v[196:199], v[52:55]
    ds_bpermute_b32 v211, v16, v163
    v_mfma_f32_16x16x32_bf16 v[56:59], v[232:235], v[200:203], v[56:59]
    ds_bpermute_b32 v212, v16, v164
    v_mfma_f32_16x16x32_bf16 v[60:63], v[232:235], v[204:207], v[60:63]
    ds_read_b64_tr_b16 v[232:233], v10 offset:57344
    ds_read_b64_tr_b16 v[234:235], v10 offset:58368
    ds_bpermute_b32 v213, v16, v165
    v_mfma_f32_16x16x32_bf16 v[64:67], v[236:239], v[196:199], v[64:67]
    ds_bpermute_b32 v214, v16, v166
    v_mfma_f32_16x16x32_bf16 v[68:71], v[236:239], v[200:203], v[68:71]
    ds_bpermute_b32 v215, v16, v167
    v_mfma_f32_16x16x32_bf16 v[72:75], v[236:239], v[204:207], v[72:75]
    ds_read_b64_tr_b16 v[236:237], v11 offset:57344
    ds_read_b64_tr_b16 v[238:239], v11 offset:58368
    s_waitcnt vmcnt(6)
    ds_bpermute_b32 v216, v16, v168
    s_waitcnt lgkmcnt(15)
    v_mfma_f32_16x16x32_bf16 v[76:79], v[240:243], v[196:199], v[76:79]
    ds_bpermute_b32 v217, v16, v169
    v_mfma_f32_16x16x32_bf16 v[80:83], v[240:243], v[200:203], v[80:83]
    ds_bpermute_b32 v218, v16, v170
    v_mfma_f32_16x16x32_bf16 v[84:87], v[240:243], v[204:207], v[84:87]
    ds_read_b64_tr_b16 v[240:241], v12 offset:57344
    ds_read_b64_tr_b16 v[242:243], v12 offset:58368
    ds_bpermute_b32 v219, v16, v171
    v_mfma_f32_16x16x32_bf16 v[88:91], v[244:247], v[196:199], v[88:91]
    v_mfma_f32_16x16x32_bf16 v[92:95], v[244:247], v[200:203], v[92:95]
    v_mfma_f32_16x16x32_bf16 v[96:99], v[244:247], v[204:207], v[96:99]
    ds_read_b64_tr_b16 v[244:245], v13 offset:57344
    ds_read_b64_tr_b16 v[246:247], v13 offset:58368
    v_mfma_f32_16x16x32_bf16 v[100:103], v[248:251], v[196:199], v[100:103]
    v_mfma_f32_16x16x32_bf16 v[104:107], v[248:251], v[200:203], v[104:107]
    v_mfma_f32_16x16x32_bf16 v[108:111], v[248:251], v[204:207], v[108:111]
    ds_read_b64_tr_b16 v[248:249], v14 offset:57344
    ds_read_b64_tr_b16 v[250:251], v14 offset:58368
    v_mfma_f32_16x16x32_bf16 v[112:115], v[252:255], v[196:199], v[112:115]
    v_mfma_f32_16x16x32_bf16 v[116:119], v[252:255], v[200:203], v[116:119]
    v_mfma_f32_16x16x32_bf16 v[120:123], v[252:255], v[204:207], v[120:123]
    ds_read_b64_tr_b16 v[252:253], v15 offset:57344
    ds_read_b64_tr_b16 v[254:255], v15 offset:58368
    s_waitcnt lgkmcnt(15)
    v_mfma_f32_16x16x32_bf16 v[28:31], v[224:227], v[208:211], v[28:31]
    s_waitcnt lgkmcnt(14)
    v_mfma_f32_16x16x32_bf16 v[32:35], v[224:227], v[212:215], v[32:35]
    s_waitcnt lgkmcnt(6)
    v_mfma_f32_16x16x32_bf16 v[36:39], v[224:227], v[216:219], v[36:39]
    v_mfma_f32_16x16x32_bf16 v[40:43], v[228:231], v[208:211], v[40:43]
    s_waitcnt vmcnt(5)
    ds_bpermute_b32 v196, v16, v172
    v_mfma_f32_16x16x32_bf16 v[44:47], v[228:231], v[212:215], v[44:47]
    ds_bpermute_b32 v197, v16, v173
    v_mfma_f32_16x16x32_bf16 v[48:51], v[228:231], v[216:219], v[48:51]
    ds_bpermute_b32 v198, v16, v174
    v_mfma_f32_16x16x32_bf16 v[52:55], v[232:235], v[208:211], v[52:55]
    ds_bpermute_b32 v199, v16, v175
    v_mfma_f32_16x16x32_bf16 v[56:59], v[232:235], v[212:215], v[56:59]
    s_waitcnt vmcnt(3)
    ds_bpermute_b32 v200, v16, v176
    v_mfma_f32_16x16x32_bf16 v[60:63], v[232:235], v[216:219], v[60:63]
    ds_bpermute_b32 v201, v16, v177
    v_mfma_f32_16x16x32_bf16 v[64:67], v[236:239], v[208:211], v[64:67]
    ds_bpermute_b32 v202, v16, v178
    v_mfma_f32_16x16x32_bf16 v[68:71], v[236:239], v[212:215], v[68:71]
    ds_bpermute_b32 v203, v16, v179
    v_mfma_f32_16x16x32_bf16 v[72:75], v[236:239], v[216:219], v[72:75]
    s_waitcnt vmcnt(1)
    ds_bpermute_b32 v204, v16, v180
    v_mfma_f32_16x16x32_bf16 v[76:79], v[240:243], v[208:211], v[76:79]
    ds_bpermute_b32 v205, v16, v181
    v_mfma_f32_16x16x32_bf16 v[80:83], v[240:243], v[212:215], v[80:83]
    ds_bpermute_b32 v206, v16, v182
    v_mfma_f32_16x16x32_bf16 v[84:87], v[240:243], v[216:219], v[84:87]
    s_waitcnt lgkmcnt(0)
    s_barrier
    ds_read_b64_tr_b16 v[224:225], v8 offset:0
    ds_read_b64_tr_b16 v[226:227], v8 offset:1024
    ds_bpermute_b32 v207, v16, v183
    v_mfma_f32_16x16x32_bf16 v[88:91], v[244:247], v[208:211], v[88:91]
    ds_read_b64_tr_b16 v[228:229], v9 offset:0
    ds_read_b64_tr_b16 v[230:231], v9 offset:1024
    v_mfma_f32_16x16x32_bf16 v[92:95], v[244:247], v[212:215], v[92:95]
    ds_read_b64_tr_b16 v[232:233], v10 offset:0
    ds_read_b64_tr_b16 v[234:235], v10 offset:1024
    v_mfma_f32_16x16x32_bf16 v[96:99], v[244:247], v[216:219], v[96:99]
    ds_read_b64_tr_b16 v[236:237], v11 offset:0
    ds_read_b64_tr_b16 v[238:239], v11 offset:1024
    v_mfma_f32_16x16x32_bf16 v[100:103], v[248:251], v[208:211], v[100:103]
    ds_read_b64_tr_b16 v[240:241], v12 offset:0
    ds_read_b64_tr_b16 v[242:243], v12 offset:1024
    v_mfma_f32_16x16x32_bf16 v[104:107], v[248:251], v[212:215], v[104:107]
    ds_read_b64_tr_b16 v[244:245], v13 offset:0
    ds_read_b64_tr_b16 v[246:247], v13 offset:1024
    v_mfma_f32_16x16x32_bf16 v[108:111], v[248:251], v[216:219], v[108:111]
    ds_read_b64_tr_b16 v[248:249], v14 offset:0
    ds_read_b64_tr_b16 v[250:251], v14 offset:1024
    v_mfma_f32_16x16x32_bf16 v[112:115], v[252:255], v[208:211], v[112:115]
    v_mfma_f32_16x16x32_bf16 v[116:119], v[252:255], v[212:215], v[116:119]
    v_mfma_f32_16x16x32_bf16 v[120:123], v[252:255], v[216:219], v[120:123]
    ds_read_b64_tr_b16 v[252:253], v15 offset:0
    ds_read_b64_tr_b16 v[254:255], v15 offset:1024
    s_waitcnt lgkmcnt(15)
    v_mfma_f32_16x16x32_bf16 v[28:31], v[224:227], v[196:199], v[28:31]
    v_mfma_f32_16x16x32_bf16 v[32:35], v[224:227], v[200:203], v[32:35]
    s_waitcnt lgkmcnt(14)
    v_mfma_f32_16x16x32_bf16 v[36:39], v[224:227], v[204:207], v[36:39]
    ds_read_b64_tr_b16 v[224:225], v8 offset:8192
    ds_read_b64_tr_b16 v[226:227], v8 offset:9216
    s_waitcnt lgkmcnt(14)
    v_mfma_f32_16x16x32_bf16 v[40:43], v[228:231], v[196:199], v[40:43]
    ds_bpermute_b32 v208, v16, v184
    v_mfma_f32_16x16x32_bf16 v[44:47], v[228:231], v[200:203], v[44:47]
    ds_bpermute_b32 v209, v16, v185
    v_mfma_f32_16x16x32_bf16 v[48:51], v[228:231], v[204:207], v[48:51]
    ds_read_b64_tr_b16 v[228:229], v9 offset:8192
    ds_read_b64_tr_b16 v[230:231], v9 offset:9216
    ds_bpermute_b32 v210, v16, v186
    s_waitcnt lgkmcnt(15)
    v_mfma_f32_16x16x32_bf16 v[52:55], v[232:235], v[196:199], v[52:55]
    ds_bpermute_b32 v211, v16, v187
    v_mfma_f32_16x16x32_bf16 v[56:59], v[232:235], v[200:203], v[56:59]
    ds_bpermute_b32 v212, v16, v188
    v_mfma_f32_16x16x32_bf16 v[60:63], v[232:235], v[204:207], v[60:63]
    ds_read_b64_tr_b16 v[232:233], v10 offset:8192
    ds_read_b64_tr_b16 v[234:235], v10 offset:9216
    ds_bpermute_b32 v213, v16, v189
    v_mfma_f32_16x16x32_bf16 v[64:67], v[236:239], v[196:199], v[64:67]
    ds_bpermute_b32 v214, v16, v190
    v_mfma_f32_16x16x32_bf16 v[68:71], v[236:239], v[200:203], v[68:71]
    ds_bpermute_b32 v215, v16, v191
    v_mfma_f32_16x16x32_bf16 v[72:75], v[236:239], v[204:207], v[72:75]
    ds_read_b64_tr_b16 v[236:237], v11 offset:8192
    ds_read_b64_tr_b16 v[238:239], v11 offset:9216
    s_waitcnt vmcnt(0)
    ds_bpermute_b32 v216, v16, v192
    s_waitcnt lgkmcnt(15)
    v_mfma_f32_16x16x32_bf16 v[76:79], v[240:243], v[196:199], v[76:79]
    ds_bpermute_b32 v217, v16, v193
    v_mfma_f32_16x16x32_bf16 v[80:83], v[240:243], v[200:203], v[80:83]
    ds_bpermute_b32 v218, v16, v194
    v_mfma_f32_16x16x32_bf16 v[84:87], v[240:243], v[204:207], v[84:87]
    ds_read_b64_tr_b16 v[240:241], v12 offset:8192
    ds_read_b64_tr_b16 v[242:243], v12 offset:9216
    ds_bpermute_b32 v219, v16, v195
    v_mfma_f32_16x16x32_bf16 v[88:91], v[244:247], v[196:199], v[88:91]
    v_mfma_f32_16x16x32_bf16 v[92:95], v[244:247], v[200:203], v[92:95]
    v_mfma_f32_16x16x32_bf16 v[96:99], v[244:247], v[204:207], v[96:99]
    ds_read_b64_tr_b16 v[244:245], v13 offset:8192
    ds_read_b64_tr_b16 v[246:247], v13 offset:9216
    v_mfma_f32_16x16x32_bf16 v[100:103], v[248:251], v[196:199], v[100:103]
    v_mfma_f32_16x16x32_bf16 v[104:107], v[248:251], v[200:203], v[104:107]
    v_mfma_f32_16x16x32_bf16 v[108:111], v[248:251], v[204:207], v[108:111]
    ds_read_b64_tr_b16 v[248:249], v14 offset:8192
    ds_read_b64_tr_b16 v[250:251], v14 offset:9216
    v_mfma_f32_16x16x32_bf16 v[112:115], v[252:255], v[196:199], v[112:115]
    v_mfma_f32_16x16x32_bf16 v[116:119], v[252:255], v[200:203], v[116:119]
    v_mfma_f32_16x16x32_bf16 v[120:123], v[252:255], v[204:207], v[120:123]
    ds_read_b64_tr_b16 v[252:253], v15 offset:8192
    ds_read_b64_tr_b16 v[254:255], v15 offset:9216
    s_waitcnt lgkmcnt(15)
    v_mfma_f32_16x16x32_bf16 v[28:31], v[224:227], v[208:211], v[28:31]
    s_waitcnt lgkmcnt(14)
    v_mfma_f32_16x16x32_bf16 v[32:35], v[224:227], v[212:215], v[32:35]
    s_waitcnt lgkmcnt(6)
    v_mfma_f32_16x16x32_bf16 v[36:39], v[224:227], v[216:219], v[36:39]
    v_mfma_f32_16x16x32_bf16 v[40:43], v[228:231], v[208:211], v[40:43]
    v_mfma_f32_16x16x32_bf16 v[44:47], v[228:231], v[212:215], v[44:47]
    v_mfma_f32_16x16x32_bf16 v[48:51], v[228:231], v[216:219], v[48:51]
    v_mfma_f32_16x16x32_bf16 v[52:55], v[232:235], v[208:211], v[52:55]
    v_mfma_f32_16x16x32_bf16 v[56:59], v[232:235], v[212:215], v[56:59]
    v_mfma_f32_16x16x32_bf16 v[60:63], v[232:235], v[216:219], v[60:63]
    v_mfma_f32_16x16x32_bf16 v[64:67], v[236:239], v[208:211], v[64:67]
    v_mfma_f32_16x16x32_bf16 v[68:71], v[236:239], v[212:215], v[68:71]
    v_mfma_f32_16x16x32_bf16 v[72:75], v[236:239], v[216:219], v[72:75]
    v_mfma_f32_16x16x32_bf16 v[76:79], v[240:243], v[208:211], v[76:79]
    v_mfma_f32_16x16x32_bf16 v[80:83], v[240:243], v[212:215], v[80:83]
    v_mfma_f32_16x16x32_bf16 v[84:87], v[240:243], v[216:219], v[84:87]
    s_waitcnt lgkmcnt(0)
    s_barrier
    ds_read_b128 v[224:227], v4 offset:16384
    v_mfma_f32_16x16x32_bf16 v[88:91], v[244:247], v[208:211], v[88:91]
    ds_read_b128 v[228:231], v5 offset:16384
    v_mfma_f32_16x16x32_bf16 v[92:95], v[244:247], v[212:215], v[92:95]
    ds_read_b128 v[232:235], v6 offset:16384
    v_mfma_f32_16x16x32_bf16 v[96:99], v[244:247], v[216:219], v[96:99]
    ds_read_b128 v[236:239], v7 offset:16384
    v_mfma_f32_16x16x32_bf16 v[100:103], v[248:251], v[208:211], v[100:103]
    ds_read_b128 v[240:243], v4 offset:17408
    v_mfma_f32_16x16x32_bf16 v[104:107], v[248:251], v[212:215], v[104:107]
    ds_read_b128 v[244:247], v5 offset:17408
    v_mfma_f32_16x16x32_bf16 v[108:111], v[248:251], v[216:219], v[108:111]
    ds_read_b128 v[248:251], v6 offset:17408
    v_mfma_f32_16x16x32_bf16 v[112:115], v[252:255], v[208:211], v[112:115]
    v_mfma_f32_16x16x32_bf16 v[116:119], v[252:255], v[212:215], v[116:119]
    v_mfma_f32_16x16x32_bf16 v[120:123], v[252:255], v[216:219], v[120:123]
    ds_read_b128 v[252:255], v7 offset:17408
    v_pk_mul_f32 v[28:29], v[28:29], s[44:45]
    v_pk_mul_f32 v[30:31], v[30:31], s[44:45]
    v_pk_mul_f32 v[40:41], v[40:41], s[44:45]
    v_pk_mul_f32 v[42:43], v[42:43], s[44:45]
    v_pk_mul_f32 v[32:33], v[32:33], s[44:45]
    v_pk_mul_f32 v[34:35], v[34:35], s[44:45]
    v_pk_mul_f32 v[44:45], v[44:45], s[44:45]
    v_pk_mul_f32 v[46:47], v[46:47], s[44:45]
    v_pk_mul_f32 v[36:37], v[36:37], s[44:45]
    v_pk_mul_f32 v[38:39], v[38:39], s[44:45]
    v_pk_mul_f32 v[48:49], v[48:49], s[44:45]
    v_pk_mul_f32 v[50:51], v[50:51], s[44:45]
    v_cvt_pk_bf16_f32 v124, v28, v29
    v_cvt_pk_bf16_f32 v125, v30, v31
    v_cvt_pk_bf16_f32 v126, v40, v41
    v_cvt_pk_bf16_f32 v127, v42, v43
    v_cvt_pk_bf16_f32 v128, v32, v33
    v_cvt_pk_bf16_f32 v129, v34, v35
    v_cvt_pk_bf16_f32 v130, v44, v45
    v_cvt_pk_bf16_f32 v131, v46, v47
    v_cvt_pk_bf16_f32 v132, v36, v37
    v_cvt_pk_bf16_f32 v133, v38, v39
    v_cvt_pk_bf16_f32 v134, v48, v49
    v_cvt_pk_bf16_f32 v135, v50, v51
    v_permlane32_swap_b32 v124, v126
    v_permlane32_swap_b32 v125, v127
    v_permlane32_swap_b32 v128, v130
    v_permlane32_swap_b32 v129, v131
    v_permlane32_swap_b32 v132, v134
    v_permlane32_swap_b32 v133, v135
    v_permlane16_swap_b32 v124, v126
    v_permlane16_swap_b32 v125, v127
    v_permlane16_swap_b32 v128, v130
    v_permlane16_swap_b32 v129, v131
    v_permlane16_swap_b32 v132, v134
    v_permlane16_swap_b32 v133, v135
    v_pk_mul_f32 v[52:53], v[52:53], s[44:45]
    v_pk_mul_f32 v[54:55], v[54:55], s[44:45]
    v_pk_mul_f32 v[64:65], v[64:65], s[44:45]
    v_pk_mul_f32 v[66:67], v[66:67], s[44:45]
    v_pk_mul_f32 v[56:57], v[56:57], s[44:45]
    v_pk_mul_f32 v[58:59], v[58:59], s[44:45]
    v_pk_mul_f32 v[68:69], v[68:69], s[44:45]
    v_pk_mul_f32 v[70:71], v[70:71], s[44:45]
    v_pk_mul_f32 v[60:61], v[60:61], s[44:45]
    v_pk_mul_f32 v[62:63], v[62:63], s[44:45]
    v_pk_mul_f32 v[72:73], v[72:73], s[44:45]
    v_pk_mul_f32 v[74:75], v[74:75], s[44:45]
    v_cvt_pk_bf16_f32 v136, v52, v53
    v_cvt_pk_bf16_f32 v137, v54, v55
    v_cvt_pk_bf16_f32 v138, v64, v65
    v_cvt_pk_bf16_f32 v139, v66, v67
    v_cvt_pk_bf16_f32 v140, v56, v57
    v_cvt_pk_bf16_f32 v141, v58, v59
    v_cvt_pk_bf16_f32 v142, v68, v69
    v_cvt_pk_bf16_f32 v143, v70, v71
    v_cvt_pk_bf16_f32 v144, v60, v61
    v_cvt_pk_bf16_f32 v145, v62, v63
    v_cvt_pk_bf16_f32 v146, v72, v73
    v_cvt_pk_bf16_f32 v147, v74, v75
    v_permlane32_swap_b32 v136, v138
    v_permlane32_swap_b32 v137, v139
    v_permlane32_swap_b32 v140, v142
    v_permlane32_swap_b32 v141, v143
    v_permlane32_swap_b32 v144, v146
    v_permlane32_swap_b32 v145, v147
    v_permlane16_swap_b32 v136, v138
    v_permlane16_swap_b32 v137, v139
    v_permlane16_swap_b32 v140, v142
    v_permlane16_swap_b32 v141, v143
    v_permlane16_swap_b32 v144, v146
    v_permlane16_swap_b32 v145, v147
    v_pk_mul_f32 v[76:77], v[76:77], s[44:45]
    v_pk_mul_f32 v[78:79], v[78:79], s[44:45]
    v_pk_mul_f32 v[88:89], v[88:89], s[44:45]
    v_pk_mul_f32 v[90:91], v[90:91], s[44:45]
    v_pk_mul_f32 v[80:81], v[80:81], s[44:45]
    v_pk_mul_f32 v[82:83], v[82:83], s[44:45]
    v_pk_mul_f32 v[92:93], v[92:93], s[44:45]
    v_pk_mul_f32 v[94:95], v[94:95], s[44:45]
    v_pk_mul_f32 v[84:85], v[84:85], s[44:45]
    v_pk_mul_f32 v[86:87], v[86:87], s[44:45]
    v_pk_mul_f32 v[96:97], v[96:97], s[44:45]
    v_pk_mul_f32 v[98:99], v[98:99], s[44:45]
    v_cvt_pk_bf16_f32 v148, v76, v77
    v_cvt_pk_bf16_f32 v149, v78, v79
    v_cvt_pk_bf16_f32 v150, v88, v89
    v_cvt_pk_bf16_f32 v151, v90, v91
    v_cvt_pk_bf16_f32 v152, v80, v81
    v_cvt_pk_bf16_f32 v153, v82, v83
    v_cvt_pk_bf16_f32 v154, v92, v93
    v_cvt_pk_bf16_f32 v155, v94, v95
    v_cvt_pk_bf16_f32 v156, v84, v85
    v_cvt_pk_bf16_f32 v157, v86, v87
    v_cvt_pk_bf16_f32 v158, v96, v97
    v_cvt_pk_bf16_f32 v159, v98, v99
    v_permlane32_swap_b32 v148, v150
    v_permlane32_swap_b32 v149, v151
    v_permlane32_swap_b32 v152, v154
    v_permlane32_swap_b32 v153, v155
    v_permlane32_swap_b32 v156, v158
    v_permlane32_swap_b32 v157, v159
    v_permlane16_swap_b32 v148, v150
    v_permlane16_swap_b32 v149, v151
    v_permlane16_swap_b32 v152, v154
    v_permlane16_swap_b32 v153, v155
    v_permlane16_swap_b32 v156, v158
    v_permlane16_swap_b32 v157, v159
    v_pk_mul_f32 v[100:101], v[100:101], s[44:45]
    v_pk_mul_f32 v[102:103], v[102:103], s[44:45]
    v_pk_mul_f32 v[112:113], v[112:113], s[44:45]
    v_pk_mul_f32 v[114:115], v[114:115], s[44:45]
    v_pk_mul_f32 v[104:105], v[104:105], s[44:45]
    v_pk_mul_f32 v[106:107], v[106:107], s[44:45]
    v_pk_mul_f32 v[116:117], v[116:117], s[44:45]
    v_pk_mul_f32 v[118:119], v[118:119], s[44:45]
    v_pk_mul_f32 v[108:109], v[108:109], s[44:45]
    v_pk_mul_f32 v[110:111], v[110:111], s[44:45]
    v_pk_mul_f32 v[120:121], v[120:121], s[44:45]
    v_pk_mul_f32 v[122:123], v[122:123], s[44:45]
    v_cvt_pk_bf16_f32 v160, v100, v101
    v_cvt_pk_bf16_f32 v161, v102, v103
    v_cvt_pk_bf16_f32 v162, v112, v113
    v_cvt_pk_bf16_f32 v163, v114, v115
    v_cvt_pk_bf16_f32 v164, v104, v105
    v_cvt_pk_bf16_f32 v165, v106, v107
    v_cvt_pk_bf16_f32 v166, v116, v117
    v_cvt_pk_bf16_f32 v167, v118, v119
    v_cvt_pk_bf16_f32 v168, v108, v109
    v_cvt_pk_bf16_f32 v169, v110, v111
    v_cvt_pk_bf16_f32 v170, v120, v121
    v_cvt_pk_bf16_f32 v171, v122, v123
    v_permlane32_swap_b32 v160, v162
    v_permlane32_swap_b32 v161, v163
    v_permlane32_swap_b32 v164, v166
    v_permlane32_swap_b32 v165, v167
    v_permlane32_swap_b32 v168, v170
    v_permlane32_swap_b32 v169, v171
    v_permlane16_swap_b32 v160, v162
    v_permlane16_swap_b32 v161, v163
    v_permlane16_swap_b32 v164, v166
    v_permlane16_swap_b32 v165, v167
    v_permlane16_swap_b32 v168, v170
    v_permlane16_swap_b32 v169, v171
    v_mov_b32 v16, 0
    v_mov_b32 v17, 0
    v_mov_b32 v0, 0
    v_mov_b32 v220, 0xff7fffff
    v_mov_b32 v18, 0
    v_mov_b32 v19, 0
    v_mov_b32 v2, 0
    v_mov_b32 v221, 0xff7fffff
    v_mov_b32 v20, 0
    v_mov_b32 v21, 0
    v_mov_b32 v3, 0
    v_mov_b32 v222, 0xff7fffff
    s_waitcnt lgkmcnt(7)
    v_mfma_f32_16x16x32_bf16 v[172:175], v[224:227], v[124:127], 0
    v_mfma_f32_16x16x32_bf16 v[176:179], v[224:227], v[128:131], 0
    v_mfma_f32_16x16x32_bf16 v[180:183], v[224:227], v[132:135], 0
    ds_read_b128 v[224:227], v4 offset:24576
    s_waitcnt lgkmcnt(7)
    v_mfma_f32_16x16x32_bf16 v[172:175], v[228:231], v[136:139], v[172:175]
    v_mfma_f32_16x16x32_bf16 v[176:179], v[228:231], v[140:143], v[176:179]
    v_mfma_f32_16x16x32_bf16 v[180:183], v[228:231], v[144:147], v[180:183]
    ds_read_b128 v[228:231], v5 offset:24576
    s_waitcnt lgkmcnt(7)
    v_mfma_f32_16x16x32_bf16 v[172:175], v[232:235], v[148:151], v[172:175]
    v_mfma_f32_16x16x32_bf16 v[176:179], v[232:235], v[152:155], v[176:179]
    v_mfma_f32_16x16x32_bf16 v[180:183], v[232:235], v[156:159], v[180:183]
    ds_read_b128 v[232:235], v6 offset:24576
    s_waitcnt lgkmcnt(7)
    v_mfma_f32_16x16x32_bf16 v[172:175], v[236:239], v[160:163], v[172:175]
    v_mfma_f32_16x16x32_bf16 v[176:179], v[236:239], v[164:167], v[176:179]
    v_mfma_f32_16x16x32_bf16 v[180:183], v[236:239], v[168:171], v[180:183]
    ds_read_b128 v[236:239], v7 offset:24576
    s_waitcnt lgkmcnt(7)
    v_mfma_f32_16x16x32_bf16 v[184:187], v[240:243], v[124:127], 0
    v_mfma_f32_16x16x32_bf16 v[188:191], v[240:243], v[128:131], 0
    v_mfma_f32_16x16x32_bf16 v[192:195], v[240:243], v[132:135], 0
    ds_read_b128 v[240:243], v4 offset:25600
    s_waitcnt lgkmcnt(7)
    v_mfma_f32_16x16x32_bf16 v[184:187], v[244:247], v[136:139], v[184:187]
    v_exp_f32 v22, v172
    v_exp_f32 v23, v173
    v_exp_f32 v24, v174
    v_exp_f32 v25, v175
    v_cvt_pk_bf16_f32 v196, v22, v23
    v_add_f32 v16, v16, v22
    v_mfma_f32_16x16x32_bf16 v[188:191], v[244:247], v[140:143], v[188:191]
    v_add_f32 v17, v17, v23
    v_exp_f32 v26, v176
    v_exp_f32 v27, v177
    v_cvt_pk_bf16_f32 v197, v24, v25
    v_add_f32 v16, v16, v24
    v_add_f32 v17, v17, v25
    v_exp_f32 v22, v178
    v_mfma_f32_16x16x32_bf16 v[192:195], v[244:247], v[144:147], v[192:195]
    ds_read_b128 v[244:247], v5 offset:25600
    v_exp_f32 v23, v179
    v_cvt_pk_bf16_f32 v200, v26, v27
    v_add_f32 v18, v18, v26
    v_add_f32 v19, v19, v27
    v_exp_f32 v24, v180
    v_exp_f32 v25, v181
    v_cvt_pk_bf16_f32 v201, v22, v23
    s_waitcnt lgkmcnt(7)
    v_mfma_f32_16x16x32_bf16 v[184:187], v[248:251], v[148:151], v[184:187]
    v_add_f32 v18, v18, v22
    v_add_f32 v19, v19, v23
    v_exp_f32 v26, v182
    v_exp_f32 v27, v183
    v_cvt_pk_bf16_f32 v204, v24, v25
    v_add_f32 v20, v20, v24
    v_add_f32 v21, v21, v25
    v_mfma_f32_16x16x32_bf16 v[188:191], v[248:251], v[152:155], v[188:191]
    v_cvt_pk_bf16_f32 v205, v26, v27
    v_add_f32 v20, v20, v26
    v_add_f32 v21, v21, v27
    v_mfma_f32_16x16x32_bf16 v[192:195], v[248:251], v[156:159], v[192:195]
    ds_read_b128 v[248:251], v6 offset:25600
    s_waitcnt lgkmcnt(7)
    v_mfma_f32_16x16x32_bf16 v[184:187], v[252:255], v[160:163], v[184:187]
    v_mfma_f32_16x16x32_bf16 v[188:191], v[252:255], v[164:167], v[188:191]
    v_mfma_f32_16x16x32_bf16 v[192:195], v[252:255], v[168:171], v[192:195]
    ds_read_b128 v[252:255], v7 offset:25600
    s_nop 4
    v_exp_f32 v22, v184
    v_exp_f32 v23, v185
    v_exp_f32 v24, v186
    v_exp_f32 v25, v187
    v_cvt_pk_bf16_f32 v198, v22, v23
    v_add_f32 v16, v16, v22
    v_add_f32 v17, v17, v23
    v_exp_f32 v26, v188
    v_exp_f32 v27, v189
    v_cvt_pk_bf16_f32 v199, v24, v25
    v_add_f32 v16, v16, v24
    v_add_f32 v17, v17, v25
    v_exp_f32 v22, v190
    v_exp_f32 v23, v191
    v_cvt_pk_bf16_f32 v202, v26, v27
    v_add_f32 v18, v18, v26
    v_add_f32 v19, v19, v27
    v_exp_f32 v24, v192
    v_exp_f32 v25, v193
    v_cvt_pk_bf16_f32 v203, v22, v23
    v_add_f32 v18, v18, v22
    v_add_f32 v19, v19, v23
    v_exp_f32 v26, v194
    v_exp_f32 v27, v195
    v_cvt_pk_bf16_f32 v206, v24, v25
    v_add_f32 v20, v20, v24
    v_add_f32 v21, v21, v25
    v_cvt_pk_bf16_f32 v207, v26, v27
    v_add_f32 v20, v20, v26
    v_add_f32 v21, v21, v27
    s_cmp_eq_u32 s43, 0
    s_cbranch_scc1 attn_kernel_a_skip0
    s_call_b64 s[54:55], attn_kernel_a_rare0
attn_kernel_a_skip0:
    s_waitcnt lgkmcnt(7)
    v_mfma_f32_16x16x32_bf16 v[172:175], v[224:227], v[124:127], 0
    v_mfma_f32_16x16x32_bf16 v[176:179], v[224:227], v[128:131], 0
    v_mfma_f32_16x16x32_bf16 v[180:183], v[224:227], v[132:135], 0
    s_waitcnt lgkmcnt(6)
    v_mfma_f32_16x16x32_bf16 v[172:175], v[228:231], v[136:139], v[172:175]
    v_mfma_f32_16x16x32_bf16 v[176:179], v[228:231], v[140:143], v[176:179]
    v_mfma_f32_16x16x32_bf16 v[180:183], v[228:231], v[144:147], v[180:183]
    s_waitcnt lgkmcnt(5)
    v_mfma_f32_16x16x32_bf16 v[172:175], v[232:235], v[148:151], v[172:175]
    v_mfma_f32_16x16x32_bf16 v[176:179], v[232:235], v[152:155], v[176:179]
    v_mfma_f32_16x16x32_bf16 v[180:183], v[232:235], v[156:159], v[180:183]
    s_waitcnt lgkmcnt(4)
    v_mfma_f32_16x16x32_bf16 v[172:175], v[236:239], v[160:163], v[172:175]
    v_mfma_f32_16x16x32_bf16 v[176:179], v[236:239], v[164:167], v[176:179]
    v_mfma_f32_16x16x32_bf16 v[180:183], v[236:239], v[168:171], v[180:183]
    s_waitcnt lgkmcnt(3)
    v_mfma_f32_16x16x32_bf16 v[184:187], v[240:243], v[124:127], 0
    v_mfma_f32_16x16x32_bf16 v[188:191], v[240:243], v[128:131], 0
    v_mfma_f32_16x16x32_bf16 v[192:195], v[240:243], v[132:135], 0
    s_waitcnt lgkmcnt(0)
    s_barrier
    ds_read_b64_tr_b16 v[224:225], v8 offset:32768
    ds_read_b64_tr_b16 v[226:227], v8 offset:33792
    v_mfma_f32_16x16x32_bf16 v[184:187], v[244:247], v[136:139], v[184:187]
    ds_read_b64_tr_b16 v[228:229], v9 offset:32768
    ds_read_b64_tr_b16 v[230:231], v9 offset:33792
    v_exp_f32 v22, v172
    v_exp_f32 v23, v173
    v_mfma_f32_16x16x32_bf16 v[188:191], v[244:247], v[140:143], v[188:191]
    ds_read_b64_tr_b16 v[232:233], v10 offset:32768
    ds_read_b64_tr_b16 v[234:235], v10 offset:33792
    v_exp_f32 v24, v174
    v_exp_f32 v25, v175
    v_mfma_f32_16x16x32_bf16 v[192:195], v[244:247], v[144:147], v[192:195]
    ds_read_b64_tr_b16 v[236:237], v11 offset:32768
    ds_read_b64_tr_b16 v[238:239], v11 offset:33792
    v_cvt_pk_bf16_f32 v208, v22, v23
    v_add_f32 v16, v16, v22
    v_add_f32 v17, v17, v23
    v_mfma_f32_16x16x32_bf16 v[184:187], v[248:251], v[148:151], v[184:187]
    ds_read_b64_tr_b16 v[240:241], v12 offset:32768
    ds_read_b64_tr_b16 v[242:243], v12 offset:33792
    v_exp_f32 v26, v176
    v_exp_f32 v27, v177
    v_mfma_f32_16x16x32_bf16 v[188:191], v[248:251], v[152:155], v[188:191]
    ds_read_b64_tr_b16 v[244:245], v13 offset:32768
    ds_read_b64_tr_b16 v[246:247], v13 offset:33792
    v_cvt_pk_bf16_f32 v209, v24, v25
    v_add_f32 v16, v16, v24
    v_add_f32 v17, v17, v25
    v_mfma_f32_16x16x32_bf16 v[192:195], v[248:251], v[156:159], v[192:195]
    ds_read_b64_tr_b16 v[248:249], v14 offset:32768
    ds_read_b64_tr_b16 v[250:251], v14 offset:33792
    v_exp_f32 v22, v178
    v_exp_f32 v23, v179
    v_mfma_f32_16x16x32_bf16 v[184:187], v[252:255], v[160:163], v[184:187]
    v_cvt_pk_bf16_f32 v212, v26, v27
    v_add_f32 v18, v18, v26
    v_add_f32 v19, v19, v27
    v_mfma_f32_16x16x32_bf16 v[188:191], v[252:255], v[164:167], v[188:191]
    v_exp_f32 v24, v180
    v_exp_f32 v25, v181
    v_mfma_f32_16x16x32_bf16 v[192:195], v[252:255], v[168:171], v[192:195]
    ds_read_b64_tr_b16 v[252:253], v15 offset:32768
    ds_read_b64_tr_b16 v[254:255], v15 offset:33792
    v_cvt_pk_bf16_f32 v213, v22, v23
    v_add_f32 v18, v18, v22
    v_add_f32 v19, v19, v23
    s_waitcnt lgkmcnt(14)
    v_mfma_f32_16x16x32_bf16 v[28:31], v[224:227], v[196:199], 0
    v_exp_f32 v26, v182
    v_exp_f32 v27, v183
    v_mfma_f32_16x16x32_bf16 v[32:35], v[224:227], v[200:203], 0
    v_cvt_pk_bf16_f32 v216, v24, v25
    v_add_f32 v20, v20, v24
    v_add_f32 v21, v21, v25
    v_mfma_f32_16x16x32_bf16 v[36:39], v[224:227], v[204:207], 0
    ds_read_b128 v[224:227], v4 offset:40960
    v_cvt_pk_bf16_f32 v217, v26, v27
    v_add_f32 v20, v20, v26
    v_add_f32 v21, v21, v27
    s_waitcnt lgkmcnt(13)
    v_mfma_f32_16x16x32_bf16 v[40:43], v[228:231], v[196:199], 0
    v_exp_f32 v22, v184
    v_mfma_f32_16x16x32_bf16 v[44:47], v[228:231], v[200:203], 0
    v_exp_f32 v23, v185
    v_mfma_f32_16x16x32_bf16 v[48:51], v[228:231], v[204:207], 0
    ds_read_b128 v[228:231], v5 offset:40960
    v_exp_f32 v24, v186
    s_waitcnt lgkmcnt(12)
    v_mfma_f32_16x16x32_bf16 v[52:55], v[232:235], v[196:199], 0
    v_exp_f32 v25, v187
    v_mfma_f32_16x16x32_bf16 v[56:59], v[232:235], v[200:203], 0
    v_cvt_pk_bf16_f32 v210, v22, v23
    v_add_f32 v16, v16, v22
    v_mfma_f32_16x16x32_bf16 v[60:63], v[232:235], v[204:207], 0
    ds_read_b128 v[232:235], v6 offset:40960
    v_add_f32 v17, v17, v23
    v_exp_f32 v26, v188
    s_waitcnt lgkmcnt(11)
    v_mfma_f32_16x16x32_bf16 v[64:67], v[236:239], v[196:199], 0
    v_exp_f32 v27, v189
    v_mfma_f32_16x16x32_bf16 v[68:71], v[236:239], v[200:203], 0
    v_cvt_pk_bf16_f32 v211, v24, v25
    v_add_f32 v16, v16, v24
    v_mfma_f32_16x16x32_bf16 v[72:75], v[236:239], v[204:207], 0
    ds_read_b128 v[236:239], v7 offset:40960
    v_add_f32 v17, v17, v25
    v_exp_f32 v22, v190
    s_waitcnt lgkmcnt(10)
    v_mfma_f32_16x16x32_bf16 v[76:79], v[240:243], v[196:199], 0
    v_exp_f32 v23, v191
    v_mfma_f32_16x16x32_bf16 v[80:83], v[240:243], v[200:203], 0
    v_cvt_pk_bf16_f32 v214, v26, v27
    v_add_f32 v18, v18, v26
    v_mfma_f32_16x16x32_bf16 v[84:87], v[240:243], v[204:207], 0
    ds_read_b128 v[240:243], v4 offset:41984
    v_add_f32 v19, v19, v27
    v_exp_f32 v24, v192
    s_waitcnt lgkmcnt(9)
    v_mfma_f32_16x16x32_bf16 v[88:91], v[244:247], v[196:199], 0
    v_exp_f32 v25, v193
    v_mfma_f32_16x16x32_bf16 v[92:95], v[244:247], v[200:203], 0
    v_cvt_pk_bf16_f32 v215, v22, v23
    v_add_f32 v18, v18, v22
    v_mfma_f32_16x16x32_bf16 v[96:99], v[244:247], v[204:207], 0
    ds_read_b128 v[244:247], v5 offset:41984
    v_add_f32 v19, v19, v23
    v_exp_f32 v26, v194
    s_waitcnt lgkmcnt(8)
    v_mfma_f32_16x16x32_bf16 v[100:103], v[248:251], v[196:199], 0
    v_exp_f32 v27, v195
    v_mfma_f32_16x16x32_bf16 v[104:107], v[248:251], v[200:203], 0
    v_cvt_pk_bf16_f32 v218, v24, v25
    v_add_f32 v20, v20, v24
    v_mfma_f32_16x16x32_bf16 v[108:111], v[248:251], v[204:207], 0
    ds_read_b128 v[248:251], v6 offset:41984
    v_add_f32 v21, v21, v25
    s_waitcnt lgkmcnt(7)
    v_mfma_f32_16x16x32_bf16 v[112:115], v[252:255], v[196:199], 0
    v_cvt_pk_bf16_f32 v219, v26, v27
    v_mfma_f32_16x16x32_bf16 v[116:119], v[252:255], v[200:203], 0
    v_add_f32 v20, v20, v26
    v_mfma_f32_16x16x32_bf16 v[120:123], v[252:255], v[204:207], 0
    ds_read_b128 v[252:255], v7 offset:41984
    v_add_f32 v21, v21, v27
    s_cmp_eq_u32 s43, 0
    s_cbranch_scc1 attn_kernel_a_skip1
    s_call_b64 s[54:55], attn_kernel_a_rare1
attn_kernel_a_skip1:
    s_waitcnt lgkmcnt(7)
    v_mfma_f32_16x16x32_bf16 v[172:175], v[224:227], v[124:127], 0
    v_mfma_f32_16x16x32_bf16 v[176:179], v[224:227], v[128:131], 0
    v_mfma_f32_16x16x32_bf16 v[180:183], v[224:227], v[132:135], 0
    s_waitcnt lgkmcnt(6)
    v_mfma_f32_16x16x32_bf16 v[172:175], v[228:231], v[136:139], v[172:175]
    v_mfma_f32_16x16x32_bf16 v[176:179], v[228:231], v[140:143], v[176:179]
    v_mfma_f32_16x16x32_bf16 v[180:183], v[228:231], v[144:147], v[180:183]
    s_waitcnt lgkmcnt(5)
    v_mfma_f32_16x16x32_bf16 v[172:175], v[232:235], v[148:151], v[172:175]
    v_mfma_f32_16x16x32_bf16 v[176:179], v[232:235], v[152:155], v[176:179]
    v_mfma_f32_16x16x32_bf16 v[180:183], v[232:235], v[156:159], v[180:183]
    s_waitcnt lgkmcnt(4)
    v_mfma_f32_16x16x32_bf16 v[172:175], v[236:239], v[160:163], v[172:175]
    v_mfma_f32_16x16x32_bf16 v[176:179], v[236:239], v[164:167], v[176:179]
    v_mfma_f32_16x16x32_bf16 v[180:183], v[236:239], v[168:171], v[180:183]
    s_waitcnt lgkmcnt(3)
    v_mfma_f32_16x16x32_bf16 v[184:187], v[240:243], v[124:127], 0
    v_mfma_f32_16x16x32_bf16 v[188:191], v[240:243], v[128:131], 0
    v_mfma_f32_16x16x32_bf16 v[192:195], v[240:243], v[132:135], 0
    s_waitcnt lgkmcnt(0)
    s_barrier
    ds_read_b64_tr_b16 v[224:225], v8 offset:49152
    ds_read_b64_tr_b16 v[226:227], v8 offset:50176
    v_mfma_f32_16x16x32_bf16 v[184:187], v[244:247], v[136:139], v[184:187]
    ds_read_b64_tr_b16 v[228:229], v9 offset:49152
    ds_read_b64_tr_b16 v[230:231], v9 offset:50176
    v_exp_f32 v22, v172
    v_exp_f32 v23, v173
    v_mfma_f32_16x16x32_bf16 v[188:191], v[244:247], v[140:143], v[188:191]
    ds_read_b64_tr_b16 v[232:233], v10 offset:49152
    ds_read_b64_tr_b16 v[234:235], v10 offset:50176
    v_exp_f32 v24, v174
    v_exp_f32 v25, v175
    v_mfma_f32_16x16x32_bf16 v[192:195], v[244:247], v[144:147], v[192:195]
    ds_read_b64_tr_b16 v[236:237], v11 offset:49152
    ds_read_b64_tr_b16 v[238:239], v11 offset:50176
    v_cvt_pk_bf16_f32 v196, v22, v23
    v_add_f32 v16, v16, v22
    v_add_f32 v17, v17, v23
    v_mfma_f32_16x16x32_bf16 v[184:187], v[248:251], v[148:151], v[184:187]
    ds_read_b64_tr_b16 v[240:241], v12 offset:49152
    ds_read_b64_tr_b16 v[242:243], v12 offset:50176
    v_exp_f32 v26, v176
    v_exp_f32 v27, v177
    v_mfma_f32_16x16x32_bf16 v[188:191], v[248:251], v[152:155], v[188:191]
    ds_read_b64_tr_b16 v[244:245], v13 offset:49152
    ds_read_b64_tr_b16 v[246:247], v13 offset:50176
    v_cvt_pk_bf16_f32 v197, v24, v25
    v_add_f32 v16, v16, v24
    v_add_f32 v17, v17, v25
    v_mfma_f32_16x16x32_bf16 v[192:195], v[248:251], v[156:159], v[192:195]
    ds_read_b64_tr_b16 v[248:249], v14 offset:49152
    ds_read_b64_tr_b16 v[250:251], v14 offset:50176
    v_exp_f32 v22, v178
    v_exp_f32 v23, v179
    v_mfma_f32_16x16x32_bf16 v[184:187], v[252:255], v[160:163], v[184:187]
    v_cvt_pk_bf16_f32 v200, v26, v27
    v_add_f32 v18, v18, v26
    v_add_f32 v19, v19, v27
    v_mfma_f32_16x16x32_bf16 v[188:191], v[252:255], v[164:167], v[188:191]
    v_exp_f32 v24, v180
    v_exp_f32 v25, v181
    v_mfma_f32_16x16x32_bf16 v[192:195], v[252:255], v[168:171], v[192:195]
    ds_read_b64_tr_b16 v[252:253], v15 offset:49152
    ds_read_b64_tr_b16 v[254:255], v15 offset:50176
    v_cvt_pk_bf16_f32 v201, v22, v23
    v_add_f32 v18, v18, v22
    v_add_f32 v19, v19, v23
    s_waitcnt lgkmcnt(14)
    v_mfma_f32_16x16x32_bf16 v[28:31], v[224:227], v[208:211], v[28:31]
    v_exp_f32 v26, v182
    v_exp_f32 v27, v183
    v_mfma_f32_16x16x32_bf16 v[32:35], v[224:227], v[212:215], v[32:35]
    v_cvt_pk_bf16_f32 v204, v24, v25
    v_add_f32 v20, v20, v24
    v_add_f32 v21, v21, v25
    v_mfma_f32_16x16x32_bf16 v[36:39], v[224:227], v[216:219], v[36:39]
    ds_read_b128 v[224:227], v4 offset:57344
    v_cvt_pk_bf16_f32 v205, v26, v27
    v_add_f32 v20, v20, v26
    v_add_f32 v21, v21, v27
    s_waitcnt lgkmcnt(13)
    v_mfma_f32_16x16x32_bf16 v[40:43], v[228:231], v[208:211], v[40:43]
    v_exp_f32 v22, v184
    v_mfma_f32_16x16x32_bf16 v[44:47], v[228:231], v[212:215], v[44:47]
    v_exp_f32 v23, v185
    v_mfma_f32_16x16x32_bf16 v[48:51], v[228:231], v[216:219], v[48:51]
    ds_read_b128 v[228:231], v5 offset:57344
    v_exp_f32 v24, v186
    s_waitcnt lgkmcnt(12)
    v_mfma_f32_16x16x32_bf16 v[52:55], v[232:235], v[208:211], v[52:55]
    v_exp_f32 v25, v187
    v_mfma_f32_16x16x32_bf16 v[56:59], v[232:235], v[212:215], v[56:59]
    v_cvt_pk_bf16_f32 v198, v22, v23
    v_add_f32 v16, v16, v22
    v_mfma_f32_16x16x32_bf16 v[60:63], v[232:235], v[216:219], v[60:63]
    ds_read_b128 v[232:235], v6 offset:57344
    v_add_f32 v17, v17, v23
    v_exp_f32 v26, v188
    s_waitcnt lgkmcnt(11)
    v_mfma_f32_16x16x32_bf16 v[64:67], v[236:239], v[208:211], v[64:67]
    v_exp_f32 v27, v189
    v_mfma_f32_16x16x32_bf16 v[68:71], v[236:239], v[212:215], v[68:71]
    v_cvt_pk_bf16_f32 v199, v24, v25
    v_add_f32 v16, v16, v24
    v_mfma_f32_16x16x32_bf16 v[72:75], v[236:239], v[216:219], v[72:75]
    ds_read_b128 v[236:239], v7 offset:57344
    v_add_f32 v17, v17, v25
    v_exp_f32 v22, v190
    s_waitcnt lgkmcnt(10)
    v_mfma_f32_16x16x32_bf16 v[76:79], v[240:243], v[208:211], v[76:79]
    v_exp_f32 v23, v191
    v_mfma_f32_16x16x32_bf16 v[80:83], v[240:243], v[212:215], v[80:83]
    v_cvt_pk_bf16_f32 v202, v26, v27
    v_add_f32 v18, v18, v26
    v_mfma_f32_16x16x32_bf16 v[84:87], v[240:243], v[216:219], v[84:87]
    ds_read_b128 v[240:243], v4 offset:58368
    v_add_f32 v19, v19, v27
    v_exp_f32 v24, v192
    s_waitcnt lgkmcnt(9)
    v_mfma_f32_16x16x32_bf16 v[88:91], v[244:247], v[208:211], v[88:91]
    v_exp_f32 v25, v193
    v_mfma_f32_16x16x32_bf16 v[92:95], v[244:247], v[212:215], v[92:95]
    v_cvt_pk_bf16_f32 v203, v22, v23
    v_add_f32 v18, v18, v22
    v_mfma_f32_16x16x32_bf16 v[96:99], v[244:247], v[216:219], v[96:99]
    ds_read_b128 v[244:247], v5 offset:58368
    v_add_f32 v19, v19, v23
    v_exp_f32 v26, v194
    s_waitcnt lgkmcnt(8)
    v_mfma_f32_16x16x32_bf16 v[100:103], v[248:251], v[208:211], v[100:103]
    v_exp_f32 v27, v195
    v_mfma_f32_16x16x32_bf16 v[104:107], v[248:251], v[212:215], v[104:107]
    v_cvt_pk_bf16_f32 v206, v24, v25
    v_add_f32 v20, v20, v24
    v_mfma_f32_16x16x32_bf16 v[108:111], v[248:251], v[216:219], v[108:111]
    ds_read_b128 v[248:251], v6 offset:58368
    v_add_f32 v21, v21, v25
    s_waitcnt lgkmcnt(7)
    v_mfma_f32_16x16x32_bf16 v[112:115], v[252:255], v[208:211], v[112:115]
    v_cvt_pk_bf16_f32 v207, v26, v27
    v_mfma_f32_16x16x32_bf16 v[116:119], v[252:255], v[212:215], v[116:119]
    v_add_f32 v20, v20, v26
    v_mfma_f32_16x16x32_bf16 v[120:123], v[252:255], v[216:219], v[120:123]
    ds_read_b128 v[252:255], v7 offset:58368
    v_add_f32 v21, v21, v27
    s_cmp_eq_u32 s43, 0
    s_cbranch_scc1 attn_kernel_a_skip2
    s_call_b64 s[54:55], attn_kernel_a_rare0
attn_kernel_a_skip2:
    s_waitcnt lgkmcnt(7)
    v_mfma_f32_16x16x32_bf16 v[172:175], v[224:227], v[124:127], 0
    v_mfma_f32_16x16x32_bf16 v[176:179], v[224:227], v[128:131], 0
    v_mfma_f32_16x16x32_bf16 v[180:183], v[224:227], v[132:135], 0
    s_waitcnt lgkmcnt(6)
    v_mfma_f32_16x16x32_bf16 v[172:175], v[228:231], v[136:139], v[172:175]
    v_mfma_f32_16x16x32_bf16 v[176:179], v[228:231], v[140:143], v[176:179]
    v_mfma_f32_16x16x32_bf16 v[180:183], v[228:231], v[144:147], v[180:183]
    s_waitcnt lgkmcnt(5)
    v_mfma_f32_16x16x32_bf16 v[172:175], v[232:235], v[148:151], v[172:175]
    v_mfma_f32_16x16x32_bf16 v[176:179], v[232:235], v[152:155], v[176:179]
    v_mfma_f32_16x16x32_bf16 v[180:183], v[232:235], v[156:159], v[180:183]
    s_waitcnt lgkmcnt(4)
    v_mfma_f32_16x16x32_bf16 v[172:175], v[236:239], v[160:163], v[172:175]
    v_mfma_f32_16x16x32_bf16 v[176:179], v[236:239], v[164:167], v[176:179]
    v_mfma_f32_16x16x32_bf16 v[180:183], v[236:239], v[168:171], v[180:183]
    s_waitcnt lgkmcnt(3)
    v_mfma_f32_16x16x32_bf16 v[184:187], v[240:243], v[124:127], 0
    v_mfma_f32_16x16x32_bf16 v[188:191], v[240:243], v[128:131], 0
    v_mfma_f32_16x16x32_bf16 v[192:195], v[240:243], v[132:135], 0
    s_waitcnt lgkmcnt(0)
    s_barrier
    ds_read_b64_tr_b16 v[224:225], v8 offset:0
    ds_read_b64_tr_b16 v[226:227], v8 offset:1024
    v_mfma_f32_16x16x32_bf16 v[184:187], v[244:247], v[136:139], v[184:187]
    ds_read_b64_tr_b16 v[228:229], v9 offset:0
    ds_read_b64_tr_b16 v[230:231], v9 offset:1024
    v_exp_f32 v22, v172
    v_exp_f32 v23, v173
    v_mfma_f32_16x16x32_bf16 v[188:191], v[244:247], v[140:143], v[188:191]
    ds_read_b64_tr_b16 v[232:233], v10 offset:0
    ds_read_b64_tr_b16 v[234:235], v10 offset:1024
    v_exp_f32 v24, v174
    v_exp_f32 v25, v175
    v_mfma_f32_16x16x32_bf16 v[192:195], v[244:247], v[144:147], v[192:195]
    ds_read_b64_tr_b16 v[236:237], v11 offset:0
    ds_read_b64_tr_b16 v[238:239], v11 offset:1024
    v_cvt_pk_bf16_f32 v208, v22, v23
    v_add_f32 v16, v16, v22
    v_add_f32 v17, v17, v23
    v_mfma_f32_16x16x32_bf16 v[184:187], v[248:251], v[148:151], v[184:187]
    ds_read_b64_tr_b16 v[240:241], v12 offset:0
    ds_read_b64_tr_b16 v[242:243], v12 offset:1024
    v_exp_f32 v26, v176
    v_exp_f32 v27, v177
    v_mfma_f32_16x16x32_bf16 v[188:191], v[248:251], v[152:155], v[188:191]
    ds_read_b64_tr_b16 v[244:245], v13 offset:0
    ds_read_b64_tr_b16 v[246:247], v13 offset:1024
    v_cvt_pk_bf16_f32 v209, v24, v25
    v_add_f32 v16, v16, v24
    v_add_f32 v17, v17, v25
    v_mfma_f32_16x16x32_bf16 v[192:195], v[248:251], v[156:159], v[192:195]
    ds_read_b64_tr_b16 v[248:249], v14 offset:0
    ds_read_b64_tr_b16 v[250:251], v14 offset:1024
    v_exp_f32 v22, v178
    v_exp_f32 v23, v179
    v_mfma_f32_16x16x32_bf16 v[184:187], v[252:255], v[160:163], v[184:187]
    v_cvt_pk_bf16_f32 v212, v26, v27
    v_add_f32 v18, v18, v26
    v_add_f32 v19, v19, v27
    v_mfma_f32_16x16x32_bf16 v[188:191], v[252:255], v[164:167], v[188:191]
    v_exp_f32 v24, v180
    v_exp_f32 v25, v181
    v_mfma_f32_16x16x32_bf16 v[192:195], v[252:255], v[168:171], v[192:195]
    ds_read_b64_tr_b16 v[252:253], v15 offset:0
    ds_read_b64_tr_b16 v[254:255], v15 offset:1024
    v_cvt_pk_bf16_f32 v213, v22, v23
    v_add_f32 v18, v18, v22
    v_add_f32 v19, v19, v23
    s_waitcnt lgkmcnt(14)
    v_mfma_f32_16x16x32_bf16 v[28:31], v[224:227], v[196:199], v[28:31]
    v_exp_f32 v26, v182
    v_exp_f32 v27, v183
    v_mfma_f32_16x16x32_bf16 v[32:35], v[224:227], v[200:203], v[32:35]
    v_cvt_pk_bf16_f32 v216, v24, v25
    v_add_f32 v20, v20, v24
    v_add_f32 v21, v21, v25
    v_mfma_f32_16x16x32_bf16 v[36:39], v[224:227], v[204:207], v[36:39]
    ds_read_b128 v[224:227], v4 offset:8192
    v_cvt_pk_bf16_f32 v217, v26, v27
    v_add_f32 v20, v20, v26
    v_add_f32 v21, v21, v27
    s_waitcnt lgkmcnt(13)
    v_mfma_f32_16x16x32_bf16 v[40:43], v[228:231], v[196:199], v[40:43]
    v_exp_f32 v22, v184
    v_mfma_f32_16x16x32_bf16 v[44:47], v[228:231], v[200:203], v[44:47]
    v_exp_f32 v23, v185
    v_mfma_f32_16x16x32_bf16 v[48:51], v[228:231], v[204:207], v[48:51]
    ds_read_b128 v[228:231], v5 offset:8192
    v_exp_f32 v24, v186
    s_waitcnt lgkmcnt(12)
    v_mfma_f32_16x16x32_bf16 v[52:55], v[232:235], v[196:199], v[52:55]
    v_exp_f32 v25, v187
    v_mfma_f32_16x16x32_bf16 v[56:59], v[232:235], v[200:203], v[56:59]
    v_cvt_pk_bf16_f32 v210, v22, v23
    v_add_f32 v16, v16, v22
    v_mfma_f32_16x16x32_bf16 v[60:63], v[232:235], v[204:207], v[60:63]
    ds_read_b128 v[232:235], v6 offset:8192
    v_add_f32 v17, v17, v23
    v_exp_f32 v26, v188
    s_waitcnt lgkmcnt(11)
    v_mfma_f32_16x16x32_bf16 v[64:67], v[236:239], v[196:199], v[64:67]
    v_exp_f32 v27, v189
    v_mfma_f32_16x16x32_bf16 v[68:71], v[236:239], v[200:203], v[68:71]
    v_cvt_pk_bf16_f32 v211, v24, v25
    v_add_f32 v16, v16, v24
    v_mfma_f32_16x16x32_bf16 v[72:75], v[236:239], v[204:207], v[72:75]
    ds_read_b128 v[236:239], v7 offset:8192
    v_add_f32 v17, v17, v25
    v_exp_f32 v22, v190
    s_waitcnt lgkmcnt(10)
    v_mfma_f32_16x16x32_bf16 v[76:79], v[240:243], v[196:199], v[76:79]
    v_exp_f32 v23, v191
    v_mfma_f32_16x16x32_bf16 v[80:83], v[240:243], v[200:203], v[80:83]
    v_cvt_pk_bf16_f32 v214, v26, v27
    v_add_f32 v18, v18, v26
    v_mfma_f32_16x16x32_bf16 v[84:87], v[240:243], v[204:207], v[84:87]
    ds_read_b128 v[240:243], v4 offset:9216
    v_add_f32 v19, v19, v27
    v_exp_f32 v24, v192
    s_waitcnt lgkmcnt(9)
    v_mfma_f32_16x16x32_bf16 v[88:91], v[244:247], v[196:199], v[88:91]
    v_exp_f32 v25, v193
    v_mfma_f32_16x16x32_bf16 v[92:95], v[244:247], v[200:203], v[92:95]
    v_cvt_pk_bf16_f32 v215, v22, v23
    v_add_f32 v18, v18, v22
    v_mfma_f32_16x16x32_bf16 v[96:99], v[244:247], v[204:207], v[96:99]
    ds_read_b128 v[244:247], v5 offset:9216
    v_add_f32 v19, v19, v23
    v_exp_f32 v26, v194
    s_waitcnt lgkmcnt(8)
    v_mfma_f32_16x16x32_bf16 v[100:103], v[248:251], v[196:199], v[100:103]
    v_exp_f32 v27, v195
    v_mfma_f32_16x16x32_bf16 v[104:107], v[248:251], v[200:203], v[104:107]
    v_cvt_pk_bf16_f32 v218, v24, v25
    v_add_f32 v20, v20, v24
    v_mfma_f32_16x16x32_bf16 v[108:111], v[248:251], v[204:207], v[108:111]
    ds_read_b128 v[248:251], v6 offset:9216
    v_add_f32 v21, v21, v25
    s_waitcnt lgkmcnt(7)
    v_mfma_f32_16x16x32_bf16 v[112:115], v[252:255], v[196:199], v[112:115]
    v_cvt_pk_bf16_f32 v219, v26, v27
    v_mfma_f32_16x16x32_bf16 v[116:119], v[252:255], v[200:203], v[116:119]
    v_add_f32 v20, v20, v26
    v_mfma_f32_16x16x32_bf16 v[120:123], v[252:255], v[204:207], v[120:123]
    ds_read_b128 v[252:255], v7 offset:9216
    v_add_f32 v21, v21, v27
    s_cmp_eq_u32 s43, 0
    s_cbranch_scc1 attn_kernel_a_skip3
    s_call_b64 s[54:55], attn_kernel_a_rare1
attn_kernel_a_skip3:
    s_waitcnt lgkmcnt(7)
    v_mfma_f32_16x16x32_bf16 v[172:175], v[224:227], v[124:127], 0
    v_mfma_f32_16x16x32_bf16 v[176:179], v[224:227], v[128:131], 0
    v_mfma_f32_16x16x32_bf16 v[180:183], v[224:227], v[132:135], 0
    s_waitcnt lgkmcnt(6)
    v_mfma_f32_16x16x32_bf16 v[172:175], v[228:231], v[136:139], v[172:175]
    v_mfma_f32_16x16x32_bf16 v[176:179], v[228:231], v[140:143], v[176:179]
    v_mfma_f32_16x16x32_bf16 v[180:183], v[228:231], v[144:147], v[180:183]
    s_waitcnt lgkmcnt(5)
    v_mfma_f32_16x16x32_bf16 v[172:175], v[232:235], v[148:151], v[172:175]
    v_mfma_f32_16x16x32_bf16 v[176:179], v[232:235], v[152:155], v[176:179]
    v_mfma_f32_16x16x32_bf16 v[180:183], v[232:235], v[156:159], v[180:183]
    s_waitcnt lgkmcnt(4)
    v_mfma_f32_16x16x32_bf16 v[172:175], v[236:239], v[160:163], v[172:175]
    v_mfma_f32_16x16x32_bf16 v[176:179], v[236:239], v[164:167], v[176:179]
    v_mfma_f32_16x16x32_bf16 v[180:183], v[236:239], v[168:171], v[180:183]
    s_waitcnt lgkmcnt(3)
    v_mfma_f32_16x16x32_bf16 v[184:187], v[240:243], v[124:127], 0
    v_mfma_f32_16x16x32_bf16 v[188:191], v[240:243], v[128:131], 0
    v_mfma_f32_16x16x32_bf16 v[192:195], v[240:243], v[132:135], 0
    s_waitcnt lgkmcnt(0)
    s_barrier
    ds_read_b64_tr_b16 v[224:225], v8 offset:16384
    ds_read_b64_tr_b16 v[226:227], v8 offset:17408
    v_mfma_f32_16x16x32_bf16 v[184:187], v[244:247], v[136:139], v[184:187]
    ds_read_b64_tr_b16 v[228:229], v9 offset:16384
    ds_read_b64_tr_b16 v[230:231], v9 offset:17408
    v_exp_f32 v22, v172
    v_exp_f32 v23, v173
    v_mfma_f32_16x16x32_bf16 v[188:191], v[244:247], v[140:143], v[188:191]
    ds_read_b64_tr_b16 v[232:233], v10 offset:16384
    ds_read_b64_tr_b16 v[234:235], v10 offset:17408
    v_exp_f32 v24, v174
    v_exp_f32 v25, v175
    v_mfma_f32_16x16x32_bf16 v[192:195], v[244:247], v[144:147], v[192:195]
    ds_read_b64_tr_b16 v[236:237], v11 offset:16384
    ds_read_b64_tr_b16 v[238:239], v11 offset:17408
    v_cvt_pk_bf16_f32 v196, v22, v23
    v_add_f32 v16, v16, v22
    v_add_f32 v17, v17, v23
    v_mfma_f32_16x16x32_bf16 v[184:187], v[248:251], v[148:151], v[184:187]
    ds_read_b64_tr_b16 v[240:241], v12 offset:16384
    ds_read_b64_tr_b16 v[242:243], v12 offset:17408
    v_exp_f32 v26, v176
    v_exp_f32 v27, v177
    v_mfma_f32_16x16x32_bf16 v[188:191], v[248:251], v[152:155], v[188:191]
    ds_read_b64_tr_b16 v[244:245], v13 offset:16384
    ds_read_b64_tr_b16 v[246:247], v13 offset:17408
    v_cvt_pk_bf16_f32 v197, v24, v25
    v_add_f32 v16, v16, v24
    v_add_f32 v17, v17, v25
    v_mfma_f32_16x16x32_bf16 v[192:195], v[248:251], v[156:159], v[192:195]
    ds_read_b64_tr_b16 v[248:249], v14 offset:16384
    ds_read_b64_tr_b16 v[250:251], v14 offset:17408
    v_exp_f32 v22, v178
    v_exp_f32 v23, v179
    v_mfma_f32_16x16x32_bf16 v[184:187], v[252:255], v[160:163], v[184:187]
    v_cvt_pk_bf16_f32 v200, v26, v27
    v_add_f32 v18, v18, v26
    v_add_f32 v19, v19, v27
    v_mfma_f32_16x16x32_bf16 v[188:191], v[252:255], v[164:167], v[188:191]
    v_exp_f32 v24, v180
    v_exp_f32 v25, v181
    v_mfma_f32_16x16x32_bf16 v[192:195], v[252:255], v[168:171], v[192:195]
    ds_read_b64_tr_b16 v[252:253], v15 offset:16384
    ds_read_b64_tr_b16 v[254:255], v15 offset:17408
    v_cvt_pk_bf16_f32 v201, v22, v23
    v_add_f32 v18, v18, v22
    v_add_f32 v19, v19, v23
    s_waitcnt lgkmcnt(14)
    v_mfma_f32_16x16x32_bf16 v[28:31], v[224:227], v[208:211], v[28:31]
    v_exp_f32 v26, v182
    v_exp_f32 v27, v183
    v_mfma_f32_16x16x32_bf16 v[32:35], v[224:227], v[212:215], v[32:35]
    v_cvt_pk_bf16_f32 v204, v24, v25
    v_add_f32 v20, v20, v24
    v_add_f32 v21, v21, v25
    v_mfma_f32_16x16x32_bf16 v[36:39], v[224:227], v[216:219], v[36:39]
    ds_read_b128 v[224:227], v4 offset:24576
    v_cvt_pk_bf16_f32 v205, v26, v27
    v_add_f32 v20, v20, v26
    v_add_f32 v21, v21, v27
    s_waitcnt lgkmcnt(13)
    v_mfma_f32_16x16x32_bf16 v[40:43], v[228:231], v[208:211], v[40:43]
    v_exp_f32 v22, v184
    v_mfma_f32_16x16x32_bf16 v[44:47], v[228:231], v[212:215], v[44:47]
    v_exp_f32 v23, v185
    v_mfma_f32_16x16x32_bf16 v[48:51], v[228:231], v[216:219], v[48:51]
    ds_read_b128 v[228:231], v5 offset:24576
    v_exp_f32 v24, v186
    s_waitcnt lgkmcnt(12)
    v_mfma_f32_16x16x32_bf16 v[52:55], v[232:235], v[208:211], v[52:55]
    v_exp_f32 v25, v187
    v_mfma_f32_16x16x32_bf16 v[56:59], v[232:235], v[212:215], v[56:59]
    v_cvt_pk_bf16_f32 v198, v22, v23
    v_add_f32 v16, v16, v22
    v_mfma_f32_16x16x32_bf16 v[60:63], v[232:235], v[216:219], v[60:63]
    ds_read_b128 v[232:235], v6 offset:24576
    v_add_f32 v17, v17, v23
    v_exp_f32 v26, v188
    s_waitcnt lgkmcnt(11)
    v_mfma_f32_16x16x32_bf16 v[64:67], v[236:239], v[208:211], v[64:67]
    v_exp_f32 v27, v189
    v_mfma_f32_16x16x32_bf16 v[68:71], v[236:239], v[212:215], v[68:71]
    v_cvt_pk_bf16_f32 v199, v24, v25
    v_add_f32 v16, v16, v24
    v_mfma_f32_16x16x32_bf16 v[72:75], v[236:239], v[216:219], v[72:75]
    ds_read_b128 v[236:239], v7 offset:24576
    v_add_f32 v17, v17, v25
    v_exp_f32 v22, v190
    s_waitcnt lgkmcnt(10)
    v_mfma_f32_16x16x32_bf16 v[76:79], v[240:243], v[208:211], v[76:79]
    v_exp_f32 v23, v191
    v_mfma_f32_16x16x32_bf16 v[80:83], v[240:243], v[212:215], v[80:83]
    v_cvt_pk_bf16_f32 v202, v26, v27
    v_add_f32 v18, v18, v26
    v_mfma_f32_16x16x32_bf16 v[84:87], v[240:243], v[216:219], v[84:87]
    ds_read_b128 v[240:243], v4 offset:25600
    v_add_f32 v19, v19, v27
    v_exp_f32 v24, v192
    s_waitcnt lgkmcnt(9)
    v_mfma_f32_16x16x32_bf16 v[88:91], v[244:247], v[208:211], v[88:91]
    v_exp_f32 v25, v193
    v_mfma_f32_16x16x32_bf16 v[92:95], v[244:247], v[212:215], v[92:95]
    v_cvt_pk_bf16_f32 v203, v22, v23
    v_add_f32 v18, v18, v22
    v_mfma_f32_16x16x32_bf16 v[96:99], v[244:247], v[216:219], v[96:99]
    ds_read_b128 v[244:247], v5 offset:25600
    v_add_f32 v19, v19, v23
    v_exp_f32 v26, v194
    s_waitcnt lgkmcnt(8)
    v_mfma_f32_16x16x32_bf16 v[100:103], v[248:251], v[208:211], v[100:103]
    v_exp_f32 v27, v195
    v_mfma_f32_16x16x32_bf16 v[104:107], v[248:251], v[212:215], v[104:107]
    v_cvt_pk_bf16_f32 v206, v24, v25
    v_add_f32 v20, v20, v24
    v_mfma_f32_16x16x32_bf16 v[108:111], v[248:251], v[216:219], v[108:111]
    ds_read_b128 v[248:251], v6 offset:25600
    v_add_f32 v21, v21, v25
    s_waitcnt lgkmcnt(7)
    v_mfma_f32_16x16x32_bf16 v[112:115], v[252:255], v[208:211], v[112:115]
    v_cvt_pk_bf16_f32 v207, v26, v27
    v_mfma_f32_16x16x32_bf16 v[116:119], v[252:255], v[212:215], v[116:119]
    v_add_f32 v20, v20, v26
    v_mfma_f32_16x16x32_bf16 v[120:123], v[252:255], v[216:219], v[120:123]
    ds_read_b128 v[252:255], v7 offset:25600
    v_add_f32 v21, v21, v27
    s_cmp_eq_u32 s43, 0
    s_cbranch_scc1 attn_kernel_a_skip4
    s_call_b64 s[54:55], attn_kernel_a_rare0
attn_kernel_a_skip4:
    s_waitcnt lgkmcnt(7)
    v_mfma_f32_16x16x32_bf16 v[172:175], v[224:227], v[124:127], 0
    v_mfma_f32_16x16x32_bf16 v[176:179], v[224:227], v[128:131], 0
    v_mfma_f32_16x16x32_bf16 v[180:183], v[224:227], v[132:135], 0
    s_waitcnt lgkmcnt(6)
    v_mfma_f32_16x16x32_bf16 v[172:175], v[228:231], v[136:139], v[172:175]
    v_mfma_f32_16x16x32_bf16 v[176:179], v[228:231], v[140:143], v[176:179]
    v_mfma_f32_16x16x32_bf16 v[180:183], v[228:231], v[144:147], v[180:183]
    s_waitcnt lgkmcnt(5)
    v_mfma_f32_16x16x32_bf16 v[172:175], v[232:235], v[148:151], v[172:175]
    v_mfma_f32_16x16x32_bf16 v[176:179], v[232:235], v[152:155], v[176:179]
    v_mfma_f32_16x16x32_bf16 v[180:183], v[232:235], v[156:159], v[180:183]
    s_waitcnt lgkmcnt(4)
    v_mfma_f32_16x16x32_bf16 v[172:175], v[236:239], v[160:163], v[172:175]
    v_mfma_f32_16x16x32_bf16 v[176:179], v[236:239], v[164:167], v[176:179]
    v_mfma_f32_16x16x32_bf16 v[180:183], v[236:239], v[168:171], v[180:183]
    s_waitcnt lgkmcnt(3)
    v_mfma_f32_16x16x32_bf16 v[184:187], v[240:243], v[124:127], 0
    v_mfma_f32_16x16x32_bf16 v[188:191], v[240:243], v[128:131], 0
    v_mfma_f32_16x16x32_bf16 v[192:195], v[240:243], v[132:135], 0
    s_waitcnt lgkmcnt(0)
    s_barrier
    ds_read_b64_tr_b16 v[224:225], v8 offset:32768
    ds_read_b64_tr_b16 v[226:227], v8 offset:33792
    v_mfma_f32_16x16x32_bf16 v[184:187], v[244:247], v[136:139], v[184:187]
    ds_read_b64_tr_b16 v[228:229], v9 offset:32768
    ds_read_b64_tr_b16 v[230:231], v9 offset:33792
    v_exp_f32 v22, v172
    v_exp_f32 v23, v173
    v_mfma_f32_16x16x32_bf16 v[188:191], v[244:247], v[140:143], v[188:191]
    ds_read_b64_tr_b16 v[232:233], v10 offset:32768
    ds_read_b64_tr_b16 v[234:235], v10 offset:33792
    v_exp_f32 v24, v174
    v_exp_f32 v25, v175
    v_mfma_f32_16x16x32_bf16 v[192:195], v[244:247], v[144:147], v[192:195]
    ds_read_b64_tr_b16 v[236:237], v11 offset:32768
    ds_read_b64_tr_b16 v[238:239], v11 offset:33792
    v_cvt_pk_bf16_f32 v208, v22, v23
    v_add_f32 v16, v16, v22
    v_add_f32 v17, v17, v23
    v_mfma_f32_16x16x32_bf16 v[184:187], v[248:251], v[148:151], v[184:187]
    ds_read_b64_tr_b16 v[240:241], v12 offset:32768
    ds_read_b64_tr_b16 v[242:243], v12 offset:33792
    v_exp_f32 v26, v176
    v_exp_f32 v27, v177
    v_mfma_f32_16x16x32_bf16 v[188:191], v[248:251], v[152:155], v[188:191]
    ds_read_b64_tr_b16 v[244:245], v13 offset:32768
    ds_read_b64_tr_b16 v[246:247], v13 offset:33792
    v_cvt_pk_bf16_f32 v209, v24, v25
    v_add_f32 v16, v16, v24
    v_add_f32 v17, v17, v25
    v_mfma_f32_16x16x32_bf16 v[192:195], v[248:251], v[156:159], v[192:195]
    ds_read_b64_tr_b16 v[248:249], v14 offset:32768
    ds_read_b64_tr_b16 v[250:251], v14 offset:33792
    v_exp_f32 v22, v178
    v_exp_f32 v23, v179
    v_mfma_f32_16x16x32_bf16 v[184:187], v[252:255], v[160:163], v[184:187]
    v_cvt_pk_bf16_f32 v212, v26, v27
    v_add_f32 v18, v18, v26
    v_add_f32 v19, v19, v27
    v_mfma_f32_16x16x32_bf16 v[188:191], v[252:255], v[164:167], v[188:191]
    v_exp_f32 v24, v180
    v_exp_f32 v25, v181
    v_mfma_f32_16x16x32_bf16 v[192:195], v[252:255], v[168:171], v[192:195]
    ds_read_b64_tr_b16 v[252:253], v15 offset:32768
    ds_read_b64_tr_b16 v[254:255], v15 offset:33792
    v_cvt_pk_bf16_f32 v213, v22, v23
    v_add_f32 v18, v18, v22
    v_add_f32 v19, v19, v23
    s_waitcnt lgkmcnt(14)
    v_mfma_f32_16x16x32_bf16 v[28:31], v[224:227], v[196:199], v[28:31]
    v_exp_f32 v26, v182
    v_exp_f32 v27, v183
    v_mfma_f32_16x16x32_bf16 v[32:35], v[224:227], v[200:203], v[32:35]
    v_cvt_pk_bf16_f32 v216, v24, v25
    v_add_f32 v20, v20, v24
    v_add_f32 v21, v21, v25
    v_mfma_f32_16x16x32_bf16 v[36:39], v[224:227], v[204:207], v[36:39]
    ds_read_b128 v[224:227], v4 offset:40960
    v_cvt_pk_bf16_f32 v217, v26, v27
    v_add_f32 v20, v20, v26
    v_add_f32 v21, v21, v27
    s_waitcnt lgkmcnt(13)
    v_mfma_f32_16x16x32_bf16 v[40:43], v[228:231], v[196:199], v[40:43]
    v_exp_f32 v22, v184
    v_mfma_f32_16x16x32_bf16 v[44:47], v[228:231], v[200:203], v[44:47]
    v_exp_f32 v23, v185
    v_mfma_f32_16x16x32_bf16 v[48:51], v[228:231], v[204:207], v[48:51]
    ds_read_b128 v[228:231], v5 offset:40960
    v_exp_f32 v24, v186
    s_waitcnt lgkmcnt(12)
    v_mfma_f32_16x16x32_bf16 v[52:55], v[232:235], v[196:199], v[52:55]
    v_exp_f32 v25, v187
    v_mfma_f32_16x16x32_bf16 v[56:59], v[232:235], v[200:203], v[56:59]
    v_cvt_pk_bf16_f32 v210, v22, v23
    v_add_f32 v16, v16, v22
    v_mfma_f32_16x16x32_bf16 v[60:63], v[232:235], v[204:207], v[60:63]
    ds_read_b128 v[232:235], v6 offset:40960
    v_add_f32 v17, v17, v23
    v_exp_f32 v26, v188
    s_waitcnt lgkmcnt(11)
    v_mfma_f32_16x16x32_bf16 v[64:67], v[236:239], v[196:199], v[64:67]
    v_exp_f32 v27, v189
    v_mfma_f32_16x16x32_bf16 v[68:71], v[236:239], v[200:203], v[68:71]
    v_cvt_pk_bf16_f32 v211, v24, v25
    v_add_f32 v16, v16, v24
    v_mfma_f32_16x16x32_bf16 v[72:75], v[236:239], v[204:207], v[72:75]
    ds_read_b128 v[236:239], v7 offset:40960
    v_add_f32 v17, v17, v25
    v_exp_f32 v22, v190
    s_waitcnt lgkmcnt(10)
    v_mfma_f32_16x16x32_bf16 v[76:79], v[240:243], v[196:199], v[76:79]
    v_exp_f32 v23, v191
    v_mfma_f32_16x16x32_bf16 v[80:83], v[240:243], v[200:203], v[80:83]
    v_cvt_pk_bf16_f32 v214, v26, v27
    v_add_f32 v18, v18, v26
    v_mfma_f32_16x16x32_bf16 v[84:87], v[240:243], v[204:207], v[84:87]
    ds_read_b128 v[240:243], v4 offset:41984
    v_add_f32 v19, v19, v27
    v_exp_f32 v24, v192
    s_waitcnt lgkmcnt(9)
    v_mfma_f32_16x16x32_bf16 v[88:91], v[244:247], v[196:199], v[88:91]
    v_exp_f32 v25, v193
    v_mfma_f32_16x16x32_bf16 v[92:95], v[244:247], v[200:203], v[92:95]
    v_cvt_pk_bf16_f32 v215, v22, v23
    v_add_f32 v18, v18, v22
    v_mfma_f32_16x16x32_bf16 v[96:99], v[244:247], v[204:207], v[96:99]
    ds_read_b128 v[244:247], v5 offset:41984
    v_add_f32 v19, v19, v23
    v_exp_f32 v26, v194
    s_waitcnt lgkmcnt(8)
    v_mfma_f32_16x16x32_bf16 v[100:103], v[248:251], v[196:199], v[100:103]
    v_exp_f32 v27, v195
    v_mfma_f32_16x16x32_bf16 v[104:107], v[248:251], v[200:203], v[104:107]
    v_cvt_pk_bf16_f32 v218, v24, v25
    v_add_f32 v20, v20, v24
    v_mfma_f32_16x16x32_bf16 v[108:111], v[248:251], v[204:207], v[108:111]
    ds_read_b128 v[248:251], v6 offset:41984
    v_add_f32 v21, v21, v25
    s_waitcnt lgkmcnt(7)
    v_mfma_f32_16x16x32_bf16 v[112:115], v[252:255], v[196:199], v[112:115]
    v_cvt_pk_bf16_f32 v219, v26, v27
    v_mfma_f32_16x16x32_bf16 v[116:119], v[252:255], v[200:203], v[116:119]
    v_add_f32 v20, v20, v26
    v_mfma_f32_16x16x32_bf16 v[120:123], v[252:255], v[204:207], v[120:123]
    ds_read_b128 v[252:255], v7 offset:41984
    v_add_f32 v21, v21, v27
    s_cmp_eq_u32 s43, 0
    s_cbranch_scc1 attn_kernel_a_skip5
    s_call_b64 s[54:55], attn_kernel_a_rare1
attn_kernel_a_skip5:
    s_waitcnt lgkmcnt(7)
    v_mfma_f32_16x16x32_bf16 v[172:175], v[224:227], v[124:127], 0
    v_mfma_f32_16x16x32_bf16 v[176:179], v[224:227], v[128:131], 0
    v_mfma_f32_16x16x32_bf16 v[180:183], v[224:227], v[132:135], 0
    s_waitcnt lgkmcnt(6)
    v_mfma_f32_16x16x32_bf16 v[172:175], v[228:231], v[136:139], v[172:175]
    v_mfma_f32_16x16x32_bf16 v[176:179], v[228:231], v[140:143], v[176:179]
    v_mfma_f32_16x16x32_bf16 v[180:183], v[228:231], v[144:147], v[180:183]
    s_waitcnt lgkmcnt(5)
    v_mfma_f32_16x16x32_bf16 v[172:175], v[232:235], v[148:151], v[172:175]
    v_mfma_f32_16x16x32_bf16 v[176:179], v[232:235], v[152:155], v[176:179]
    v_mfma_f32_16x16x32_bf16 v[180:183], v[232:235], v[156:159], v[180:183]
    s_waitcnt lgkmcnt(4)
    v_mfma_f32_16x16x32_bf16 v[172:175], v[236:239], v[160:163], v[172:175]
    v_mfma_f32_16x16x32_bf16 v[176:179], v[236:239], v[164:167], v[176:179]
    v_mfma_f32_16x16x32_bf16 v[180:183], v[236:239], v[168:171], v[180:183]
    s_waitcnt lgkmcnt(3)
    v_mfma_f32_16x16x32_bf16 v[184:187], v[240:243], v[124:127], 0
    v_mfma_f32_16x16x32_bf16 v[188:191], v[240:243], v[128:131], 0
    v_mfma_f32_16x16x32_bf16 v[192:195], v[240:243], v[132:135], 0
    s_waitcnt lgkmcnt(0)
    s_barrier
    ds_read_b64_tr_b16 v[224:225], v8 offset:49152
    ds_read_b64_tr_b16 v[226:227], v8 offset:50176
    v_mfma_f32_16x16x32_bf16 v[184:187], v[244:247], v[136:139], v[184:187]
    ds_read_b64_tr_b16 v[228:229], v9 offset:49152
    ds_read_b64_tr_b16 v[230:231], v9 offset:50176
    v_exp_f32 v22, v172
    v_exp_f32 v23, v173
    v_mfma_f32_16x16x32_bf16 v[188:191], v[244:247], v[140:143], v[188:191]
    ds_read_b64_tr_b16 v[232:233], v10 offset:49152
    ds_read_b64_tr_b16 v[234:235], v10 offset:50176
    v_exp_f32 v24, v174
    v_exp_f32 v25, v175
    v_mfma_f32_16x16x32_bf16 v[192:195], v[244:247], v[144:147], v[192:195]
    ds_read_b64_tr_b16 v[236:237], v11 offset:49152
    ds_read_b64_tr_b16 v[238:239], v11 offset:50176
    v_cvt_pk_bf16_f32 v196, v22, v23
    v_add_f32 v16, v16, v22
    v_add_f32 v17, v17, v23
    v_mfma_f32_16x16x32_bf16 v[184:187], v[248:251], v[148:151], v[184:187]
    ds_read_b64_tr_b16 v[240:241], v12 offset:49152
    ds_read_b64_tr_b16 v[242:243], v12 offset:50176
    v_exp_f32 v26, v176
    v_exp_f32 v27, v177
    v_mfma_f32_16x16x32_bf16 v[188:191], v[248:251], v[152:155], v[188:191]
    ds_read_b64_tr_b16 v[244:245], v13 offset:49152
    ds_read_b64_tr_b16 v[246:247], v13 offset:50176
    v_cvt_pk_bf16_f32 v197, v24, v25
    v_add_f32 v16, v16, v24
    v_add_f32 v17, v17, v25
    v_mfma_f32_16x16x32_bf16 v[192:195], v[248:251], v[156:159], v[192:195]
    ds_read_b64_tr_b16 v[248:249], v14 offset:49152
    ds_read_b64_tr_b16 v[250:251], v14 offset:50176
    v_exp_f32 v22, v178
    v_exp_f32 v23, v179
    v_mfma_f32_16x16x32_bf16 v[184:187], v[252:255], v[160:163], v[184:187]
    v_cvt_pk_bf16_f32 v200, v26, v27
    v_add_f32 v18, v18, v26
    v_add_f32 v19, v19, v27
    v_mfma_f32_16x16x32_bf16 v[188:191], v[252:255], v[164:167], v[188:191]
    v_exp_f32 v24, v180
    v_exp_f32 v25, v181
    v_mfma_f32_16x16x32_bf16 v[192:195], v[252:255], v[168:171], v[192:195]
    ds_read_b64_tr_b16 v[252:253], v15 offset:49152
    ds_read_b64_tr_b16 v[254:255], v15 offset:50176
    v_cvt_pk_bf16_f32 v201, v22, v23
    v_add_f32 v18, v18, v22
    v_add_f32 v19, v19, v23
    s_waitcnt lgkmcnt(14)
    v_mfma_f32_16x16x32_bf16 v[28:31], v[224:227], v[208:211], v[28:31]
    v_exp_f32 v26, v182
    v_exp_f32 v27, v183
    v_mfma_f32_16x16x32_bf16 v[32:35], v[224:227], v[212:215], v[32:35]
    v_cvt_pk_bf16_f32 v204, v24, v25
    v_add_f32 v20, v20, v24
    v_add_f32 v21, v21, v25
    v_mfma_f32_16x16x32_bf16 v[36:39], v[224:227], v[216:219], v[36:39]
    ds_read_b128 v[224:227], v4 offset:57344
    v_cvt_pk_bf16_f32 v205, v26, v27
    v_add_f32 v20, v20, v26
    v_add_f32 v21, v21, v27
    s_waitcnt lgkmcnt(13)
    v_mfma_f32_16x16x32_bf16 v[40:43], v[228:231], v[208:211], v[40:43]
    v_exp_f32 v22, v184
    v_mfma_f32_16x16x32_bf16 v[44:47], v[228:231], v[212:215], v[44:47]
    v_exp_f32 v23, v185
    v_mfma_f32_16x16x32_bf16 v[48:51], v[228:231], v[216:219], v[48:51]
    ds_read_b128 v[228:231], v5 offset:57344
    v_exp_f32 v24, v186
    s_waitcnt lgkmcnt(12)
    v_mfma_f32_16x16x32_bf16 v[52:55], v[232:235], v[208:211], v[52:55]
    v_exp_f32 v25, v187
    v_mfma_f32_16x16x32_bf16 v[56:59], v[232:235], v[212:215], v[56:59]
    v_cvt_pk_bf16_f32 v198, v22, v23
    v_add_f32 v16, v16, v22
    v_mfma_f32_16x16x32_bf16 v[60:63], v[232:235], v[216:219], v[60:63]
    ds_read_b128 v[232:235], v6 offset:57344
    v_add_f32 v17, v17, v23
    v_exp_f32 v26, v188
    s_waitcnt lgkmcnt(11)
    v_mfma_f32_16x16x32_bf16 v[64:67], v[236:239], v[208:211], v[64:67]
    v_exp_f32 v27, v189
    v_mfma_f32_16x16x32_bf16 v[68:71], v[236:239], v[212:215], v[68:71]
    v_cvt_pk_bf16_f32 v199, v24, v25
    v_add_f32 v16, v16, v24
    v_mfma_f32_16x16x32_bf16 v[72:75], v[236:239], v[216:219], v[72:75]
    ds_read_b128 v[236:239], v7 offset:57344
    v_add_f32 v17, v17, v25
    v_exp_f32 v22, v190
    s_waitcnt lgkmcnt(10)
    v_mfma_f32_16x16x32_bf16 v[76:79], v[240:243], v[208:211], v[76:79]
    v_exp_f32 v23, v191
    v_mfma_f32_16x16x32_bf16 v[80:83], v[240:243], v[212:215], v[80:83]
    v_cvt_pk_bf16_f32 v202, v26, v27
    v_add_f32 v18, v18, v26
    v_mfma_f32_16x16x32_bf16 v[84:87], v[240:243], v[216:219], v[84:87]
    ds_read_b128 v[240:243], v4 offset:58368
    v_add_f32 v19, v19, v27
    v_exp_f32 v24, v192
    s_waitcnt lgkmcnt(9)
    v_mfma_f32_16x16x32_bf16 v[88:91], v[244:247], v[208:211], v[88:91]
    v_exp_f32 v25, v193
    v_mfma_f32_16x16x32_bf16 v[92:95], v[244:247], v[212:215], v[92:95]
    v_cvt_pk_bf16_f32 v203, v22, v23
    v_add_f32 v18, v18, v22
    v_mfma_f32_16x16x32_bf16 v[96:99], v[244:247], v[216:219], v[96:99]
    ds_read_b128 v[244:247], v5 offset:58368
    v_add_f32 v19, v19, v23
    v_exp_f32 v26, v194
    s_waitcnt lgkmcnt(8)
    v_mfma_f32_16x16x32_bf16 v[100:103], v[248:251], v[208:211], v[100:103]
    v_exp_f32 v27, v195
    v_mfma_f32_16x16x32_bf16 v[104:107], v[248:251], v[212:215], v[104:107]
    v_cvt_pk_bf16_f32 v206, v24, v25
    v_add_f32 v20, v20, v24
    v_mfma_f32_16x16x32_bf16 v[108:111], v[248:251], v[216:219], v[108:111]
    ds_read_b128 v[248:251], v6 offset:58368
    v_add_f32 v21, v21, v25
    s_waitcnt lgkmcnt(7)
    v_mfma_f32_16x16x32_bf16 v[112:115], v[252:255], v[208:211], v[112:115]
    v_cvt_pk_bf16_f32 v207, v26, v27
    v_mfma_f32_16x16x32_bf16 v[116:119], v[252:255], v[212:215], v[116:119]
    v_add_f32 v20, v20, v26
    v_mfma_f32_16x16x32_bf16 v[120:123], v[252:255], v[216:219], v[120:123]
    ds_read_b128 v[252:255], v7 offset:58368
    v_add_f32 v21, v21, v27
    s_cmp_eq_u32 s43, 0
    s_cbranch_scc1 attn_kernel_a_skip6
    s_call_b64 s[54:55], attn_kernel_a_rare0
attn_kernel_a_skip6:
    s_waitcnt lgkmcnt(7)
    v_mfma_f32_16x16x32_bf16 v[172:175], v[224:227], v[124:127], 0
    v_mfma_f32_16x16x32_bf16 v[176:179], v[224:227], v[128:131], 0
    v_mfma_f32_16x16x32_bf16 v[180:183], v[224:227], v[132:135], 0
    s_waitcnt lgkmcnt(6)
    v_mfma_f32_16x16x32_bf16 v[172:175], v[228:231], v[136:139], v[172:175]
    v_mfma_f32_16x16x32_bf16 v[176:179], v[228:231], v[140:143], v[176:179]
    v_mfma_f32_16x16x32_bf16 v[180:183], v[228:231], v[144:147], v[180:183]
    s_waitcnt lgkmcnt(5)
    v_mfma_f32_16x16x32_bf16 v[172:175], v[232:235], v[148:151], v[172:175]
    v_mfma_f32_16x16x32_bf16 v[176:179], v[232:235], v[152:155], v[176:179]
    v_mfma_f32_16x16x32_bf16 v[180:183], v[232:235], v[156:159], v[180:183]
    s_waitcnt lgkmcnt(4)
    v_mfma_f32_16x16x32_bf16 v[172:175], v[236:239], v[160:163], v[172:175]
    v_mfma_f32_16x16x32_bf16 v[176:179], v[236:239], v[164:167], v[176:179]
    v_mfma_f32_16x16x32_bf16 v[180:183], v[236:239], v[168:171], v[180:183]
    s_waitcnt lgkmcnt(3)
    v_mfma_f32_16x16x32_bf16 v[184:187], v[240:243], v[124:127], 0
    v_mfma_f32_16x16x32_bf16 v[188:191], v[240:243], v[128:131], 0
    v_mfma_f32_16x16x32_bf16 v[192:195], v[240:243], v[132:135], 0
    s_waitcnt lgkmcnt(0)
    s_barrier
    ds_read_b64_tr_b16 v[224:225], v8 offset:0
    ds_read_b64_tr_b16 v[226:227], v8 offset:1024
    v_mfma_f32_16x16x32_bf16 v[184:187], v[244:247], v[136:139], v[184:187]
    ds_read_b64_tr_b16 v[228:229], v9 offset:0
    ds_read_b64_tr_b16 v[230:231], v9 offset:1024
    v_exp_f32 v22, v172
    v_exp_f32 v23, v173
    v_mfma_f32_16x16x32_bf16 v[188:191], v[244:247], v[140:143], v[188:191]
    ds_read_b64_tr_b16 v[232:233], v10 offset:0
    ds_read_b64_tr_b16 v[234:235], v10 offset:1024
    v_exp_f32 v24, v174
    v_exp_f32 v25, v175
    v_mfma_f32_16x16x32_bf16 v[192:195], v[244:247], v[144:147], v[192:195]
    ds_read_b64_tr_b16 v[236:237], v11 offset:0
    ds_read_b64_tr_b16 v[238:239], v11 offset:1024
    v_cvt_pk_bf16_f32 v208, v22, v23
    v_add_f32 v16, v16, v22
    v_add_f32 v17, v17, v23
    v_mfma_f32_16x16x32_bf16 v[184:187], v[248:251], v[148:151], v[184:187]
    ds_read_b64_tr_b16 v[240:241], v12 offset:0
    ds_read_b64_tr_b16 v[242:243], v12 offset:1024
    v_exp_f32 v26, v176
    v_exp_f32 v27, v177
    v_mfma_f32_16x16x32_bf16 v[188:191], v[248:251], v[152:155], v[188:191]
    ds_read_b64_tr_b16 v[244:245], v13 offset:0
    ds_read_b64_tr_b16 v[246:247], v13 offset:1024
    v_cvt_pk_bf16_f32 v209, v24, v25
    v_add_f32 v16, v16, v24
    v_add_f32 v17, v17, v25
    v_mfma_f32_16x16x32_bf16 v[192:195], v[248:251], v[156:159], v[192:195]
    ds_read_b64_tr_b16 v[248:249], v14 offset:0
    ds_read_b64_tr_b16 v[250:251], v14 offset:1024
    v_exp_f32 v22, v178
    v_exp_f32 v23, v179
    v_mfma_f32_16x16x32_bf16 v[184:187], v[252:255], v[160:163], v[184:187]
    v_cvt_pk_bf16_f32 v212, v26, v27
    v_add_f32 v18, v18, v26
    v_add_f32 v19, v19, v27
    v_mfma_f32_16x16x32_bf16 v[188:191], v[252:255], v[164:167], v[188:191]
    v_exp_f32 v24, v180
    v_exp_f32 v25, v181
    v_mfma_f32_16x16x32_bf16 v[192:195], v[252:255], v[168:171], v[192:195]
    ds_read_b64_tr_b16 v[252:253], v15 offset:0
    ds_read_b64_tr_b16 v[254:255], v15 offset:1024
    v_cvt_pk_bf16_f32 v213, v22, v23
    v_add_f32 v18, v18, v22
    v_add_f32 v19, v19, v23
    s_waitcnt lgkmcnt(14)
    v_mfma_f32_16x16x32_bf16 v[28:31], v[224:227], v[196:199], v[28:31]
    v_exp_f32 v26, v182
    v_exp_f32 v27, v183
    v_mfma_f32_16x16x32_bf16 v[32:35], v[224:227], v[200:203], v[32:35]
    v_cvt_pk_bf16_f32 v216, v24, v25
    v_add_f32 v20, v20, v24
    v_add_f32 v21, v21, v25
    v_mfma_f32_16x16x32_bf16 v[36:39], v[224:227], v[204:207], v[36:39]
    ds_read_b128 v[224:227], v4 offset:8192
    v_cvt_pk_bf16_f32 v217, v26, v27
    v_add_f32 v20, v20, v26
    v_add_f32 v21, v21, v27
    s_waitcnt lgkmcnt(13)
    v_mfma_f32_16x16x32_bf16 v[40:43], v[228:231], v[196:199], v[40:43]
    v_exp_f32 v22, v184
    v_mfma_f32_16x16x32_bf16 v[44:47], v[228:231], v[200:203], v[44:47]
    v_exp_f32 v23, v185
    v_mfma_f32_16x16x32_bf16 v[48:51], v[228:231], v[204:207], v[48:51]
    ds_read_b128 v[228:231], v5 offset:8192
    v_exp_f32 v24, v186
    s_waitcnt lgkmcnt(12)
    v_mfma_f32_16x16x32_bf16 v[52:55], v[232:235], v[196:199], v[52:55]
    v_exp_f32 v25, v187
    v_mfma_f32_16x16x32_bf16 v[56:59], v[232:235], v[200:203], v[56:59]
    v_cvt_pk_bf16_f32 v210, v22, v23
    v_add_f32 v16, v16, v22
    v_mfma_f32_16x16x32_bf16 v[60:63], v[232:235], v[204:207], v[60:63]
    ds_read_b128 v[232:235], v6 offset:8192
    v_add_f32 v17, v17, v23
    v_exp_f32 v26, v188
    s_waitcnt lgkmcnt(11)
    v_mfma_f32_16x16x32_bf16 v[64:67], v[236:239], v[196:199], v[64:67]
    v_exp_f32 v27, v189
    v_mfma_f32_16x16x32_bf16 v[68:71], v[236:239], v[200:203], v[68:71]
    v_cvt_pk_bf16_f32 v211, v24, v25
    v_add_f32 v16, v16, v24
    v_mfma_f32_16x16x32_bf16 v[72:75], v[236:239], v[204:207], v[72:75]
    ds_read_b128 v[236:239], v7 offset:8192
    v_add_f32 v17, v17, v25
    v_exp_f32 v22, v190
    s_waitcnt lgkmcnt(10)
    v_mfma_f32_16x16x32_bf16 v[76:79], v[240:243], v[196:199], v[76:79]
    v_exp_f32 v23, v191
    v_mfma_f32_16x16x32_bf16 v[80:83], v[240:243], v[200:203], v[80:83]
    v_cvt_pk_bf16_f32 v214, v26, v27
    v_add_f32 v18, v18, v26
    v_mfma_f32_16x16x32_bf16 v[84:87], v[240:243], v[204:207], v[84:87]
    ds_read_b128 v[240:243], v4 offset:9216
    v_add_f32 v19, v19, v27
    v_exp_f32 v24, v192
    s_waitcnt lgkmcnt(9)
    v_mfma_f32_16x16x32_bf16 v[88:91], v[244:247], v[196:199], v[88:91]
    v_exp_f32 v25, v193
    v_mfma_f32_16x16x32_bf16 v[92:95], v[244:247], v[200:203], v[92:95]
    v_cvt_pk_bf16_f32 v215, v22, v23
    v_add_f32 v18, v18, v22
    v_mfma_f32_16x16x32_bf16 v[96:99], v[244:247], v[204:207], v[96:99]
    ds_read_b128 v[244:247], v5 offset:9216
    v_add_f32 v19, v19, v23
    v_exp_f32 v26, v194
    s_waitcnt lgkmcnt(8)
    v_mfma_f32_16x16x32_bf16 v[100:103], v[248:251], v[196:199], v[100:103]
    v_exp_f32 v27, v195
    v_mfma_f32_16x16x32_bf16 v[104:107], v[248:251], v[200:203], v[104:107]
    v_cvt_pk_bf16_f32 v218, v24, v25
    v_add_f32 v20, v20, v24
    v_mfma_f32_16x16x32_bf16 v[108:111], v[248:251], v[204:207], v[108:111]
    ds_read_b128 v[248:251], v6 offset:9216
    v_add_f32 v21, v21, v25
    s_waitcnt lgkmcnt(7)
    v_mfma_f32_16x16x32_bf16 v[112:115], v[252:255], v[196:199], v[112:115]
    v_cvt_pk_bf16_f32 v219, v26, v27
    v_mfma_f32_16x16x32_bf16 v[116:119], v[252:255], v[200:203], v[116:119]
    v_add_f32 v20, v20, v26
    v_mfma_f32_16x16x32_bf16 v[120:123], v[252:255], v[204:207], v[120:123]
    ds_read_b128 v[252:255], v7 offset:9216
    v_add_f32 v21, v21, v27
    s_cmp_eq_u32 s43, 0
    s_cbranch_scc1 attn_kernel_a_skip7
    s_call_b64 s[54:55], attn_kernel_a_rare1
attn_kernel_a_skip7:
    s_waitcnt lgkmcnt(7)
    v_mfma_f32_16x16x32_bf16 v[172:175], v[224:227], v[124:127], 0
    v_mfma_f32_16x16x32_bf16 v[176:179], v[224:227], v[128:131], 0
    v_mfma_f32_16x16x32_bf16 v[180:183], v[224:227], v[132:135], 0
    s_waitcnt lgkmcnt(6)
    v_mfma_f32_16x16x32_bf16 v[172:175], v[228:231], v[136:139], v[172:175]
    v_mfma_f32_16x16x32_bf16 v[176:179], v[228:231], v[140:143], v[176:179]
    v_mfma_f32_16x16x32_bf16 v[180:183], v[228:231], v[144:147], v[180:183]
    s_waitcnt lgkmcnt(5)
    v_mfma_f32_16x16x32_bf16 v[172:175], v[232:235], v[148:151], v[172:175]
    v_mfma_f32_16x16x32_bf16 v[176:179], v[232:235], v[152:155], v[176:179]
    v_mfma_f32_16x16x32_bf16 v[180:183], v[232:235], v[156:159], v[180:183]
    s_waitcnt lgkmcnt(4)
    v_mfma_f32_16x16x32_bf16 v[172:175], v[236:239], v[160:163], v[172:175]
    v_mfma_f32_16x16x32_bf16 v[176:179], v[236:239], v[164:167], v[176:179]
    v_mfma_f32_16x16x32_bf16 v[180:183], v[236:239], v[168:171], v[180:183]
    s_waitcnt lgkmcnt(3)
    v_mfma_f32_16x16x32_bf16 v[184:187], v[240:243], v[124:127], 0
    v_mfma_f32_16x16x32_bf16 v[188:191], v[240:243], v[128:131], 0
    v_mfma_f32_16x16x32_bf16 v[192:195], v[240:243], v[132:135], 0
    s_waitcnt lgkmcnt(0)
    s_barrier
    ds_read_b64_tr_b16 v[224:225], v8 offset:16384
    ds_read_b64_tr_b16 v[226:227], v8 offset:17408
    v_mfma_f32_16x16x32_bf16 v[184:187], v[244:247], v[136:139], v[184:187]
    ds_read_b64_tr_b16 v[228:229], v9 offset:16384
    ds_read_b64_tr_b16 v[230:231], v9 offset:17408
    v_exp_f32 v22, v172
    v_exp_f32 v23, v173
    v_mfma_f32_16x16x32_bf16 v[188:191], v[244:247], v[140:143], v[188:191]
    ds_read_b64_tr_b16 v[232:233], v10 offset:16384
    ds_read_b64_tr_b16 v[234:235], v10 offset:17408
    v_exp_f32 v24, v174
    v_exp_f32 v25, v175
    v_mfma_f32_16x16x32_bf16 v[192:195], v[244:247], v[144:147], v[192:195]
    ds_read_b64_tr_b16 v[236:237], v11 offset:16384
    ds_read_b64_tr_b16 v[238:239], v11 offset:17408
    v_cvt_pk_bf16_f32 v196, v22, v23
    v_add_f32 v16, v16, v22
    v_add_f32 v17, v17, v23
    v_mfma_f32_16x16x32_bf16 v[184:187], v[248:251], v[148:151], v[184:187]
    ds_read_b64_tr_b16 v[240:241], v12 offset:16384
    ds_read_b64_tr_b16 v[242:243], v12 offset:17408
    v_exp_f32 v26, v176
    v_exp_f32 v27, v177
    v_mfma_f32_16x16x32_bf16 v[188:191], v[248:251], v[152:155], v[188:191]
    ds_read_b64_tr_b16 v[244:245], v13 offset:16384
    ds_read_b64_tr_b16 v[246:247], v13 offset:17408
    v_cvt_pk_bf16_f32 v197, v24, v25
    v_add_f32 v16, v16, v24
    v_add_f32 v17, v17, v25
    v_mfma_f32_16x16x32_bf16 v[192:195], v[248:251], v[156:159], v[192:195]
    ds_read_b64_tr_b16 v[248:249], v14 offset:16384
    ds_read_b64_tr_b16 v[250:251], v14 offset:17408
    v_exp_f32 v22, v178
    v_exp_f32 v23, v179
    v_mfma_f32_16x16x32_bf16 v[184:187], v[252:255], v[160:163], v[184:187]
    v_cvt_pk_bf16_f32 v200, v26, v27
    v_add_f32 v18, v18, v26
    v_add_f32 v19, v19, v27
    v_mfma_f32_16x16x32_bf16 v[188:191], v[252:255], v[164:167], v[188:191]
    v_exp_f32 v24, v180
    v_exp_f32 v25, v181
    v_mfma_f32_16x16x32_bf16 v[192:195], v[252:255], v[168:171], v[192:195]
    ds_read_b64_tr_b16 v[252:253], v15 offset:16384
    ds_read_b64_tr_b16 v[254:255], v15 offset:17408
    v_cvt_pk_bf16_f32 v201, v22, v23
    v_add_f32 v18, v18, v22
    v_add_f32 v19, v19, v23
    s_waitcnt lgkmcnt(14)
    v_mfma_f32_16x16x32_bf16 v[28:31], v[224:227], v[208:211], v[28:31]
    v_exp_f32 v26, v182
    v_exp_f32 v27, v183
    v_mfma_f32_16x16x32_bf16 v[32:35], v[224:227], v[212:215], v[32:35]
    v_cvt_pk_bf16_f32 v204, v24, v25
    v_add_f32 v20, v20, v24
    v_add_f32 v21, v21, v25
    v_mfma_f32_16x16x32_bf16 v[36:39], v[224:227], v[216:219], v[36:39]
    ds_read_b128 v[224:227], v4 offset:24576
    v_cvt_pk_bf16_f32 v205, v26, v27
    v_add_f32 v20, v20, v26
    v_add_f32 v21, v21, v27
    s_waitcnt lgkmcnt(13)
    v_mfma_f32_16x16x32_bf16 v[40:43], v[228:231], v[208:211], v[40:43]
    v_exp_f32 v22, v184
    v_mfma_f32_16x16x32_bf16 v[44:47], v[228:231], v[212:215], v[44:47]
    v_exp_f32 v23, v185
    v_mfma_f32_16x16x32_bf16 v[48:51], v[228:231], v[216:219], v[48:51]
    ds_read_b128 v[228:231], v5 offset:24576
    v_exp_f32 v24, v186
    s_waitcnt lgkmcnt(12)
    v_mfma_f32_16x16x32_bf16 v[52:55], v[232:235], v[208:211], v[52:55]
    v_exp_f32 v25, v187
    v_mfma_f32_16x16x32_bf16 v[56:59], v[232:235], v[212:215], v[56:59]
    v_cvt_pk_bf16_f32 v198, v22, v23
    v_add_f32 v16, v16, v22
    v_mfma_f32_16x16x32_bf16 v[60:63], v[232:235], v[216:219], v[60:63]
    ds_read_b128 v[232:235], v6 offset:24576
    v_add_f32 v17, v17, v23
    v_exp_f32 v26, v188
    s_waitcnt lgkmcnt(11)
    v_mfma_f32_16x16x32_bf16 v[64:67], v[236:239], v[208:211], v[64:67]
    v_exp_f32 v27, v189
    v_mfma_f32_16x16x32_bf16 v[68:71], v[236:239], v[212:215], v[68:71]
    v_cvt_pk_bf16_f32 v199, v24, v25
    v_add_f32 v16, v16, v24
    v_mfma_f32_16x16x32_bf16 v[72:75], v[236:239], v[216:219], v[72:75]
    ds_read_b128 v[236:239], v7 offset:24576
    v_add_f32 v17, v17, v25
    v_exp_f32 v22, v190
    s_waitcnt lgkmcnt(10)
    v_mfma_f32_16x16x32_bf16 v[76:79], v[240:243], v[208:211], v[76:79]
    v_exp_f32 v23, v191
    v_mfma_f32_16x16x32_bf16 v[80:83], v[240:243], v[212:215], v[80:83]
    v_cvt_pk_bf16_f32 v202, v26, v27
    v_add_f32 v18, v18, v26
    v_mfma_f32_16x16x32_bf16 v[84:87], v[240:243], v[216:219], v[84:87]
    ds_read_b128 v[240:243], v4 offset:25600
    v_add_f32 v19, v19, v27
    v_exp_f32 v24, v192
    s_waitcnt lgkmcnt(9)
    v_mfma_f32_16x16x32_bf16 v[88:91], v[244:247], v[208:211], v[88:91]
    v_exp_f32 v25, v193
    v_mfma_f32_16x16x32_bf16 v[92:95], v[244:247], v[212:215], v[92:95]
    v_cvt_pk_bf16_f32 v203, v22, v23
    v_add_f32 v18, v18, v22
    v_mfma_f32_16x16x32_bf16 v[96:99], v[244:247], v[216:219], v[96:99]
    ds_read_b128 v[244:247], v5 offset:25600
    v_add_f32 v19, v19, v23
    v_exp_f32 v26, v194
    s_waitcnt lgkmcnt(8)
    v_mfma_f32_16x16x32_bf16 v[100:103], v[248:251], v[208:211], v[100:103]
    v_exp_f32 v27, v195
    v_mfma_f32_16x16x32_bf16 v[104:107], v[248:251], v[212:215], v[104:107]
    v_cvt_pk_bf16_f32 v206, v24, v25
    v_add_f32 v20, v20, v24
    v_mfma_f32_16x16x32_bf16 v[108:111], v[248:251], v[216:219], v[108:111]
    ds_read_b128 v[248:251], v6 offset:25600
    v_add_f32 v21, v21, v25
    s_waitcnt lgkmcnt(7)
    v_mfma_f32_16x16x32_bf16 v[112:115], v[252:255], v[208:211], v[112:115]
    v_cvt_pk_bf16_f32 v207, v26, v27
    v_mfma_f32_16x16x32_bf16 v[116:119], v[252:255], v[212:215], v[116:119]
    v_add_f32 v20, v20, v26
    v_mfma_f32_16x16x32_bf16 v[120:123], v[252:255], v[216:219], v[120:123]
    ds_read_b128 v[252:255], v7 offset:25600
    v_add_f32 v21, v21, v27
    s_cmp_eq_u32 s43, 0
    s_cbranch_scc1 attn_kernel_a_skip8
    s_call_b64 s[54:55], attn_kernel_a_rare0
attn_kernel_a_skip8:
    s_waitcnt lgkmcnt(7)
    v_mfma_f32_16x16x32_bf16 v[172:175], v[224:227], v[124:127], 0
    v_mfma_f32_16x16x32_bf16 v[176:179], v[224:227], v[128:131], 0
    v_mfma_f32_16x16x32_bf16 v[180:183], v[224:227], v[132:135], 0
    s_waitcnt lgkmcnt(6)
    v_mfma_f32_16x16x32_bf16 v[172:175], v[228:231], v[136:139], v[172:175]
    v_mfma_f32_16x16x32_bf16 v[176:179], v[228:231], v[140:143], v[176:179]
    v_mfma_f32_16x16x32_bf16 v[180:183], v[228:231], v[144:147], v[180:183]
    s_waitcnt lgkmcnt(5)
    v_mfma_f32_16x16x32_bf16 v[172:175], v[232:235], v[148:151], v[172:175]
    v_mfma_f32_16x16x32_bf16 v[176:179], v[232:235], v[152:155], v[176:179]
    v_mfma_f32_16x16x32_bf16 v[180:183], v[232:235], v[156:159], v[180:183]
    s_waitcnt lgkmcnt(4)
    v_mfma_f32_16x16x32_bf16 v[172:175], v[236:239], v[160:163], v[172:175]
    v_mfma_f32_16x16x32_bf16 v[176:179], v[236:239], v[164:167], v[176:179]
    v_mfma_f32_16x16x32_bf16 v[180:183], v[236:239], v[168:171], v[180:183]
    s_waitcnt lgkmcnt(3)
    v_mfma_f32_16x16x32_bf16 v[184:187], v[240:243], v[124:127], 0
    v_mfma_f32_16x16x32_bf16 v[188:191], v[240:243], v[128:131], 0
    v_mfma_f32_16x16x32_bf16 v[192:195], v[240:243], v[132:135], 0
    s_waitcnt lgkmcnt(0)
    s_barrier
    ds_read_b64_tr_b16 v[224:225], v8 offset:32768
    ds_read_b64_tr_b16 v[226:227], v8 offset:33792
    v_mfma_f32_16x16x32_bf16 v[184:187], v[244:247], v[136:139], v[184:187]
    ds_read_b64_tr_b16 v[228:229], v9 offset:32768
    ds_read_b64_tr_b16 v[230:231], v9 offset:33792
    v_exp_f32 v22, v172
    v_exp_f32 v23, v173
    v_mfma_f32_16x16x32_bf16 v[188:191], v[244:247], v[140:143], v[188:191]
    ds_read_b64_tr_b16 v[232:233], v10 offset:32768
    ds_read_b64_tr_b16 v[234:235], v10 offset:33792
    v_exp_f32 v24, v174
    v_exp_f32 v25, v175
    v_mfma_f32_16x16x32_bf16 v[192:195], v[244:247], v[144:147], v[192:195]
    ds_read_b64_tr_b16 v[236:237], v11 offset:32768
    ds_read_b64_tr_b16 v[238:239], v11 offset:33792
    v_cvt_pk_bf16_f32 v208, v22, v23
    v_add_f32 v16, v16, v22
    v_add_f32 v17, v17, v23
    v_mfma_f32_16x16x32_bf16 v[184:187], v[248:251], v[148:151], v[184:187]
    ds_read_b64_tr_b16 v[240:241], v12 offset:32768
    ds_read_b64_tr_b16 v[242:243], v12 offset:33792
    v_exp_f32 v26, v176
    v_exp_f32 v27, v177
    v_mfma_f32_16x16x32_bf16 v[188:191], v[248:251], v[152:155], v[188:191]
    ds_read_b64_tr_b16 v[244:245], v13 offset:32768
    ds_read_b64_tr_b16 v[246:247], v13 offset:33792
    v_cvt_pk_bf16_f32 v209, v24, v25
    v_add_f32 v16, v16, v24
    v_add_f32 v17, v17, v25
    v_mfma_f32_16x16x32_bf16 v[192:195], v[248:251], v[156:159], v[192:195]
    ds_read_b64_tr_b16 v[248:249], v14 offset:32768
    ds_read_b64_tr_b16 v[250:251], v14 offset:33792
    v_exp_f32 v22, v178
    v_exp_f32 v23, v179
    v_mfma_f32_16x16x32_bf16 v[184:187], v[252:255], v[160:163], v[184:187]
    v_cvt_pk_bf16_f32 v212, v26, v27
    v_add_f32 v18, v18, v26
    v_add_f32 v19, v19, v27
    v_mfma_f32_16x16x32_bf16 v[188:191], v[252:255], v[164:167], v[188:191]
    v_exp_f32 v24, v180
    v_exp_f32 v25, v181
    v_mfma_f32_16x16x32_bf16 v[192:195], v[252:255], v[168:171], v[192:195]
    ds_read_b64_tr_b16 v[252:253], v15 offset:32768
    ds_read_b64_tr_b16 v[254:255], v15 offset:33792
    v_cvt_pk_bf16_f32 v213, v22, v23
    v_add_f32 v18, v18, v22
    v_add_f32 v19, v19, v23
    s_waitcnt lgkmcnt(14)
    v_mfma_f32_16x16x32_bf16 v[28:31], v[224:227], v[196:199], v[28:31]
    v_exp_f32 v26, v182
    v_exp_f32 v27, v183
    v_mfma_f32_16x16x32_bf16 v[32:35], v[224:227], v[200:203], v[32:35]
    v_cvt_pk_bf16_f32 v216, v24, v25
    v_add_f32 v20, v20, v24
    v_add_f32 v21, v21, v25
    v_mfma_f32_16x16x32_bf16 v[36:39], v[224:227], v[204:207], v[36:39]
    ds_read_b128 v[224:227], v4 offset:40960
    v_cvt_pk_bf16_f32 v217, v26, v27
    v_add_f32 v20, v20, v26
    v_add_f32 v21, v21, v27
    s_waitcnt lgkmcnt(13)
    v_mfma_f32_16x16x32_bf16 v[40:43], v[228:231], v[196:199], v[40:43]
    v_exp_f32 v22, v184
    v_mfma_f32_16x16x32_bf16 v[44:47], v[228:231], v[200:203], v[44:47]
    v_exp_f32 v23, v185
    v_mfma_f32_16x16x32_bf16 v[48:51], v[228:231], v[204:207], v[48:51]
    ds_read_b128 v[228:231], v5 offset:40960
    v_exp_f32 v24, v186
    s_waitcnt lgkmcnt(12)
    v_mfma_f32_16x16x32_bf16 v[52:55], v[232:235], v[196:199], v[52:55]
    v_exp_f32 v25, v187
    v_mfma_f32_16x16x32_bf16 v[56:59], v[232:235], v[200:203], v[56:59]
    v_cvt_pk_bf16_f32 v210, v22, v23
    v_add_f32 v16, v16, v22
    v_mfma_f32_16x16x32_bf16 v[60:63], v[232:235], v[204:207], v[60:63]
    ds_read_b128 v[232:235], v6 offset:40960
    v_add_f32 v17, v17, v23
    v_exp_f32 v26, v188
    s_waitcnt lgkmcnt(11)
    v_mfma_f32_16x16x32_bf16 v[64:67], v[236:239], v[196:199], v[64:67]
    v_exp_f32 v27, v189
    v_mfma_f32_16x16x32_bf16 v[68:71], v[236:239], v[200:203], v[68:71]
    v_cvt_pk_bf16_f32 v211, v24, v25
    v_add_f32 v16, v16, v24
    v_mfma_f32_16x16x32_bf16 v[72:75], v[236:239], v[204:207], v[72:75]
    ds_read_b128 v[236:239], v7 offset:40960
    v_add_f32 v17, v17, v25
    v_exp_f32 v22, v190
    s_waitcnt lgkmcnt(10)
    v_mfma_f32_16x16x32_bf16 v[76:79], v[240:243], v[196:199], v[76:79]
    v_exp_f32 v23, v191
    v_mfma_f32_16x16x32_bf16 v[80:83], v[240:243], v[200:203], v[80:83]
    v_cvt_pk_bf16_f32 v214, v26, v27
    v_add_f32 v18, v18, v26
    v_mfma_f32_16x16x32_bf16 v[84:87], v[240:243], v[204:207], v[84:87]
    ds_read_b128 v[240:243], v4 offset:41984
    v_add_f32 v19, v19, v27
    v_exp_f32 v24, v192
    s_waitcnt lgkmcnt(9)
    v_mfma_f32_16x16x32_bf16 v[88:91], v[244:247], v[196:199], v[88:91]
    v_exp_f32 v25, v193
    v_mfma_f32_16x16x32_bf16 v[92:95], v[244:247], v[200:203], v[92:95]
    v_cvt_pk_bf16_f32 v215, v22, v23
    v_add_f32 v18, v18, v22
    v_mfma_f32_16x16x32_bf16 v[96:99], v[244:247], v[204:207], v[96:99]
    ds_read_b128 v[244:247], v5 offset:41984
    v_add_f32 v19, v19, v23
    v_exp_f32 v26, v194
    s_waitcnt lgkmcnt(8)
    v_mfma_f32_16x16x32_bf16 v[100:103], v[248:251], v[196:199], v[100:103]
    v_exp_f32 v27, v195
    v_mfma_f32_16x16x32_bf16 v[104:107], v[248:251], v[200:203], v[104:107]
    v_cvt_pk_bf16_f32 v218, v24, v25
    v_add_f32 v20, v20, v24
    v_mfma_f32_16x16x32_bf16 v[108:111], v[248:251], v[204:207], v[108:111]
    ds_read_b128 v[248:251], v6 offset:41984
    v_add_f32 v21, v21, v25
    s_waitcnt lgkmcnt(7)
    v_mfma_f32_16x16x32_bf16 v[112:115], v[252:255], v[196:199], v[112:115]
    v_cvt_pk_bf16_f32 v219, v26, v27
    v_mfma_f32_16x16x32_bf16 v[116:119], v[252:255], v[200:203], v[116:119]
    v_add_f32 v20, v20, v26
    v_mfma_f32_16x16x32_bf16 v[120:123], v[252:255], v[204:207], v[120:123]
    ds_read_b128 v[252:255], v7 offset:41984
    v_add_f32 v21, v21, v27
    s_cmp_eq_u32 s43, 0
    s_cbranch_scc1 attn_kernel_a_skip9
    s_call_b64 s[54:55], attn_kernel_a_rare1
attn_kernel_a_skip9:
    s_waitcnt lgkmcnt(7)
    v_mfma_f32_16x16x32_bf16 v[172:175], v[224:227], v[124:127], 0
    v_mfma_f32_16x16x32_bf16 v[176:179], v[224:227], v[128:131], 0
    v_mfma_f32_16x16x32_bf16 v[180:183], v[224:227], v[132:135], 0
    s_waitcnt lgkmcnt(6)
    v_mfma_f32_16x16x32_bf16 v[172:175], v[228:231], v[136:139], v[172:175]
    v_mfma_f32_16x16x32_bf16 v[176:179], v[228:231], v[140:143], v[176:179]
    v_mfma_f32_16x16x32_bf16 v[180:183], v[228:231], v[144:147], v[180:183]
    s_waitcnt lgkmcnt(5)
    v_mfma_f32_16x16x32_bf16 v[172:175], v[232:235], v[148:151], v[172:175]
    v_mfma_f32_16x16x32_bf16 v[176:179], v[232:235], v[152:155], v[176:179]
    v_mfma_f32_16x16x32_bf16 v[180:183], v[232:235], v[156:159], v[180:183]
    s_waitcnt lgkmcnt(4)
    v_mfma_f32_16x16x32_bf16 v[172:175], v[236:239], v[160:163], v[172:175]
    v_mfma_f32_16x16x32_bf16 v[176:179], v[236:239], v[164:167], v[176:179]
    v_mfma_f32_16x16x32_bf16 v[180:183], v[236:239], v[168:171], v[180:183]
    s_waitcnt lgkmcnt(3)
    v_mfma_f32_16x16x32_bf16 v[184:187], v[240:243], v[124:127], 0
    v_mfma_f32_16x16x32_bf16 v[188:191], v[240:243], v[128:131], 0
    v_mfma_f32_16x16x32_bf16 v[192:195], v[240:243], v[132:135], 0
    s_waitcnt lgkmcnt(0)
    s_barrier
    ds_read_b64_tr_b16 v[224:225], v8 offset:49152
    ds_read_b64_tr_b16 v[226:227], v8 offset:50176
    v_mfma_f32_16x16x32_bf16 v[184:187], v[244:247], v[136:139], v[184:187]
    ds_read_b64_tr_b16 v[228:229], v9 offset:49152
    ds_read_b64_tr_b16 v[230:231], v9 offset:50176
    v_exp_f32 v22, v172
    v_exp_f32 v23, v173
    v_mfma_f32_16x16x32_bf16 v[188:191], v[244:247], v[140:143], v[188:191]
    ds_read_b64_tr_b16 v[232:233], v10 offset:49152
    ds_read_b64_tr_b16 v[234:235], v10 offset:50176
    v_exp_f32 v24, v174
    v_exp_f32 v25, v175
    v_mfma_f32_16x16x32_bf16 v[192:195], v[244:247], v[144:147], v[192:195]
    ds_read_b64_tr_b16 v[236:237], v11 offset:49152
    ds_read_b64_tr_b16 v[238:239], v11 offset:50176
    v_cvt_pk_bf16_f32 v196, v22, v23
    v_add_f32 v16, v16, v22
    v_add_f32 v17, v17, v23
    v_mfma_f32_16x16x32_bf16 v[184:187], v[248:251], v[148:151], v[184:187]
    ds_read_b64_tr_b16 v[240:241], v12 offset:49152
    ds_read_b64_tr_b16 v[242:243], v12 offset:50176
    v_exp_f32 v26, v176
    v_exp_f32 v27, v177
    v_mfma_f32_16x16x32_bf16 v[188:191], v[248:251], v[152:155], v[188:191]
    ds_read_b64_tr_b16 v[244:245], v13 offset:49152
    ds_read_b64_tr_b16 v[246:247], v13 offset:50176
    v_cvt_pk_bf16_f32 v197, v24, v25
    v_add_f32 v16, v16, v24
    v_add_f32 v17, v17, v25
    v_mfma_f32_16x16x32_bf16 v[192:195], v[248:251], v[156:159], v[192:195]
    ds_read_b64_tr_b16 v[248:249], v14 offset:49152
    ds_read_b64_tr_b16 v[250:251], v14 offset:50176
    v_exp_f32 v22, v178
    v_exp_f32 v23, v179
    v_mfma_f32_16x16x32_bf16 v[184:187], v[252:255], v[160:163], v[184:187]
    v_cvt_pk_bf16_f32 v200, v26, v27
    v_add_f32 v18, v18, v26
    v_add_f32 v19, v19, v27
    v_mfma_f32_16x16x32_bf16 v[188:191], v[252:255], v[164:167], v[188:191]
    v_exp_f32 v24, v180
    v_exp_f32 v25, v181
    v_mfma_f32_16x16x32_bf16 v[192:195], v[252:255], v[168:171], v[192:195]
    ds_read_b64_tr_b16 v[252:253], v15 offset:49152
    ds_read_b64_tr_b16 v[254:255], v15 offset:50176
    v_cvt_pk_bf16_f32 v201, v22, v23
    v_add_f32 v18, v18, v22
    v_add_f32 v19, v19, v23
    s_waitcnt lgkmcnt(14)
    v_mfma_f32_16x16x32_bf16 v[28:31], v[224:227], v[208:211], v[28:31]
    v_exp_f32 v26, v182
    v_exp_f32 v27, v183
    v_mfma_f32_16x16x32_bf16 v[32:35], v[224:227], v[212:215], v[32:35]
    v_cvt_pk_bf16_f32 v204, v24, v25
    v_add_f32 v20, v20, v24
    v_add_f32 v21, v21, v25
    v_mfma_f32_16x16x32_bf16 v[36:39], v[224:227], v[216:219], v[36:39]
    ds_read_b128 v[224:227], v4 offset:57344
    v_cvt_pk_bf16_f32 v205, v26, v27
    v_add_f32 v20, v20, v26
    v_add_f32 v21, v21, v27
    s_waitcnt lgkmcnt(13)
    v_mfma_f32_16x16x32_bf16 v[40:43], v[228:231], v[208:211], v[40:43]
    v_exp_f32 v22, v184
    v_mfma_f32_16x16x32_bf16 v[44:47], v[228:231], v[212:215], v[44:47]
    v_exp_f32 v23, v185
    v_mfma_f32_16x16x32_bf16 v[48:51], v[228:231], v[216:219], v[48:51]
    ds_read_b128 v[228:231], v5 offset:57344
    v_exp_f32 v24, v186
    s_waitcnt lgkmcnt(12)
    v_mfma_f32_16x16x32_bf16 v[52:55], v[232:235], v[208:211], v[52:55]
    v_exp_f32 v25, v187
    v_mfma_f32_16x16x32_bf16 v[56:59], v[232:235], v[212:215], v[56:59]
    v_cvt_pk_bf16_f32 v198, v22, v23
    v_add_f32 v16, v16, v22
    v_mfma_f32_16x16x32_bf16 v[60:63], v[232:235], v[216:219], v[60:63]
    ds_read_b128 v[232:235], v6 offset:57344
    v_add_f32 v17, v17, v23
    v_exp_f32 v26, v188
    s_waitcnt lgkmcnt(11)
    v_mfma_f32_16x16x32_bf16 v[64:67], v[236:239], v[208:211], v[64:67]
    v_exp_f32 v27, v189
    v_mfma_f32_16x16x32_bf16 v[68:71], v[236:239], v[212:215], v[68:71]
    v_cvt_pk_bf16_f32 v199, v24, v25
    v_add_f32 v16, v16, v24
    v_mfma_f32_16x16x32_bf16 v[72:75], v[236:239], v[216:219], v[72:75]
    ds_read_b128 v[236:239], v7 offset:57344
    v_add_f32 v17, v17, v25
    v_exp_f32 v22, v190
    s_waitcnt lgkmcnt(10)
    v_mfma_f32_16x16x32_bf16 v[76:79], v[240:243], v[208:211], v[76:79]
    v_exp_f32 v23, v191
    v_mfma_f32_16x16x32_bf16 v[80:83], v[240:243], v[212:215], v[80:83]
    v_cvt_pk_bf16_f32 v202, v26, v27
    v_add_f32 v18, v18, v26
    v_mfma_f32_16x16x32_bf16 v[84:87], v[240:243], v[216:219], v[84:87]
    ds_read_b128 v[240:243], v4 offset:58368
    v_add_f32 v19, v19, v27
    v_exp_f32 v24, v192
    s_waitcnt lgkmcnt(9)
    v_mfma_f32_16x16x32_bf16 v[88:91], v[244:247], v[208:211], v[88:91]
    v_exp_f32 v25, v193
    v_mfma_f32_16x16x32_bf16 v[92:95], v[244:247], v[212:215], v[92:95]
    v_cvt_pk_bf16_f32 v203, v22, v23
    v_add_f32 v18, v18, v22
    v_mfma_f32_16x16x32_bf16 v[96:99], v[244:247], v[216:219], v[96:99]
    ds_read_b128 v[244:247], v5 offset:58368
    v_add_f32 v19, v19, v23
    v_exp_f32 v26, v194
    s_waitcnt lgkmcnt(8)
    v_mfma_f32_16x16x32_bf16 v[100:103], v[248:251], v[208:211], v[100:103]
    v_exp_f32 v27, v195
    v_mfma_f32_16x16x32_bf16 v[104:107], v[248:251], v[212:215], v[104:107]
    v_cvt_pk_bf16_f32 v206, v24, v25
    v_add_f32 v20, v20, v24
    v_mfma_f32_16x16x32_bf16 v[108:111], v[248:251], v[216:219], v[108:111]
    ds_read_b128 v[248:251], v6 offset:58368
    v_add_f32 v21, v21, v25
    s_waitcnt lgkmcnt(7)
    v_mfma_f32_16x16x32_bf16 v[112:115], v[252:255], v[208:211], v[112:115]
    v_cvt_pk_bf16_f32 v207, v26, v27
    v_mfma_f32_16x16x32_bf16 v[116:119], v[252:255], v[212:215], v[116:119]
    v_add_f32 v20, v20, v26
    v_mfma_f32_16x16x32_bf16 v[120:123], v[252:255], v[216:219], v[120:123]
    ds_read_b128 v[252:255], v7 offset:58368
    v_add_f32 v21, v21, v27
    s_cmp_eq_u32 s43, 0
    s_cbranch_scc1 attn_kernel_a_skip10
    s_call_b64 s[54:55], attn_kernel_a_rare0
attn_kernel_a_skip10:
    s_waitcnt lgkmcnt(7)
    v_mfma_f32_16x16x32_bf16 v[172:175], v[224:227], v[124:127], 0
    v_mfma_f32_16x16x32_bf16 v[176:179], v[224:227], v[128:131], 0
    v_mfma_f32_16x16x32_bf16 v[180:183], v[224:227], v[132:135], 0
    s_waitcnt lgkmcnt(6)
    v_mfma_f32_16x16x32_bf16 v[172:175], v[228:231], v[136:139], v[172:175]
    v_mfma_f32_16x16x32_bf16 v[176:179], v[228:231], v[140:143], v[176:179]
    v_mfma_f32_16x16x32_bf16 v[180:183], v[228:231], v[144:147], v[180:183]
    s_waitcnt lgkmcnt(5)
    v_mfma_f32_16x16x32_bf16 v[172:175], v[232:235], v[148:151], v[172:175]
    v_mfma_f32_16x16x32_bf16 v[176:179], v[232:235], v[152:155], v[176:179]
    v_mfma_f32_16x16x32_bf16 v[180:183], v[232:235], v[156:159], v[180:183]
    s_waitcnt lgkmcnt(4)
    v_mfma_f32_16x16x32_bf16 v[172:175], v[236:239], v[160:163], v[172:175]
    v_mfma_f32_16x16x32_bf16 v[176:179], v[236:239], v[164:167], v[176:179]
    v_mfma_f32_16x16x32_bf16 v[180:183], v[236:239], v[168:171], v[180:183]
    s_waitcnt lgkmcnt(3)
    v_mfma_f32_16x16x32_bf16 v[184:187], v[240:243], v[124:127], 0
    v_mfma_f32_16x16x32_bf16 v[188:191], v[240:243], v[128:131], 0
    v_mfma_f32_16x16x32_bf16 v[192:195], v[240:243], v[132:135], 0
    s_waitcnt lgkmcnt(0)
    s_barrier
    ds_read_b64_tr_b16 v[224:225], v8 offset:0
    ds_read_b64_tr_b16 v[226:227], v8 offset:1024
    v_mfma_f32_16x16x32_bf16 v[184:187], v[244:247], v[136:139], v[184:187]
    ds_read_b64_tr_b16 v[228:229], v9 offset:0
    ds_read_b64_tr_b16 v[230:231], v9 offset:1024
    v_exp_f32 v22, v172
    v_exp_f32 v23, v173
    v_mfma_f32_16x16x32_bf16 v[188:191], v[244:247], v[140:143], v[188:191]
    ds_read_b64_tr_b16 v[232:233], v10 offset:0
    ds_read_b64_tr_b16 v[234:235], v10 offset:1024
    v_exp_f32 v24, v174
    v_exp_f32 v25, v175
    v_mfma_f32_16x16x32_bf16 v[192:195], v[244:247], v[144:147], v[192:195]
    ds_read_b64_tr_b16 v[236:237], v11 offset:0
    ds_read_b64_tr_b16 v[238:239], v11 offset:1024
    v_cvt_pk_bf16_f32 v208, v22, v23
    v_add_f32 v16, v16, v22
    v_add_f32 v17, v17, v23
    v_mfma_f32_16x16x32_bf16 v[184:187], v[248:251], v[148:151], v[184:187]
    ds_read_b64_tr_b16 v[240:241], v12 offset:0
    ds_read_b64_tr_b16 v[242:243], v12 offset:1024
    v_exp_f32 v26, v176
    v_exp_f32 v27, v177
    v_mfma_f32_16x16x32_bf16 v[188:191], v[248:251], v[152:155], v[188:191]
    ds_read_b64_tr_b16 v[244:245], v13 offset:0
    ds_read_b64_tr_b16 v[246:247], v13 offset:1024
    v_cvt_pk_bf16_f32 v209, v24, v25
    v_add_f32 v16, v16, v24
    v_add_f32 v17, v17, v25
    v_mfma_f32_16x16x32_bf16 v[192:195], v[248:251], v[156:159], v[192:195]
    ds_read_b64_tr_b16 v[248:249], v14 offset:0
    ds_read_b64_tr_b16 v[250:251], v14 offset:1024
    v_exp_f32 v22, v178
    v_exp_f32 v23, v179
    v_mfma_f32_16x16x32_bf16 v[184:187], v[252:255], v[160:163], v[184:187]
    v_cvt_pk_bf16_f32 v212, v26, v27
    v_add_f32 v18, v18, v26
    v_add_f32 v19, v19, v27
    v_mfma_f32_16x16x32_bf16 v[188:191], v[252:255], v[164:167], v[188:191]
    v_exp_f32 v24, v180
    v_exp_f32 v25, v181
    v_mfma_f32_16x16x32_bf16 v[192:195], v[252:255], v[168:171], v[192:195]
    ds_read_b64_tr_b16 v[252:253], v15 offset:0
    ds_read_b64_tr_b16 v[254:255], v15 offset:1024
    v_cvt_pk_bf16_f32 v213, v22, v23
    v_add_f32 v18, v18, v22
    v_add_f32 v19, v19, v23
    s_waitcnt lgkmcnt(14)
    v_mfma_f32_16x16x32_bf16 v[28:31], v[224:227], v[196:199], v[28:31]
    v_exp_f32 v26, v182
    v_exp_f32 v27, v183
    v_mfma_f32_16x16x32_bf16 v[32:35], v[224:227], v[200:203], v[32:35]
    v_cvt_pk_bf16_f32 v216, v24, v25
    v_add_f32 v20, v20, v24
    v_add_f32 v21, v21, v25
    v_mfma_f32_16x16x32_bf16 v[36:39], v[224:227], v[204:207], v[36:39]
    ds_read_b128 v[224:227], v4 offset:8192
    v_cvt_pk_bf16_f32 v217, v26, v27
    v_add_f32 v20, v20, v26
    v_add_f32 v21, v21, v27
    s_waitcnt lgkmcnt(13)
    v_mfma_f32_16x16x32_bf16 v[40:43], v[228:231], v[196:199], v[40:43]
    v_exp_f32 v22, v184
    v_mfma_f32_16x16x32_bf16 v[44:47], v[228:231], v[200:203], v[44:47]
    v_exp_f32 v23, v185
    v_mfma_f32_16x16x32_bf16 v[48:51], v[228:231], v[204:207], v[48:51]
    ds_read_b128 v[228:231], v5 offset:8192
    v_exp_f32 v24, v186
    s_waitcnt lgkmcnt(12)
    v_mfma_f32_16x16x32_bf16 v[52:55], v[232:235], v[196:199], v[52:55]
    v_exp_f32 v25, v187
    v_mfma_f32_16x16x32_bf16 v[56:59], v[232:235], v[200:203], v[56:59]
    v_cvt_pk_bf16_f32 v210, v22, v23
    v_add_f32 v16, v16, v22
    v_mfma_f32_16x16x32_bf16 v[60:63], v[232:235], v[204:207], v[60:63]
    ds_read_b128 v[232:235], v6 offset:8192
    v_add_f32 v17, v17, v23
    v_exp_f32 v26, v188
    s_waitcnt lgkmcnt(11)
    v_mfma_f32_16x16x32_bf16 v[64:67], v[236:239], v[196:199], v[64:67]
    v_exp_f32 v27, v189
    v_mfma_f32_16x16x32_bf16 v[68:71], v[236:239], v[200:203], v[68:71]
    v_cvt_pk_bf16_f32 v211, v24, v25
    v_add_f32 v16, v16, v24
    v_mfma_f32_16x16x32_bf16 v[72:75], v[236:239], v[204:207], v[72:75]
    ds_read_b128 v[236:239], v7 offset:8192
    v_add_f32 v17, v17, v25
    v_exp_f32 v22, v190
    s_waitcnt lgkmcnt(10)
    v_mfma_f32_16x16x32_bf16 v[76:79], v[240:243], v[196:199], v[76:79]
    v_exp_f32 v23, v191
    v_mfma_f32_16x16x32_bf16 v[80:83], v[240:243], v[200:203], v[80:83]
    v_cvt_pk_bf16_f32 v214, v26, v27
    v_add_f32 v18, v18, v26
    v_mfma_f32_16x16x32_bf16 v[84:87], v[240:243], v[204:207], v[84:87]
    ds_read_b128 v[240:243], v4 offset:9216
    v_add_f32 v19, v19, v27
    v_exp_f32 v24, v192
    s_waitcnt lgkmcnt(9)
    v_mfma_f32_16x16x32_bf16 v[88:91], v[244:247], v[196:199], v[88:91]
    v_exp_f32 v25, v193
    v_mfma_f32_16x16x32_bf16 v[92:95], v[244:247], v[200:203], v[92:95]
    v_cvt_pk_bf16_f32 v215, v22, v23
    v_add_f32 v18, v18, v22
    v_mfma_f32_16x16x32_bf16 v[96:99], v[244:247], v[204:207], v[96:99]
    ds_read_b128 v[244:247], v5 offset:9216
    v_add_f32 v19, v19, v23
    v_exp_f32 v26, v194
    s_waitcnt lgkmcnt(8)
    v_mfma_f32_16x16x32_bf16 v[100:103], v[248:251], v[196:199], v[100:103]
    v_exp_f32 v27, v195
    v_mfma_f32_16x16x32_bf16 v[104:107], v[248:251], v[200:203], v[104:107]
    v_cvt_pk_bf16_f32 v218, v24, v25
    v_add_f32 v20, v20, v24
    v_mfma_f32_16x16x32_bf16 v[108:111], v[248:251], v[204:207], v[108:111]
    ds_read_b128 v[248:251], v6 offset:9216
    v_add_f32 v21, v21, v25
    s_waitcnt lgkmcnt(7)
    v_mfma_f32_16x16x32_bf16 v[112:115], v[252:255], v[196:199], v[112:115]
    v_cvt_pk_bf16_f32 v219, v26, v27
    v_mfma_f32_16x16x32_bf16 v[116:119], v[252:255], v[200:203], v[116:119]
    v_add_f32 v20, v20, v26
    v_mfma_f32_16x16x32_bf16 v[120:123], v[252:255], v[204:207], v[120:123]
    ds_read_b128 v[252:255], v7 offset:9216
    v_add_f32 v21, v21, v27
    s_cmp_eq_u32 s43, 0
    s_cbranch_scc1 attn_kernel_a_skip11
    s_call_b64 s[54:55], attn_kernel_a_rare1
attn_kernel_a_skip11:
    s_waitcnt lgkmcnt(7)
    v_mfma_f32_16x16x32_bf16 v[172:175], v[224:227], v[124:127], 0
    v_mfma_f32_16x16x32_bf16 v[176:179], v[224:227], v[128:131], 0
    v_mfma_f32_16x16x32_bf16 v[180:183], v[224:227], v[132:135], 0
    s_waitcnt lgkmcnt(6)
    v_mfma_f32_16x16x32_bf16 v[172:175], v[228:231], v[136:139], v[172:175]
    v_mfma_f32_16x16x32_bf16 v[176:179], v[228:231], v[140:143], v[176:179]
    v_mfma_f32_16x16x32_bf16 v[180:183], v[228:231], v[144:147], v[180:183]
    s_waitcnt lgkmcnt(5)
    v_mfma_f32_16x16x32_bf16 v[172:175], v[232:235], v[148:151], v[172:175]
    v_mfma_f32_16x16x32_bf16 v[176:179], v[232:235], v[152:155], v[176:179]
    v_mfma_f32_16x16x32_bf16 v[180:183], v[232:235], v[156:159], v[180:183]
    s_waitcnt lgkmcnt(4)
    v_mfma_f32_16x16x32_bf16 v[172:175], v[236:239], v[160:163], v[172:175]
    v_mfma_f32_16x16x32_bf16 v[176:179], v[236:239], v[164:167], v[176:179]
    v_mfma_f32_16x16x32_bf16 v[180:183], v[236:239], v[168:171], v[180:183]
    s_waitcnt lgkmcnt(3)
    v_mfma_f32_16x16x32_bf16 v[184:187], v[240:243], v[124:127], 0
    v_mfma_f32_16x16x32_bf16 v[188:191], v[240:243], v[128:131], 0
    v_mfma_f32_16x16x32_bf16 v[192:195], v[240:243], v[132:135], 0
    s_waitcnt lgkmcnt(0)
    s_barrier
    ds_read_b64_tr_b16 v[224:225], v8 offset:16384
    ds_read_b64_tr_b16 v[226:227], v8 offset:17408
    v_mfma_f32_16x16x32_bf16 v[184:187], v[244:247], v[136:139], v[184:187]
    ds_read_b64_tr_b16 v[228:229], v9 offset:16384
    ds_read_b64_tr_b16 v[230:231], v9 offset:17408
    v_exp_f32 v22, v172
    v_exp_f32 v23, v173
    v_mfma_f32_16x16x32_bf16 v[188:191], v[244:247], v[140:143], v[188:191]
    ds_read_b64_tr_b16 v[232:233], v10 offset:16384
    ds_read_b64_tr_b16 v[234:235], v10 offset:17408
    v_exp_f32 v24, v174
    v_exp_f32 v25, v175
    v_mfma_f32_16x16x32_bf16 v[192:195], v[244:247], v[144:147], v[192:195]
    ds_read_b64_tr_b16 v[236:237], v11 offset:16384
    ds_read_b64_tr_b16 v[238:239], v11 offset:17408
    v_cvt_pk_bf16_f32 v196, v22, v23
    v_add_f32 v16, v16, v22
    v_add_f32 v17, v17, v23
    v_mfma_f32_16x16x32_bf16 v[184:187], v[248:251], v[148:151], v[184:187]
    ds_read_b64_tr_b16 v[240:241], v12 offset:16384
    ds_read_b64_tr_b16 v[242:243], v12 offset:17408
    v_exp_f32 v26, v176
    v_exp_f32 v27, v177
    v_mfma_f32_16x16x32_bf16 v[188:191], v[248:251], v[152:155], v[188:191]
    ds_read_b64_tr_b16 v[244:245], v13 offset:16384
    ds_read_b64_tr_b16 v[246:247], v13 offset:17408
    v_cvt_pk_bf16_f32 v197, v24, v25
    v_add_f32 v16, v16, v24
    v_add_f32 v17, v17, v25
    v_mfma_f32_16x16x32_bf16 v[192:195], v[248:251], v[156:159], v[192:195]
    ds_read_b64_tr_b16 v[248:249], v14 offset:16384
    ds_read_b64_tr_b16 v[250:251], v14 offset:17408
    v_exp_f32 v22, v178
    v_exp_f32 v23, v179
    v_mfma_f32_16x16x32_bf16 v[184:187], v[252:255], v[160:163], v[184:187]
    v_cvt_pk_bf16_f32 v200, v26, v27
    v_add_f32 v18, v18, v26
    v_add_f32 v19, v19, v27
    v_mfma_f32_16x16x32_bf16 v[188:191], v[252:255], v[164:167], v[188:191]
    v_exp_f32 v24, v180
    v_exp_f32 v25, v181
    v_mfma_f32_16x16x32_bf16 v[192:195], v[252:255], v[168:171], v[192:195]
    ds_read_b64_tr_b16 v[252:253], v15 offset:16384
    ds_read_b64_tr_b16 v[254:255], v15 offset:17408
    v_cvt_pk_bf16_f32 v201, v22, v23
    v_add_f32 v18, v18, v22
    v_add_f32 v19, v19, v23
    s_waitcnt lgkmcnt(14)
    v_mfma_f32_16x16x32_bf16 v[28:31], v[224:227], v[208:211], v[28:31]
    v_exp_f32 v26, v182
    v_exp_f32 v27, v183
    v_mfma_f32_16x16x32_bf16 v[32:35], v[224:227], v[212:215], v[32:35]
    v_cvt_pk_bf16_f32 v204, v24, v25
    v_add_f32 v20, v20, v24
    v_add_f32 v21, v21, v25
    v_mfma_f32_16x16x32_bf16 v[36:39], v[224:227], v[216:219], v[36:39]
    ds_read_b128 v[224:227], v4 offset:24576
    v_cvt_pk_bf16_f32 v205, v26, v27
    v_add_f32 v20, v20, v26
    v_add_f32 v21, v21, v27
    s_waitcnt lgkmcnt(13)
    v_mfma_f32_16x16x32_bf16 v[40:43], v[228:231], v[208:211], v[40:43]
    v_exp_f32 v22, v184
    v_mfma_f32_16x16x32_bf16 v[44:47], v[228:231], v[212:215], v[44:47]
    v_exp_f32 v23, v185
    v_mfma_f32_16x16x32_bf16 v[48:51], v[228:231], v[216:219], v[48:51]
    ds_read_b128 v[228:231], v5 offset:24576
    v_exp_f32 v24, v186
    s_waitcnt lgkmcnt(12)
    v_mfma_f32_16x16x32_bf16 v[52:55], v[232:235], v[208:211], v[52:55]
    v_exp_f32 v25, v187
    v_mfma_f32_16x16x32_bf16 v[56:59], v[232:235], v[212:215], v[56:59]
    v_cvt_pk_bf16_f32 v198, v22, v23
    v_add_f32 v16, v16, v22
    v_mfma_f32_16x16x32_bf16 v[60:63], v[232:235], v[216:219], v[60:63]
    ds_read_b128 v[232:235], v6 offset:24576
    v_add_f32 v17, v17, v23
    v_exp_f32 v26, v188
    s_waitcnt lgkmcnt(11)
    v_mfma_f32_16x16x32_bf16 v[64:67], v[236:239], v[208:211], v[64:67]
    v_exp_f32 v27, v189
    v_mfma_f32_16x16x32_bf16 v[68:71], v[236:239], v[212:215], v[68:71]
    v_cvt_pk_bf16_f32 v199, v24, v25
    v_add_f32 v16, v16, v24
    v_mfma_f32_16x16x32_bf16 v[72:75], v[236:239], v[216:219], v[72:75]
    ds_read_b128 v[236:239], v7 offset:24576
    v_add_f32 v17, v17, v25
    v_exp_f32 v22, v190
    s_waitcnt lgkmcnt(10)
    v_mfma_f32_16x16x32_bf16 v[76:79], v[240:243], v[208:211], v[76:79]
    v_exp_f32 v23, v191
    v_mfma_f32_16x16x32_bf16 v[80:83], v[240:243], v[212:215], v[80:83]
    v_cvt_pk_bf16_f32 v202, v26, v27
    v_add_f32 v18, v18, v26
    v_mfma_f32_16x16x32_bf16 v[84:87], v[240:243], v[216:219], v[84:87]
    ds_read_b128 v[240:243], v4 offset:25600
    v_add_f32 v19, v19, v27
    v_exp_f32 v24, v192
    s_waitcnt lgkmcnt(9)
    v_mfma_f32_16x16x32_bf16 v[88:91], v[244:247], v[208:211], v[88:91]
    v_exp_f32 v25, v193
    v_mfma_f32_16x16x32_bf16 v[92:95], v[244:247], v[212:215], v[92:95]
    v_cvt_pk_bf16_f32 v203, v22, v23
    v_add_f32 v18, v18, v22
    v_mfma_f32_16x16x32_bf16 v[96:99], v[244:247], v[216:219], v[96:99]
    ds_read_b128 v[244:247], v5 offset:25600
    v_add_f32 v19, v19, v23
    v_exp_f32 v26, v194
    s_waitcnt lgkmcnt(8)
    v_mfma_f32_16x16x32_bf16 v[100:103], v[248:251], v[208:211], v[100:103]
    v_exp_f32 v27, v195
    v_mfma_f32_16x16x32_bf16 v[104:107], v[248:251], v[212:215], v[104:107]
    v_cvt_pk_bf16_f32 v206, v24, v25
    v_add_f32 v20, v20, v24
    v_mfma_f32_16x16x32_bf16 v[108:111], v[248:251], v[216:219], v[108:111]
    ds_read_b128 v[248:251], v6 offset:25600
    v_add_f32 v21, v21, v25
    s_waitcnt lgkmcnt(7)
    v_mfma_f32_16x16x32_bf16 v[112:115], v[252:255], v[208:211], v[112:115]
    v_cvt_pk_bf16_f32 v207, v26, v27
    v_mfma_f32_16x16x32_bf16 v[116:119], v[252:255], v[212:215], v[116:119]
    v_add_f32 v20, v20, v26
    v_mfma_f32_16x16x32_bf16 v[120:123], v[252:255], v[216:219], v[120:123]
    ds_read_b128 v[252:255], v7 offset:25600
    v_add_f32 v21, v21, v27
    s_cmp_eq_u32 s43, 0
    s_cbranch_scc1 attn_kernel_a_skip12
    s_call_b64 s[54:55], attn_kernel_a_rare0
attn_kernel_a_skip12:
    s_waitcnt lgkmcnt(7)
    v_mfma_f32_16x16x32_bf16 v[172:175], v[224:227], v[124:127], 0
    v_mfma_f32_16x16x32_bf16 v[176:179], v[224:227], v[128:131], 0
    v_mfma_f32_16x16x32_bf16 v[180:183], v[224:227], v[132:135], 0
    s_waitcnt lgkmcnt(6)
    v_mfma_f32_16x16x32_bf16 v[172:175], v[228:231], v[136:139], v[172:175]
    v_mfma_f32_16x16x32_bf16 v[176:179], v[228:231], v[140:143], v[176:179]
    v_mfma_f32_16x16x32_bf16 v[180:183], v[228:231], v[144:147], v[180:183]
    s_waitcnt lgkmcnt(5)
    v_mfma_f32_16x16x32_bf16 v[172:175], v[232:235], v[148:151], v[172:175]
    v_mfma_f32_16x16x32_bf16 v[176:179], v[232:235], v[152:155], v[176:179]
    v_mfma_f32_16x16x32_bf16 v[180:183], v[232:235], v[156:159], v[180:183]
    s_waitcnt lgkmcnt(4)
    v_mfma_f32_16x16x32_bf16 v[172:175], v[236:239], v[160:163], v[172:175]
    v_mfma_f32_16x16x32_bf16 v[176:179], v[236:239], v[164:167], v[176:179]
    v_mfma_f32_16x16x32_bf16 v[180:183], v[236:239], v[168:171], v[180:183]
    s_waitcnt lgkmcnt(3)
    v_mfma_f32_16x16x32_bf16 v[184:187], v[240:243], v[124:127], 0
    v_mfma_f32_16x16x32_bf16 v[188:191], v[240:243], v[128:131], 0
    v_mfma_f32_16x16x32_bf16 v[192:195], v[240:243], v[132:135], 0
    s_waitcnt lgkmcnt(0)
    s_barrier
    ds_read_b64_tr_b16 v[224:225], v8 offset:32768
    ds_read_b64_tr_b16 v[226:227], v8 offset:33792
    v_mfma_f32_16x16x32_bf16 v[184:187], v[244:247], v[136:139], v[184:187]
    ds_read_b64_tr_b16 v[228:229], v9 offset:32768
    ds_read_b64_tr_b16 v[230:231], v9 offset:33792
    v_exp_f32 v22, v172
    v_exp_f32 v23, v173
    v_mfma_f32_16x16x32_bf16 v[188:191], v[244:247], v[140:143], v[188:191]
    ds_read_b64_tr_b16 v[232:233], v10 offset:32768
    ds_read_b64_tr_b16 v[234:235], v10 offset:33792
    v_exp_f32 v24, v174
    v_exp_f32 v25, v175
    v_mfma_f32_16x16x32_bf16 v[192:195], v[244:247], v[144:147], v[192:195]
    ds_read_b64_tr_b16 v[236:237], v11 offset:32768
    ds_read_b64_tr_b16 v[238:239], v11 offset:33792
    v_cvt_pk_bf16_f32 v208, v22, v23
    v_add_f32 v16, v16, v22
    v_add_f32 v17, v17, v23
    v_mfma_f32_16x16x32_bf16 v[184:187], v[248:251], v[148:151], v[184:187]
    ds_read_b64_tr_b16 v[240:241], v12 offset:32768
    ds_read_b64_tr_b16 v[242:243], v12 offset:33792
    v_exp_f32 v26, v176
    v_exp_f32 v27, v177
    v_mfma_f32_16x16x32_bf16 v[188:191], v[248:251], v[152:155], v[188:191]
    ds_read_b64_tr_b16 v[244:245], v13 offset:32768
    ds_read_b64_tr_b16 v[246:247], v13 offset:33792
    v_cvt_pk_bf16_f32 v209, v24, v25
    v_add_f32 v16, v16, v24
    v_add_f32 v17, v17, v25
    v_mfma_f32_16x16x32_bf16 v[192:195], v[248:251], v[156:159], v[192:195]
    ds_read_b64_tr_b16 v[248:249], v14 offset:32768
    ds_read_b64_tr_b16 v[250:251], v14 offset:33792
    v_exp_f32 v22, v178
    v_exp_f32 v23, v179
    v_mfma_f32_16x16x32_bf16 v[184:187], v[252:255], v[160:163], v[184:187]
    v_cvt_pk_bf16_f32 v212, v26, v27
    v_add_f32 v18, v18, v26
    v_add_f32 v19, v19, v27
    v_mfma_f32_16x16x32_bf16 v[188:191], v[252:255], v[164:167], v[188:191]
    v_exp_f32 v24, v180
    v_exp_f32 v25, v181
    v_mfma_f32_16x16x32_bf16 v[192:195], v[252:255], v[168:171], v[192:195]
    ds_read_b64_tr_b16 v[252:253], v15 offset:32768
    ds_read_b64_tr_b16 v[254:255], v15 offset:33792
    v_cvt_pk_bf16_f32 v213, v22, v23
    v_add_f32 v18, v18, v22
    v_add_f32 v19, v19, v23
    s_waitcnt lgkmcnt(14)
    v_mfma_f32_16x16x32_bf16 v[28:31], v[224:227], v[196:199], v[28:31]
    v_exp_f32 v26, v182
    v_exp_f32 v27, v183
    v_mfma_f32_16x16x32_bf16 v[32:35], v[224:227], v[200:203], v[32:35]
    v_cvt_pk_bf16_f32 v216, v24, v25
    v_add_f32 v20, v20, v24
    v_add_f32 v21, v21, v25
    v_mfma_f32_16x16x32_bf16 v[36:39], v[224:227], v[204:207], v[36:39]
    ds_read_b128 v[224:227], v4 offset:40960
    v_cvt_pk_bf16_f32 v217, v26, v27
    v_add_f32 v20, v20, v26
    v_add_f32 v21, v21, v27
    s_waitcnt lgkmcnt(13)
    v_mfma_f32_16x16x32_bf16 v[40:43], v[228:231], v[196:199], v[40:43]
    v_exp_f32 v22, v184
    v_mfma_f32_16x16x32_bf16 v[44:47], v[228:231], v[200:203], v[44:47]
    v_exp_f32 v23, v185
    v_mfma_f32_16x16x32_bf16 v[48:51], v[228:231], v[204:207], v[48:51]
    ds_read_b128 v[228:231], v5 offset:40960
    v_exp_f32 v24, v186
    s_waitcnt lgkmcnt(12)
    v_mfma_f32_16x16x32_bf16 v[52:55], v[232:235], v[196:199], v[52:55]
    v_exp_f32 v25, v187
    v_mfma_f32_16x16x32_bf16 v[56:59], v[232:235], v[200:203], v[56:59]
    v_cvt_pk_bf16_f32 v210, v22, v23
    v_add_f32 v16, v16, v22
    v_mfma_f32_16x16x32_bf16 v[60:63], v[232:235], v[204:207], v[60:63]
    ds_read_b128 v[232:235], v6 offset:40960
    v_add_f32 v17, v17, v23
    v_exp_f32 v26, v188
    s_waitcnt lgkmcnt(11)
    v_mfma_f32_16x16x32_bf16 v[64:67], v[236:239], v[196:199], v[64:67]
    v_exp_f32 v27, v189
    v_mfma_f32_16x16x32_bf16 v[68:71], v[236:239], v[200:203], v[68:71]
    v_cvt_pk_bf16_f32 v211, v24, v25
    v_add_f32 v16, v16, v24
    v_mfma_f32_16x16x32_bf16 v[72:75], v[236:239], v[204:207], v[72:75]
    ds_read_b128 v[236:239], v7 offset:40960
    v_add_f32 v17, v17, v25
    v_exp_f32 v22, v190
    s_waitcnt lgkmcnt(10)
    v_mfma_f32_16x16x32_bf16 v[76:79], v[240:243], v[196:199], v[76:79]
    v_exp_f32 v23, v191
    v_mfma_f32_16x16x32_bf16 v[80:83], v[240:243], v[200:203], v[80:83]
    v_cvt_pk_bf16_f32 v214, v26, v27
    v_add_f32 v18, v18, v26
    v_mfma_f32_16x16x32_bf16 v[84:87], v[240:243], v[204:207], v[84:87]
    ds_read_b128 v[240:243], v4 offset:41984
    v_add_f32 v19, v19, v27
    v_exp_f32 v24, v192
    s_waitcnt lgkmcnt(9)
    v_mfma_f32_16x16x32_bf16 v[88:91], v[244:247], v[196:199], v[88:91]
    v_exp_f32 v25, v193
    v_mfma_f32_16x16x32_bf16 v[92:95], v[244:247], v[200:203], v[92:95]
    v_cvt_pk_bf16_f32 v215, v22, v23
    v_add_f32 v18, v18, v22
    v_mfma_f32_16x16x32_bf16 v[96:99], v[244:247], v[204:207], v[96:99]
    ds_read_b128 v[244:247], v5 offset:41984
    v_add_f32 v19, v19, v23
    v_exp_f32 v26, v194
    s_waitcnt lgkmcnt(8)
    v_mfma_f32_16x16x32_bf16 v[100:103], v[248:251], v[196:199], v[100:103]
    v_exp_f32 v27, v195
    v_mfma_f32_16x16x32_bf16 v[104:107], v[248:251], v[200:203], v[104:107]
    v_cvt_pk_bf16_f32 v218, v24, v25
    v_add_f32 v20, v20, v24
    v_mfma_f32_16x16x32_bf16 v[108:111], v[248:251], v[204:207], v[108:111]
    ds_read_b128 v[248:251], v6 offset:41984
    v_add_f32 v21, v21, v25
    s_waitcnt lgkmcnt(7)
    v_mfma_f32_16x16x32_bf16 v[112:115], v[252:255], v[196:199], v[112:115]
    v_cvt_pk_bf16_f32 v219, v26, v27
    v_mfma_f32_16x16x32_bf16 v[116:119], v[252:255], v[200:203], v[116:119]
    v_add_f32 v20, v20, v26
    v_mfma_f32_16x16x32_bf16 v[120:123], v[252:255], v[204:207], v[120:123]
    ds_read_b128 v[252:255], v7 offset:41984
    v_add_f32 v21, v21, v27
    s_cmp_eq_u32 s43, 0
    s_cbranch_scc1 attn_kernel_a_skip13
    s_call_b64 s[54:55], attn_kernel_a_rare1
attn_kernel_a_skip13:
    s_waitcnt lgkmcnt(7)
    v_mfma_f32_16x16x32_bf16 v[172:175], v[224:227], v[124:127], 0
    v_mfma_f32_16x16x32_bf16 v[176:179], v[224:227], v[128:131], 0
    v_mfma_f32_16x16x32_bf16 v[180:183], v[224:227], v[132:135], 0
    s_waitcnt lgkmcnt(6)
    v_mfma_f32_16x16x32_bf16 v[172:175], v[228:231], v[136:139], v[172:175]
    v_mfma_f32_16x16x32_bf16 v[176:179], v[228:231], v[140:143], v[176:179]
    v_mfma_f32_16x16x32_bf16 v[180:183], v[228:231], v[144:147], v[180:183]
    s_waitcnt lgkmcnt(5)
    v_mfma_f32_16x16x32_bf16 v[172:175], v[232:235], v[148:151], v[172:175]
    v_mfma_f32_16x16x32_bf16 v[176:179], v[232:235], v[152:155], v[176:179]
    v_mfma_f32_16x16x32_bf16 v[180:183], v[232:235], v[156:159], v[180:183]
    s_waitcnt lgkmcnt(4)
    v_mfma_f32_16x16x32_bf16 v[172:175], v[236:239], v[160:163], v[172:175]
    v_mfma_f32_16x16x32_bf16 v[176:179], v[236:239], v[164:167], v[176:179]
    v_mfma_f32_16x16x32_bf16 v[180:183], v[236:239], v[168:171], v[180:183]
    s_waitcnt lgkmcnt(3)
    v_mfma_f32_16x16x32_bf16 v[184:187], v[240:243], v[124:127], 0
    v_mfma_f32_16x16x32_bf16 v[188:191], v[240:243], v[128:131], 0
    v_mfma_f32_16x16x32_bf16 v[192:195], v[240:243], v[132:135], 0
    s_waitcnt lgkmcnt(0)
    s_barrier
    ds_read_b64_tr_b16 v[224:225], v8 offset:49152
    ds_read_b64_tr_b16 v[226:227], v8 offset:50176
    v_mfma_f32_16x16x32_bf16 v[184:187], v[244:247], v[136:139], v[184:187]
    ds_read_b64_tr_b16 v[228:229], v9 offset:49152
    ds_read_b64_tr_b16 v[230:231], v9 offset:50176
    v_exp_f32 v22, v172
    v_exp_f32 v23, v173
    v_mfma_f32_16x16x32_bf16 v[188:191], v[244:247], v[140:143], v[188:191]
    ds_read_b64_tr_b16 v[232:233], v10 offset:49152
    ds_read_b64_tr_b16 v[234:235], v10 offset:50176
    v_exp_f32 v24, v174
    v_exp_f32 v25, v175
    v_mfma_f32_16x16x32_bf16 v[192:195], v[244:247], v[144:147], v[192:195]
    ds_read_b64_tr_b16 v[236:237], v11 offset:49152
    ds_read_b64_tr_b16 v[238:239], v11 offset:50176
    v_cvt_pk_bf16_f32 v196, v22, v23
    v_add_f32 v16, v16, v22
    v_add_f32 v17, v17, v23
    v_mfma_f32_16x16x32_bf16 v[184:187], v[248:251], v[148:151], v[184:187]
    ds_read_b64_tr_b16 v[240:241], v12 offset:49152
    ds_read_b64_tr_b16 v[242:243], v12 offset:50176
    v_exp_f32 v26, v176
    v_exp_f32 v27, v177
    v_mfma_f32_16x16x32_bf16 v[188:191], v[248:251], v[152:155], v[188:191]
    ds_read_b64_tr_b16 v[244:245], v13 offset:49152
    ds_read_b64_tr_b16 v[246:247], v13 offset:50176
    v_cvt_pk_bf16_f32 v197, v24, v25
    v_add_f32 v16, v16, v24
    v_add_f32 v17, v17, v25
    v_mfma_f32_16x16x32_bf16 v[192:195], v[248:251], v[156:159], v[192:195]
    ds_read_b64_tr_b16 v[248:249], v14 offset:49152
    ds_read_b64_tr_b16 v[250:251], v14 offset:50176
    v_exp_f32 v22, v178
    v_exp_f32 v23, v179
    v_mfma_f32_16x16x32_bf16 v[184:187], v[252:255], v[160:163], v[184:187]
    v_cvt_pk_bf16_f32 v200, v26, v27
    v_add_f32 v18, v18, v26
    v_add_f32 v19, v19, v27
    v_mfma_f32_16x16x32_bf16 v[188:191], v[252:255], v[164:167], v[188:191]
    v_exp_f32 v24, v180
    v_exp_f32 v25, v181
    v_mfma_f32_16x16x32_bf16 v[192:195], v[252:255], v[168:171], v[192:195]
    ds_read_b64_tr_b16 v[252:253], v15 offset:49152
    ds_read_b64_tr_b16 v[254:255], v15 offset:50176
    v_cvt_pk_bf16_f32 v201, v22, v23
    v_add_f32 v18, v18, v22
    v_add_f32 v19, v19, v23
    s_waitcnt lgkmcnt(14)
    v_mfma_f32_16x16x32_bf16 v[28:31], v[224:227], v[208:211], v[28:31]
    v_exp_f32 v26, v182
    v_exp_f32 v27, v183
    v_mfma_f32_16x16x32_bf16 v[32:35], v[224:227], v[212:215], v[32:35]
    v_cvt_pk_bf16_f32 v204, v24, v25
    v_add_f32 v20, v20, v24
    v_add_f32 v21, v21, v25
    v_mfma_f32_16x16x32_bf16 v[36:39], v[224:227], v[216:219], v[36:39]
    ds_read_b128 v[224:227], v4 offset:57344
    v_cvt_pk_bf16_f32 v205, v26, v27
    v_add_f32 v20, v20, v26
    v_add_f32 v21, v21, v27
    s_waitcnt lgkmcnt(13)
    v_mfma_f32_16x16x32_bf16 v[40:43], v[228:231], v[208:211], v[40:43]
    v_exp_f32 v22, v184
    v_mfma_f32_16x16x32_bf16 v[44:47], v[228:231], v[212:215], v[44:47]
    v_exp_f32 v23, v185
    v_mfma_f32_16x16x32_bf16 v[48:51], v[228:231], v[216:219], v[48:51]
    ds_read_b128 v[228:231], v5 offset:57344
    v_exp_f32 v24, v186
    s_waitcnt lgkmcnt(12)
    v_mfma_f32_16x16x32_bf16 v[52:55], v[232:235], v[208:211], v[52:55]
    v_exp_f32 v25, v187
    v_mfma_f32_16x16x32_bf16 v[56:59], v[232:235], v[212:215], v[56:59]
    v_cvt_pk_bf16_f32 v198, v22, v23
    v_add_f32 v16, v16, v22
    v_mfma_f32_16x16x32_bf16 v[60:63], v[232:235], v[216:219], v[60:63]
    ds_read_b128 v[232:235], v6 offset:57344
    v_add_f32 v17, v17, v23
    v_exp_f32 v26, v188
    s_waitcnt lgkmcnt(11)
    v_mfma_f32_16x16x32_bf16 v[64:67], v[236:239], v[208:211], v[64:67]
    v_exp_f32 v27, v189
    v_mfma_f32_16x16x32_bf16 v[68:71], v[236:239], v[212:215], v[68:71]
    v_cvt_pk_bf16_f32 v199, v24, v25
    v_add_f32 v16, v16, v24
    v_mfma_f32_16x16x32_bf16 v[72:75], v[236:239], v[216:219], v[72:75]
    ds_read_b128 v[236:239], v7 offset:57344
    v_add_f32 v17, v17, v25
    v_exp_f32 v22, v190
    s_waitcnt lgkmcnt(10)
    v_mfma_f32_16x16x32_bf16 v[76:79], v[240:243], v[208:211], v[76:79]
    v_exp_f32 v23, v191
    v_mfma_f32_16x16x32_bf16 v[80:83], v[240:243], v[212:215], v[80:83]
    v_cvt_pk_bf16_f32 v202, v26, v27
    v_add_f32 v18, v18, v26
    v_mfma_f32_16x16x32_bf16 v[84:87], v[240:243], v[216:219], v[84:87]
    ds_read_b128 v[240:243], v4 offset:58368
    v_add_f32 v19, v19, v27
    v_exp_f32 v24, v192
    s_waitcnt lgkmcnt(9)
    v_mfma_f32_16x16x32_bf16 v[88:91], v[244:247], v[208:211], v[88:91]
    v_exp_f32 v25, v193
    v_mfma_f32_16x16x32_bf16 v[92:95], v[244:247], v[212:215], v[92:95]
    v_cvt_pk_bf16_f32 v203, v22, v23
    v_add_f32 v18, v18, v22
    v_mfma_f32_16x16x32_bf16 v[96:99], v[244:247], v[216:219], v[96:99]
    ds_read_b128 v[244:247], v5 offset:58368
    v_add_f32 v19, v19, v23
    v_exp_f32 v26, v194
    s_waitcnt lgkmcnt(8)
    v_mfma_f32_16x16x32_bf16 v[100:103], v[248:251], v[208:211], v[100:103]
    v_exp_f32 v27, v195
    v_mfma_f32_16x16x32_bf16 v[104:107], v[248:251], v[212:215], v[104:107]
    v_cvt_pk_bf16_f32 v206, v24, v25
    v_add_f32 v20, v20, v24
    v_mfma_f32_16x16x32_bf16 v[108:111], v[248:251], v[216:219], v[108:111]
    ds_read_b128 v[248:251], v6 offset:58368
    v_add_f32 v21, v21, v25
    s_waitcnt lgkmcnt(7)
    v_mfma_f32_16x16x32_bf16 v[112:115], v[252:255], v[208:211], v[112:115]
    v_cvt_pk_bf16_f32 v207, v26, v27
    v_mfma_f32_16x16x32_bf16 v[116:119], v[252:255], v[212:215], v[116:119]
    v_add_f32 v20, v20, v26
    v_mfma_f32_16x16x32_bf16 v[120:123], v[252:255], v[216:219], v[120:123]
    ds_read_b128 v[252:255], v7 offset:58368
    v_add_f32 v21, v21, v27
    s_cmp_eq_u32 s43, 0
    s_cbranch_scc1 attn_kernel_a_skip14
    s_call_b64 s[54:55], attn_kernel_a_rare0
attn_kernel_a_skip14:
    s_waitcnt lgkmcnt(7)
    v_mfma_f32_16x16x32_bf16 v[172:175], v[224:227], v[124:127], 0
    v_mfma_f32_16x16x32_bf16 v[176:179], v[224:227], v[128:131], 0
    v_mfma_f32_16x16x32_bf16 v[180:183], v[224:227], v[132:135], 0
    s_waitcnt lgkmcnt(6)
    v_mfma_f32_16x16x32_bf16 v[172:175], v[228:231], v[136:139], v[172:175]
    v_mfma_f32_16x16x32_bf16 v[176:179], v[228:231], v[140:143], v[176:179]
    v_mfma_f32_16x16x32_bf16 v[180:183], v[228:231], v[144:147], v[180:183]
    s_waitcnt lgkmcnt(5)
    v_mfma_f32_16x16x32_bf16 v[172:175], v[232:235], v[148:151], v[172:175]
    v_mfma_f32_16x16x32_bf16 v[176:179], v[232:235], v[152:155], v[176:179]
    v_mfma_f32_16x16x32_bf16 v[180:183], v[232:235], v[156:159], v[180:183]
    s_waitcnt lgkmcnt(4)
    v_mfma_f32_16x16x32_bf16 v[172:175], v[236:239], v[160:163], v[172:175]
    v_mfma_f32_16x16x32_bf16 v[176:179], v[236:239], v[164:167], v[176:179]
    v_mfma_f32_16x16x32_bf16 v[180:183], v[236:239], v[168:171], v[180:183]
    s_waitcnt lgkmcnt(3)
    v_mfma_f32_16x16x32_bf16 v[184:187], v[240:243], v[124:127], 0
    v_mfma_f32_16x16x32_bf16 v[188:191], v[240:243], v[128:131], 0
    v_mfma_f32_16x16x32_bf16 v[192:195], v[240:243], v[132:135], 0
    s_waitcnt lgkmcnt(0)
    s_barrier
    ds_read_b64_tr_b16 v[224:225], v8 offset:0
    ds_read_b64_tr_b16 v[226:227], v8 offset:1024
    v_mfma_f32_16x16x32_bf16 v[184:187], v[244:247], v[136:139], v[184:187]
    ds_read_b64_tr_b16 v[228:229], v9 offset:0
    ds_read_b64_tr_b16 v[230:231], v9 offset:1024
    v_exp_f32 v22, v172
    v_exp_f32 v23, v173
    v_mfma_f32_16x16x32_bf16 v[188:191], v[244:247], v[140:143], v[188:191]
    ds_read_b64_tr_b16 v[232:233], v10 offset:0
    ds_read_b64_tr_b16 v[234:235], v10 offset:1024
    v_exp_f32 v24, v174
    v_exp_f32 v25, v175
    v_mfma_f32_16x16x32_bf16 v[192:195], v[244:247], v[144:147], v[192:195]
    ds_read_b64_tr_b16 v[236:237], v11 offset:0
    ds_read_b64_tr_b16 v[238:239], v11 offset:1024
    v_cvt_pk_bf16_f32 v208, v22, v23
    v_add_f32 v16, v16, v22
    v_add_f32 v17, v17, v23
    v_mfma_f32_16x16x32_bf16 v[184:187], v[248:251], v[148:151], v[184:187]
    ds_read_b64_tr_b16 v[240:241], v12 offset:0
    ds_read_b64_tr_b16 v[242:243], v12 offset:1024
    v_exp_f32 v26, v176
    v_exp_f32 v27, v177
    v_mfma_f32_16x16x32_bf16 v[188:191], v[248:251], v[152:155], v[188:191]
    ds_read_b64_tr_b16 v[244:245], v13 offset:0
    ds_read_b64_tr_b16 v[246:247], v13 offset:1024
    v_cvt_pk_bf16_f32 v209, v24, v25
    v_add_f32 v16, v16, v24
    v_add_f32 v17, v17, v25
    v_mfma_f32_16x16x32_bf16 v[192:195], v[248:251], v[156:159], v[192:195]
    ds_read_b64_tr_b16 v[248:249], v14 offset:0
    ds_read_b64_tr_b16 v[250:251], v14 offset:1024
    v_exp_f32 v22, v178
    v_exp_f32 v23, v179
    v_mfma_f32_16x16x32_bf16 v[184:187], v[252:255], v[160:163], v[184:187]
    v_cvt_pk_bf16_f32 v212, v26, v27
    v_add_f32 v18, v18, v26
    v_add_f32 v19, v19, v27
    v_mfma_f32_16x16x32_bf16 v[188:191], v[252:255], v[164:167], v[188:191]
    v_exp_f32 v24, v180
    v_exp_f32 v25, v181
    v_mfma_f32_16x16x32_bf16 v[192:195], v[252:255], v[168:171], v[192:195]
    ds_read_b64_tr_b16 v[252:253], v15 offset:0
    ds_read_b64_tr_b16 v[254:255], v15 offset:1024
    v_cvt_pk_bf16_f32 v213, v22, v23
    v_add_f32 v18, v18, v22
    v_add_f32 v19, v19, v23
    s_waitcnt lgkmcnt(14)
    v_mfma_f32_16x16x32_bf16 v[28:31], v[224:227], v[196:199], v[28:31]
    v_exp_f32 v26, v182
    v_exp_f32 v27, v183
    v_mfma_f32_16x16x32_bf16 v[32:35], v[224:227], v[200:203], v[32:35]
    v_cvt_pk_bf16_f32 v216, v24, v25
    v_add_f32 v20, v20, v24
    v_add_f32 v21, v21, v25
    v_mfma_f32_16x16x32_bf16 v[36:39], v[224:227], v[204:207], v[36:39]
    ds_read_b64_tr_b16 v[224:225], v8 offset:8192
    ds_read_b64_tr_b16 v[226:227], v8 offset:9216
    v_cvt_pk_bf16_f32 v217, v26, v27
    v_add_f32 v20, v20, v26
    v_add_f32 v21, v21, v27
    s_waitcnt lgkmcnt(14)
    v_mfma_f32_16x16x32_bf16 v[40:43], v[228:231], v[196:199], v[40:43]
    v_exp_f32 v22, v184
    v_mfma_f32_16x16x32_bf16 v[44:47], v[228:231], v[200:203], v[44:47]
    v_exp_f32 v23, v185
    v_mfma_f32_16x16x32_bf16 v[48:51], v[228:231], v[204:207], v[48:51]
    ds_read_b64_tr_b16 v[228:229], v9 offset:8192
    ds_read_b64_tr_b16 v[230:231], v9 offset:9216
    v_exp_f32 v24, v186
    s_waitcnt lgkmcnt(14)
    v_mfma_f32_16x16x32_bf16 v[52:55], v[232:235], v[196:199], v[52:55]
    v_exp_f32 v25, v187
    v_mfma_f32_16x16x32_bf16 v[56:59], v[232:235], v[200:203], v[56:59]
    v_cvt_pk_bf16_f32 v210, v22, v23
    v_add_f32 v16, v16, v22
    v_mfma_f32_16x16x32_bf16 v[60:63], v[232:235], v[204:207], v[60:63]
    ds_read_b64_tr_b16 v[232:233], v10 offset:8192
    ds_read_b64_tr_b16 v[234:235], v10 offset:9216
    v_add_f32 v17, v17, v23
    v_exp_f32 v26, v188
    s_waitcnt lgkmcnt(14)
    v_mfma_f32_16x16x32_bf16 v[64:67], v[236:239], v[196:199], v[64:67]
    v_exp_f32 v27, v189
    v_mfma_f32_16x16x32_bf16 v[68:71], v[236:239], v[200:203], v[68:71]
    v_cvt_pk_bf16_f32 v211, v24, v25
    v_add_f32 v16, v16, v24
    v_mfma_f32_16x16x32_bf16 v[72:75], v[236:239], v[204:207], v[72:75]
    ds_read_b64_tr_b16 v[236:237], v11 offset:8192
    ds_read_b64_tr_b16 v[238:239], v11 offset:9216
    v_add_f32 v17, v17, v25
    v_exp_f32 v22, v190
    s_waitcnt lgkmcnt(14)
    v_mfma_f32_16x16x32_bf16 v[76:79], v[240:243], v[196:199], v[76:79]
    v_exp_f32 v23, v191
    v_mfma_f32_16x16x32_bf16 v[80:83], v[240:243], v[200:203], v[80:83]
    v_cvt_pk_bf16_f32 v214, v26, v27
    v_add_f32 v18, v18, v26
    v_mfma_f32_16x16x32_bf16 v[84:87], v[240:243], v[204:207], v[84:87]
    ds_read_b64_tr_b16 v[240:241], v12 offset:8192
    ds_read_b64_tr_b16 v[242:243], v12 offset:9216
    v_add_f32 v19, v19, v27
    v_exp_f32 v24, v192
    s_waitcnt lgkmcnt(14)
    v_mfma_f32_16x16x32_bf16 v[88:91], v[244:247], v[196:199], v[88:91]
    v_exp_f32 v25, v193
    v_mfma_f32_16x16x32_bf16 v[92:95], v[244:247], v[200:203], v[92:95]
    v_cvt_pk_bf16_f32 v215, v22, v23
    v_add_f32 v18, v18, v22
    v_mfma_f32_16x16x32_bf16 v[96:99], v[244:247], v[204:207], v[96:99]
    ds_read_b64_tr_b16 v[244:245], v13 offset:8192
    ds_read_b64_tr_b16 v[246:247], v13 offset:9216
    v_add_f32 v19, v19, v23
    v_exp_f32 v26, v194
    s_waitcnt lgkmcnt(14)
    v_mfma_f32_16x16x32_bf16 v[100:103], v[248:251], v[196:199], v[100:103]
    v_exp_f32 v27, v195
    v_mfma_f32_16x16x32_bf16 v[104:107], v[248:251], v[200:203], v[104:107]
    v_cvt_pk_bf16_f32 v218, v24, v25
    v_add_f32 v20, v20, v24
    v_mfma_f32_16x16x32_bf16 v[108:111], v[248:251], v[204:207], v[108:111]
    ds_read_b64_tr_b16 v[248:249], v14 offset:8192
    ds_read_b64_tr_b16 v[250:251], v14 offset:9216
    v_add_f32 v21, v21, v25
    s_waitcnt lgkmcnt(14)
    v_mfma_f32_16x16x32_bf16 v[112:115], v[252:255], v[196:199], v[112:115]
    v_cvt_pk_bf16_f32 v219, v26, v27
    v_mfma_f32_16x16x32_bf16 v[116:119], v[252:255], v[200:203], v[116:119]
    v_add_f32 v20, v20, v26
    v_mfma_f32_16x16x32_bf16 v[120:123], v[252:255], v[204:207], v[120:123]
    ds_read_b64_tr_b16 v[252:253], v15 offset:8192
    ds_read_b64_tr_b16 v[254:255], v15 offset:9216
    v_add_f32 v21, v21, v27
    s_cmp_eq_u32 s43, 0
    s_cbranch_scc1 attn_kernel_a_skip15
    s_call_b64 s[54:55], attn_kernel_a_rare1
attn_kernel_a_skip15:
    s_waitcnt lgkmcnt(14)
    v_mfma_f32_16x16x32_bf16 v[28:31], v[224:227], v[208:211], v[28:31]
    v_mfma_f32_16x16x32_bf16 v[32:35], v[224:227], v[212:215], v[32:35]
    v_mfma_f32_16x16x32_bf16 v[36:39], v[224:227], v[216:219], v[36:39]
    s_waitcnt lgkmcnt(12)
    v_mfma_f32_16x16x32_bf16 v[40:43], v[228:231], v[208:211], v[40:43]
    v_mfma_f32_16x16x32_bf16 v[44:47], v[228:231], v[212:215], v[44:47]
    v_mfma_f32_16x16x32_bf16 v[48:51], v[228:231], v[216:219], v[48:51]
    s_waitcnt lgkmcnt(10)
    v_mfma_f32_16x16x32_bf16 v[52:55], v[232:235], v[208:211], v[52:55]
    v_mfma_f32_16x16x32_bf16 v[56:59], v[232:235], v[212:215], v[56:59]
    v_mfma_f32_16x16x32_bf16 v[60:63], v[232:235], v[216:219], v[60:63]
    s_waitcnt lgkmcnt(8)
    v_mfma_f32_16x16x32_bf16 v[64:67], v[236:239], v[208:211], v[64:67]
    v_mfma_f32_16x16x32_bf16 v[68:71], v[236:239], v[212:215], v[68:71]
    v_mfma_f32_16x16x32_bf16 v[72:75], v[236:239], v[216:219], v[72:75]
    s_waitcnt lgkmcnt(6)
    v_mfma_f32_16x16x32_bf16 v[76:79], v[240:243], v[208:211], v[76:79]
    v_mfma_f32_16x16x32_bf16 v[80:83], v[240:243], v[212:215], v[80:83]
    v_mfma_f32_16x16x32_bf16 v[84:87], v[240:243], v[216:219], v[84:87]
    s_waitcnt lgkmcnt(4)
    v_mfma_f32_16x16x32_bf16 v[88:91], v[244:247], v[208:211], v[88:91]
    v_mfma_f32_16x16x32_bf16 v[92:95], v[244:247], v[212:215], v[92:95]
    v_mfma_f32_16x16x32_bf16 v[96:99], v[244:247], v[216:219], v[96:99]
    s_waitcnt lgkmcnt(2)
    v_mfma_f32_16x16x32_bf16 v[100:103], v[248:251], v[208:211], v[100:103]
    v_mfma_f32_16x16x32_bf16 v[104:107], v[248:251], v[212:215], v[104:107]
    v_mfma_f32_16x16x32_bf16 v[108:111], v[248:251], v[216:219], v[108:111]
    s_waitcnt lgkmcnt(0)
    v_mfma_f32_16x16x32_bf16 v[112:115], v[252:255], v[208:211], v[112:115]
    v_mfma_f32_16x16x32_bf16 v[116:119], v[252:255], v[212:215], v[116:119]
    v_mfma_f32_16x16x32_bf16 v[120:123], v[252:255], v[216:219], v[120:123]
    v_add_f32 v16, v16, v17
    v_add_f32 v18, v18, v19
    v_add_f32 v20, v20, v21
    v_mov_b32 v22, v16
    v_mov_b32 v23, v18
    v_mov_b32 v24, v20
    v_permlane32_swap_b32 v16, v22
    v_permlane32_swap_b32 v18, v23
    v_permlane32_swap_b32 v20, v24
    v_add_f32 v16, v16, v22
    v_add_f32 v18, v18, v23
    v_add_f32 v20, v20, v24
    v_mov_b32 v22, v16
    v_mov_b32 v23, v18
    v_mov_b32 v24, v20
    v_permlane16_swap_b32 v16, v22
    v_permlane16_swap_b32 v18, v23
    v_permlane16_swap_b32 v20, v24
    v_add_f32 v16, v16, v22
    v_add_f32 v18, v18, v23
    v_add_f32 v20, v20, v24
    v_add_f32 v22, v16, v18
    v_add_f32 v22, v22, v20
    v_min3_f32 v23, v16, v18, v20
    v_cmp_nge_f32 vcc, s42, v22
    v_cmp_nle_f32 s[54:55], s49, v23
    s_nop 1
    s_or_b64 vcc, vcc, s[54:55]
    v_mov_b32 v24, s79
    v_mov_b32 v25, 0
    s_nop 1
    s_cmp_lg_u64 vcc, 0
    s_cselect_b32 s40, 1, 0
    v_mov_b32 v23, s40
    ds_write_b32 v24, v23 offset:49152
    v_rcp_f32 v16, v16
    v_rcp_f32 v18, v18
    v_rcp_f32 v20, v20
    v_mbcnt_lo_u32_b32 v1, -1, 0
    v_mbcnt_hi_u32_b32 v1, -1, v1
    s_waitcnt lgkmcnt(0)
    s_barrier
    ds_read_b128 v[224:227], v25 offset:49152
    v_mov_b32 v0, v1
    v_lshlrev_b32 v2, 4, v1
    s_waitcnt lgkmcnt(0)
    v_or3_b32 v224, v224, v225, v226
    v_or_b32 v224, v224, v227
    s_nop 0
    v_readfirstlane_b32 s40, v224
    s_nop 1
    s_andn2_b32 s40, s40, s43
    s_cbranch_scc0 attn_kernel_a_fin
    s_mov_b32 s43, 1
    s_waitcnt vmcnt(0) lgkmcnt(0)
    s_barrier
    s_branch attn_kernel_restart
attn_kernel_a_fin:
    v_mul_f32 v28, v28, v16
    v_mul_f32 v29, v29, v16
    v_mul_f32 v30, v30, v16
    v_mul_f32 v31, v31, v16
    v_mul_f32 v40, v40, v16
    v_mul_f32 v41, v41, v16
    v_mul_f32 v42, v42, v16
    v_mul_f32 v43, v43, v16
    v_cvt_pk_bf16_f32 v124, v28, v29
    v_cvt_pk_bf16_f32 v125, v30, v31
    v_cvt_pk_bf16_f32 v126, v40, v41
    v_cvt_pk_bf16_f32 v127, v42, v43
    buffer_store_dwordx4 v[124:127], v2, s[36:39], s50 offen offset:0 sc1
    v_mul_f32 v32, v32, v18
    v_mul_f32 v33, v33, v18
    v_mul_f32 v34, v34, v18
    v_mul_f32 v35, v35, v18
    v_mul_f32 v44, v44, v18
    v_mul_f32 v45, v45, v18
    v_mul_f32 v46, v46, v18
    v_mul_f32 v47, v47, v18
    v_cvt_pk_bf16_f32 v128, v32, v33
    v_cvt_pk_bf16_f32 v129, v34, v35
    v_cvt_pk_bf16_f32 v130, v44, v45
    v_cvt_pk_bf16_f32 v131, v46, v47
    buffer_store_dwordx4 v[128:131], v2, s[36:39], s51 offen offset:0 sc1
    v_mul_f32 v36, v36, v20
    v_mul_f32 v37, v37, v20
    v_mul_f32 v38, v38, v20
    v_mul_f32 v39, v39, v20
    v_mul_f32 v48, v48, v20
    v_mul_f32 v49, v49, v20
    v_mul_f32 v50, v50, v20
    v_mul_f32 v51, v51, v20
    v_cvt_pk_bf16_f32 v132, v36, v37
    v_cvt_pk_bf16_f32 v133, v38, v39
    v_cvt_pk_bf16_f32 v134, v48, v49
    v_cvt_pk_bf16_f32 v135, v50, v51
    buffer_store_dwordx4 v[132:135], v2, s[36:39], s52 offen offset:0 sc1
    v_mul_f32 v52, v52, v16
    v_mul_f32 v53, v53, v16
    v_mul_f32 v54, v54, v16
    v_mul_f32 v55, v55, v16
    v_mul_f32 v64, v64, v16
    v_mul_f32 v65, v65, v16
    v_mul_f32 v66, v66, v16
    v_mul_f32 v67, v67, v16
    v_cvt_pk_bf16_f32 v136, v52, v53
    v_cvt_pk_bf16_f32 v137, v54, v55
    v_cvt_pk_bf16_f32 v138, v64, v65
    v_cvt_pk_bf16_f32 v139, v66, v67
    buffer_store_dwordx4 v[136:139], v2, s[36:39], s50 offen offset:1024 sc1
    v_mul_f32 v56, v56, v18
    v_mul_f32 v57, v57, v18
    v_mul_f32 v58, v58, v18
    v_mul_f32 v59, v59, v18
    v_mul_f32 v68, v68, v18
    v_mul_f32 v69, v69, v18
    v_mul_f32 v70, v70, v18
    v_mul_f32 v71, v71, v18
    v_cvt_pk_bf16_f32 v140, v56, v57
    v_cvt_pk_bf16_f32 v141, v58, v59
    v_cvt_pk_bf16_f32 v142, v68, v69
    v_cvt_pk_bf16_f32 v143, v70, v71
    buffer_store_dwordx4 v[140:143], v2, s[36:39], s51 offen offset:1024 sc1
    v_mul_f32 v60, v60, v20
    v_mul_f32 v61, v61, v20
    v_mul_f32 v62, v62, v20
    v_mul_f32 v63, v63, v20
    v_mul_f32 v72, v72, v20
    v_mul_f32 v73, v73, v20
    v_mul_f32 v74, v74, v20
    v_mul_f32 v75, v75, v20
    v_cvt_pk_bf16_f32 v144, v60, v61
    v_cvt_pk_bf16_f32 v145, v62, v63
    v_cvt_pk_bf16_f32 v146, v72, v73
    v_cvt_pk_bf16_f32 v147, v74, v75
    buffer_store_dwordx4 v[144:147], v2, s[36:39], s52 offen offset:1024 sc1
    v_mul_f32 v76, v76, v16
    v_mul_f32 v77, v77, v16
    v_mul_f32 v78, v78, v16
    v_mul_f32 v79, v79, v16
    v_mul_f32 v88, v88, v16
    v_mul_f32 v89, v89, v16
    v_mul_f32 v90, v90, v16
    v_mul_f32 v91, v91, v16
    v_cvt_pk_bf16_f32 v148, v76, v77
    v_cvt_pk_bf16_f32 v149, v78, v79
    v_cvt_pk_bf16_f32 v150, v88, v89
    v_cvt_pk_bf16_f32 v151, v90, v91
    buffer_store_dwordx4 v[148:151], v2, s[36:39], s50 offen offset:2048 sc1
    v_mul_f32 v80, v80, v18
    v_mul_f32 v81, v81, v18
    v_mul_f32 v82, v82, v18
    v_mul_f32 v83, v83, v18
    v_mul_f32 v92, v92, v18
    v_mul_f32 v93, v93, v18
    v_mul_f32 v94, v94, v18
    v_mul_f32 v95, v95, v18
    v_cvt_pk_bf16_f32 v152, v80, v81
    v_cvt_pk_bf16_f32 v153, v82, v83
    v_cvt_pk_bf16_f32 v154, v92, v93
    v_cvt_pk_bf16_f32 v155, v94, v95
    buffer_store_dwordx4 v[152:155], v2, s[36:39], s51 offen offset:2048 sc1
    v_mul_f32 v84, v84, v20
    v_mul_f32 v85, v85, v20
    v_mul_f32 v86, v86, v20
    v_mul_f32 v87, v87, v20
    v_mul_f32 v96, v96, v20
    v_mul_f32 v97, v97, v20
    v_mul_f32 v98, v98, v20
    v_mul_f32 v99, v99, v20
    v_cvt_pk_bf16_f32 v156, v84, v85
    v_cvt_pk_bf16_f32 v157, v86, v87
    v_cvt_pk_bf16_f32 v158, v96, v97
    v_cvt_pk_bf16_f32 v159, v98, v99
    buffer_store_dwordx4 v[156:159], v2, s[36:39], s52 offen offset:2048 sc1
    v_mul_f32 v100, v100, v16
    v_mul_f32 v101, v101, v16
    v_mul_f32 v102, v102, v16
    v_mul_f32 v103, v103, v16
    v_mul_f32 v112, v112, v16
    v_mul_f32 v113, v113, v16
    v_mul_f32 v114, v114, v16
    v_mul_f32 v115, v115, v16
    v_cvt_pk_bf16_f32 v160, v100, v101
    v_cvt_pk_bf16_f32 v161, v102, v103
    v_cvt_pk_bf16_f32 v162, v112, v113
    v_cvt_pk_bf16_f32 v163, v114, v115
    buffer_store_dwordx4 v[160:163], v2, s[36:39], s50 offen offset:3072 sc1
    v_mul_f32 v104, v104, v18
    v_mul_f32 v105, v105, v18
    v_mul_f32 v106, v106, v18
    v_mul_f32 v107, v107, v18
    v_mul_f32 v116, v116, v18
    v_mul_f32 v117, v117, v18
    v_mul_f32 v118, v118, v18
    v_mul_f32 v119, v119, v18
    v_cvt_pk_bf16_f32 v164, v104, v105
    v_cvt_pk_bf16_f32 v165, v106, v107
    v_cvt_pk_bf16_f32 v166, v116, v117
    v_cvt_pk_bf16_f32 v167, v118, v119
    buffer_store_dwordx4 v[164:167], v2, s[36:39], s51 offen offset:3072 sc1
    v_mul_f32 v108, v108, v20
    v_mul_f32 v109, v109, v20
    v_mul_f32 v110, v110, v20
    v_mul_f32 v111, v111, v20
    v_mul_f32 v120, v120, v20
    v_mul_f32 v121, v121, v20
    v_mul_f32 v122, v122, v20
    v_mul_f32 v123, v123, v20
    v_cvt_pk_bf16_f32 v168, v108, v109
    v_cvt_pk_bf16_f32 v169, v110, v111
    v_cvt_pk_bf16_f32 v170, v120, v121
    v_cvt_pk_bf16_f32 v171, v122, v123
    buffer_store_dwordx4 v[168:171], v2, s[36:39], s52 offen offset:3072 sc1
    s_endpgm
attn_kernel_a_rare0:
    s_nop 11
    v_max3_f32 v22, v172, v173, v174
    v_max3_f32 v23, v175, v184, v185
    v_max3_f32 v22, v22, v186, v187
    v_max_f32 v22, v22, v23
    v_mov_b32 v23, v22
    s_nop 1
    v_permlane32_swap_b32 v22, v23
    v_max_f32 v22, v22, v23
    v_mov_b32 v23, v22
    s_nop 1
    v_permlane16_swap_b32 v22, v23
    v_max_f32 v22, v22, v23
    v_max_f32 v22, v220, v22
    v_sub_f32 v23, v220, v22
    v_exp_f32 v23, v23
    v_mov_b32 v220, v22
    v_sub_f32 v172, v172, v22
    v_sub_f32 v173, v173, v22
    v_sub_f32 v174, v174, v22
    v_sub_f32 v175, v175, v22
    v_sub_f32 v184, v184, v22
    v_sub_f32 v185, v185, v22
    v_sub_f32 v186, v186, v22
    v_sub_f32 v187, v187, v22
    v_mul_f32 v16, v0, v23
    v_mov_b32 v17, 0
    v_mul_f32 v28, v28, v23
    v_mul_f32 v29, v29, v23
    v_mul_f32 v30, v30, v23
    v_mul_f32 v31, v31, v23
    v_mul_f32 v40, v40, v23
    v_mul_f32 v41, v41, v23
    v_mul_f32 v42, v42, v23
    v_mul_f32 v43, v43, v23
    v_mul_f32 v52, v52, v23
    v_mul_f32 v53, v53, v23
    v_mul_f32 v54, v54, v23
    v_mul_f32 v55, v55, v23
    v_mul_f32 v64, v64, v23
    v_mul_f32 v65, v65, v23
    v_mul_f32 v66, v66, v23
    v_mul_f32 v67, v67, v23
    v_mul_f32 v76, v76, v23
    v_mul_f32 v77, v77, v23
    v_mul_f32 v78, v78, v23
    v_mul_f32 v79, v79, v23
    v_mul_f32 v88, v88, v23
    v_mul_f32 v89, v89, v23
    v_mul_f32 v90, v90, v23
    v_mul_f32 v91, v91, v23
    v_mul_f32 v100, v100, v23
    v_mul_f32 v101, v101, v23
    v_mul_f32 v102, v102, v23
    v_mul_f32 v103, v103, v23
    v_mul_f32 v112, v112, v23
    v_mul_f32 v113, v113, v23
    v_mul_f32 v114, v114, v23
    v_mul_f32 v115, v115, v23
    v_max3_f32 v22, v176, v177, v178
    v_max3_f32 v23, v179, v188, v189
    v_max3_f32 v22, v22, v190, v191
    v_max_f32 v22, v22, v23
    v_mov_b32 v23, v22
    s_nop 1
    v_permlane32_swap_b32 v22, v23
    v_max_f32 v22, v22, v23
    v_mov_b32 v23, v22
    s_nop 1
    v_permlane16_swap_b32 v22, v23
    v_max_f32 v22, v22, v23
    v_max_f32 v22, v221, v22
    v_sub_f32 v23, v221, v22
    v_exp_f32 v23, v23
    v_mov_b32 v221, v22
    v_sub_f32 v176, v176, v22
    v_sub_f32 v177, v177, v22
    v_sub_f32 v178, v178, v22
    v_sub_f32 v179, v179, v22
    v_sub_f32 v188, v188, v22
    v_sub_f32 v189, v189, v22
    v_sub_f32 v190, v190, v22
    v_sub_f32 v191, v191, v22
    v_mul_f32 v18, v2, v23
    v_mov_b32 v19, 0
    v_mul_f32 v32, v32, v23
    v_mul_f32 v33, v33, v23
    v_mul_f32 v34, v34, v23
    v_mul_f32 v35, v35, v23
    v_mul_f32 v44, v44, v23
    v_mul_f32 v45, v45, v23
    v_mul_f32 v46, v46, v23
    v_mul_f32 v47, v47, v23
    v_mul_f32 v56, v56, v23
    v_mul_f32 v57, v57, v23
    v_mul_f32 v58, v58, v23
    v_mul_f32 v59, v59, v23
    v_mul_f32 v68, v68, v23
    v_mul_f32 v69, v69, v23
    v_mul_f32 v70, v70, v23
    v_mul_f32 v71, v71, v23
    v_mul_f32 v80, v80, v23
    v_mul_f32 v81, v81, v23
    v_mul_f32 v82, v82, v23
    v_mul_f32 v83, v83, v23
    v_mul_f32 v92, v92, v23
    v_mul_f32 v93, v93, v23
    v_mul_f32 v94, v94, v23
    v_mul_f32 v95, v95, v23
    v_mul_f32 v104, v104, v23
    v_mul_f32 v105, v105, v23
    v_mul_f32 v106, v106, v23
    v_mul_f32 v107, v107, v23
    v_mul_f32 v116, v116, v23
    v_mul_f32 v117, v117, v23
    v_mul_f32 v118, v118, v23
    v_mul_f32 v119, v119, v23
    v_max3_f32 v22, v180, v181, v182
    v_max3_f32 v23, v183, v192, v193
    v_max3_f32 v22, v22, v194, v195
    v_max_f32 v22, v22, v23
    v_mov_b32 v23, v22
    s_nop 1
    v_permlane32_swap_b32 v22, v23
    v_max_f32 v22, v22, v23
    v_mov_b32 v23, v22
    s_nop 1
    v_permlane16_swap_b32 v22, v23
    v_max_f32 v22, v22, v23
    v_max_f32 v22, v222, v22
    v_sub_f32 v23, v222, v22
    v_exp_f32 v23, v23
    v_mov_b32 v222, v22
    v_sub_f32 v180, v180, v22
    v_sub_f32 v181, v181, v22
    v_sub_f32 v182, v182, v22
    v_sub_f32 v183, v183, v22
    v_sub_f32 v192, v192, v22
    v_sub_f32 v193, v193, v22
    v_sub_f32 v194, v194, v22
    v_sub_f32 v195, v195, v22
    v_mul_f32 v20, v3, v23
    v_mov_b32 v21, 0
    v_mul_f32 v36, v36, v23
    v_mul_f32 v37, v37, v23
    v_mul_f32 v38, v38, v23
    v_mul_f32 v39, v39, v23
    v_mul_f32 v48, v48, v23
    v_mul_f32 v49, v49, v23
    v_mul_f32 v50, v50, v23
    v_mul_f32 v51, v51, v23
    v_mul_f32 v60, v60, v23
    v_mul_f32 v61, v61, v23
    v_mul_f32 v62, v62, v23
    v_mul_f32 v63, v63, v23
    v_mul_f32 v72, v72, v23
    v_mul_f32 v73, v73, v23
    v_mul_f32 v74, v74, v23
    v_mul_f32 v75, v75, v23
    v_mul_f32 v84, v84, v23
    v_mul_f32 v85, v85, v23
    v_mul_f32 v86, v86, v23
    v_mul_f32 v87, v87, v23
    v_mul_f32 v96, v96, v23
    v_mul_f32 v97, v97, v23
    v_mul_f32 v98, v98, v23
    v_mul_f32 v99, v99, v23
    v_mul_f32 v108, v108, v23
    v_mul_f32 v109, v109, v23
    v_mul_f32 v110, v110, v23
    v_mul_f32 v111, v111, v23
    v_mul_f32 v120, v120, v23
    v_mul_f32 v121, v121, v23
    v_mul_f32 v122, v122, v23
    v_mul_f32 v123, v123, v23
    v_exp_f32 v22, v172
    v_exp_f32 v23, v173
    v_exp_f32 v24, v174
    v_exp_f32 v25, v175
    v_cvt_pk_bf16_f32 v196, v22, v23
    v_add_f32 v16, v16, v22
    v_add_f32 v17, v17, v23
    v_exp_f32 v26, v176
    v_exp_f32 v27, v177
    v_cvt_pk_bf16_f32 v197, v24, v25
    v_add_f32 v16, v16, v24
    v_add_f32 v17, v17, v25
    v_exp_f32 v22, v178
    v_exp_f32 v23, v179
    v_cvt_pk_bf16_f32 v200, v26, v27
    v_add_f32 v18, v18, v26
    v_add_f32 v19, v19, v27
    v_exp_f32 v24, v180
    v_exp_f32 v25, v181
    v_cvt_pk_bf16_f32 v201, v22, v23
    v_add_f32 v18, v18, v22
    v_add_f32 v19, v19, v23
    v_exp_f32 v26, v182
    v_exp_f32 v27, v183
    v_cvt_pk_bf16_f32 v204, v24, v25
    v_add_f32 v20, v20, v24
    v_add_f32 v21, v21, v25
    v_cvt_pk_bf16_f32 v205, v26, v27
    v_add_f32 v20, v20, v26
    v_add_f32 v21, v21, v27
    v_exp_f32 v22, v184
    v_exp_f32 v23, v185
    v_exp_f32 v24, v186
    v_exp_f32 v25, v187
    v_cvt_pk_bf16_f32 v198, v22, v23
    v_add_f32 v16, v16, v22
    v_add_f32 v17, v17, v23
    v_exp_f32 v26, v188
    v_exp_f32 v27, v189
    v_cvt_pk_bf16_f32 v199, v24, v25
    v_add_f32 v16, v16, v24
    v_add_f32 v17, v17, v25
    v_exp_f32 v22, v190
    v_exp_f32 v23, v191
    v_cvt_pk_bf16_f32 v202, v26, v27
    v_add_f32 v18, v18, v26
    v_add_f32 v19, v19, v27
    v_exp_f32 v24, v192
    v_exp_f32 v25, v193
    v_cvt_pk_bf16_f32 v203, v22, v23
    v_add_f32 v18, v18, v22
    v_add_f32 v19, v19, v23
    v_exp_f32 v26, v194
    v_exp_f32 v27, v195
    v_cvt_pk_bf16_f32 v206, v24, v25
    v_add_f32 v20, v20, v24
    v_add_f32 v21, v21, v25
    v_cvt_pk_bf16_f32 v207, v26, v27
    v_add_f32 v20, v20, v26
    v_add_f32 v21, v21, v27
    v_add_f32 v0, v16, v17
    v_add_f32 v2, v18, v19
    v_add_f32 v3, v20, v21
    s_nop 3
    s_setpc_b64 s[54:55]
attn_kernel_a_rare1:
    s_nop 11
    v_max3_f32 v22, v172, v173, v174
    v_max3_f32 v23, v175, v184, v185
    v_max3_f32 v22, v22, v186, v187
    v_max_f32 v22, v22, v23
    v_mov_b32 v23, v22
    s_nop 1
    v_permlane32_swap_b32 v22, v23
    v_max_f32 v22, v22, v23
    v_mov_b32 v23, v22
    s_nop 1
    v_permlane16_swap_b32 v22, v23
    v_max_f32 v22, v22, v23
    v_max_f32 v22, v220, v22
    v_sub_f32 v23, v220, v22
    v_exp_f32 v23, v23
    v_mov_b32 v220, v22
    v_sub_f32 v172, v172, v22
    v_sub_f32 v173, v173, v22
    v_sub_f32 v174, v174, v22
    v_sub_f32 v175, v175, v22
    v_sub_f32 v184, v184, v22
    v_sub_f32 v185, v185, v22
    v_sub_f32 v186, v186, v22
    v_sub_f32 v187, v187, v22
    v_mul_f32 v16, v0, v23
    v_mov_b32 v17, 0
    v_mul_f32 v28, v28, v23
    v_mul_f32 v29, v29, v23
    v_mul_f32 v30, v30, v23
    v_mul_f32 v31, v31, v23
    v_mul_f32 v40, v40, v23
    v_mul_f32 v41, v41, v23
    v_mul_f32 v42, v42, v23
    v_mul_f32 v43, v43, v23
    v_mul_f32 v52, v52, v23
    v_mul_f32 v53, v53, v23
    v_mul_f32 v54, v54, v23
    v_mul_f32 v55, v55, v23
    v_mul_f32 v64, v64, v23
    v_mul_f32 v65, v65, v23
    v_mul_f32 v66, v66, v23
    v_mul_f32 v67, v67, v23
    v_mul_f32 v76, v76, v23
    v_mul_f32 v77, v77, v23
    v_mul_f32 v78, v78, v23
    v_mul_f32 v79, v79, v23
    v_mul_f32 v88, v88, v23
    v_mul_f32 v89, v89, v23
    v_mul_f32 v90, v90, v23
    v_mul_f32 v91, v91, v23
    v_mul_f32 v100, v100, v23
    v_mul_f32 v101, v101, v23
    v_mul_f32 v102, v102, v23
    v_mul_f32 v103, v103, v23
    v_mul_f32 v112, v112, v23
    v_mul_f32 v113, v113, v23
    v_mul_f32 v114, v114, v23
    v_mul_f32 v115, v115, v23
    v_max3_f32 v22, v176, v177, v178
    v_max3_f32 v23, v179, v188, v189
    v_max3_f32 v22, v22, v190, v191
    v_max_f32 v22, v22, v23
    v_mov_b32 v23, v22
    s_nop 1
    v_permlane32_swap_b32 v22, v23
    v_max_f32 v22, v22, v23
    v_mov_b32 v23, v22
    s_nop 1
    v_permlane16_swap_b32 v22, v23
    v_max_f32 v22, v22, v23
    v_max_f32 v22, v221, v22
    v_sub_f32 v23, v221, v22
    v_exp_f32 v23, v23
    v_mov_b32 v221, v22
    v_sub_f32 v176, v176, v22
    v_sub_f32 v177, v177, v22
    v_sub_f32 v178, v178, v22
    v_sub_f32 v179, v179, v22
    v_sub_f32 v188, v188, v22
    v_sub_f32 v189, v189, v22
    v_sub_f32 v190, v190, v22
    v_sub_f32 v191, v191, v22
    v_mul_f32 v18, v2, v23
    v_mov_b32 v19, 0
    v_mul_f32 v32, v32, v23
    v_mul_f32 v33, v33, v23
    v_mul_f32 v34, v34, v23
    v_mul_f32 v35, v35, v23
    v_mul_f32 v44, v44, v23
    v_mul_f32 v45, v45, v23
    v_mul_f32 v46, v46, v23
    v_mul_f32 v47, v47, v23
    v_mul_f32 v56, v56, v23
    v_mul_f32 v57, v57, v23
    v_mul_f32 v58, v58, v23
    v_mul_f32 v59, v59, v23
    v_mul_f32 v68, v68, v23
    v_mul_f32 v69, v69, v23
    v_mul_f32 v70, v70, v23
    v_mul_f32 v71, v71, v23
    v_mul_f32 v80, v80, v23
    v_mul_f32 v81, v81, v23
    v_mul_f32 v82, v82, v23
    v_mul_f32 v83, v83, v23
    v_mul_f32 v92, v92, v23
    v_mul_f32 v93, v93, v23
    v_mul_f32 v94, v94, v23
    v_mul_f32 v95, v95, v23
    v_mul_f32 v104, v104, v23
    v_mul_f32 v105, v105, v23
    v_mul_f32 v106, v106, v23
    v_mul_f32 v107, v107, v23
    v_mul_f32 v116, v116, v23
    v_mul_f32 v117, v117, v23
    v_mul_f32 v118, v118, v23
    v_mul_f32 v119, v119, v23
    v_max3_f32 v22, v180, v181, v182
    v_max3_f32 v23, v183, v192, v193
    v_max3_f32 v22, v22, v194, v195
    v_max_f32 v22, v22, v23
    v_mov_b32 v23, v22
    s_nop 1
    v_permlane32_swap_b32 v22, v23
    v_max_f32 v22, v22, v23
    v_mov_b32 v23, v22
    s_nop 1
    v_permlane16_swap_b32 v22, v23
    v_max_f32 v22, v22, v23
    v_max_f32 v22, v222, v22
    v_sub_f32 v23, v222, v22
    v_exp_f32 v23, v23
    v_mov_b32 v222, v22
    v_sub_f32 v180, v180, v22
    v_sub_f32 v181, v181, v22
    v_sub_f32 v182, v182, v22
    v_sub_f32 v183, v183, v22
    v_sub_f32 v192, v192, v22
    v_sub_f32 v193, v193, v22
    v_sub_f32 v194, v194, v22
    v_sub_f32 v195, v195, v22
    v_mul_f32 v20, v3, v23
    v_mov_b32 v21, 0
    v_mul_f32 v36, v36, v23
    v_mul_f32 v37, v37, v23
    v_mul_f32 v38, v38, v23
    v_mul_f32 v39, v39, v23
    v_mul_f32 v48, v48, v23
    v_mul_f32 v49, v49, v23
    v_mul_f32 v50, v50, v23
    v_mul_f32 v51, v51, v23
    v_mul_f32 v60, v60, v23
    v_mul_f32 v61, v61, v23
    v_mul_f32 v62, v62, v23
    v_mul_f32 v63, v63, v23
    v_mul_f32 v72, v72, v23
    v_mul_f32 v73, v73, v23
    v_mul_f32 v74, v74, v23
    v_mul_f32 v75, v75, v23
    v_mul_f32 v84, v84, v23
    v_mul_f32 v85, v85, v23
    v_mul_f32 v86, v86, v23
    v_mul_f32 v87, v87, v23
    v_mul_f32 v96, v96, v23
    v_mul_f32 v97, v97, v23
    v_mul_f32 v98, v98, v23
    v_mul_f32 v99, v99, v23
    v_mul_f32 v108, v108, v23
    v_mul_f32 v109, v109, v23
    v_mul_f32 v110, v110, v23
    v_mul_f32 v111, v111, v23
    v_mul_f32 v120, v120, v23
    v_mul_f32 v121, v121, v23
    v_mul_f32 v122, v122, v23
    v_mul_f32 v123, v123, v23
    v_exp_f32 v22, v172
    v_exp_f32 v23, v173
    v_exp_f32 v24, v174
    v_exp_f32 v25, v175
    v_cvt_pk_bf16_f32 v208, v22, v23
    v_add_f32 v16, v16, v22
    v_add_f32 v17, v17, v23
    v_exp_f32 v26, v176
    v_exp_f32 v27, v177
    v_cvt_pk_bf16_f32 v209, v24, v25
    v_add_f32 v16, v16, v24
    v_add_f32 v17, v17, v25
    v_exp_f32 v22, v178
    v_exp_f32 v23, v179
    v_cvt_pk_bf16_f32 v212, v26, v27
    v_add_f32 v18, v18, v26
    v_add_f32 v19, v19, v27
    v_exp_f32 v24, v180
    v_exp_f32 v25, v181
    v_cvt_pk_bf16_f32 v213, v22, v23
    v_add_f32 v18, v18, v22
    v_add_f32 v19, v19, v23
    v_exp_f32 v26, v182
    v_exp_f32 v27, v183
    v_cvt_pk_bf16_f32 v216, v24, v25
    v_add_f32 v20, v20, v24
    v_add_f32 v21, v21, v25
    v_cvt_pk_bf16_f32 v217, v26, v27
    v_add_f32 v20, v20, v26
    v_add_f32 v21, v21, v27
    v_exp_f32 v22, v184
    v_exp_f32 v23, v185
    v_exp_f32 v24, v186
    v_exp_f32 v25, v187
    v_cvt_pk_bf16_f32 v210, v22, v23
    v_add_f32 v16, v16, v22
    v_add_f32 v17, v17, v23
    v_exp_f32 v26, v188
    v_exp_f32 v27, v189
    v_cvt_pk_bf16_f32 v211, v24, v25
    v_add_f32 v16, v16, v24
    v_add_f32 v17, v17, v25
    v_exp_f32 v22, v190
    v_exp_f32 v23, v191
    v_cvt_pk_bf16_f32 v214, v26, v27
    v_add_f32 v18, v18, v26
    v_add_f32 v19, v19, v27
    v_exp_f32 v24, v192
    v_exp_f32 v25, v193
    v_cvt_pk_bf16_f32 v215, v22, v23
    v_add_f32 v18, v18, v22
    v_add_f32 v19, v19, v23
    v_exp_f32 v26, v194
    v_exp_f32 v27, v195
    v_cvt_pk_bf16_f32 v218, v24, v25
    v_add_f32 v20, v20, v24
    v_add_f32 v21, v21, v25
    v_cvt_pk_bf16_f32 v219, v26, v27
    v_add_f32 v20, v20, v26
    v_add_f32 v21, v21, v27
    v_add_f32 v0, v16, v17
    v_add_f32 v2, v18, v19
    v_add_f32 v3, v20, v21
    s_nop 3
    s_setpc_b64 s[54:55]
attn_kernel_nt2:
    v_mul_u32_u24 v116, 4608, v22
    v_lshl_add_u32 v116, v24, 1, v116
    s_and_b32 s65, s60, 1
    s_lshl_b32 s41, s65, 12

    v_lshlrev_b32 v23, 1, v22
    v_xor_b32 v23, v23, v24
    v_lshlrev_b32 v23, 4, v23
    s_lshl_b32 s65, s65, 4
    v_add_u32 v25, s65, v22
    v_lshl_add_u32 v1, v25, 8, v23
    v_lshl_add_u32 v2, v25, 13, v23
    v_xor_b32 v117, 0x80, v1
    v_xor_b32 v118, 0x80, v2
    s_add_u32 m0, s41, 0
    s_mov_b32 s40, 0
    buffer_load_dwordx4 v2, s[32:35], s40 offen offset:0 lds
    s_mov_b32 s40, 31744
    buffer_load_dwordx4 v2, s[32:35], s40 offen offset:1024 lds
    s_mov_b32 s40, 63488
    buffer_load_dwordx4 v118, s[32:35], s40 offen offset:2048 lds
    s_mov_b32 s40, 95232
    buffer_load_dwordx4 v118, s[32:35], s40 offen offset:3072 lds
    s_add_u32 m0, s41, 8192
    s_mov_b32 s40, 262144
    buffer_load_dwordx4 v2, s[32:35], s40 offen offset:0 lds
    s_mov_b32 s40, 293888
    buffer_load_dwordx4 v2, s[32:35], s40 offen offset:1024 lds
    s_mov_b32 s40, 325632
    buffer_load_dwordx4 v118, s[32:35], s40 offen offset:2048 lds
    s_mov_b32 s40, 357376
    buffer_load_dwordx4 v118, s[32:35], s40 offen offset:3072 lds
    buffer_load_dwordx4 v[124:127], v3, s[20:23], s46 offen offset:0
    buffer_load_dwordx4 v[132:135], v3, s[20:23], s46 offen offset:64
    buffer_load_dwordx4 v[128:131], v3, s[20:23], s47 offen offset:0
    buffer_load_dwordx4 v[136:139], v3, s[20:23], s47 offen offset:64
    s_add_u32 m0, s41, 16384
    s_mov_b32 s40, 524288
    buffer_load_dwordx4 v2, s[32:35], s40 offen offset:0 lds
    s_mov_b32 s40, 556032
    buffer_load_dwordx4 v2, s[32:35], s40 offen offset:1024 lds
    s_mov_b32 s40, 587776
    buffer_load_dwordx4 v118, s[32:35], s40 offen offset:2048 lds
    s_mov_b32 s40, 619520
    buffer_load_dwordx4 v118, s[32:35], s40 offen offset:3072 lds
    s_add_u32 m0, s41, 24576
    s_mov_b32 s40, 786432
    buffer_load_dwordx4 v2, s[32:35], s40 offen offset:0 lds
    s_mov_b32 s40, 818176
    buffer_load_dwordx4 v2, s[32:35], s40 offen offset:1024 lds
    s_mov_b32 s40, 849920
    buffer_load_dwordx4 v118, s[32:35], s40 offen offset:2048 lds
    s_mov_b32 s40, 881664
    buffer_load_dwordx4 v118, s[32:35], s40 offen offset:3072 lds
    buffer_load_dwordx4 v[140:143], v3, s[20:23], s46 offen offset:128
    buffer_load_dwordx4 v[148:151], v3, s[20:23], s46 offen offset:192
    buffer_load_dwordx4 v[144:147], v3, s[20:23], s47 offen offset:128
    buffer_load_dwordx4 v[152:155], v3, s[20:23], s47 offen offset:192
    s_add_u32 m0, s41, 32768
    s_mov_b32 s40, 1048576
    buffer_load_dwordx4 v2, s[32:35], s40 offen offset:0 lds
    s_mov_b32 s40, 1080320
    buffer_load_dwordx4 v2, s[32:35], s40 offen offset:1024 lds
    s_mov_b32 s40, 1112064
    buffer_load_dwordx4 v118, s[32:35], s40 offen offset:2048 lds
    s_mov_b32 s40, 1143808
    buffer_load_dwordx4 v118, s[32:35], s40 offen offset:3072 lds
    s_add_u32 m0, s41, 40960
    s_mov_b32 s40, 1310720
    buffer_load_dwordx4 v2, s[32:35], s40 offen offset:0 lds
    s_mov_b32 s40, 1342464
    buffer_load_dwordx4 v2, s[32:35], s40 offen offset:1024 lds
    s_mov_b32 s40, 1374208
    buffer_load_dwordx4 v118, s[32:35], s40 offen offset:2048 lds
    s_mov_b32 s40, 1405952
    buffer_load_dwordx4 v118, s[32:35], s40 offen offset:3072 lds
    buffer_load_dwordx4 v[156:159], v3, s[20:23], s46 offen offset:256
    buffer_load_dwordx4 v[164:167], v3, s[20:23], s46 offen offset:320
    buffer_load_dwordx4 v[160:163], v3, s[20:23], s47 offen offset:256
    buffer_load_dwordx4 v[168:171], v3, s[20:23], s47 offen offset:320
    s_waitcnt vmcnt(27)
    ds_bpermute_b32 v196, v16, v124
    ds_bpermute_b32 v197, v16, v125
    ds_bpermute_b32 v198, v16, v126
    ds_bpermute_b32 v199, v16, v127
    s_waitcnt vmcnt(25)
    ds_bpermute_b32 v200, v16, v128
    ds_bpermute_b32 v201, v16, v129
    ds_bpermute_b32 v202, v16, v130
    ds_bpermute_b32 v203, v16, v131
    s_waitcnt lgkmcnt(0)
    s_barrier
    ds_read_b64_tr_b16 v[224:225], v8 offset:0
    ds_read_b64_tr_b16 v[226:227], v8 offset:1024
    ds_read_b64_tr_b16 v[228:229], v9 offset:0
    ds_read_b64_tr_b16 v[230:231], v9 offset:1024
    ds_read_b64_tr_b16 v[232:233], v10 offset:0
    ds_read_b64_tr_b16 v[234:235], v10 offset:1024
    ds_read_b64_tr_b16 v[236:237], v11 offset:0
    ds_read_b64_tr_b16 v[238:239], v11 offset:1024
    ds_read_b64_tr_b16 v[240:241], v12 offset:0
    ds_read_b64_tr_b16 v[242:243], v12 offset:1024
    ds_read_b64_tr_b16 v[244:245], v13 offset:0
    ds_read_b64_tr_b16 v[246:247], v13 offset:1024
    ds_read_b64_tr_b16 v[248:249], v14 offset:0
    ds_read_b64_tr_b16 v[250:251], v14 offset:1024
    ds_read_b64_tr_b16 v[252:253], v15 offset:0
    ds_read_b64_tr_b16 v[254:255], v15 offset:1024
    s_waitcnt lgkmcnt(14)
    v_mfma_f32_16x16x32_bf16 v[28:31], v[224:227], v[196:199], 0
    v_mfma_f32_16x16x32_bf16 v[32:35], v[224:227], v[200:203], 0
    ds_read_b64_tr_b16 v[224:225], v8 offset:8192
    ds_read_b64_tr_b16 v[226:227], v8 offset:9216
    s_waitcnt lgkmcnt(14)
    v_mfma_f32_16x16x32_bf16 v[36:39], v[228:231], v[196:199], 0
    s_add_u32 m0, s41, 49152
    s_mov_b32 s40, 1572864
    buffer_load_dwordx4 v2, s[32:35], s40 offen offset:0 lds
    ds_bpermute_b32 v204, v16, v132
    v_mfma_f32_16x16x32_bf16 v[40:43], v[228:231], v[200:203], 0
    ds_read_b64_tr_b16 v[228:229], v9 offset:8192
    ds_read_b64_tr_b16 v[230:231], v9 offset:9216
    ds_bpermute_b32 v205, v16, v133
    s_waitcnt lgkmcnt(15)
    v_mfma_f32_16x16x32_bf16 v[44:47], v[232:235], v[196:199], 0
    ds_bpermute_b32 v206, v16, v134
    v_mfma_f32_16x16x32_bf16 v[48:51], v[232:235], v[200:203], 0
    ds_read_b64_tr_b16 v[232:233], v10 offset:8192
    ds_read_b64_tr_b16 v[234:235], v10 offset:9216
    s_mov_b32 s40, 1604608
    buffer_load_dwordx4 v2, s[32:35], s40 offen offset:1024 lds
    ds_bpermute_b32 v207, v16, v135
    s_waitcnt lgkmcnt(15)
    v_mfma_f32_16x16x32_bf16 v[52:55], v[236:239], v[196:199], 0
    s_waitcnt vmcnt(26)
    ds_bpermute_b32 v208, v16, v136
    v_mfma_f32_16x16x32_bf16 v[56:59], v[236:239], v[200:203], 0
    ds_read_b64_tr_b16 v[236:237], v11 offset:8192
    ds_read_b64_tr_b16 v[238:239], v11 offset:9216
    ds_bpermute_b32 v209, v16, v137
    v_mfma_f32_16x16x32_bf16 v[60:63], v[240:243], v[196:199], 0
    s_mov_b32 s40, 1636352
    buffer_load_dwordx4 v118, s[32:35], s40 offen offset:2048 lds
    ds_bpermute_b32 v210, v16, v138
    v_mfma_f32_16x16x32_bf16 v[64:67], v[240:243], v[200:203], 0
    ds_read_b64_tr_b16 v[240:241], v12 offset:8192
    ds_read_b64_tr_b16 v[242:243], v12 offset:9216
    ds_bpermute_b32 v211, v16, v139
    s_waitcnt lgkmcnt(15)
    v_mfma_f32_16x16x32_bf16 v[68:71], v[244:247], v[196:199], 0
    buffer_load_dwordx4 v[124:127], v3, s[20:23], s46 offen offset:384
    v_mfma_f32_16x16x32_bf16 v[72:75], v[244:247], v[200:203], 0
    ds_read_b64_tr_b16 v[244:245], v13 offset:8192
    ds_read_b64_tr_b16 v[246:247], v13 offset:9216
    s_mov_b32 s40, 1668096
    buffer_load_dwordx4 v118, s[32:35], s40 offen offset:3072 lds
    buffer_load_dwordx4 v[132:135], v3, s[20:23], s46 offen offset:448
    v_mfma_f32_16x16x32_bf16 v[76:79], v[248:251], v[196:199], 0
    buffer_load_dwordx4 v[128:131], v3, s[20:23], s47 offen offset:384
    v_mfma_f32_16x16x32_bf16 v[80:83], v[248:251], v[200:203], 0
    ds_read_b64_tr_b16 v[248:249], v14 offset:8192
    ds_read_b64_tr_b16 v[250:251], v14 offset:9216
    buffer_load_dwordx4 v[136:139], v3, s[20:23], s47 offen offset:448
    v_mfma_f32_16x16x32_bf16 v[84:87], v[252:255], v[196:199], 0
    s_add_u32 m0, s41, 57344
    s_mov_b32 s40, 1835008
    buffer_load_dwordx4 v2, s[32:35], s40 offen offset:0 lds
    v_mfma_f32_16x16x32_bf16 v[88:91], v[252:255], v[200:203], 0
    ds_read_b64_tr_b16 v[252:253], v15 offset:8192
    ds_read_b64_tr_b16 v[254:255], v15 offset:9216
    s_waitcnt lgkmcnt(14)
    v_mfma_f32_16x16x32_bf16 v[28:31], v[224:227], v[204:207], v[28:31]
    s_waitcnt lgkmcnt(6)
    v_mfma_f32_16x16x32_bf16 v[32:35], v[224:227], v[208:211], v[32:35]
    s_mov_b32 s40, 1866752
    buffer_load_dwordx4 v2, s[32:35], s40 offen offset:1024 lds
    v_mfma_f32_16x16x32_bf16 v[36:39], v[228:231], v[204:207], v[36:39]
    s_waitcnt vmcnt(25)
    ds_bpermute_b32 v196, v16, v140
    v_mfma_f32_16x16x32_bf16 v[40:43], v[228:231], v[208:211], v[40:43]
    ds_bpermute_b32 v197, v16, v141
    v_mfma_f32_16x16x32_bf16 v[44:47], v[232:235], v[204:207], v[44:47]
    s_mov_b32 s40, 1898496
    buffer_load_dwordx4 v118, s[32:35], s40 offen offset:2048 lds
    ds_bpermute_b32 v198, v16, v142
    v_mfma_f32_16x16x32_bf16 v[48:51], v[232:235], v[208:211], v[48:51]
    ds_bpermute_b32 v199, v16, v143
    v_mfma_f32_16x16x32_bf16 v[52:55], v[236:239], v[204:207], v[52:55]
    s_waitcnt vmcnt(24)
    ds_bpermute_b32 v200, v16, v144
    v_mfma_f32_16x16x32_bf16 v[56:59], v[236:239], v[208:211], v[56:59]
    s_mov_b32 s40, 1930240
    buffer_load_dwordx4 v118, s[32:35], s40 offen offset:3072 lds
    ds_bpermute_b32 v201, v16, v145
    v_mfma_f32_16x16x32_bf16 v[60:63], v[240:243], v[204:207], v[60:63]
    ds_bpermute_b32 v202, v16, v146
    v_mfma_f32_16x16x32_bf16 v[64:67], v[240:243], v[208:211], v[64:67]
    s_waitcnt lgkmcnt(0)
    s_barrier
    ds_read_b64_tr_b16 v[224:225], v8 offset:16384
    ds_read_b64_tr_b16 v[226:227], v8 offset:17408
    ds_bpermute_b32 v203, v16, v147
    v_mfma_f32_16x16x32_bf16 v[68:71], v[244:247], v[204:207], v[68:71]
    ds_read_b64_tr_b16 v[228:229], v9 offset:16384
    ds_read_b64_tr_b16 v[230:231], v9 offset:17408
    s_add_u32 m0, s41, 0
    s_mov_b32 s40, 2097152
    buffer_load_dwordx4 v2, s[32:35], s40 offen offset:0 lds
    v_mfma_f32_16x16x32_bf16 v[72:75], v[244:247], v[208:211], v[72:75]
    ds_read_b64_tr_b16 v[232:233], v10 offset:16384
    ds_read_b64_tr_b16 v[234:235], v10 offset:17408
    v_mfma_f32_16x16x32_bf16 v[76:79], v[248:251], v[204:207], v[76:79]
    ds_read_b64_tr_b16 v[236:237], v11 offset:16384
    ds_read_b64_tr_b16 v[238:239], v11 offset:17408
    v_mfma_f32_16x16x32_bf16 v[80:83], v[248:251], v[208:211], v[80:83]
    ds_read_b64_tr_b16 v[240:241], v12 offset:16384
    ds_read_b64_tr_b16 v[242:243], v12 offset:17408
    s_mov_b32 s40, 2128896
    buffer_load_dwordx4 v2, s[32:35], s40 offen offset:1024 lds
    v_mfma_f32_16x16x32_bf16 v[84:87], v[252:255], v[204:207], v[84:87]
    ds_read_b64_tr_b16 v[244:245], v13 offset:16384
    ds_read_b64_tr_b16 v[246:247], v13 offset:17408
    v_mfma_f32_16x16x32_bf16 v[88:91], v[252:255], v[208:211], v[88:91]
    ds_read_b64_tr_b16 v[248:249], v14 offset:16384
    ds_read_b64_tr_b16 v[250:251], v14 offset:17408
    s_waitcnt lgkmcnt(13)
    v_mfma_f32_16x16x32_bf16 v[28:31], v[224:227], v[196:199], v[28:31]
    ds_read_b64_tr_b16 v[252:253], v15 offset:16384
    ds_read_b64_tr_b16 v[254:255], v15 offset:17408
    s_mov_b32 s40, 2160640
    buffer_load_dwordx4 v118, s[32:35], s40 offen offset:2048 lds
    s_waitcnt lgkmcnt(14)
    v_mfma_f32_16x16x32_bf16 v[32:35], v[224:227], v[200:203], v[32:35]
    ds_read_b64_tr_b16 v[224:225], v8 offset:24576
    ds_read_b64_tr_b16 v[226:227], v8 offset:25600
    s_waitcnt lgkmcnt(14)
    v_mfma_f32_16x16x32_bf16 v[36:39], v[228:231], v[196:199], v[36:39]
    ds_bpermute_b32 v204, v16, v148
    v_mfma_f32_16x16x32_bf16 v[40:43], v[228:231], v[200:203], v[40:43]
    ds_read_b64_tr_b16 v[228:229], v9 offset:24576
    ds_read_b64_tr_b16 v[230:231], v9 offset:25600
    s_mov_b32 s40, 2192384
    buffer_load_dwordx4 v118, s[32:35], s40 offen offset:3072 lds
    ds_bpermute_b32 v205, v16, v149
    s_waitcnt lgkmcnt(15)
    v_mfma_f32_16x16x32_bf16 v[44:47], v[232:235], v[196:199], v[44:47]
    ds_bpermute_b32 v206, v16, v150
    v_mfma_f32_16x16x32_bf16 v[48:51], v[232:235], v[200:203], v[48:51]
    ds_read_b64_tr_b16 v[232:233], v10 offset:24576
    ds_read_b64_tr_b16 v[234:235], v10 offset:25600
    ds_bpermute_b32 v207, v16, v151
    s_waitcnt lgkmcnt(15)
    v_mfma_f32_16x16x32_bf16 v[52:55], v[236:239], v[196:199], v[52:55]
    s_add_u32 m0, s41, 8192
    s_mov_b32 s40, 2359296
    buffer_load_dwordx4 v2, s[32:35], s40 offen offset:0 lds
    s_waitcnt vmcnt(29)
    ds_bpermute_b32 v208, v16, v152
    v_mfma_f32_16x16x32_bf16 v[56:59], v[236:239], v[200:203], v[56:59]
    ds_read_b64_tr_b16 v[236:237], v11 offset:24576
    ds_read_b64_tr_b16 v[238:239], v11 offset:25600
    ds_bpermute_b32 v209, v16, v153
    v_mfma_f32_16x16x32_bf16 v[60:63], v[240:243], v[196:199], v[60:63]
    ds_bpermute_b32 v210, v16, v154
    v_mfma_f32_16x16x32_bf16 v[64:67], v[240:243], v[200:203], v[64:67]
    ds_read_b64_tr_b16 v[240:241], v12 offset:24576
    ds_read_b64_tr_b16 v[242:243], v12 offset:25600
    s_mov_b32 s40, 2391040
    buffer_load_dwordx4 v2, s[32:35], s40 offen offset:1024 lds
    ds_bpermute_b32 v211, v16, v155
    s_waitcnt lgkmcnt(15)
    v_mfma_f32_16x16x32_bf16 v[68:71], v[244:247], v[196:199], v[68:71]
    buffer_load_dwordx4 v[140:143], v3, s[20:23], s46 offen offset:512
    v_mfma_f32_16x16x32_bf16 v[72:75], v[244:247], v[200:203], v[72:75]
    ds_read_b64_tr_b16 v[244:245], v13 offset:24576
    ds_read_b64_tr_b16 v[246:247], v13 offset:25600
    buffer_load_dwordx4 v[148:151], v3, s[20:23], s46 offen offset:576
    v_mfma_f32_16x16x32_bf16 v[76:79], v[248:251], v[196:199], v[76:79]
    s_mov_b32 s40, 2422784
    buffer_load_dwordx4 v118, s[32:35], s40 offen offset:2048 lds
    buffer_load_dwordx4 v[144:147], v3, s[20:23], s47 offen offset:512
    v_mfma_f32_16x16x32_bf16 v[80:83], v[248:251], v[200:203], v[80:83]
    ds_read_b64_tr_b16 v[248:249], v14 offset:24576
    ds_read_b64_tr_b16 v[250:251], v14 offset:25600
    buffer_load_dwordx4 v[152:155], v3, s[20:23], s47 offen offset:576
    v_mfma_f32_16x16x32_bf16 v[84:87], v[252:255], v[196:199], v[84:87]
    v_mfma_f32_16x16x32_bf16 v[88:91], v[252:255], v[200:203], v[88:91]
    ds_read_b64_tr_b16 v[252:253], v15 offset:24576
    ds_read_b64_tr_b16 v[254:255], v15 offset:25600
    s_mov_b32 s40, 2454528
    buffer_load_dwordx4 v118, s[32:35], s40 offen offset:3072 lds
    s_waitcnt lgkmcnt(14)
    v_mfma_f32_16x16x32_bf16 v[28:31], v[224:227], v[204:207], v[28:31]
    s_waitcnt lgkmcnt(6)
    v_mfma_f32_16x16x32_bf16 v[32:35], v[224:227], v[208:211], v[32:35]
    v_mfma_f32_16x16x32_bf16 v[36:39], v[228:231], v[204:207], v[36:39]
    s_waitcnt vmcnt(27)
    ds_bpermute_b32 v196, v16, v156
    v_mfma_f32_16x16x32_bf16 v[40:43], v[228:231], v[208:211], v[40:43]
    ds_bpermute_b32 v197, v16, v157
    v_mfma_f32_16x16x32_bf16 v[44:47], v[232:235], v[204:207], v[44:47]
    ds_bpermute_b32 v198, v16, v158
    v_mfma_f32_16x16x32_bf16 v[48:51], v[232:235], v[208:211], v[48:51]
    ds_bpermute_b32 v199, v16, v159
    v_mfma_f32_16x16x32_bf16 v[52:55], v[236:239], v[204:207], v[52:55]
    s_waitcnt vmcnt(25)
    ds_bpermute_b32 v200, v16, v160
    v_mfma_f32_16x16x32_bf16 v[56:59], v[236:239], v[208:211], v[56:59]
    ds_bpermute_b32 v201, v16, v161
    v_mfma_f32_16x16x32_bf16 v[60:63], v[240:243], v[204:207], v[60:63]
    ds_bpermute_b32 v202, v16, v162
    v_mfma_f32_16x16x32_bf16 v[64:67], v[240:243], v[208:211], v[64:67]
    s_waitcnt lgkmcnt(0)
    s_barrier
    ds_read_b64_tr_b16 v[224:225], v8 offset:32768
    ds_read_b64_tr_b16 v[226:227], v8 offset:33792
    ds_bpermute_b32 v203, v16, v163
    v_mfma_f32_16x16x32_bf16 v[68:71], v[244:247], v[204:207], v[68:71]
    ds_read_b64_tr_b16 v[228:229], v9 offset:32768
    ds_read_b64_tr_b16 v[230:231], v9 offset:33792
    v_mfma_f32_16x16x32_bf16 v[72:75], v[244:247], v[208:211], v[72:75]
    ds_read_b64_tr_b16 v[232:233], v10 offset:32768
    ds_read_b64_tr_b16 v[234:235], v10 offset:33792
    s_add_u32 m0, s41, 16384
    s_mov_b32 s40, 2621440
    buffer_load_dwordx4 v2, s[32:35], s40 offen offset:0 lds
    v_mfma_f32_16x16x32_bf16 v[76:79], v[248:251], v[204:207], v[76:79]
    ds_read_b64_tr_b16 v[236:237], v11 offset:32768
    ds_read_b64_tr_b16 v[238:239], v11 offset:33792
    v_mfma_f32_16x16x32_bf16 v[80:83], v[248:251], v[208:211], v[80:83]
    ds_read_b64_tr_b16 v[240:241], v12 offset:32768
    ds_read_b64_tr_b16 v[242:243], v12 offset:33792
    v_mfma_f32_16x16x32_bf16 v[84:87], v[252:255], v[204:207], v[84:87]
    ds_read_b64_tr_b16 v[244:245], v13 offset:32768
    ds_read_b64_tr_b16 v[246:247], v13 offset:33792
    s_mov_b32 s40, 2653184
    buffer_load_dwordx4 v2, s[32:35], s40 offen offset:1024 lds
    v_mfma_f32_16x16x32_bf16 v[88:91], v[252:255], v[208:211], v[88:91]
    ds_read_b64_tr_b16 v[248:249], v14 offset:32768
    ds_read_b64_tr_b16 v[250:251], v14 offset:33792
    s_waitcnt lgkmcnt(13)
    v_mfma_f32_16x16x32_bf16 v[28:31], v[224:227], v[196:199], v[28:31]
    ds_read_b64_tr_b16 v[252:253], v15 offset:32768
    ds_read_b64_tr_b16 v[254:255], v15 offset:33792
    s_waitcnt lgkmcnt(14)
    v_mfma_f32_16x16x32_bf16 v[32:35], v[224:227], v[200:203], v[32:35]
    ds_read_b64_tr_b16 v[224:225], v8 offset:40960
    ds_read_b64_tr_b16 v[226:227], v8 offset:41984
    s_mov_b32 s40, 2684928
    buffer_load_dwordx4 v118, s[32:35], s40 offen offset:2048 lds
    s_waitcnt lgkmcnt(14)
    v_mfma_f32_16x16x32_bf16 v[36:39], v[228:231], v[196:199], v[36:39]
    ds_bpermute_b32 v204, v16, v164
    v_mfma_f32_16x16x32_bf16 v[40:43], v[228:231], v[200:203], v[40:43]
    ds_read_b64_tr_b16 v[228:229], v9 offset:40960
    ds_read_b64_tr_b16 v[230:231], v9 offset:41984
    ds_bpermute_b32 v205, v16, v165
    s_waitcnt lgkmcnt(15)
    v_mfma_f32_16x16x32_bf16 v[44:47], v[232:235], v[196:199], v[44:47]
    s_mov_b32 s40, 2716672
    buffer_load_dwordx4 v118, s[32:35], s40 offen offset:3072 lds
    ds_bpermute_b32 v206, v16, v166
    v_mfma_f32_16x16x32_bf16 v[48:51], v[232:235], v[200:203], v[48:51]
    ds_read_b64_tr_b16 v[232:233], v10 offset:40960
    ds_read_b64_tr_b16 v[234:235], v10 offset:41984
    ds_bpermute_b32 v207, v16, v167
    s_waitcnt lgkmcnt(15)
    v_mfma_f32_16x16x32_bf16 v[52:55], v[236:239], v[196:199], v[52:55]
    s_waitcnt vmcnt(28)
    ds_bpermute_b32 v208, v16, v168
    v_mfma_f32_16x16x32_bf16 v[56:59], v[236:239], v[200:203], v[56:59]
    ds_read_b64_tr_b16 v[236:237], v11 offset:40960
    ds_read_b64_tr_b16 v[238:239], v11 offset:41984
    s_add_u32 m0, s41, 24576
    s_mov_b32 s40, 2883584
    buffer_load_dwordx4 v2, s[32:35], s40 offen offset:0 lds
    ds_bpermute_b32 v209, v16, v169
    v_mfma_f32_16x16x32_bf16 v[60:63], v[240:243], v[196:199], v[60:63]
    ds_bpermute_b32 v210, v16, v170
    v_mfma_f32_16x16x32_bf16 v[64:67], v[240:243], v[200:203], v[64:67]
    ds_read_b64_tr_b16 v[240:241], v12 offset:40960
    ds_read_b64_tr_b16 v[242:243], v12 offset:41984
    ds_bpermute_b32 v211, v16, v171
    s_waitcnt lgkmcnt(15)
    v_mfma_f32_16x16x32_bf16 v[68:71], v[244:247], v[196:199], v[68:71]
    s_mov_b32 s40, 2915328
    buffer_load_dwordx4 v2, s[32:35], s40 offen offset:1024 lds
    buffer_load_dwordx4 v[156:159], v3, s[20:23], s46 offen offset:640
    v_mfma_f32_16x16x32_bf16 v[72:75], v[244:247], v[200:203], v[72:75]
    ds_read_b64_tr_b16 v[244:245], v13 offset:40960
    ds_read_b64_tr_b16 v[246:247], v13 offset:41984
    buffer_load_dwordx4 v[164:167], v3, s[20:23], s46 offen offset:704
    v_mfma_f32_16x16x32_bf16 v[76:79], v[248:251], v[196:199], v[76:79]
    buffer_load_dwordx4 v[160:163], v3, s[20:23], s47 offen offset:640
    v_mfma_f32_16x16x32_bf16 v[80:83], v[248:251], v[200:203], v[80:83]
    ds_read_b64_tr_b16 v[248:249], v14 offset:40960
    ds_read_b64_tr_b16 v[250:251], v14 offset:41984
    s_mov_b32 s40, 2947072
    buffer_load_dwordx4 v118, s[32:35], s40 offen offset:2048 lds
    buffer_load_dwordx4 v[168:171], v3, s[20:23], s47 offen offset:704
    v_mfma_f32_16x16x32_bf16 v[84:87], v[252:255], v[196:199], v[84:87]
    v_mfma_f32_16x16x32_bf16 v[88:91], v[252:255], v[200:203], v[88:91]
    ds_read_b64_tr_b16 v[252:253], v15 offset:40960
    ds_read_b64_tr_b16 v[254:255], v15 offset:41984
    s_waitcnt lgkmcnt(14)
    v_mfma_f32_16x16x32_bf16 v[28:31], v[224:227], v[204:207], v[28:31]
    s_mov_b32 s40, 2978816
    buffer_load_dwordx4 v118, s[32:35], s40 offen offset:3072 lds
    s_waitcnt lgkmcnt(6)
    v_mfma_f32_16x16x32_bf16 v[32:35], v[224:227], v[208:211], v[32:35]
    v_mfma_f32_16x16x32_bf16 v[36:39], v[228:231], v[204:207], v[36:39]
    s_waitcnt vmcnt(32)
    ds_bpermute_b32 v196, v16, v124
    v_mfma_f32_16x16x32_bf16 v[40:43], v[228:231], v[208:211], v[40:43]
    ds_bpermute_b32 v197, v16, v125
    v_mfma_f32_16x16x32_bf16 v[44:47], v[232:235], v[204:207], v[44:47]
    ds_bpermute_b32 v198, v16, v126
    v_mfma_f32_16x16x32_bf16 v[48:51], v[232:235], v[208:211], v[48:51]
    ds_bpermute_b32 v199, v16, v127
    v_mfma_f32_16x16x32_bf16 v[52:55], v[236:239], v[204:207], v[52:55]
    s_waitcnt vmcnt(29)
    ds_bpermute_b32 v200, v16, v128
    v_mfma_f32_16x16x32_bf16 v[56:59], v[236:239], v[208:211], v[56:59]
    ds_bpermute_b32 v201, v16, v129
    v_mfma_f32_16x16x32_bf16 v[60:63], v[240:243], v[204:207], v[60:63]
    ds_bpermute_b32 v202, v16, v130
    v_mfma_f32_16x16x32_bf16 v[64:67], v[240:243], v[208:211], v[64:67]
    s_waitcnt vmcnt(24) lgkmcnt(0)
    s_barrier
    ds_read_b64_tr_b16 v[224:225], v8 offset:49152
    ds_read_b64_tr_b16 v[226:227], v8 offset:50176
    s_add_u32 m0, s41, 32768
    s_mov_b32 s40, 3145728
    buffer_load_dwordx4 v2, s[32:35], s40 offen offset:0 lds
    ds_bpermute_b32 v203, v16, v131
    v_mfma_f32_16x16x32_bf16 v[68:71], v[244:247], v[204:207], v[68:71]
    ds_read_b64_tr_b16 v[228:229], v9 offset:49152
    ds_read_b64_tr_b16 v[230:231], v9 offset:50176
    v_mfma_f32_16x16x32_bf16 v[72:75], v[244:247], v[208:211], v[72:75]
    ds_read_b64_tr_b16 v[232:233], v10 offset:49152
    ds_read_b64_tr_b16 v[234:235], v10 offset:50176
    v_mfma_f32_16x16x32_bf16 v[76:79], v[248:251], v[204:207], v[76:79]
    ds_read_b64_tr_b16 v[236:237], v11 offset:49152
    ds_read_b64_tr_b16 v[238:239], v11 offset:50176
    s_mov_b32 s40, 3177472
    buffer_load_dwordx4 v2, s[32:35], s40 offen offset:1024 lds
    v_mfma_f32_16x16x32_bf16 v[80:83], v[248:251], v[208:211], v[80:83]
    ds_read_b64_tr_b16 v[240:241], v12 offset:49152
    ds_read_b64_tr_b16 v[242:243], v12 offset:50176
    v_mfma_f32_16x16x32_bf16 v[84:87], v[252:255], v[204:207], v[84:87]
    ds_read_b64_tr_b16 v[244:245], v13 offset:49152
    ds_read_b64_tr_b16 v[246:247], v13 offset:50176
    v_mfma_f32_16x16x32_bf16 v[88:91], v[252:255], v[208:211], v[88:91]
    ds_read_b64_tr_b16 v[248:249], v14 offset:49152
    ds_read_b64_tr_b16 v[250:251], v14 offset:50176
    s_mov_b32 s40, 3209216
    buffer_load_dwordx4 v118, s[32:35], s40 offen offset:2048 lds
    s_waitcnt lgkmcnt(13)
    v_mfma_f32_16x16x32_bf16 v[28:31], v[224:227], v[196:199], v[28:31]
    ds_read_b64_tr_b16 v[252:253], v15 offset:49152
    ds_read_b64_tr_b16 v[254:255], v15 offset:50176
    s_waitcnt lgkmcnt(14)
    v_mfma_f32_16x16x32_bf16 v[32:35], v[224:227], v[200:203], v[32:35]
    ds_read_b64_tr_b16 v[224:225], v8 offset:57344
    ds_read_b64_tr_b16 v[226:227], v8 offset:58368
    s_waitcnt lgkmcnt(14)
    v_mfma_f32_16x16x32_bf16 v[36:39], v[228:231], v[196:199], v[36:39]
    s_mov_b32 s40, 3240960
    buffer_load_dwordx4 v118, s[32:35], s40 offen offset:3072 lds
    ds_bpermute_b32 v204, v16, v132
    v_mfma_f32_16x16x32_bf16 v[40:43], v[228:231], v[200:203], v[40:43]
    ds_read_b64_tr_b16 v[228:229], v9 offset:57344
    ds_read_b64_tr_b16 v[230:231], v9 offset:58368
    ds_bpermute_b32 v205, v16, v133
    s_waitcnt lgkmcnt(15)
    v_mfma_f32_16x16x32_bf16 v[44:47], v[232:235], v[196:199], v[44:47]
    ds_bpermute_b32 v206, v16, v134
    v_mfma_f32_16x16x32_bf16 v[48:51], v[232:235], v[200:203], v[48:51]
    ds_read_b64_tr_b16 v[232:233], v10 offset:57344
    ds_read_b64_tr_b16 v[234:235], v10 offset:58368
    s_add_u32 m0, s41, 40960
    s_mov_b32 s40, 3407872
    buffer_load_dwordx4 v2, s[32:35], s40 offen offset:0 lds
    ds_bpermute_b32 v207, v16, v135
    s_waitcnt lgkmcnt(15)
    v_mfma_f32_16x16x32_bf16 v[52:55], v[236:239], v[196:199], v[52:55]
    ds_bpermute_b32 v208, v16, v136
    v_mfma_f32_16x16x32_bf16 v[56:59], v[236:239], v[200:203], v[56:59]
    ds_read_b64_tr_b16 v[236:237], v11 offset:57344
    ds_read_b64_tr_b16 v[238:239], v11 offset:58368
    ds_bpermute_b32 v209, v16, v137
    v_mfma_f32_16x16x32_bf16 v[60:63], v[240:243], v[196:199], v[60:63]
    s_mov_b32 s40, 3439616
    buffer_load_dwordx4 v2, s[32:35], s40 offen offset:1024 lds
    ds_bpermute_b32 v210, v16, v138
    v_mfma_f32_16x16x32_bf16 v[64:67], v[240:243], v[200:203], v[64:67]
    ds_read_b64_tr_b16 v[240:241], v12 offset:57344
    ds_read_b64_tr_b16 v[242:243], v12 offset:58368
    ds_bpermute_b32 v211, v16, v139
    s_waitcnt lgkmcnt(15)
    v_mfma_f32_16x16x32_bf16 v[68:71], v[244:247], v[196:199], v[68:71]
    buffer_load_dwordx4 v[124:127], v3, s[20:23], s46 offen offset:768
    v_mfma_f32_16x16x32_bf16 v[72:75], v[244:247], v[200:203], v[72:75]
    ds_read_b64_tr_b16 v[244:245], v13 offset:57344
    ds_read_b64_tr_b16 v[246:247], v13 offset:58368
    s_mov_b32 s40, 3471360
    buffer_load_dwordx4 v118, s[32:35], s40 offen offset:2048 lds
    buffer_load_dwordx4 v[132:135], v3, s[20:23], s46 offen offset:832
    v_mfma_f32_16x16x32_bf16 v[76:79], v[248:251], v[196:199], v[76:79]
    buffer_load_dwordx4 v[128:131], v3, s[20:23], s47 offen offset:768
    v_mfma_f32_16x16x32_bf16 v[80:83], v[248:251], v[200:203], v[80:83]
    ds_read_b64_tr_b16 v[248:249], v14 offset:57344
    ds_read_b64_tr_b16 v[250:251], v14 offset:58368
    buffer_load_dwordx4 v[136:139], v3, s[20:23], s47 offen offset:832
    v_mfma_f32_16x16x32_bf16 v[84:87], v[252:255], v[196:199], v[84:87]
    s_mov_b32 s40, 3503104
    buffer_load_dwordx4 v118, s[32:35], s40 offen offset:3072 lds
    v_mfma_f32_16x16x32_bf16 v[88:91], v[252:255], v[200:203], v[88:91]
    ds_read_b64_tr_b16 v[252:253], v15 offset:57344
    ds_read_b64_tr_b16 v[254:255], v15 offset:58368
    s_waitcnt lgkmcnt(14)
    v_mfma_f32_16x16x32_bf16 v[28:31], v[224:227], v[204:207], v[28:31]
    s_waitcnt lgkmcnt(6)
    v_mfma_f32_16x16x32_bf16 v[32:35], v[224:227], v[208:211], v[32:35]
    v_mfma_f32_16x16x32_bf16 v[36:39], v[228:231], v[204:207], v[36:39]
    s_waitcnt vmcnt(29)
    ds_bpermute_b32 v196, v16, v140
    v_mfma_f32_16x16x32_bf16 v[40:43], v[228:231], v[208:211], v[40:43]
    ds_bpermute_b32 v197, v16, v141
    v_mfma_f32_16x16x32_bf16 v[44:47], v[232:235], v[204:207], v[44:47]
    ds_bpermute_b32 v198, v16, v142
    v_mfma_f32_16x16x32_bf16 v[48:51], v[232:235], v[208:211], v[48:51]
    ds_bpermute_b32 v199, v16, v143
    v_mfma_f32_16x16x32_bf16 v[52:55], v[236:239], v[204:207], v[52:55]
    s_waitcnt vmcnt(26)
    ds_bpermute_b32 v200, v16, v144
    v_mfma_f32_16x16x32_bf16 v[56:59], v[236:239], v[208:211], v[56:59]
    ds_bpermute_b32 v201, v16, v145
    v_mfma_f32_16x16x32_bf16 v[60:63], v[240:243], v[204:207], v[60:63]
    ds_bpermute_b32 v202, v16, v146
    v_mfma_f32_16x16x32_bf16 v[64:67], v[240:243], v[208:211], v[64:67]
    s_waitcnt vmcnt(24) lgkmcnt(0)
    s_barrier
    ds_read_b64_tr_b16 v[224:225], v8 offset:0
    ds_read_b64_tr_b16 v[226:227], v8 offset:1024
    ds_bpermute_b32 v203, v16, v147
    v_mfma_f32_16x16x32_bf16 v[68:71], v[244:247], v[204:207], v[68:71]
    ds_read_b64_tr_b16 v[228:229], v9 offset:0
    ds_read_b64_tr_b16 v[230:231], v9 offset:1024
    s_add_u32 m0, s41, 49152
    s_mov_b32 s40, 3670016
    buffer_load_dwordx4 v2, s[32:35], s40 offen offset:0 lds
    v_mfma_f32_16x16x32_bf16 v[72:75], v[244:247], v[208:211], v[72:75]
    ds_read_b64_tr_b16 v[232:233], v10 offset:0
    ds_read_b64_tr_b16 v[234:235], v10 offset:1024
    v_mfma_f32_16x16x32_bf16 v[76:79], v[248:251], v[204:207], v[76:79]
    ds_read_b64_tr_b16 v[236:237], v11 offset:0
    ds_read_b64_tr_b16 v[238:239], v11 offset:1024
    v_mfma_f32_16x16x32_bf16 v[80:83], v[248:251], v[208:211], v[80:83]
    ds_read_b64_tr_b16 v[240:241], v12 offset:0
    ds_read_b64_tr_b16 v[242:243], v12 offset:1024
    s_mov_b32 s40, 3701760
    buffer_load_dwordx4 v2, s[32:35], s40 offen offset:1024 lds
    v_mfma_f32_16x16x32_bf16 v[84:87], v[252:255], v[204:207], v[84:87]
    ds_read_b64_tr_b16 v[244:245], v13 offset:0
    ds_read_b64_tr_b16 v[246:247], v13 offset:1024
    v_mfma_f32_16x16x32_bf16 v[88:91], v[252:255], v[208:211], v[88:91]
    ds_read_b64_tr_b16 v[248:249], v14 offset:0
    ds_read_b64_tr_b16 v[250:251], v14 offset:1024
    s_waitcnt lgkmcnt(13)
    v_mfma_f32_16x16x32_bf16 v[28:31], v[224:227], v[196:199], v[28:31]
    ds_read_b64_tr_b16 v[252:253], v15 offset:0
    ds_read_b64_tr_b16 v[254:255], v15 offset:1024
    s_mov_b32 s40, 3733504
    buffer_load_dwordx4 v118, s[32:35], s40 offen offset:2048 lds
    s_waitcnt lgkmcnt(14)
    v_mfma_f32_16x16x32_bf16 v[32:35], v[224:227], v[200:203], v[32:35]
    ds_read_b64_tr_b16 v[224:225], v8 offset:8192
    ds_read_b64_tr_b16 v[226:227], v8 offset:9216
    s_waitcnt lgkmcnt(14)
    v_mfma_f32_16x16x32_bf16 v[36:39], v[228:231], v[196:199], v[36:39]
    ds_bpermute_b32 v204, v16, v148
    v_mfma_f32_16x16x32_bf16 v[40:43], v[228:231], v[200:203], v[40:43]
    ds_read_b64_tr_b16 v[228:229], v9 offset:8192
    ds_read_b64_tr_b16 v[230:231], v9 offset:9216
    s_mov_b32 s40, 3765248
    buffer_load_dwordx4 v118, s[32:35], s40 offen offset:3072 lds
    ds_bpermute_b32 v205, v16, v149
    s_waitcnt lgkmcnt(15)
    v_mfma_f32_16x16x32_bf16 v[44:47], v[232:235], v[196:199], v[44:47]
    ds_bpermute_b32 v206, v16, v150
    v_mfma_f32_16x16x32_bf16 v[48:51], v[232:235], v[200:203], v[48:51]
    ds_read_b64_tr_b16 v[232:233], v10 offset:8192
    ds_read_b64_tr_b16 v[234:235], v10 offset:9216
    ds_bpermute_b32 v207, v16, v151
    s_waitcnt lgkmcnt(15)
    v_mfma_f32_16x16x32_bf16 v[52:55], v[236:239], v[196:199], v[52:55]
    s_add_u32 m0, s41, 57344
    s_mov_b32 s40, 3932160
    buffer_load_dwordx4 v2, s[32:35], s40 offen offset:0 lds
    ds_bpermute_b32 v208, v16, v152
    v_mfma_f32_16x16x32_bf16 v[56:59], v[236:239], v[200:203], v[56:59]
    ds_read_b64_tr_b16 v[236:237], v11 offset:8192
    ds_read_b64_tr_b16 v[238:239], v11 offset:9216
    ds_bpermute_b32 v209, v16, v153
    v_mfma_f32_16x16x32_bf16 v[60:63], v[240:243], v[196:199], v[60:63]
    ds_bpermute_b32 v210, v16, v154
    v_mfma_f32_16x16x32_bf16 v[64:67], v[240:243], v[200:203], v[64:67]
    ds_read_b64_tr_b16 v[240:241], v12 offset:8192
    ds_read_b64_tr_b16 v[242:243], v12 offset:9216
    s_mov_b32 s40, 3963904
    buffer_load_dwordx4 v2, s[32:35], s40 offen offset:1024 lds
    ds_bpermute_b32 v211, v16, v155
    s_waitcnt lgkmcnt(15)
    v_mfma_f32_16x16x32_bf16 v[68:71], v[244:247], v[196:199], v[68:71]
    buffer_load_dwordx4 v[140:143], v3, s[20:23], s46 offen offset:896
    v_mfma_f32_16x16x32_bf16 v[72:75], v[244:247], v[200:203], v[72:75]
    ds_read_b64_tr_b16 v[244:245], v13 offset:8192
    ds_read_b64_tr_b16 v[246:247], v13 offset:9216
    buffer_load_dwordx4 v[148:151], v3, s[20:23], s46 offen offset:960
    v_mfma_f32_16x16x32_bf16 v[76:79], v[248:251], v[196:199], v[76:79]
    s_mov_b32 s40, 3995648
    buffer_load_dwordx4 v118, s[32:35], s40 offen offset:2048 lds
    buffer_load_dwordx4 v[144:147], v3, s[20:23], s47 offen offset:896
    v_mfma_f32_16x16x32_bf16 v[80:83], v[248:251], v[200:203], v[80:83]
    ds_read_b64_tr_b16 v[248:249], v14 offset:8192
    ds_read_b64_tr_b16 v[250:251], v14 offset:9216
    buffer_load_dwordx4 v[152:155], v3, s[20:23], s47 offen offset:960
    v_mfma_f32_16x16x32_bf16 v[84:87], v[252:255], v[196:199], v[84:87]
    v_mfma_f32_16x16x32_bf16 v[88:91], v[252:255], v[200:203], v[88:91]
    ds_read_b64_tr_b16 v[252:253], v15 offset:8192
    ds_read_b64_tr_b16 v[254:255], v15 offset:9216
    s_mov_b32 s40, 4027392
    buffer_load_dwordx4 v118, s[32:35], s40 offen offset:3072 lds
    s_waitcnt lgkmcnt(14)
    v_mfma_f32_16x16x32_bf16 v[28:31], v[224:227], v[204:207], v[28:31]
    s_waitcnt lgkmcnt(6)
    v_mfma_f32_16x16x32_bf16 v[32:35], v[224:227], v[208:211], v[32:35]
    v_mfma_f32_16x16x32_bf16 v[36:39], v[228:231], v[204:207], v[36:39]
    s_waitcnt vmcnt(29)
    ds_bpermute_b32 v196, v16, v156
    v_mfma_f32_16x16x32_bf16 v[40:43], v[228:231], v[208:211], v[40:43]
    ds_bpermute_b32 v197, v16, v157
    v_mfma_f32_16x16x32_bf16 v[44:47], v[232:235], v[204:207], v[44:47]
    ds_bpermute_b32 v198, v16, v158
    v_mfma_f32_16x16x32_bf16 v[48:51], v[232:235], v[208:211], v[48:51]
    ds_bpermute_b32 v199, v16, v159
    v_mfma_f32_16x16x32_bf16 v[52:55], v[236:239], v[204:207], v[52:55]
    s_waitcnt vmcnt(27)
    ds_bpermute_b32 v200, v16, v160
    v_mfma_f32_16x16x32_bf16 v[56:59], v[236:239], v[208:211], v[56:59]
    ds_bpermute_b32 v201, v16, v161
    v_mfma_f32_16x16x32_bf16 v[60:63], v[240:243], v[204:207], v[60:63]
    ds_bpermute_b32 v202, v16, v162
    v_mfma_f32_16x16x32_bf16 v[64:67], v[240:243], v[208:211], v[64:67]
    s_waitcnt vmcnt(24) lgkmcnt(0)
    s_barrier
    ds_read_b64_tr_b16 v[224:225], v8 offset:16384
    ds_read_b64_tr_b16 v[226:227], v8 offset:17408
    ds_bpermute_b32 v203, v16, v163
    v_mfma_f32_16x16x32_bf16 v[68:71], v[244:247], v[204:207], v[68:71]
    ds_read_b64_tr_b16 v[228:229], v9 offset:16384
    ds_read_b64_tr_b16 v[230:231], v9 offset:17408
    v_mfma_f32_16x16x32_bf16 v[72:75], v[244:247], v[208:211], v[72:75]
    ds_read_b64_tr_b16 v[232:233], v10 offset:16384
    ds_read_b64_tr_b16 v[234:235], v10 offset:17408
    s_add_u32 m0, s41, 0
    s_mov_b32 s40, 4194304
    buffer_load_dwordx4 v2, s[32:35], s40 offen offset:0 lds
    v_mfma_f32_16x16x32_bf16 v[76:79], v[248:251], v[204:207], v[76:79]
    ds_read_b64_tr_b16 v[236:237], v11 offset:16384
    ds_read_b64_tr_b16 v[238:239], v11 offset:17408
    v_mfma_f32_16x16x32_bf16 v[80:83], v[248:251], v[208:211], v[80:83]
    ds_read_b64_tr_b16 v[240:241], v12 offset:16384
    ds_read_b64_tr_b16 v[242:243], v12 offset:17408
    v_mfma_f32_16x16x32_bf16 v[84:87], v[252:255], v[204:207], v[84:87]
    ds_read_b64_tr_b16 v[244:245], v13 offset:16384
    ds_read_b64_tr_b16 v[246:247], v13 offset:17408
    s_mov_b32 s40, 4226048
    buffer_load_dwordx4 v2, s[32:35], s40 offen offset:1024 lds
    v_mfma_f32_16x16x32_bf16 v[88:91], v[252:255], v[208:211], v[88:91]
    ds_read_b64_tr_b16 v[248:249], v14 offset:16384
    ds_read_b64_tr_b16 v[250:251], v14 offset:17408
    s_waitcnt lgkmcnt(13)
    v_mfma_f32_16x16x32_bf16 v[28:31], v[224:227], v[196:199], v[28:31]
    ds_read_b64_tr_b16 v[252:253], v15 offset:16384
    ds_read_b64_tr_b16 v[254:255], v15 offset:17408
    s_waitcnt lgkmcnt(14)
    v_mfma_f32_16x16x32_bf16 v[32:35], v[224:227], v[200:203], v[32:35]
    ds_read_b64_tr_b16 v[224:225], v8 offset:24576
    ds_read_b64_tr_b16 v[226:227], v8 offset:25600
    s_mov_b32 s40, 4257792
    buffer_load_dwordx4 v118, s[32:35], s40 offen offset:2048 lds
    s_waitcnt lgkmcnt(14)
    v_mfma_f32_16x16x32_bf16 v[36:39], v[228:231], v[196:199], v[36:39]
    ds_bpermute_b32 v204, v16, v164
    v_mfma_f32_16x16x32_bf16 v[40:43], v[228:231], v[200:203], v[40:43]
    ds_read_b64_tr_b16 v[228:229], v9 offset:24576
    ds_read_b64_tr_b16 v[230:231], v9 offset:25600
    ds_bpermute_b32 v205, v16, v165
    s_waitcnt lgkmcnt(15)
    v_mfma_f32_16x16x32_bf16 v[44:47], v[232:235], v[196:199], v[44:47]
    s_mov_b32 s40, 4289536
    buffer_load_dwordx4 v118, s[32:35], s40 offen offset:3072 lds
    ds_bpermute_b32 v206, v16, v166
    v_mfma_f32_16x16x32_bf16 v[48:51], v[232:235], v[200:203], v[48:51]
    ds_read_b64_tr_b16 v[232:233], v10 offset:24576
    ds_read_b64_tr_b16 v[234:235], v10 offset:25600
    ds_bpermute_b32 v207, v16, v167
    s_waitcnt lgkmcnt(15)
    v_mfma_f32_16x16x32_bf16 v[52:55], v[236:239], v[196:199], v[52:55]
    ds_bpermute_b32 v208, v16, v168
    v_mfma_f32_16x16x32_bf16 v[56:59], v[236:239], v[200:203], v[56:59]
    ds_read_b64_tr_b16 v[236:237], v11 offset:24576
    ds_read_b64_tr_b16 v[238:239], v11 offset:25600
    s_add_u32 m0, s41, 8192
    s_mov_b32 s40, 4456448
    buffer_load_dwordx4 v2, s[32:35], s40 offen offset:0 lds
    ds_bpermute_b32 v209, v16, v169
    v_mfma_f32_16x16x32_bf16 v[60:63], v[240:243], v[196:199], v[60:63]
    ds_bpermute_b32 v210, v16, v170
    v_mfma_f32_16x16x32_bf16 v[64:67], v[240:243], v[200:203], v[64:67]
    ds_read_b64_tr_b16 v[240:241], v12 offset:24576
    ds_read_b64_tr_b16 v[242:243], v12 offset:25600
    ds_bpermute_b32 v211, v16, v171
    s_waitcnt lgkmcnt(15)
    v_mfma_f32_16x16x32_bf16 v[68:71], v[244:247], v[196:199], v[68:71]
    s_mov_b32 s40, 4488192
    buffer_load_dwordx4 v2, s[32:35], s40 offen offset:1024 lds
    buffer_load_dwordx4 v[156:159], v3, s[20:23], s46 offen offset:1024
    v_mfma_f32_16x16x32_bf16 v[72:75], v[244:247], v[200:203], v[72:75]
    ds_read_b64_tr_b16 v[244:245], v13 offset:24576
    ds_read_b64_tr_b16 v[246:247], v13 offset:25600
    buffer_load_dwordx4 v[164:167], v3, s[20:23], s46 offen offset:1088
    v_mfma_f32_16x16x32_bf16 v[76:79], v[248:251], v[196:199], v[76:79]
    buffer_load_dwordx4 v[160:163], v3, s[20:23], s47 offen offset:1024
    v_mfma_f32_16x16x32_bf16 v[80:83], v[248:251], v[200:203], v[80:83]
    ds_read_b64_tr_b16 v[248:249], v14 offset:24576
    ds_read_b64_tr_b16 v[250:251], v14 offset:25600
    s_mov_b32 s40, 4519936
    buffer_load_dwordx4 v118, s[32:35], s40 offen offset:2048 lds
    buffer_load_dwordx4 v[168:171], v3, s[20:23], s47 offen offset:1088
    v_mfma_f32_16x16x32_bf16 v[84:87], v[252:255], v[196:199], v[84:87]
    v_mfma_f32_16x16x32_bf16 v[88:91], v[252:255], v[200:203], v[88:91]
    ds_read_b64_tr_b16 v[252:253], v15 offset:24576
    ds_read_b64_tr_b16 v[254:255], v15 offset:25600
    s_waitcnt lgkmcnt(14)
    v_mfma_f32_16x16x32_bf16 v[28:31], v[224:227], v[204:207], v[28:31]
    s_mov_b32 s40, 4551680
    buffer_load_dwordx4 v118, s[32:35], s40 offen offset:3072 lds
    s_waitcnt lgkmcnt(6)
    v_mfma_f32_16x16x32_bf16 v[32:35], v[224:227], v[208:211], v[32:35]
    v_mfma_f32_16x16x32_bf16 v[36:39], v[228:231], v[204:207], v[36:39]
    s_waitcnt vmcnt(29)
    ds_bpermute_b32 v196, v16, v124
    v_mfma_f32_16x16x32_bf16 v[40:43], v[228:231], v[208:211], v[40:43]
    ds_bpermute_b32 v197, v16, v125
    v_mfma_f32_16x16x32_bf16 v[44:47], v[232:235], v[204:207], v[44:47]
    ds_bpermute_b32 v198, v16, v126
    v_mfma_f32_16x16x32_bf16 v[48:51], v[232:235], v[208:211], v[48:51]
    ds_bpermute_b32 v199, v16, v127
    v_mfma_f32_16x16x32_bf16 v[52:55], v[236:239], v[204:207], v[52:55]
    s_waitcnt vmcnt(26)
    ds_bpermute_b32 v200, v16, v128
    v_mfma_f32_16x16x32_bf16 v[56:59], v[236:239], v[208:211], v[56:59]
    ds_bpermute_b32 v201, v16, v129
    v_mfma_f32_16x16x32_bf16 v[60:63], v[240:243], v[204:207], v[60:63]
    ds_bpermute_b32 v202, v16, v130
    v_mfma_f32_16x16x32_bf16 v[64:67], v[240:243], v[208:211], v[64:67]
    s_waitcnt vmcnt(24) lgkmcnt(0)
    s_barrier
    ds_read_b64_tr_b16 v[224:225], v8 offset:32768
    ds_read_b64_tr_b16 v[226:227], v8 offset:33792
    s_add_u32 m0, s41, 16384
    s_mov_b32 s40, 0
    buffer_load_dwordx4 v1, s[24:27], s40 offen offset:0 nt lds
    ds_bpermute_b32 v203, v16, v131
    v_mfma_f32_16x16x32_bf16 v[68:71], v[244:247], v[204:207], v[68:71]
    ds_read_b64_tr_b16 v[228:229], v9 offset:32768
    ds_read_b64_tr_b16 v[230:231], v9 offset:33792
    v_mfma_f32_16x16x32_bf16 v[72:75], v[244:247], v[208:211], v[72:75]
    ds_read_b64_tr_b16 v[232:233], v10 offset:32768
    ds_read_b64_tr_b16 v[234:235], v10 offset:33792
    v_mfma_f32_16x16x32_bf16 v[76:79], v[248:251], v[204:207], v[76:79]
    ds_read_b64_tr_b16 v[236:237], v11 offset:32768
    ds_read_b64_tr_b16 v[238:239], v11 offset:33792
    buffer_load_dwordx4 v1, s[24:27], s40 offen offset:1024 nt lds
    v_mfma_f32_16x16x32_bf16 v[80:83], v[248:251], v[208:211], v[80:83]
    ds_read_b64_tr_b16 v[240:241], v12 offset:32768
    ds_read_b64_tr_b16 v[242:243], v12 offset:33792
    v_mfma_f32_16x16x32_bf16 v[84:87], v[252:255], v[204:207], v[84:87]
    ds_read_b64_tr_b16 v[244:245], v13 offset:32768
    ds_read_b64_tr_b16 v[246:247], v13 offset:33792
    v_mfma_f32_16x16x32_bf16 v[88:91], v[252:255], v[208:211], v[88:91]
    ds_read_b64_tr_b16 v[248:249], v14 offset:32768
    ds_read_b64_tr_b16 v[250:251], v14 offset:33792
    buffer_load_dwordx4 v117, s[24:27], s40 offen offset:2048 nt lds
    s_waitcnt lgkmcnt(13)
    v_mfma_f32_16x16x32_bf16 v[28:31], v[224:227], v[196:199], v[28:31]
    ds_read_b64_tr_b16 v[252:253], v15 offset:32768
    ds_read_b64_tr_b16 v[254:255], v15 offset:33792
    s_waitcnt lgkmcnt(14)
    v_mfma_f32_16x16x32_bf16 v[32:35], v[224:227], v[200:203], v[32:35]
    ds_read_b64_tr_b16 v[224:225], v8 offset:40960
    ds_read_b64_tr_b16 v[226:227], v8 offset:41984
    s_waitcnt lgkmcnt(14)
    v_mfma_f32_16x16x32_bf16 v[36:39], v[228:231], v[196:199], v[36:39]
    buffer_load_dwordx4 v117, s[24:27], s40 offen offset:3072 nt lds
    ds_bpermute_b32 v204, v16, v132
    v_mfma_f32_16x16x32_bf16 v[40:43], v[228:231], v[200:203], v[40:43]
    ds_read_b64_tr_b16 v[228:229], v9 offset:40960
    ds_read_b64_tr_b16 v[230:231], v9 offset:41984
    ds_bpermute_b32 v205, v16, v133
    s_waitcnt lgkmcnt(15)
    v_mfma_f32_16x16x32_bf16 v[44:47], v[232:235], v[196:199], v[44:47]
    ds_bpermute_b32 v206, v16, v134
    v_mfma_f32_16x16x32_bf16 v[48:51], v[232:235], v[200:203], v[48:51]
    ds_read_b64_tr_b16 v[232:233], v10 offset:40960
    ds_read_b64_tr_b16 v[234:235], v10 offset:41984
    s_add_u32 m0, s41, 24576
    s_mov_b32 s40, 8192
    buffer_load_dwordx4 v1, s[24:27], s40 offen offset:0 nt lds
    ds_bpermute_b32 v207, v16, v135
    s_waitcnt lgkmcnt(15)
    v_mfma_f32_16x16x32_bf16 v[52:55], v[236:239], v[196:199], v[52:55]
    ds_bpermute_b32 v208, v16, v136
    v_mfma_f32_16x16x32_bf16 v[56:59], v[236:239], v[200:203], v[56:59]
    ds_read_b64_tr_b16 v[236:237], v11 offset:40960
    ds_read_b64_tr_b16 v[238:239], v11 offset:41984
    ds_bpermute_b32 v209, v16, v137
    v_mfma_f32_16x16x32_bf16 v[60:63], v[240:243], v[196:199], v[60:63]
    buffer_load_dwordx4 v1, s[24:27], s40 offen offset:1024 nt lds
    ds_bpermute_b32 v210, v16, v138
    v_mfma_f32_16x16x32_bf16 v[64:67], v[240:243], v[200:203], v[64:67]
    ds_read_b64_tr_b16 v[240:241], v12 offset:40960
    ds_read_b64_tr_b16 v[242:243], v12 offset:41984
    ds_bpermute_b32 v211, v16, v139
    s_waitcnt lgkmcnt(15)
    v_mfma_f32_16x16x32_bf16 v[68:71], v[244:247], v[196:199], v[68:71]
    v_mfma_f32_16x16x32_bf16 v[72:75], v[244:247], v[200:203], v[72:75]
    ds_read_b64_tr_b16 v[244:245], v13 offset:40960
    ds_read_b64_tr_b16 v[246:247], v13 offset:41984
    buffer_load_dwordx4 v117, s[24:27], s40 offen offset:2048 nt lds
    v_mfma_f32_16x16x32_bf16 v[76:79], v[248:251], v[196:199], v[76:79]
    v_mfma_f32_16x16x32_bf16 v[80:83], v[248:251], v[200:203], v[80:83]
    ds_read_b64_tr_b16 v[248:249], v14 offset:40960
    ds_read_b64_tr_b16 v[250:251], v14 offset:41984
    v_mfma_f32_16x16x32_bf16 v[84:87], v[252:255], v[196:199], v[84:87]
    buffer_load_dwordx4 v117, s[24:27], s40 offen offset:3072 nt lds
    v_mfma_f32_16x16x32_bf16 v[88:91], v[252:255], v[200:203], v[88:91]
    ds_read_b64_tr_b16 v[252:253], v15 offset:40960
    ds_read_b64_tr_b16 v[254:255], v15 offset:41984
    s_waitcnt lgkmcnt(14)
    v_mfma_f32_16x16x32_bf16 v[28:31], v[224:227], v[204:207], v[28:31]
    s_waitcnt lgkmcnt(6)
    v_mfma_f32_16x16x32_bf16 v[32:35], v[224:227], v[208:211], v[32:35]
    v_mfma_f32_16x16x32_bf16 v[36:39], v[228:231], v[204:207], v[36:39]
    s_waitcnt vmcnt(25)
    ds_bpermute_b32 v196, v16, v140
    v_mfma_f32_16x16x32_bf16 v[40:43], v[228:231], v[208:211], v[40:43]
    ds_bpermute_b32 v197, v16, v141
    v_mfma_f32_16x16x32_bf16 v[44:47], v[232:235], v[204:207], v[44:47]
    ds_bpermute_b32 v198, v16, v142
    v_mfma_f32_16x16x32_bf16 v[48:51], v[232:235], v[208:211], v[48:51]
    ds_bpermute_b32 v199, v16, v143
    v_mfma_f32_16x16x32_bf16 v[52:55], v[236:239], v[204:207], v[52:55]
    s_waitcnt vmcnt(22)
    ds_bpermute_b32 v200, v16, v144
    v_mfma_f32_16x16x32_bf16 v[56:59], v[236:239], v[208:211], v[56:59]
    ds_bpermute_b32 v201, v16, v145
    v_mfma_f32_16x16x32_bf16 v[60:63], v[240:243], v[204:207], v[60:63]
    ds_bpermute_b32 v202, v16, v146
    v_mfma_f32_16x16x32_bf16 v[64:67], v[240:243], v[208:211], v[64:67]
    s_waitcnt vmcnt(20) lgkmcnt(0)
    s_barrier
    ds_read_b64_tr_b16 v[224:225], v8 offset:49152
    ds_read_b64_tr_b16 v[226:227], v8 offset:50176
    ds_bpermute_b32 v203, v16, v147
    v_mfma_f32_16x16x32_bf16 v[68:71], v[244:247], v[204:207], v[68:71]
    ds_read_b64_tr_b16 v[228:229], v9 offset:49152
    ds_read_b64_tr_b16 v[230:231], v9 offset:50176
    s_add_u32 m0, s41, 32768
    s_mov_b32 s40, 0
    buffer_load_dwordx4 v1, s[28:31], s40 offen offset:0 nt lds
    v_mfma_f32_16x16x32_bf16 v[72:75], v[244:247], v[208:211], v[72:75]
    ds_read_b64_tr_b16 v[232:233], v10 offset:49152
    ds_read_b64_tr_b16 v[234:235], v10 offset:50176
    v_mfma_f32_16x16x32_bf16 v[76:79], v[248:251], v[204:207], v[76:79]
    ds_read_b64_tr_b16 v[236:237], v11 offset:49152
    ds_read_b64_tr_b16 v[238:239], v11 offset:50176
    v_mfma_f32_16x16x32_bf16 v[80:83], v[248:251], v[208:211], v[80:83]
    ds_read_b64_tr_b16 v[240:241], v12 offset:49152
    ds_read_b64_tr_b16 v[242:243], v12 offset:50176
    buffer_load_dwordx4 v1, s[28:31], s40 offen offset:1024 nt lds
    v_mfma_f32_16x16x32_bf16 v[84:87], v[252:255], v[204:207], v[84:87]
    ds_read_b64_tr_b16 v[244:245], v13 offset:49152
    ds_read_b64_tr_b16 v[246:247], v13 offset:50176
    v_mfma_f32_16x16x32_bf16 v[88:91], v[252:255], v[208:211], v[88:91]
    ds_read_b64_tr_b16 v[248:249], v14 offset:49152
    ds_read_b64_tr_b16 v[250:251], v14 offset:50176
    s_waitcnt lgkmcnt(13)
    v_mfma_f32_16x16x32_bf16 v[28:31], v[224:227], v[196:199], v[28:31]
    ds_read_b64_tr_b16 v[252:253], v15 offset:49152
    ds_read_b64_tr_b16 v[254:255], v15 offset:50176
    buffer_load_dwordx4 v117, s[28:31], s40 offen offset:2048 nt lds
    s_waitcnt lgkmcnt(14)
    v_mfma_f32_16x16x32_bf16 v[32:35], v[224:227], v[200:203], v[32:35]
    ds_read_b64_tr_b16 v[224:225], v8 offset:57344
    ds_read_b64_tr_b16 v[226:227], v8 offset:58368
    s_waitcnt lgkmcnt(14)
    v_mfma_f32_16x16x32_bf16 v[36:39], v[228:231], v[196:199], v[36:39]
    ds_bpermute_b32 v204, v16, v148
    v_mfma_f32_16x16x32_bf16 v[40:43], v[228:231], v[200:203], v[40:43]
    ds_read_b64_tr_b16 v[228:229], v9 offset:57344
    ds_read_b64_tr_b16 v[230:231], v9 offset:58368
    buffer_load_dwordx4 v117, s[28:31], s40 offen offset:3072 nt lds
    ds_bpermute_b32 v205, v16, v149
    s_waitcnt lgkmcnt(15)
    v_mfma_f32_16x16x32_bf16 v[44:47], v[232:235], v[196:199], v[44:47]
    ds_bpermute_b32 v206, v16, v150
    v_mfma_f32_16x16x32_bf16 v[48:51], v[232:235], v[200:203], v[48:51]
    ds_read_b64_tr_b16 v[232:233], v10 offset:57344
    ds_read_b64_tr_b16 v[234:235], v10 offset:58368
    ds_bpermute_b32 v207, v16, v151
    s_waitcnt lgkmcnt(15)
    v_mfma_f32_16x16x32_bf16 v[52:55], v[236:239], v[196:199], v[52:55]
    s_add_u32 m0, s41, 40960
    s_mov_b32 s40, 16384
    buffer_load_dwordx4 v1, s[24:27], s40 offen offset:0 nt lds
    ds_bpermute_b32 v208, v16, v152
    v_mfma_f32_16x16x32_bf16 v[56:59], v[236:239], v[200:203], v[56:59]
    ds_read_b64_tr_b16 v[236:237], v11 offset:57344
    ds_read_b64_tr_b16 v[238:239], v11 offset:58368
    ds_bpermute_b32 v209, v16, v153
    v_mfma_f32_16x16x32_bf16 v[60:63], v[240:243], v[196:199], v[60:63]
    ds_bpermute_b32 v210, v16, v154
    v_mfma_f32_16x16x32_bf16 v[64:67], v[240:243], v[200:203], v[64:67]
    ds_read_b64_tr_b16 v[240:241], v12 offset:57344
    ds_read_b64_tr_b16 v[242:243], v12 offset:58368
    buffer_load_dwordx4 v1, s[24:27], s40 offen offset:1024 nt lds
    ds_bpermute_b32 v211, v16, v155
    s_waitcnt lgkmcnt(15)
    v_mfma_f32_16x16x32_bf16 v[68:71], v[244:247], v[196:199], v[68:71]
    v_mfma_f32_16x16x32_bf16 v[72:75], v[244:247], v[200:203], v[72:75]
    ds_read_b64_tr_b16 v[244:245], v13 offset:57344
    ds_read_b64_tr_b16 v[246:247], v13 offset:58368
    v_mfma_f32_16x16x32_bf16 v[76:79], v[248:251], v[196:199], v[76:79]
    buffer_load_dwordx4 v117, s[24:27], s40 offen offset:2048 nt lds
    v_mfma_f32_16x16x32_bf16 v[80:83], v[248:251], v[200:203], v[80:83]
    ds_read_b64_tr_b16 v[248:249], v14 offset:57344
    ds_read_b64_tr_b16 v[250:251], v14 offset:58368
    v_mfma_f32_16x16x32_bf16 v[84:87], v[252:255], v[196:199], v[84:87]
    v_mfma_f32_16x16x32_bf16 v[88:91], v[252:255], v[200:203], v[88:91]
    ds_read_b64_tr_b16 v[252:253], v15 offset:57344
    ds_read_b64_tr_b16 v[254:255], v15 offset:58368
    buffer_load_dwordx4 v117, s[24:27], s40 offen offset:3072 nt lds
    s_waitcnt lgkmcnt(14)
    v_mfma_f32_16x16x32_bf16 v[28:31], v[224:227], v[204:207], v[28:31]
    s_waitcnt lgkmcnt(6)
    v_mfma_f32_16x16x32_bf16 v[32:35], v[224:227], v[208:211], v[32:35]
    v_mfma_f32_16x16x32_bf16 v[36:39], v[228:231], v[204:207], v[36:39]
    s_waitcnt vmcnt(21)
    ds_bpermute_b32 v196, v16, v156
    v_mfma_f32_16x16x32_bf16 v[40:43], v[228:231], v[208:211], v[40:43]
    ds_bpermute_b32 v197, v16, v157
    v_mfma_f32_16x16x32_bf16 v[44:47], v[232:235], v[204:207], v[44:47]
    ds_bpermute_b32 v198, v16, v158
    v_mfma_f32_16x16x32_bf16 v[48:51], v[232:235], v[208:211], v[48:51]
    ds_bpermute_b32 v199, v16, v159
    v_mfma_f32_16x16x32_bf16 v[52:55], v[236:239], v[204:207], v[52:55]
    s_waitcnt vmcnt(19)
    ds_bpermute_b32 v200, v16, v160
    v_mfma_f32_16x16x32_bf16 v[56:59], v[236:239], v[208:211], v[56:59]
    ds_bpermute_b32 v201, v16, v161
    v_mfma_f32_16x16x32_bf16 v[60:63], v[240:243], v[204:207], v[60:63]
    ds_bpermute_b32 v202, v16, v162
    v_mfma_f32_16x16x32_bf16 v[64:67], v[240:243], v[208:211], v[64:67]
    s_waitcnt vmcnt(16) lgkmcnt(0)
    s_barrier
    ds_read_b64_tr_b16 v[224:225], v8 offset:0
    ds_read_b64_tr_b16 v[226:227], v8 offset:1024
    ds_bpermute_b32 v203, v16, v163
    v_mfma_f32_16x16x32_bf16 v[68:71], v[244:247], v[204:207], v[68:71]
    ds_read_b64_tr_b16 v[228:229], v9 offset:0
    ds_read_b64_tr_b16 v[230:231], v9 offset:1024
    v_mfma_f32_16x16x32_bf16 v[72:75], v[244:247], v[208:211], v[72:75]
    ds_read_b64_tr_b16 v[232:233], v10 offset:0
    ds_read_b64_tr_b16 v[234:235], v10 offset:1024
    s_add_u32 m0, s41, 49152
    s_mov_b32 s40, 8192
    buffer_load_dwordx4 v1, s[28:31], s40 offen offset:0 nt lds
    v_mfma_f32_16x16x32_bf16 v[76:79], v[248:251], v[204:207], v[76:79]
    ds_read_b64_tr_b16 v[236:237], v11 offset:0
    ds_read_b64_tr_b16 v[238:239], v11 offset:1024
    v_mfma_f32_16x16x32_bf16 v[80:83], v[248:251], v[208:211], v[80:83]
    ds_read_b64_tr_b16 v[240:241], v12 offset:0
    ds_read_b64_tr_b16 v[242:243], v12 offset:1024
    v_mfma_f32_16x16x32_bf16 v[84:87], v[252:255], v[204:207], v[84:87]
    ds_read_b64_tr_b16 v[244:245], v13 offset:0
    ds_read_b64_tr_b16 v[246:247], v13 offset:1024
    buffer_load_dwordx4 v1, s[28:31], s40 offen offset:1024 nt lds
    v_mfma_f32_16x16x32_bf16 v[88:91], v[252:255], v[208:211], v[88:91]
    ds_read_b64_tr_b16 v[248:249], v14 offset:0
    ds_read_b64_tr_b16 v[250:251], v14 offset:1024
    s_waitcnt lgkmcnt(13)
    v_mfma_f32_16x16x32_bf16 v[28:31], v[224:227], v[196:199], v[28:31]
    ds_read_b64_tr_b16 v[252:253], v15 offset:0
    ds_read_b64_tr_b16 v[254:255], v15 offset:1024
    s_waitcnt lgkmcnt(14)
    v_mfma_f32_16x16x32_bf16 v[32:35], v[224:227], v[200:203], v[32:35]
    ds_read_b64_tr_b16 v[224:225], v8 offset:8192
    ds_read_b64_tr_b16 v[226:227], v8 offset:9216
    buffer_load_dwordx4 v117, s[28:31], s40 offen offset:2048 nt lds
    s_waitcnt lgkmcnt(14)
    v_mfma_f32_16x16x32_bf16 v[36:39], v[228:231], v[196:199], v[36:39]
    ds_bpermute_b32 v204, v16, v164
    v_mfma_f32_16x16x32_bf16 v[40:43], v[228:231], v[200:203], v[40:43]
    ds_read_b64_tr_b16 v[228:229], v9 offset:8192
    ds_read_b64_tr_b16 v[230:231], v9 offset:9216
    ds_bpermute_b32 v205, v16, v165
    s_waitcnt lgkmcnt(15)
    v_mfma_f32_16x16x32_bf16 v[44:47], v[232:235], v[196:199], v[44:47]
    buffer_load_dwordx4 v117, s[28:31], s40 offen offset:3072 nt lds
    ds_bpermute_b32 v206, v16, v166
    v_mfma_f32_16x16x32_bf16 v[48:51], v[232:235], v[200:203], v[48:51]
    ds_read_b64_tr_b16 v[232:233], v10 offset:8192
    ds_read_b64_tr_b16 v[234:235], v10 offset:9216
    ds_bpermute_b32 v207, v16, v167
    s_waitcnt lgkmcnt(15)
    v_mfma_f32_16x16x32_bf16 v[52:55], v[236:239], v[196:199], v[52:55]
    ds_bpermute_b32 v208, v16, v168
    v_mfma_f32_16x16x32_bf16 v[56:59], v[236:239], v[200:203], v[56:59]
    ds_read_b64_tr_b16 v[236:237], v11 offset:8192
    ds_read_b64_tr_b16 v[238:239], v11 offset:9216
    s_add_u32 m0, s41, 57344
    s_mov_b32 s40, 24576
    buffer_load_dwordx4 v1, s[24:27], s40 offen offset:0 nt lds
    ds_bpermute_b32 v209, v16, v169
    v_mfma_f32_16x16x32_bf16 v[60:63], v[240:243], v[196:199], v[60:63]
    ds_bpermute_b32 v210, v16, v170
    v_mfma_f32_16x16x32_bf16 v[64:67], v[240:243], v[200:203], v[64:67]
    ds_read_b64_tr_b16 v[240:241], v12 offset:8192
    ds_read_b64_tr_b16 v[242:243], v12 offset:9216
    ds_bpermute_b32 v211, v16, v171
    s_waitcnt lgkmcnt(15)
    v_mfma_f32_16x16x32_bf16 v[68:71], v[244:247], v[196:199], v[68:71]
    buffer_load_dwordx4 v1, s[24:27], s40 offen offset:1024 nt lds
    v_mfma_f32_16x16x32_bf16 v[72:75], v[244:247], v[200:203], v[72:75]
    ds_read_b64_tr_b16 v[244:245], v13 offset:8192
    ds_read_b64_tr_b16 v[246:247], v13 offset:9216
    v_mfma_f32_16x16x32_bf16 v[76:79], v[248:251], v[196:199], v[76:79]
    v_mfma_f32_16x16x32_bf16 v[80:83], v[248:251], v[200:203], v[80:83]
    ds_read_b64_tr_b16 v[248:249], v14 offset:8192
    ds_read_b64_tr_b16 v[250:251], v14 offset:9216
    buffer_load_dwordx4 v117, s[24:27], s40 offen offset:2048 nt lds
    v_mfma_f32_16x16x32_bf16 v[84:87], v[252:255], v[196:199], v[84:87]
    v_mfma_f32_16x16x32_bf16 v[88:91], v[252:255], v[200:203], v[88:91]
    ds_read_b64_tr_b16 v[252:253], v15 offset:8192
    ds_read_b64_tr_b16 v[254:255], v15 offset:9216
    s_waitcnt lgkmcnt(14)
    v_mfma_f32_16x16x32_bf16 v[28:31], v[224:227], v[204:207], v[28:31]
    buffer_load_dwordx4 v117, s[24:27], s40 offen offset:3072 nt lds
    s_waitcnt lgkmcnt(6)
    v_mfma_f32_16x16x32_bf16 v[32:35], v[224:227], v[208:211], v[32:35]
    v_mfma_f32_16x16x32_bf16 v[36:39], v[228:231], v[204:207], v[36:39]
    v_mfma_f32_16x16x32_bf16 v[40:43], v[228:231], v[208:211], v[40:43]
    v_mfma_f32_16x16x32_bf16 v[44:47], v[232:235], v[204:207], v[44:47]
    v_mfma_f32_16x16x32_bf16 v[48:51], v[232:235], v[208:211], v[48:51]
    v_mfma_f32_16x16x32_bf16 v[52:55], v[236:239], v[204:207], v[52:55]
    v_mfma_f32_16x16x32_bf16 v[56:59], v[236:239], v[208:211], v[56:59]
    v_mfma_f32_16x16x32_bf16 v[60:63], v[240:243], v[204:207], v[60:63]
    v_mfma_f32_16x16x32_bf16 v[64:67], v[240:243], v[208:211], v[64:67]
    s_waitcnt vmcnt(16) lgkmcnt(0)
    s_barrier
    ds_read_b128 v[224:227], v4 offset:16384
    s_add_u32 m0, s41, 0
    s_mov_b32 s40, 16384
    buffer_load_dwordx4 v1, s[28:31], s40 offen offset:0 nt lds
    v_mfma_f32_16x16x32_bf16 v[68:71], v[244:247], v[204:207], v[68:71]
    ds_read_b128 v[228:231], v5 offset:16384
    v_mfma_f32_16x16x32_bf16 v[72:75], v[244:247], v[208:211], v[72:75]
    ds_read_b128 v[232:235], v6 offset:16384
    v_mfma_f32_16x16x32_bf16 v[76:79], v[248:251], v[204:207], v[76:79]
    ds_read_b128 v[236:239], v7 offset:16384
    buffer_load_dwordx4 v1, s[28:31], s40 offen offset:1024 nt lds
    v_mfma_f32_16x16x32_bf16 v[80:83], v[248:251], v[208:211], v[80:83]
    ds_read_b128 v[240:243], v4 offset:17408
    v_mfma_f32_16x16x32_bf16 v[84:87], v[252:255], v[204:207], v[84:87]
    ds_read_b128 v[244:247], v5 offset:17408
    v_mfma_f32_16x16x32_bf16 v[88:91], v[252:255], v[208:211], v[88:91]
    ds_read_b128 v[248:251], v6 offset:17408
    buffer_load_dwordx4 v117, s[28:31], s40 offen offset:2048 nt lds
    v_pk_mul_f32 v[28:29], v[28:29], s[44:45]
    v_pk_mul_f32 v[30:31], v[30:31], s[44:45]
    v_pk_mul_f32 v[36:37], v[36:37], s[44:45]
    v_pk_mul_f32 v[38:39], v[38:39], s[44:45]
    v_pk_mul_f32 v[32:33], v[32:33], s[44:45]
    v_pk_mul_f32 v[34:35], v[34:35], s[44:45]
    v_pk_mul_f32 v[40:41], v[40:41], s[44:45]
    v_pk_mul_f32 v[42:43], v[42:43], s[44:45]
    v_cvt_pk_bf16_f32 v124, v28, v29
    v_cvt_pk_bf16_f32 v125, v30, v31
    v_cvt_pk_bf16_f32 v126, v36, v37
    v_cvt_pk_bf16_f32 v127, v38, v39
    v_cvt_pk_bf16_f32 v128, v32, v33
    v_cvt_pk_bf16_f32 v129, v34, v35
    v_cvt_pk_bf16_f32 v130, v40, v41
    v_cvt_pk_bf16_f32 v131, v42, v43
    v_permlane32_swap_b32 v124, v126
    v_permlane32_swap_b32 v125, v127
    v_permlane32_swap_b32 v128, v130
    v_permlane32_swap_b32 v129, v131
    v_permlane16_swap_b32 v124, v126
    v_permlane16_swap_b32 v125, v127
    v_permlane16_swap_b32 v128, v130
    v_permlane16_swap_b32 v129, v131
    v_pk_mul_f32 v[44:45], v[44:45], s[44:45]
    v_pk_mul_f32 v[46:47], v[46:47], s[44:45]
    v_pk_mul_f32 v[52:53], v[52:53], s[44:45]
    v_pk_mul_f32 v[54:55], v[54:55], s[44:45]
    v_pk_mul_f32 v[48:49], v[48:49], s[44:45]
    v_pk_mul_f32 v[50:51], v[50:51], s[44:45]
    v_pk_mul_f32 v[56:57], v[56:57], s[44:45]
    v_pk_mul_f32 v[58:59], v[58:59], s[44:45]
    v_cvt_pk_bf16_f32 v132, v44, v45
    v_cvt_pk_bf16_f32 v133, v46, v47
    v_cvt_pk_bf16_f32 v134, v52, v53
    v_cvt_pk_bf16_f32 v135, v54, v55
    v_cvt_pk_bf16_f32 v136, v48, v49
    v_cvt_pk_bf16_f32 v137, v50, v51
    v_cvt_pk_bf16_f32 v138, v56, v57
    v_cvt_pk_bf16_f32 v139, v58, v59
    v_permlane32_swap_b32 v132, v134
    v_permlane32_swap_b32 v133, v135
    v_permlane32_swap_b32 v136, v138
    v_permlane32_swap_b32 v137, v139
    v_permlane16_swap_b32 v132, v134
    v_permlane16_swap_b32 v133, v135
    v_permlane16_swap_b32 v136, v138
    v_permlane16_swap_b32 v137, v139
    v_pk_mul_f32 v[60:61], v[60:61], s[44:45]
    v_pk_mul_f32 v[62:63], v[62:63], s[44:45]
    v_pk_mul_f32 v[68:69], v[68:69], s[44:45]
    v_pk_mul_f32 v[70:71], v[70:71], s[44:45]
    v_pk_mul_f32 v[64:65], v[64:65], s[44:45]
    v_pk_mul_f32 v[66:67], v[66:67], s[44:45]
    v_pk_mul_f32 v[72:73], v[72:73], s[44:45]
    v_pk_mul_f32 v[74:75], v[74:75], s[44:45]
    v_cvt_pk_bf16_f32 v140, v60, v61
    v_cvt_pk_bf16_f32 v141, v62, v63
    v_cvt_pk_bf16_f32 v142, v68, v69
    v_cvt_pk_bf16_f32 v143, v70, v71
    v_cvt_pk_bf16_f32 v144, v64, v65
    v_cvt_pk_bf16_f32 v145, v66, v67
    v_cvt_pk_bf16_f32 v146, v72, v73
    v_cvt_pk_bf16_f32 v147, v74, v75
    v_permlane32_swap_b32 v140, v142
    v_permlane32_swap_b32 v141, v143
    v_permlane32_swap_b32 v144, v146
    v_permlane32_swap_b32 v145, v147
    v_permlane16_swap_b32 v140, v142
    v_permlane16_swap_b32 v141, v143
    v_permlane16_swap_b32 v144, v146
    v_permlane16_swap_b32 v145, v147
    v_pk_mul_f32 v[76:77], v[76:77], s[44:45]
    v_pk_mul_f32 v[78:79], v[78:79], s[44:45]
    v_pk_mul_f32 v[84:85], v[84:85], s[44:45]
    v_pk_mul_f32 v[86:87], v[86:87], s[44:45]
    v_pk_mul_f32 v[80:81], v[80:81], s[44:45]
    v_pk_mul_f32 v[82:83], v[82:83], s[44:45]
    v_pk_mul_f32 v[88:89], v[88:89], s[44:45]
    v_pk_mul_f32 v[90:91], v[90:91], s[44:45]
    v_cvt_pk_bf16_f32 v148, v76, v77
    v_cvt_pk_bf16_f32 v149, v78, v79
    v_cvt_pk_bf16_f32 v150, v84, v85
    v_cvt_pk_bf16_f32 v151, v86, v87
    v_cvt_pk_bf16_f32 v152, v80, v81
    v_cvt_pk_bf16_f32 v153, v82, v83
    v_cvt_pk_bf16_f32 v154, v88, v89
    v_cvt_pk_bf16_f32 v155, v90, v91
    v_permlane32_swap_b32 v148, v150
    v_permlane32_swap_b32 v149, v151
    v_permlane32_swap_b32 v152, v154
    v_permlane32_swap_b32 v153, v155
    v_permlane16_swap_b32 v148, v150
    v_permlane16_swap_b32 v149, v151
    v_permlane16_swap_b32 v152, v154
    v_permlane16_swap_b32 v153, v155
    v_mov_b32 v16, 0
    v_mov_b32 v17, 0
    v_mov_b32 v0, 0
    v_mov_b32 v220, 0xff7fffff
    v_mov_b32 v18, 0
    v_mov_b32 v19, 0
    v_mov_b32 v2, 0
    v_mov_b32 v221, 0xff7fffff
    s_waitcnt lgkmcnt(6)
    v_mfma_f32_16x16x32_bf16 v[172:175], v[224:227], v[124:127], 0
    ds_read_b128 v[252:255], v7 offset:17408
    v_mfma_f32_16x16x32_bf16 v[176:179], v[224:227], v[128:131], 0
    ds_read_b128 v[224:227], v4 offset:24576
    s_waitcnt lgkmcnt(7)
    v_mfma_f32_16x16x32_bf16 v[172:175], v[228:231], v[132:135], v[172:175]
    buffer_load_dwordx4 v117, s[28:31], s40 offen offset:3072 nt lds
    v_mfma_f32_16x16x32_bf16 v[176:179], v[228:231], v[136:139], v[176:179]
    ds_read_b128 v[228:231], v5 offset:24576
    s_waitcnt lgkmcnt(7)
    v_mfma_f32_16x16x32_bf16 v[172:175], v[232:235], v[140:143], v[172:175]
    v_mfma_f32_16x16x32_bf16 v[176:179], v[232:235], v[144:147], v[176:179]
    ds_read_b128 v[232:235], v6 offset:24576
    s_add_u32 m0, s41, 8192
    s_mov_b32 s40, 32768
    buffer_load_dwordx4 v1, s[24:27], s40 offen offset:0 nt lds
    s_waitcnt lgkmcnt(7)
    v_mfma_f32_16x16x32_bf16 v[172:175], v[236:239], v[148:151], v[172:175]
    v_mfma_f32_16x16x32_bf16 v[176:179], v[236:239], v[152:155], v[176:179]
    ds_read_b128 v[236:239], v7 offset:24576
    s_waitcnt lgkmcnt(7)
    v_mfma_f32_16x16x32_bf16 v[180:183], v[240:243], v[124:127], 0
    buffer_load_dwordx4 v1, s[24:27], s40 offen offset:1024 nt lds
    v_mfma_f32_16x16x32_bf16 v[184:187], v[240:243], v[128:131], 0
    ds_read_b128 v[240:243], v4 offset:25600
    s_waitcnt lgkmcnt(7)
    v_mfma_f32_16x16x32_bf16 v[180:183], v[244:247], v[132:135], v[180:183]
    v_exp_f32 v22, v172
    v_exp_f32 v23, v173
    v_exp_f32 v24, v174
    v_exp_f32 v25, v175
    v_cvt_pk_bf16_f32 v196, v22, v23
    v_add_f32 v16, v16, v22
    v_mfma_f32_16x16x32_bf16 v[184:187], v[244:247], v[136:139], v[184:187]
    ds_read_b128 v[244:247], v5 offset:25600
    buffer_load_dwordx4 v117, s[24:27], s40 offen offset:2048 nt lds
    v_add_f32 v17, v17, v23
    v_exp_f32 v26, v176
    v_exp_f32 v27, v177
    v_cvt_pk_bf16_f32 v197, v24, v25
    v_add_f32 v16, v16, v24
    v_add_f32 v17, v17, v25
    v_exp_f32 v22, v178
    s_waitcnt lgkmcnt(7)
    v_mfma_f32_16x16x32_bf16 v[180:183], v[248:251], v[140:143], v[180:183]
    v_exp_f32 v23, v179
    v_cvt_pk_bf16_f32 v200, v26, v27
    v_add_f32 v18, v18, v26
    v_add_f32 v19, v19, v27
    v_cvt_pk_bf16_f32 v201, v22, v23
    v_add_f32 v18, v18, v22
    v_add_f32 v19, v19, v23
    v_mfma_f32_16x16x32_bf16 v[184:187], v[248:251], v[144:147], v[184:187]
    ds_read_b128 v[248:251], v6 offset:25600
    s_waitcnt lgkmcnt(7)
    v_mfma_f32_16x16x32_bf16 v[180:183], v[252:255], v[148:151], v[180:183]
    buffer_load_dwordx4 v117, s[24:27], s40 offen offset:3072 nt lds
    v_mfma_f32_16x16x32_bf16 v[184:187], v[252:255], v[152:155], v[184:187]
    ds_read_b128 v[252:255], v7 offset:25600
    s_nop 4
    v_exp_f32 v24, v180
    v_exp_f32 v25, v181
    v_exp_f32 v26, v182
    v_exp_f32 v27, v183
    v_cvt_pk_bf16_f32 v198, v24, v25
    v_add_f32 v16, v16, v24
    v_add_f32 v17, v17, v25
    v_exp_f32 v22, v184
    v_exp_f32 v23, v185
    v_cvt_pk_bf16_f32 v199, v26, v27
    v_add_f32 v16, v16, v26
    v_add_f32 v17, v17, v27
    v_exp_f32 v24, v186
    v_exp_f32 v25, v187
    v_cvt_pk_bf16_f32 v202, v22, v23
    v_add_f32 v18, v18, v22
    v_add_f32 v19, v19, v23
    v_cvt_pk_bf16_f32 v203, v24, v25
    v_add_f32 v18, v18, v24
    v_add_f32 v19, v19, v25
    s_cmp_eq_u32 s43, 0
    s_cbranch_scc1 attn_kernel_b_skip0
    s_call_b64 s[54:55], attn_kernel_b_rare0
attn_kernel_b_skip0:
    s_waitcnt lgkmcnt(7)
    v_mfma_f32_16x16x32_bf16 v[172:175], v[224:227], v[124:127], 0
    v_mfma_f32_16x16x32_bf16 v[176:179], v[224:227], v[128:131], 0
    s_waitcnt lgkmcnt(6)
    v_mfma_f32_16x16x32_bf16 v[172:175], v[228:231], v[132:135], v[172:175]
    v_mfma_f32_16x16x32_bf16 v[176:179], v[228:231], v[136:139], v[176:179]
    s_waitcnt lgkmcnt(5)
    v_mfma_f32_16x16x32_bf16 v[172:175], v[232:235], v[140:143], v[172:175]
    v_mfma_f32_16x16x32_bf16 v[176:179], v[232:235], v[144:147], v[176:179]
    s_waitcnt lgkmcnt(4)
    v_mfma_f32_16x16x32_bf16 v[172:175], v[236:239], v[148:151], v[172:175]
    v_mfma_f32_16x16x32_bf16 v[176:179], v[236:239], v[152:155], v[176:179]
    s_waitcnt lgkmcnt(3)
    v_mfma_f32_16x16x32_bf16 v[180:183], v[240:243], v[124:127], 0
    v_mfma_f32_16x16x32_bf16 v[184:187], v[240:243], v[128:131], 0
    s_waitcnt vmcnt(16) lgkmcnt(0)
    s_barrier
    ds_read_b64_tr_b16 v[224:225], v8 offset:32768
    ds_read_b64_tr_b16 v[226:227], v8 offset:33792
    v_mfma_f32_16x16x32_bf16 v[180:183], v[244:247], v[132:135], v[180:183]
    ds_read_b64_tr_b16 v[228:229], v9 offset:32768
    ds_read_b64_tr_b16 v[230:231], v9 offset:33792
    s_add_u32 m0, s41, 16384
    s_mov_b32 s40, 24576
    buffer_load_dwordx4 v1, s[28:31], s40 offen offset:0 nt lds
    v_exp_f32 v22, v172
    v_exp_f32 v23, v173
    v_mfma_f32_16x16x32_bf16 v[184:187], v[244:247], v[136:139], v[184:187]
    ds_read_b64_tr_b16 v[232:233], v10 offset:32768
    ds_read_b64_tr_b16 v[234:235], v10 offset:33792
    v_exp_f32 v24, v174
    v_exp_f32 v25, v175
    v_mfma_f32_16x16x32_bf16 v[180:183], v[248:251], v[140:143], v[180:183]
    ds_read_b64_tr_b16 v[236:237], v11 offset:32768
    ds_read_b64_tr_b16 v[238:239], v11 offset:33792
    v_cvt_pk_bf16_f32 v204, v22, v23
    v_add_f32 v16, v16, v22
    v_add_f32 v17, v17, v23
    v_mfma_f32_16x16x32_bf16 v[184:187], v[248:251], v[144:147], v[184:187]
    ds_read_b64_tr_b16 v[240:241], v12 offset:32768
    ds_read_b64_tr_b16 v[242:243], v12 offset:33792
    buffer_load_dwordx4 v1, s[28:31], s40 offen offset:1024 nt lds
    v_exp_f32 v26, v176
    v_exp_f32 v27, v177
    v_mfma_f32_16x16x32_bf16 v[180:183], v[252:255], v[148:151], v[180:183]
    ds_read_b64_tr_b16 v[244:245], v13 offset:32768
    ds_read_b64_tr_b16 v[246:247], v13 offset:33792
    v_cvt_pk_bf16_f32 v205, v24, v25
    v_add_f32 v16, v16, v24
    v_add_f32 v17, v17, v25
    v_mfma_f32_16x16x32_bf16 v[184:187], v[252:255], v[152:155], v[184:187]
    ds_read_b64_tr_b16 v[248:249], v14 offset:32768
    ds_read_b64_tr_b16 v[250:251], v14 offset:33792
    v_exp_f32 v22, v178
    v_exp_f32 v23, v179
    s_waitcnt lgkmcnt(12)
    v_mfma_f32_16x16x32_bf16 v[28:31], v[224:227], v[196:199], 0
    ds_read_b64_tr_b16 v[252:253], v15 offset:32768
    ds_read_b64_tr_b16 v[254:255], v15 offset:33792
    buffer_load_dwordx4 v117, s[28:31], s40 offen offset:2048 nt lds
    v_cvt_pk_bf16_f32 v208, v26, v27
    v_add_f32 v18, v18, v26
    v_add_f32 v19, v19, v27
    v_mfma_f32_16x16x32_bf16 v[32:35], v[224:227], v[200:203], 0
    ds_read_b128 v[224:227], v4 offset:40960
    v_cvt_pk_bf16_f32 v209, v22, v23
    v_add_f32 v18, v18, v22
    v_add_f32 v19, v19, v23
    s_waitcnt lgkmcnt(13)
    v_mfma_f32_16x16x32_bf16 v[36:39], v[228:231], v[196:199], 0
    v_exp_f32 v24, v180
    v_mfma_f32_16x16x32_bf16 v[40:43], v[228:231], v[200:203], 0
    ds_read_b128 v[228:231], v5 offset:40960
    buffer_load_dwordx4 v117, s[28:31], s40 offen offset:3072 nt lds
    v_exp_f32 v25, v181
    s_waitcnt lgkmcnt(12)
    v_mfma_f32_16x16x32_bf16 v[44:47], v[232:235], v[196:199], 0
    v_exp_f32 v26, v182
    v_mfma_f32_16x16x32_bf16 v[48:51], v[232:235], v[200:203], 0
    ds_read_b128 v[232:235], v6 offset:40960
    v_exp_f32 v27, v183
    s_waitcnt lgkmcnt(11)
    v_mfma_f32_16x16x32_bf16 v[52:55], v[236:239], v[196:199], 0
    s_add_u32 m0, s41, 24576
    s_mov_b32 s40, 40960
    buffer_load_dwordx4 v1, s[24:27], s40 offen offset:0 nt lds
    v_cvt_pk_bf16_f32 v206, v24, v25
    v_add_f32 v16, v16, v24
    v_mfma_f32_16x16x32_bf16 v[56:59], v[236:239], v[200:203], 0
    ds_read_b128 v[236:239], v7 offset:40960
    v_add_f32 v17, v17, v25
    v_exp_f32 v22, v184
    s_waitcnt lgkmcnt(10)
    v_mfma_f32_16x16x32_bf16 v[60:63], v[240:243], v[196:199], 0
    v_exp_f32 v23, v185
    v_mfma_f32_16x16x32_bf16 v[64:67], v[240:243], v[200:203], 0
    ds_read_b128 v[240:243], v4 offset:41984
    buffer_load_dwordx4 v1, s[24:27], s40 offen offset:1024 nt lds
    v_cvt_pk_bf16_f32 v207, v26, v27
    v_add_f32 v16, v16, v26
    s_waitcnt lgkmcnt(9)
    v_mfma_f32_16x16x32_bf16 v[68:71], v[244:247], v[196:199], 0
    v_add_f32 v17, v17, v27
    v_exp_f32 v24, v186
    v_mfma_f32_16x16x32_bf16 v[72:75], v[244:247], v[200:203], 0
    ds_read_b128 v[244:247], v5 offset:41984
    v_exp_f32 v25, v187
    s_waitcnt lgkmcnt(8)
    v_mfma_f32_16x16x32_bf16 v[76:79], v[248:251], v[196:199], 0
    buffer_load_dwordx4 v117, s[24:27], s40 offen offset:2048 nt lds
    v_cvt_pk_bf16_f32 v210, v22, v23
    v_add_f32 v18, v18, v22
    v_mfma_f32_16x16x32_bf16 v[80:83], v[248:251], v[200:203], 0
    ds_read_b128 v[248:251], v6 offset:41984
    v_add_f32 v19, v19, v23
    v_cvt_pk_bf16_f32 v211, v24, v25
    s_waitcnt lgkmcnt(7)
    v_mfma_f32_16x16x32_bf16 v[84:87], v[252:255], v[196:199], 0
    v_add_f32 v18, v18, v24
    v_mfma_f32_16x16x32_bf16 v[88:91], v[252:255], v[200:203], 0
    ds_read_b128 v[252:255], v7 offset:41984
    buffer_load_dwordx4 v117, s[24:27], s40 offen offset:3072 nt lds
    v_add_f32 v19, v19, v25
    s_cmp_eq_u32 s43, 0
    s_cbranch_scc1 attn_kernel_b_skip1
    s_call_b64 s[54:55], attn_kernel_b_rare1
attn_kernel_b_skip1:
    s_waitcnt lgkmcnt(7)
    v_mfma_f32_16x16x32_bf16 v[172:175], v[224:227], v[124:127], 0
    v_mfma_f32_16x16x32_bf16 v[176:179], v[224:227], v[128:131], 0
    s_waitcnt lgkmcnt(6)
    v_mfma_f32_16x16x32_bf16 v[172:175], v[228:231], v[132:135], v[172:175]
    v_mfma_f32_16x16x32_bf16 v[176:179], v[228:231], v[136:139], v[176:179]
    s_waitcnt lgkmcnt(5)
    v_mfma_f32_16x16x32_bf16 v[172:175], v[232:235], v[140:143], v[172:175]
    v_mfma_f32_16x16x32_bf16 v[176:179], v[232:235], v[144:147], v[176:179]
    s_waitcnt lgkmcnt(4)
    v_mfma_f32_16x16x32_bf16 v[172:175], v[236:239], v[148:151], v[172:175]
    v_mfma_f32_16x16x32_bf16 v[176:179], v[236:239], v[152:155], v[176:179]
    s_waitcnt lgkmcnt(3)
    v_mfma_f32_16x16x32_bf16 v[180:183], v[240:243], v[124:127], 0
    v_mfma_f32_16x16x32_bf16 v[184:187], v[240:243], v[128:131], 0
    s_waitcnt vmcnt(16) lgkmcnt(0)
    s_barrier
    ds_read_b64_tr_b16 v[224:225], v8 offset:49152
    ds_read_b64_tr_b16 v[226:227], v8 offset:50176
    v_mfma_f32_16x16x32_bf16 v[180:183], v[244:247], v[132:135], v[180:183]
    ds_read_b64_tr_b16 v[228:229], v9 offset:49152
    ds_read_b64_tr_b16 v[230:231], v9 offset:50176
    v_exp_f32 v22, v172
    v_exp_f32 v23, v173
    v_mfma_f32_16x16x32_bf16 v[184:187], v[244:247], v[136:139], v[184:187]
    ds_read_b64_tr_b16 v[232:233], v10 offset:49152
    ds_read_b64_tr_b16 v[234:235], v10 offset:50176
    s_add_u32 m0, s41, 32768
    s_mov_b32 s40, 32768
    buffer_load_dwordx4 v1, s[28:31], s40 offen offset:0 nt lds
    v_exp_f32 v24, v174
    v_exp_f32 v25, v175
    v_mfma_f32_16x16x32_bf16 v[180:183], v[248:251], v[140:143], v[180:183]
    ds_read_b64_tr_b16 v[236:237], v11 offset:49152
    ds_read_b64_tr_b16 v[238:239], v11 offset:50176
    v_cvt_pk_bf16_f32 v196, v22, v23
    v_add_f32 v16, v16, v22
    v_add_f32 v17, v17, v23
    v_mfma_f32_16x16x32_bf16 v[184:187], v[248:251], v[144:147], v[184:187]
    ds_read_b64_tr_b16 v[240:241], v12 offset:49152
    ds_read_b64_tr_b16 v[242:243], v12 offset:50176
    v_exp_f32 v26, v176
    v_exp_f32 v27, v177
    v_mfma_f32_16x16x32_bf16 v[180:183], v[252:255], v[148:151], v[180:183]
    ds_read_b64_tr_b16 v[244:245], v13 offset:49152
    ds_read_b64_tr_b16 v[246:247], v13 offset:50176
    buffer_load_dwordx4 v1, s[28:31], s40 offen offset:1024 nt lds
    v_cvt_pk_bf16_f32 v197, v24, v25
    v_add_f32 v16, v16, v24
    v_add_f32 v17, v17, v25
    v_mfma_f32_16x16x32_bf16 v[184:187], v[252:255], v[152:155], v[184:187]
    ds_read_b64_tr_b16 v[248:249], v14 offset:49152
    ds_read_b64_tr_b16 v[250:251], v14 offset:50176
    v_exp_f32 v22, v178
    v_exp_f32 v23, v179
    s_waitcnt lgkmcnt(12)
    v_mfma_f32_16x16x32_bf16 v[28:31], v[224:227], v[204:207], v[28:31]
    ds_read_b64_tr_b16 v[252:253], v15 offset:49152
    ds_read_b64_tr_b16 v[254:255], v15 offset:50176
    v_cvt_pk_bf16_f32 v200, v26, v27
    v_add_f32 v18, v18, v26
    v_add_f32 v19, v19, v27
    v_mfma_f32_16x16x32_bf16 v[32:35], v[224:227], v[208:211], v[32:35]
    ds_read_b128 v[224:227], v4 offset:57344
    buffer_load_dwordx4 v117, s[28:31], s40 offen offset:2048 nt lds
    v_cvt_pk_bf16_f32 v201, v22, v23
    v_add_f32 v18, v18, v22
    v_add_f32 v19, v19, v23
    s_waitcnt lgkmcnt(13)
    v_mfma_f32_16x16x32_bf16 v[36:39], v[228:231], v[204:207], v[36:39]
    v_exp_f32 v24, v180
    v_mfma_f32_16x16x32_bf16 v[40:43], v[228:231], v[208:211], v[40:43]
    ds_read_b128 v[228:231], v5 offset:57344
    v_exp_f32 v25, v181
    s_waitcnt lgkmcnt(12)
    v_mfma_f32_16x16x32_bf16 v[44:47], v[232:235], v[204:207], v[44:47]
    buffer_load_dwordx4 v117, s[28:31], s40 offen offset:3072 nt lds
    v_exp_f32 v26, v182
    v_mfma_f32_16x16x32_bf16 v[48:51], v[232:235], v[208:211], v[48:51]
    ds_read_b128 v[232:235], v6 offset:57344
    v_exp_f32 v27, v183
    s_waitcnt lgkmcnt(11)
    v_mfma_f32_16x16x32_bf16 v[52:55], v[236:239], v[204:207], v[52:55]
    v_cvt_pk_bf16_f32 v198, v24, v25
    v_add_f32 v16, v16, v24
    v_mfma_f32_16x16x32_bf16 v[56:59], v[236:239], v[208:211], v[56:59]
    ds_read_b128 v[236:239], v7 offset:57344
    s_add_u32 m0, s41, 40960
    s_mov_b32 s40, 49152
    buffer_load_dwordx4 v1, s[24:27], s40 offen offset:0 nt lds
    v_add_f32 v17, v17, v25
    v_exp_f32 v22, v184
    s_waitcnt lgkmcnt(10)
    v_mfma_f32_16x16x32_bf16 v[60:63], v[240:243], v[204:207], v[60:63]
    v_exp_f32 v23, v185
    v_mfma_f32_16x16x32_bf16 v[64:67], v[240:243], v[208:211], v[64:67]
    ds_read_b128 v[240:243], v4 offset:58368
    v_cvt_pk_bf16_f32 v199, v26, v27
    v_add_f32 v16, v16, v26
    s_waitcnt lgkmcnt(9)
    v_mfma_f32_16x16x32_bf16 v[68:71], v[244:247], v[204:207], v[68:71]
    buffer_load_dwordx4 v1, s[24:27], s40 offen offset:1024 nt lds
    v_add_f32 v17, v17, v27
    v_exp_f32 v24, v186
    v_mfma_f32_16x16x32_bf16 v[72:75], v[244:247], v[208:211], v[72:75]
    ds_read_b128 v[244:247], v5 offset:58368
    v_exp_f32 v25, v187
    s_waitcnt lgkmcnt(8)
    v_mfma_f32_16x16x32_bf16 v[76:79], v[248:251], v[204:207], v[76:79]
    v_cvt_pk_bf16_f32 v202, v22, v23
    v_add_f32 v18, v18, v22
    v_mfma_f32_16x16x32_bf16 v[80:83], v[248:251], v[208:211], v[80:83]
    ds_read_b128 v[248:251], v6 offset:58368
    buffer_load_dwordx4 v117, s[24:27], s40 offen offset:2048 nt lds
    v_add_f32 v19, v19, v23
    v_cvt_pk_bf16_f32 v203, v24, v25
    s_waitcnt lgkmcnt(7)
    v_mfma_f32_16x16x32_bf16 v[84:87], v[252:255], v[204:207], v[84:87]
    v_add_f32 v18, v18, v24
    v_mfma_f32_16x16x32_bf16 v[88:91], v[252:255], v[208:211], v[88:91]
    ds_read_b128 v[252:255], v7 offset:58368
    v_add_f32 v19, v19, v25
    s_cmp_eq_u32 s43, 0
    s_cbranch_scc1 attn_kernel_b_skip2
    s_call_b64 s[54:55], attn_kernel_b_rare0
attn_kernel_b_skip2:
    s_waitcnt lgkmcnt(7)
    v_mfma_f32_16x16x32_bf16 v[172:175], v[224:227], v[124:127], 0
    buffer_load_dwordx4 v117, s[24:27], s40 offen offset:3072 nt lds
    v_mfma_f32_16x16x32_bf16 v[176:179], v[224:227], v[128:131], 0
    s_waitcnt lgkmcnt(6)
    v_mfma_f32_16x16x32_bf16 v[172:175], v[228:231], v[132:135], v[172:175]
    v_mfma_f32_16x16x32_bf16 v[176:179], v[228:231], v[136:139], v[176:179]
    s_waitcnt lgkmcnt(5)
    v_mfma_f32_16x16x32_bf16 v[172:175], v[232:235], v[140:143], v[172:175]
    v_mfma_f32_16x16x32_bf16 v[176:179], v[232:235], v[144:147], v[176:179]
    s_waitcnt lgkmcnt(4)
    v_mfma_f32_16x16x32_bf16 v[172:175], v[236:239], v[148:151], v[172:175]
    v_mfma_f32_16x16x32_bf16 v[176:179], v[236:239], v[152:155], v[176:179]
    s_waitcnt lgkmcnt(3)
    v_mfma_f32_16x16x32_bf16 v[180:183], v[240:243], v[124:127], 0
    v_mfma_f32_16x16x32_bf16 v[184:187], v[240:243], v[128:131], 0
    s_waitcnt vmcnt(16) lgkmcnt(0)
    s_barrier
    ds_read_b64_tr_b16 v[224:225], v8 offset:0
    ds_read_b64_tr_b16 v[226:227], v8 offset:1024
    s_add_u32 m0, s41, 49152
    s_mov_b32 s40, 40960
    buffer_load_dwordx4 v1, s[28:31], s40 offen offset:0 nt lds
    v_mfma_f32_16x16x32_bf16 v[180:183], v[244:247], v[132:135], v[180:183]
    ds_read_b64_tr_b16 v[228:229], v9 offset:0
    ds_read_b64_tr_b16 v[230:231], v9 offset:1024
    v_exp_f32 v22, v172
    v_exp_f32 v23, v173
    v_mfma_f32_16x16x32_bf16 v[184:187], v[244:247], v[136:139], v[184:187]
    ds_read_b64_tr_b16 v[232:233], v10 offset:0
    ds_read_b64_tr_b16 v[234:235], v10 offset:1024
    v_exp_f32 v24, v174
    v_exp_f32 v25, v175
    v_mfma_f32_16x16x32_bf16 v[180:183], v[248:251], v[140:143], v[180:183]
    ds_read_b64_tr_b16 v[236:237], v11 offset:0
    ds_read_b64_tr_b16 v[238:239], v11 offset:1024
    buffer_load_dwordx4 v1, s[28:31], s40 offen offset:1024 nt lds
    v_cvt_pk_bf16_f32 v204, v22, v23
    v_add_f32 v16, v16, v22
    v_add_f32 v17, v17, v23
    v_mfma_f32_16x16x32_bf16 v[184:187], v[248:251], v[144:147], v[184:187]
    ds_read_b64_tr_b16 v[240:241], v12 offset:0
    ds_read_b64_tr_b16 v[242:243], v12 offset:1024
    v_exp_f32 v26, v176
    v_exp_f32 v27, v177
    v_mfma_f32_16x16x32_bf16 v[180:183], v[252:255], v[148:151], v[180:183]
    ds_read_b64_tr_b16 v[244:245], v13 offset:0
    ds_read_b64_tr_b16 v[246:247], v13 offset:1024
    v_cvt_pk_bf16_f32 v205, v24, v25
    v_add_f32 v16, v16, v24
    v_add_f32 v17, v17, v25
    v_mfma_f32_16x16x32_bf16 v[184:187], v[252:255], v[152:155], v[184:187]
    ds_read_b64_tr_b16 v[248:249], v14 offset:0
    ds_read_b64_tr_b16 v[250:251], v14 offset:1024
    buffer_load_dwordx4 v117, s[28:31], s40 offen offset:2048 nt lds
    v_exp_f32 v22, v178
    v_exp_f32 v23, v179
    s_add_u32 s78, s76, 0
    buffer_load_ushort v92, v116, s[68:71], s78 offen offset:0
    buffer_load_ushort v93, v116, s[68:71], s78 offen offset:1152
    buffer_load_ushort v94, v116, s[68:71], s78 offen offset:2304
    buffer_load_ushort v95, v116, s[68:71], s78 offen offset:3456
    s_add_u32 s78, s76, 18432
    buffer_load_ushort v96, v116, s[68:71], s78 offen offset:0
    buffer_load_ushort v97, v116, s[68:71], s78 offen offset:1152
    buffer_load_ushort v98, v116, s[68:71], s78 offen offset:2304
    buffer_load_ushort v99, v116, s[68:71], s78 offen offset:3456
    s_add_u32 s78, s76, 512
    buffer_load_ushort v100, v116, s[68:71], s78 offen offset:0
    buffer_load_ushort v101, v116, s[68:71], s78 offen offset:1152
    buffer_load_ushort v102, v116, s[68:71], s78 offen offset:2304
    buffer_load_ushort v103, v116, s[68:71], s78 offen offset:3456
    s_add_u32 s78, s76, 18944
    buffer_load_ushort v104, v116, s[68:71], s78 offen offset:0
    buffer_load_ushort v105, v116, s[68:71], s78 offen offset:1152
    buffer_load_ushort v106, v116, s[68:71], s78 offen offset:2304
    buffer_load_ushort v107, v116, s[68:71], s78 offen offset:3456
    s_add_u32 s78, s76, 1024
    buffer_load_ushort v108, v116, s[68:71], s78 offen offset:0
    buffer_load_ushort v109, v116, s[68:71], s78 offen offset:1152
    buffer_load_ushort v110, v116, s[68:71], s78 offen offset:2304
    buffer_load_ushort v111, v116, s[68:71], s78 offen offset:3456
    s_add_u32 s78, s76, 19456
    buffer_load_ushort v112, v116, s[68:71], s78 offen offset:0
    buffer_load_ushort v113, v116, s[68:71], s78 offen offset:1152
    buffer_load_ushort v114, v116, s[68:71], s78 offen offset:2304
    buffer_load_ushort v115, v116, s[68:71], s78 offen offset:3456
    s_waitcnt lgkmcnt(12)
    v_mfma_f32_16x16x32_bf16 v[28:31], v[224:227], v[196:199], v[28:31]
    ds_read_b64_tr_b16 v[252:253], v15 offset:0
    ds_read_b64_tr_b16 v[254:255], v15 offset:1024
    v_cvt_pk_bf16_f32 v208, v26, v27
    v_add_f32 v18, v18, v26
    v_add_f32 v19, v19, v27
    v_mfma_f32_16x16x32_bf16 v[32:35], v[224:227], v[200:203], v[32:35]
    ds_read_b128 v[224:227], v4 offset:8192
    v_cvt_pk_bf16_f32 v209, v22, v23
    v_add_f32 v18, v18, v22
    v_add_f32 v19, v19, v23
    s_waitcnt lgkmcnt(13)
    v_mfma_f32_16x16x32_bf16 v[36:39], v[228:231], v[196:199], v[36:39]
    buffer_load_dwordx4 v117, s[28:31], s40 offen offset:3072 nt lds
    v_exp_f32 v24, v180
    v_mfma_f32_16x16x32_bf16 v[40:43], v[228:231], v[200:203], v[40:43]
    ds_read_b128 v[228:231], v5 offset:8192
    v_exp_f32 v25, v181
    s_waitcnt lgkmcnt(12)
    v_mfma_f32_16x16x32_bf16 v[44:47], v[232:235], v[196:199], v[44:47]
    v_exp_f32 v26, v182
    v_mfma_f32_16x16x32_bf16 v[48:51], v[232:235], v[200:203], v[48:51]
    ds_read_b128 v[232:235], v6 offset:8192
    s_add_u32 m0, s41, 57344
    s_mov_b32 s40, 57344
    buffer_load_dwordx4 v1, s[24:27], s40 offen offset:0 nt lds
    v_exp_f32 v27, v183
    s_waitcnt lgkmcnt(11)
    v_mfma_f32_16x16x32_bf16 v[52:55], v[236:239], v[196:199], v[52:55]
    v_cvt_pk_bf16_f32 v206, v24, v25
    v_add_f32 v16, v16, v24
    v_mfma_f32_16x16x32_bf16 v[56:59], v[236:239], v[200:203], v[56:59]
    ds_read_b128 v[236:239], v7 offset:8192
    v_add_f32 v17, v17, v25
    v_exp_f32 v22, v184
    s_waitcnt lgkmcnt(10)
    v_mfma_f32_16x16x32_bf16 v[60:63], v[240:243], v[196:199], v[60:63]
    buffer_load_dwordx4 v1, s[24:27], s40 offen offset:1024 nt lds
    v_exp_f32 v23, v185
    v_mfma_f32_16x16x32_bf16 v[64:67], v[240:243], v[200:203], v[64:67]
    ds_read_b128 v[240:243], v4 offset:9216
    v_cvt_pk_bf16_f32 v207, v26, v27
    v_add_f32 v16, v16, v26
    s_waitcnt lgkmcnt(9)
    v_mfma_f32_16x16x32_bf16 v[68:71], v[244:247], v[196:199], v[68:71]
    v_add_f32 v17, v17, v27
    v_exp_f32 v24, v186
    v_mfma_f32_16x16x32_bf16 v[72:75], v[244:247], v[200:203], v[72:75]
    ds_read_b128 v[244:247], v5 offset:9216
    buffer_load_dwordx4 v117, s[24:27], s40 offen offset:2048 nt lds
    v_exp_f32 v25, v187
    s_waitcnt lgkmcnt(8)
    v_mfma_f32_16x16x32_bf16 v[76:79], v[248:251], v[196:199], v[76:79]
    v_cvt_pk_bf16_f32 v210, v22, v23
    v_add_f32 v18, v18, v22
    v_mfma_f32_16x16x32_bf16 v[80:83], v[248:251], v[200:203], v[80:83]
    ds_read_b128 v[248:251], v6 offset:9216
    v_add_f32 v19, v19, v23
    v_cvt_pk_bf16_f32 v211, v24, v25
    s_waitcnt lgkmcnt(7)
    v_mfma_f32_16x16x32_bf16 v[84:87], v[252:255], v[196:199], v[84:87]
    buffer_load_dwordx4 v117, s[24:27], s40 offen offset:3072 nt lds
    v_add_f32 v18, v18, v24
    v_mfma_f32_16x16x32_bf16 v[88:91], v[252:255], v[200:203], v[88:91]
    ds_read_b128 v[252:255], v7 offset:9216
    v_add_f32 v19, v19, v25
    s_cmp_eq_u32 s43, 0
    s_cbranch_scc1 attn_kernel_b_skip3
    s_call_b64 s[54:55], attn_kernel_b_rare1
attn_kernel_b_skip3:
    s_waitcnt lgkmcnt(7)
    v_mfma_f32_16x16x32_bf16 v[172:175], v[224:227], v[124:127], 0
    v_mfma_f32_16x16x32_bf16 v[176:179], v[224:227], v[128:131], 0
    s_waitcnt lgkmcnt(6)
    v_mfma_f32_16x16x32_bf16 v[172:175], v[228:231], v[132:135], v[172:175]
    v_mfma_f32_16x16x32_bf16 v[176:179], v[228:231], v[136:139], v[176:179]
    s_waitcnt lgkmcnt(5)
    v_mfma_f32_16x16x32_bf16 v[172:175], v[232:235], v[140:143], v[172:175]
    v_mfma_f32_16x16x32_bf16 v[176:179], v[232:235], v[144:147], v[176:179]
    s_waitcnt lgkmcnt(4)
    v_mfma_f32_16x16x32_bf16 v[172:175], v[236:239], v[148:151], v[172:175]
    v_mfma_f32_16x16x32_bf16 v[176:179], v[236:239], v[152:155], v[176:179]
    s_waitcnt lgkmcnt(3)
    v_mfma_f32_16x16x32_bf16 v[180:183], v[240:243], v[124:127], 0
    v_mfma_f32_16x16x32_bf16 v[184:187], v[240:243], v[128:131], 0
    s_waitcnt vmcnt(40) lgkmcnt(0)
    s_barrier
    ds_read_b64_tr_b16 v[224:225], v8 offset:16384
    ds_read_b64_tr_b16 v[226:227], v8 offset:17408
    v_mfma_f32_16x16x32_bf16 v[180:183], v[244:247], v[132:135], v[180:183]
    ds_read_b64_tr_b16 v[228:229], v9 offset:16384
    ds_read_b64_tr_b16 v[230:231], v9 offset:17408
    s_add_u32 m0, s41, 0
    s_mov_b32 s40, 49152
    buffer_load_dwordx4 v1, s[28:31], s40 offen offset:0 nt lds
    v_exp_f32 v22, v172
    v_exp_f32 v23, v173
    v_mfma_f32_16x16x32_bf16 v[184:187], v[244:247], v[136:139], v[184:187]
    ds_read_b64_tr_b16 v[232:233], v10 offset:16384
    ds_read_b64_tr_b16 v[234:235], v10 offset:17408
    v_exp_f32 v24, v174
    v_exp_f32 v25, v175
    v_mfma_f32_16x16x32_bf16 v[180:183], v[248:251], v[140:143], v[180:183]
    ds_read_b64_tr_b16 v[236:237], v11 offset:16384
    ds_read_b64_tr_b16 v[238:239], v11 offset:17408
    v_cvt_pk_bf16_f32 v196, v22, v23
    v_add_f32 v16, v16, v22
    v_add_f32 v17, v17, v23
    v_mfma_f32_16x16x32_bf16 v[184:187], v[248:251], v[144:147], v[184:187]
    ds_read_b64_tr_b16 v[240:241], v12 offset:16384
    ds_read_b64_tr_b16 v[242:243], v12 offset:17408
    buffer_load_dwordx4 v1, s[28:31], s40 offen offset:1024 nt lds
    v_exp_f32 v26, v176
    v_exp_f32 v27, v177
    v_mfma_f32_16x16x32_bf16 v[180:183], v[252:255], v[148:151], v[180:183]
    ds_read_b64_tr_b16 v[244:245], v13 offset:16384
    ds_read_b64_tr_b16 v[246:247], v13 offset:17408
    v_cvt_pk_bf16_f32 v197, v24, v25
    v_add_f32 v16, v16, v24
    v_add_f32 v17, v17, v25
    v_mfma_f32_16x16x32_bf16 v[184:187], v[252:255], v[152:155], v[184:187]
    ds_read_b64_tr_b16 v[248:249], v14 offset:16384
    ds_read_b64_tr_b16 v[250:251], v14 offset:17408
    v_exp_f32 v22, v178
    v_exp_f32 v23, v179
    s_waitcnt lgkmcnt(12)
    v_mfma_f32_16x16x32_bf16 v[28:31], v[224:227], v[204:207], v[28:31]
    ds_read_b64_tr_b16 v[252:253], v15 offset:16384
    ds_read_b64_tr_b16 v[254:255], v15 offset:17408
    buffer_load_dwordx4 v117, s[28:31], s40 offen offset:2048 nt lds
    v_cvt_pk_bf16_f32 v200, v26, v27
    v_add_f32 v18, v18, v26
    v_add_f32 v19, v19, v27
    v_mfma_f32_16x16x32_bf16 v[32:35], v[224:227], v[208:211], v[32:35]
    ds_read_b128 v[224:227], v4 offset:24576
    v_cvt_pk_bf16_f32 v201, v22, v23
    v_add_f32 v18, v18, v22
    v_add_f32 v19, v19, v23
    s_waitcnt lgkmcnt(13)
    v_mfma_f32_16x16x32_bf16 v[36:39], v[228:231], v[204:207], v[36:39]
    v_exp_f32 v24, v180
    v_mfma_f32_16x16x32_bf16 v[40:43], v[228:231], v[208:211], v[40:43]
    ds_read_b128 v[228:231], v5 offset:24576
    buffer_load_dwordx4 v117, s[28:31], s40 offen offset:3072 nt lds
    v_exp_f32 v25, v181
    s_waitcnt lgkmcnt(12)
    v_mfma_f32_16x16x32_bf16 v[44:47], v[232:235], v[204:207], v[44:47]
    v_exp_f32 v26, v182
    v_mfma_f32_16x16x32_bf16 v[48:51], v[232:235], v[208:211], v[48:51]
    ds_read_b128 v[232:235], v6 offset:24576
    v_exp_f32 v27, v183
    s_waitcnt lgkmcnt(11)
    v_mfma_f32_16x16x32_bf16 v[52:55], v[236:239], v[204:207], v[52:55]
    s_add_u32 m0, s41, 8192
    s_mov_b32 s40, 65536
    buffer_load_dwordx4 v1, s[24:27], s40 offen offset:0 nt lds
    v_cvt_pk_bf16_f32 v198, v24, v25
    v_add_f32 v16, v16, v24
    v_mfma_f32_16x16x32_bf16 v[56:59], v[236:239], v[208:211], v[56:59]
    ds_read_b128 v[236:239], v7 offset:24576
    v_add_f32 v17, v17, v25
    v_exp_f32 v22, v184
    s_waitcnt lgkmcnt(10)
    v_mfma_f32_16x16x32_bf16 v[60:63], v[240:243], v[204:207], v[60:63]
    v_exp_f32 v23, v185
    v_mfma_f32_16x16x32_bf16 v[64:67], v[240:243], v[208:211], v[64:67]
    ds_read_b128 v[240:243], v4 offset:25600
    buffer_load_dwordx4 v1, s[24:27], s40 offen offset:1024 nt lds
    v_cvt_pk_bf16_f32 v199, v26, v27
    v_add_f32 v16, v16, v26
    s_waitcnt lgkmcnt(9)
    v_mfma_f32_16x16x32_bf16 v[68:71], v[244:247], v[204:207], v[68:71]
    v_add_f32 v17, v17, v27
    v_exp_f32 v24, v186
    v_mfma_f32_16x16x32_bf16 v[72:75], v[244:247], v[208:211], v[72:75]
    ds_read_b128 v[244:247], v5 offset:25600
    v_exp_f32 v25, v187
    s_waitcnt lgkmcnt(8)
    v_mfma_f32_16x16x32_bf16 v[76:79], v[248:251], v[204:207], v[76:79]
    buffer_load_dwordx4 v117, s[24:27], s40 offen offset:2048 nt lds
    v_cvt_pk_bf16_f32 v202, v22, v23
    v_add_f32 v18, v18, v22
    v_mfma_f32_16x16x32_bf16 v[80:83], v[248:251], v[208:211], v[80:83]
    ds_read_b128 v[248:251], v6 offset:25600
    v_add_f32 v19, v19, v23
    v_cvt_pk_bf16_f32 v203, v24, v25
    s_waitcnt lgkmcnt(7)
    v_mfma_f32_16x16x32_bf16 v[84:87], v[252:255], v[204:207], v[84:87]
    v_add_f32 v18, v18, v24
    v_mfma_f32_16x16x32_bf16 v[88:91], v[252:255], v[208:211], v[88:91]
    ds_read_b128 v[252:255], v7 offset:25600
    buffer_load_dwordx4 v117, s[24:27], s40 offen offset:3072 nt lds
    v_add_f32 v19, v19, v25
    s_cmp_eq_u32 s43, 0
    s_cbranch_scc1 attn_kernel_b_skip4
    s_call_b64 s[54:55], attn_kernel_b_rare0
attn_kernel_b_skip4:
    s_waitcnt lgkmcnt(7)
    v_mfma_f32_16x16x32_bf16 v[172:175], v[224:227], v[124:127], 0
    v_mfma_f32_16x16x32_bf16 v[176:179], v[224:227], v[128:131], 0
    s_waitcnt lgkmcnt(6)
    v_mfma_f32_16x16x32_bf16 v[172:175], v[228:231], v[132:135], v[172:175]
    v_mfma_f32_16x16x32_bf16 v[176:179], v[228:231], v[136:139], v[176:179]
    s_waitcnt lgkmcnt(5)
    v_mfma_f32_16x16x32_bf16 v[172:175], v[232:235], v[140:143], v[172:175]
    v_mfma_f32_16x16x32_bf16 v[176:179], v[232:235], v[144:147], v[176:179]
    s_waitcnt lgkmcnt(4)
    v_mfma_f32_16x16x32_bf16 v[172:175], v[236:239], v[148:151], v[172:175]
    v_mfma_f32_16x16x32_bf16 v[176:179], v[236:239], v[152:155], v[176:179]
    s_waitcnt lgkmcnt(3)
    v_mfma_f32_16x16x32_bf16 v[180:183], v[240:243], v[124:127], 0
    v_mfma_f32_16x16x32_bf16 v[184:187], v[240:243], v[128:131], 0
    s_waitcnt vmcnt(40) lgkmcnt(0)
    s_barrier
    ds_read_b64_tr_b16 v[224:225], v8 offset:32768
    ds_read_b64_tr_b16 v[226:227], v8 offset:33792
    v_mfma_f32_16x16x32_bf16 v[180:183], v[244:247], v[132:135], v[180:183]
    ds_read_b64_tr_b16 v[228:229], v9 offset:32768
    ds_read_b64_tr_b16 v[230:231], v9 offset:33792
    v_exp_f32 v22, v172
    v_exp_f32 v23, v173
    v_mfma_f32_16x16x32_bf16 v[184:187], v[244:247], v[136:139], v[184:187]
    ds_read_b64_tr_b16 v[232:233], v10 offset:32768
    ds_read_b64_tr_b16 v[234:235], v10 offset:33792
    s_add_u32 m0, s41, 16384
    s_mov_b32 s40, 57344
    buffer_load_dwordx4 v1, s[28:31], s40 offen offset:0 nt lds
    v_exp_f32 v24, v174
    v_exp_f32 v25, v175
    v_mfma_f32_16x16x32_bf16 v[180:183], v[248:251], v[140:143], v[180:183]
    ds_read_b64_tr_b16 v[236:237], v11 offset:32768
    ds_read_b64_tr_b16 v[238:239], v11 offset:33792
    v_cvt_pk_bf16_f32 v204, v22, v23
    v_add_f32 v16, v16, v22
    v_add_f32 v17, v17, v23
    v_mfma_f32_16x16x32_bf16 v[184:187], v[248:251], v[144:147], v[184:187]
    ds_read_b64_tr_b16 v[240:241], v12 offset:32768
    ds_read_b64_tr_b16 v[242:243], v12 offset:33792
    v_exp_f32 v26, v176
    v_exp_f32 v27, v177
    v_mfma_f32_16x16x32_bf16 v[180:183], v[252:255], v[148:151], v[180:183]
    ds_read_b64_tr_b16 v[244:245], v13 offset:32768
    ds_read_b64_tr_b16 v[246:247], v13 offset:33792
    buffer_load_dwordx4 v1, s[28:31], s40 offen offset:1024 nt lds
    v_cvt_pk_bf16_f32 v205, v24, v25
    v_add_f32 v16, v16, v24
    v_add_f32 v17, v17, v25
    v_mfma_f32_16x16x32_bf16 v[184:187], v[252:255], v[152:155], v[184:187]
    ds_read_b64_tr_b16 v[248:249], v14 offset:32768
    ds_read_b64_tr_b16 v[250:251], v14 offset:33792
    v_exp_f32 v22, v178
    v_exp_f32 v23, v179
    s_waitcnt lgkmcnt(12)
    v_mfma_f32_16x16x32_bf16 v[28:31], v[224:227], v[196:199], v[28:31]
    ds_read_b64_tr_b16 v[252:253], v15 offset:32768
    ds_read_b64_tr_b16 v[254:255], v15 offset:33792
    v_cvt_pk_bf16_f32 v208, v26, v27
    v_add_f32 v18, v18, v26
    v_add_f32 v19, v19, v27
    v_mfma_f32_16x16x32_bf16 v[32:35], v[224:227], v[200:203], v[32:35]
    ds_read_b128 v[224:227], v4 offset:40960
    buffer_load_dwordx4 v117, s[28:31], s40 offen offset:2048 nt lds
    v_cvt_pk_bf16_f32 v209, v22, v23
    v_add_f32 v18, v18, v22
    v_add_f32 v19, v19, v23
    s_waitcnt lgkmcnt(13)
    v_mfma_f32_16x16x32_bf16 v[36:39], v[228:231], v[196:199], v[36:39]
    v_exp_f32 v24, v180
    v_mfma_f32_16x16x32_bf16 v[40:43], v[228:231], v[200:203], v[40:43]
    ds_read_b128 v[228:231], v5 offset:40960
    v_exp_f32 v25, v181
    s_waitcnt lgkmcnt(12)
    v_mfma_f32_16x16x32_bf16 v[44:47], v[232:235], v[196:199], v[44:47]
    buffer_load_dwordx4 v117, s[28:31], s40 offen offset:3072 nt lds
    v_exp_f32 v26, v182
    v_mfma_f32_16x16x32_bf16 v[48:51], v[232:235], v[200:203], v[48:51]
    ds_read_b128 v[232:235], v6 offset:40960
    v_exp_f32 v27, v183
    s_waitcnt lgkmcnt(11)
    v_mfma_f32_16x16x32_bf16 v[52:55], v[236:239], v[196:199], v[52:55]
    v_cvt_pk_bf16_f32 v206, v24, v25
    v_add_f32 v16, v16, v24
    v_mfma_f32_16x16x32_bf16 v[56:59], v[236:239], v[200:203], v[56:59]
    ds_read_b128 v[236:239], v7 offset:40960
    s_add_u32 m0, s41, 24576
    s_mov_b32 s40, 73728
    buffer_load_dwordx4 v1, s[24:27], s40 offen offset:0 nt lds
    v_add_f32 v17, v17, v25
    v_exp_f32 v22, v184
    s_waitcnt lgkmcnt(10)
    v_mfma_f32_16x16x32_bf16 v[60:63], v[240:243], v[196:199], v[60:63]
    v_exp_f32 v23, v185
    v_mfma_f32_16x16x32_bf16 v[64:67], v[240:243], v[200:203], v[64:67]
    ds_read_b128 v[240:243], v4 offset:41984
    v_cvt_pk_bf16_f32 v207, v26, v27
    v_add_f32 v16, v16, v26
    s_waitcnt lgkmcnt(9)
    v_mfma_f32_16x16x32_bf16 v[68:71], v[244:247], v[196:199], v[68:71]
    buffer_load_dwordx4 v1, s[24:27], s40 offen offset:1024 nt lds
    v_add_f32 v17, v17, v27
    v_exp_f32 v24, v186
    v_mfma_f32_16x16x32_bf16 v[72:75], v[244:247], v[200:203], v[72:75]
    ds_read_b128 v[244:247], v5 offset:41984
    v_exp_f32 v25, v187
    s_waitcnt lgkmcnt(8)
    v_mfma_f32_16x16x32_bf16 v[76:79], v[248:251], v[196:199], v[76:79]
    v_cvt_pk_bf16_f32 v210, v22, v23
    v_add_f32 v18, v18, v22
    v_mfma_f32_16x16x32_bf16 v[80:83], v[248:251], v[200:203], v[80:83]
    ds_read_b128 v[248:251], v6 offset:41984
    buffer_load_dwordx4 v117, s[24:27], s40 offen offset:2048 nt lds
    v_add_f32 v19, v19, v23
    v_cvt_pk_bf16_f32 v211, v24, v25
    s_waitcnt lgkmcnt(7)
    v_mfma_f32_16x16x32_bf16 v[84:87], v[252:255], v[196:199], v[84:87]
    v_add_f32 v18, v18, v24
    v_mfma_f32_16x16x32_bf16 v[88:91], v[252:255], v[200:203], v[88:91]
    ds_read_b128 v[252:255], v7 offset:41984
    v_add_f32 v19, v19, v25
    s_cmp_eq_u32 s43, 0
    s_cbranch_scc1 attn_kernel_b_skip5
    s_call_b64 s[54:55], attn_kernel_b_rare1
attn_kernel_b_skip5:
    s_waitcnt lgkmcnt(7)
    v_mfma_f32_16x16x32_bf16 v[172:175], v[224:227], v[124:127], 0
    buffer_load_dwordx4 v117, s[24:27], s40 offen offset:3072 nt lds
    v_mfma_f32_16x16x32_bf16 v[176:179], v[224:227], v[128:131], 0
    s_waitcnt lgkmcnt(6)
    v_mfma_f32_16x16x32_bf16 v[172:175], v[228:231], v[132:135], v[172:175]
    v_mfma_f32_16x16x32_bf16 v[176:179], v[228:231], v[136:139], v[176:179]
    s_waitcnt lgkmcnt(5)
    v_mfma_f32_16x16x32_bf16 v[172:175], v[232:235], v[140:143], v[172:175]
    v_mfma_f32_16x16x32_bf16 v[176:179], v[232:235], v[144:147], v[176:179]
    s_waitcnt lgkmcnt(4)
    v_mfma_f32_16x16x32_bf16 v[172:175], v[236:239], v[148:151], v[172:175]
    v_mfma_f32_16x16x32_bf16 v[176:179], v[236:239], v[152:155], v[176:179]
    s_waitcnt lgkmcnt(3)
    v_mfma_f32_16x16x32_bf16 v[180:183], v[240:243], v[124:127], 0
    v_mfma_f32_16x16x32_bf16 v[184:187], v[240:243], v[128:131], 0
    s_waitcnt vmcnt(16) lgkmcnt(0)
    s_barrier
    ds_read_b64_tr_b16 v[224:225], v8 offset:49152
    ds_read_b64_tr_b16 v[226:227], v8 offset:50176
    s_add_u32 m0, s41, 32768
    s_mov_b32 s40, 65536
    buffer_load_dwordx4 v1, s[28:31], s40 offen offset:0 nt lds
    v_mfma_f32_16x16x32_bf16 v[180:183], v[244:247], v[132:135], v[180:183]
    ds_read_b64_tr_b16 v[228:229], v9 offset:49152
    ds_read_b64_tr_b16 v[230:231], v9 offset:50176
    v_exp_f32 v22, v172
    v_exp_f32 v23, v173
    v_mfma_f32_16x16x32_bf16 v[184:187], v[244:247], v[136:139], v[184:187]
    ds_read_b64_tr_b16 v[232:233], v10 offset:49152
    ds_read_b64_tr_b16 v[234:235], v10 offset:50176
    v_exp_f32 v24, v174
    v_exp_f32 v25, v175
    v_mfma_f32_16x16x32_bf16 v[180:183], v[248:251], v[140:143], v[180:183]
    ds_read_b64_tr_b16 v[236:237], v11 offset:49152
    ds_read_b64_tr_b16 v[238:239], v11 offset:50176
    buffer_load_dwordx4 v1, s[28:31], s40 offen offset:1024 nt lds
    v_cvt_pk_bf16_f32 v196, v22, v23
    v_add_f32 v16, v16, v22
    v_add_f32 v17, v17, v23
    v_mfma_f32_16x16x32_bf16 v[184:187], v[248:251], v[144:147], v[184:187]
    ds_read_b64_tr_b16 v[240:241], v12 offset:49152
    ds_read_b64_tr_b16 v[242:243], v12 offset:50176
    v_exp_f32 v26, v176
    v_exp_f32 v27, v177
    v_mfma_f32_16x16x32_bf16 v[180:183], v[252:255], v[148:151], v[180:183]
    ds_read_b64_tr_b16 v[244:245], v13 offset:49152
    ds_read_b64_tr_b16 v[246:247], v13 offset:50176
    v_cvt_pk_bf16_f32 v197, v24, v25
    v_add_f32 v16, v16, v24
    v_add_f32 v17, v17, v25
    v_mfma_f32_16x16x32_bf16 v[184:187], v[252:255], v[152:155], v[184:187]
    ds_read_b64_tr_b16 v[248:249], v14 offset:49152
    ds_read_b64_tr_b16 v[250:251], v14 offset:50176
    buffer_load_dwordx4 v117, s[28:31], s40 offen offset:2048 nt lds
    v_exp_f32 v22, v178
    v_exp_f32 v23, v179
    s_waitcnt lgkmcnt(12)
    v_mfma_f32_16x16x32_bf16 v[28:31], v[224:227], v[204:207], v[28:31]
    ds_read_b64_tr_b16 v[252:253], v15 offset:49152
    ds_read_b64_tr_b16 v[254:255], v15 offset:50176
    v_cvt_pk_bf16_f32 v200, v26, v27
    v_add_f32 v18, v18, v26
    v_add_f32 v19, v19, v27
    v_mfma_f32_16x16x32_bf16 v[32:35], v[224:227], v[208:211], v[32:35]
    ds_read_b128 v[224:227], v4 offset:57344
    v_cvt_pk_bf16_f32 v201, v22, v23
    v_add_f32 v18, v18, v22
    v_add_f32 v19, v19, v23
    s_waitcnt lgkmcnt(13)
    v_mfma_f32_16x16x32_bf16 v[36:39], v[228:231], v[204:207], v[36:39]
    buffer_load_dwordx4 v117, s[28:31], s40 offen offset:3072 nt lds
    v_exp_f32 v24, v180
    v_mfma_f32_16x16x32_bf16 v[40:43], v[228:231], v[208:211], v[40:43]
    ds_read_b128 v[228:231], v5 offset:57344
    v_exp_f32 v25, v181
    s_waitcnt lgkmcnt(12)
    v_mfma_f32_16x16x32_bf16 v[44:47], v[232:235], v[204:207], v[44:47]
    v_exp_f32 v26, v182
    v_mfma_f32_16x16x32_bf16 v[48:51], v[232:235], v[208:211], v[48:51]
    ds_read_b128 v[232:235], v6 offset:57344
    s_add_u32 m0, s41, 40960
    s_mov_b32 s40, 81920
    buffer_load_dwordx4 v1, s[24:27], s40 offen offset:0 nt lds
    v_exp_f32 v27, v183
    s_waitcnt lgkmcnt(11)
    v_mfma_f32_16x16x32_bf16 v[52:55], v[236:239], v[204:207], v[52:55]
    v_cvt_pk_bf16_f32 v198, v24, v25
    v_add_f32 v16, v16, v24
    v_mfma_f32_16x16x32_bf16 v[56:59], v[236:239], v[208:211], v[56:59]
    ds_read_b128 v[236:239], v7 offset:57344
    v_add_f32 v17, v17, v25
    v_exp_f32 v22, v184
    s_waitcnt lgkmcnt(10)
    v_mfma_f32_16x16x32_bf16 v[60:63], v[240:243], v[204:207], v[60:63]
    buffer_load_dwordx4 v1, s[24:27], s40 offen offset:1024 nt lds
    v_exp_f32 v23, v185
    v_mfma_f32_16x16x32_bf16 v[64:67], v[240:243], v[208:211], v[64:67]
    ds_read_b128 v[240:243], v4 offset:58368
    v_cvt_pk_bf16_f32 v199, v26, v27
    v_add_f32 v16, v16, v26
    s_waitcnt lgkmcnt(9)
    v_mfma_f32_16x16x32_bf16 v[68:71], v[244:247], v[204:207], v[68:71]
    v_add_f32 v17, v17, v27
    v_exp_f32 v24, v186
    v_mfma_f32_16x16x32_bf16 v[72:75], v[244:247], v[208:211], v[72:75]
    ds_read_b128 v[244:247], v5 offset:58368
    buffer_load_dwordx4 v117, s[24:27], s40 offen offset:2048 nt lds
    v_exp_f32 v25, v187
    s_waitcnt lgkmcnt(8)
    v_mfma_f32_16x16x32_bf16 v[76:79], v[248:251], v[204:207], v[76:79]
    v_cvt_pk_bf16_f32 v202, v22, v23
    v_add_f32 v18, v18, v22
    v_mfma_f32_16x16x32_bf16 v[80:83], v[248:251], v[208:211], v[80:83]
    ds_read_b128 v[248:251], v6 offset:58368
    v_add_f32 v19, v19, v23
    v_cvt_pk_bf16_f32 v203, v24, v25
    s_waitcnt lgkmcnt(7)
    v_mfma_f32_16x16x32_bf16 v[84:87], v[252:255], v[204:207], v[84:87]
    buffer_load_dwordx4 v117, s[24:27], s40 offen offset:3072 nt lds
    v_add_f32 v18, v18, v24
    v_mfma_f32_16x16x32_bf16 v[88:91], v[252:255], v[208:211], v[88:91]
    ds_read_b128 v[252:255], v7 offset:58368
    v_add_f32 v19, v19, v25
    s_cmp_eq_u32 s43, 0
    s_cbranch_scc1 attn_kernel_b_skip6
    s_call_b64 s[54:55], attn_kernel_b_rare0
attn_kernel_b_skip6:
    s_waitcnt lgkmcnt(7)
    v_mfma_f32_16x16x32_bf16 v[172:175], v[224:227], v[124:127], 0
    v_mfma_f32_16x16x32_bf16 v[176:179], v[224:227], v[128:131], 0
    s_waitcnt lgkmcnt(6)
    v_mfma_f32_16x16x32_bf16 v[172:175], v[228:231], v[132:135], v[172:175]
    v_mfma_f32_16x16x32_bf16 v[176:179], v[228:231], v[136:139], v[176:179]
    s_waitcnt lgkmcnt(5)
    v_mfma_f32_16x16x32_bf16 v[172:175], v[232:235], v[140:143], v[172:175]
    v_mfma_f32_16x16x32_bf16 v[176:179], v[232:235], v[144:147], v[176:179]
    s_waitcnt lgkmcnt(4)
    v_mfma_f32_16x16x32_bf16 v[172:175], v[236:239], v[148:151], v[172:175]
    v_mfma_f32_16x16x32_bf16 v[176:179], v[236:239], v[152:155], v[176:179]
    s_waitcnt lgkmcnt(3)
    v_mfma_f32_16x16x32_bf16 v[180:183], v[240:243], v[124:127], 0
    v_mfma_f32_16x16x32_bf16 v[184:187], v[240:243], v[128:131], 0
    s_waitcnt vmcnt(16) lgkmcnt(0)
    s_barrier
    ds_read_b64_tr_b16 v[224:225], v8 offset:0
    ds_read_b64_tr_b16 v[226:227], v8 offset:1024
    v_mfma_f32_16x16x32_bf16 v[180:183], v[244:247], v[132:135], v[180:183]
    ds_read_b64_tr_b16 v[228:229], v9 offset:0
    ds_read_b64_tr_b16 v[230:231], v9 offset:1024
    s_add_u32 m0, s41, 49152
    s_mov_b32 s40, 73728
    buffer_load_dwordx4 v1, s[28:31], s40 offen offset:0 nt lds
    v_exp_f32 v22, v172
    v_exp_f32 v23, v173
    v_mfma_f32_16x16x32_bf16 v[184:187], v[244:247], v[136:139], v[184:187]
    ds_read_b64_tr_b16 v[232:233], v10 offset:0
    ds_read_b64_tr_b16 v[234:235], v10 offset:1024
    v_exp_f32 v24, v174
    v_exp_f32 v25, v175
    v_mfma_f32_16x16x32_bf16 v[180:183], v[248:251], v[140:143], v[180:183]
    ds_read_b64_tr_b16 v[236:237], v11 offset:0
    ds_read_b64_tr_b16 v[238:239], v11 offset:1024
    v_cvt_pk_bf16_f32 v204, v22, v23
    v_add_f32 v16, v16, v22
    v_add_f32 v17, v17, v23
    v_mfma_f32_16x16x32_bf16 v[184:187], v[248:251], v[144:147], v[184:187]
    ds_read_b64_tr_b16 v[240:241], v12 offset:0
    ds_read_b64_tr_b16 v[242:243], v12 offset:1024
    buffer_load_dwordx4 v1, s[28:31], s40 offen offset:1024 nt lds
    v_exp_f32 v26, v176
    v_exp_f32 v27, v177
    v_mfma_f32_16x16x32_bf16 v[180:183], v[252:255], v[148:151], v[180:183]
    ds_read_b64_tr_b16 v[244:245], v13 offset:0
    ds_read_b64_tr_b16 v[246:247], v13 offset:1024
    v_cvt_pk_bf16_f32 v205, v24, v25
    v_add_f32 v16, v16, v24
    v_add_f32 v17, v17, v25
    v_mfma_f32_16x16x32_bf16 v[184:187], v[252:255], v[152:155], v[184:187]
    ds_read_b64_tr_b16 v[248:249], v14 offset:0
    ds_read_b64_tr_b16 v[250:251], v14 offset:1024
    v_exp_f32 v22, v178
    v_exp_f32 v23, v179
    s_waitcnt lgkmcnt(12)
    v_mfma_f32_16x16x32_bf16 v[28:31], v[224:227], v[196:199], v[28:31]
    ds_read_b64_tr_b16 v[252:253], v15 offset:0
    ds_read_b64_tr_b16 v[254:255], v15 offset:1024
    buffer_load_dwordx4 v117, s[28:31], s40 offen offset:2048 nt lds
    v_cvt_pk_bf16_f32 v208, v26, v27
    v_add_f32 v18, v18, v26
    v_add_f32 v19, v19, v27
    v_mfma_f32_16x16x32_bf16 v[32:35], v[224:227], v[200:203], v[32:35]
    ds_read_b128 v[224:227], v4 offset:8192
    v_cvt_pk_bf16_f32 v209, v22, v23
    v_add_f32 v18, v18, v22
    v_add_f32 v19, v19, v23
    s_waitcnt lgkmcnt(13)
    v_mfma_f32_16x16x32_bf16 v[36:39], v[228:231], v[196:199], v[36:39]
    v_exp_f32 v24, v180
    v_mfma_f32_16x16x32_bf16 v[40:43], v[228:231], v[200:203], v[40:43]
    ds_read_b128 v[228:231], v5 offset:8192
    buffer_load_dwordx4 v117, s[28:31], s40 offen offset:3072 nt lds
    v_exp_f32 v25, v181
    s_waitcnt lgkmcnt(12)
    v_mfma_f32_16x16x32_bf16 v[44:47], v[232:235], v[196:199], v[44:47]
    v_exp_f32 v26, v182
    v_mfma_f32_16x16x32_bf16 v[48:51], v[232:235], v[200:203], v[48:51]
    ds_read_b128 v[232:235], v6 offset:8192
    v_exp_f32 v27, v183
    s_waitcnt lgkmcnt(11)
    v_mfma_f32_16x16x32_bf16 v[52:55], v[236:239], v[196:199], v[52:55]
    s_add_u32 m0, s41, 57344
    s_mov_b32 s40, 90112
    buffer_load_dwordx4 v1, s[24:27], s40 offen offset:0 nt lds
    v_cvt_pk_bf16_f32 v206, v24, v25
    v_add_f32 v16, v16, v24
    v_mfma_f32_16x16x32_bf16 v[56:59], v[236:239], v[200:203], v[56:59]
    ds_read_b128 v[236:239], v7 offset:8192
    v_add_f32 v17, v17, v25
    v_exp_f32 v22, v184
    s_waitcnt lgkmcnt(10)
    v_mfma_f32_16x16x32_bf16 v[60:63], v[240:243], v[196:199], v[60:63]
    v_exp_f32 v23, v185
    v_mfma_f32_16x16x32_bf16 v[64:67], v[240:243], v[200:203], v[64:67]
    ds_read_b128 v[240:243], v4 offset:9216
    buffer_load_dwordx4 v1, s[24:27], s40 offen offset:1024 nt lds
    v_cvt_pk_bf16_f32 v207, v26, v27
    v_add_f32 v16, v16, v26
    s_waitcnt lgkmcnt(9)
    v_mfma_f32_16x16x32_bf16 v[68:71], v[244:247], v[196:199], v[68:71]
    v_add_f32 v17, v17, v27
    v_exp_f32 v24, v186
    v_mfma_f32_16x16x32_bf16 v[72:75], v[244:247], v[200:203], v[72:75]
    ds_read_b128 v[244:247], v5 offset:9216
    v_exp_f32 v25, v187
    s_waitcnt lgkmcnt(8)
    v_mfma_f32_16x16x32_bf16 v[76:79], v[248:251], v[196:199], v[76:79]
    buffer_load_dwordx4 v117, s[24:27], s40 offen offset:2048 nt lds
    v_cvt_pk_bf16_f32 v210, v22, v23
    v_add_f32 v18, v18, v22
    v_mfma_f32_16x16x32_bf16 v[80:83], v[248:251], v[200:203], v[80:83]
    ds_read_b128 v[248:251], v6 offset:9216
    v_add_f32 v19, v19, v23
    v_cvt_pk_bf16_f32 v211, v24, v25
    s_waitcnt lgkmcnt(7)
    v_mfma_f32_16x16x32_bf16 v[84:87], v[252:255], v[196:199], v[84:87]
    v_add_f32 v18, v18, v24
    v_mfma_f32_16x16x32_bf16 v[88:91], v[252:255], v[200:203], v[88:91]
    ds_read_b128 v[252:255], v7 offset:9216
    buffer_load_dwordx4 v117, s[24:27], s40 offen offset:3072 nt lds
    v_add_f32 v19, v19, v25
    s_cmp_eq_u32 s43, 0
    s_cbranch_scc1 attn_kernel_b_skip7
    s_call_b64 s[54:55], attn_kernel_b_rare1
attn_kernel_b_skip7:
    s_waitcnt lgkmcnt(7)
    v_mfma_f32_16x16x32_bf16 v[172:175], v[224:227], v[124:127], 0
    v_mfma_f32_16x16x32_bf16 v[176:179], v[224:227], v[128:131], 0
    s_waitcnt lgkmcnt(6)
    v_mfma_f32_16x16x32_bf16 v[172:175], v[228:231], v[132:135], v[172:175]
    v_mfma_f32_16x16x32_bf16 v[176:179], v[228:231], v[136:139], v[176:179]
    s_waitcnt lgkmcnt(5)
    v_mfma_f32_16x16x32_bf16 v[172:175], v[232:235], v[140:143], v[172:175]
    v_mfma_f32_16x16x32_bf16 v[176:179], v[232:235], v[144:147], v[176:179]
    s_waitcnt lgkmcnt(4)
    v_mfma_f32_16x16x32_bf16 v[172:175], v[236:239], v[148:151], v[172:175]
    v_mfma_f32_16x16x32_bf16 v[176:179], v[236:239], v[152:155], v[176:179]
    s_waitcnt lgkmcnt(3)
    v_mfma_f32_16x16x32_bf16 v[180:183], v[240:243], v[124:127], 0
    v_mfma_f32_16x16x32_bf16 v[184:187], v[240:243], v[128:131], 0
    s_waitcnt vmcnt(16) lgkmcnt(0)
    s_barrier
    ds_read_b64_tr_b16 v[224:225], v8 offset:16384
    ds_read_b64_tr_b16 v[226:227], v8 offset:17408
    v_mfma_f32_16x16x32_bf16 v[180:183], v[244:247], v[132:135], v[180:183]
    ds_read_b64_tr_b16 v[228:229], v9 offset:16384
    ds_read_b64_tr_b16 v[230:231], v9 offset:17408
    v_exp_f32 v22, v172
    v_exp_f32 v23, v173
    v_mfma_f32_16x16x32_bf16 v[184:187], v[244:247], v[136:139], v[184:187]
    ds_read_b64_tr_b16 v[232:233], v10 offset:16384
    ds_read_b64_tr_b16 v[234:235], v10 offset:17408
    s_add_u32 m0, s41, 0
    s_mov_b32 s40, 81920
    buffer_load_dwordx4 v1, s[28:31], s40 offen offset:0 nt lds
    v_exp_f32 v24, v174
    v_exp_f32 v25, v175
    v_mfma_f32_16x16x32_bf16 v[180:183], v[248:251], v[140:143], v[180:183]
    ds_read_b64_tr_b16 v[236:237], v11 offset:16384
    ds_read_b64_tr_b16 v[238:239], v11 offset:17408
    v_cvt_pk_bf16_f32 v196, v22, v23
    v_add_f32 v16, v16, v22
    v_add_f32 v17, v17, v23
    v_mfma_f32_16x16x32_bf16 v[184:187], v[248:251], v[144:147], v[184:187]
    ds_read_b64_tr_b16 v[240:241], v12 offset:16384
    ds_read_b64_tr_b16 v[242:243], v12 offset:17408
    v_exp_f32 v26, v176
    v_exp_f32 v27, v177
    v_mfma_f32_16x16x32_bf16 v[180:183], v[252:255], v[148:151], v[180:183]
    ds_read_b64_tr_b16 v[244:245], v13 offset:16384
    ds_read_b64_tr_b16 v[246:247], v13 offset:17408
    buffer_load_dwordx4 v1, s[28:31], s40 offen offset:1024 nt lds
    v_cvt_pk_bf16_f32 v197, v24, v25
    v_add_f32 v16, v16, v24
    v_add_f32 v17, v17, v25
    v_mfma_f32_16x16x32_bf16 v[184:187], v[252:255], v[152:155], v[184:187]
    ds_read_b64_tr_b16 v[248:249], v14 offset:16384
    ds_read_b64_tr_b16 v[250:251], v14 offset:17408
    v_exp_f32 v22, v178
    v_exp_f32 v23, v179
    s_waitcnt lgkmcnt(12)
    v_mfma_f32_16x16x32_bf16 v[28:31], v[224:227], v[204:207], v[28:31]
    ds_read_b64_tr_b16 v[252:253], v15 offset:16384
    ds_read_b64_tr_b16 v[254:255], v15 offset:17408
    v_cvt_pk_bf16_f32 v200, v26, v27
    v_add_f32 v18, v18, v26
    v_add_f32 v19, v19, v27
    v_mfma_f32_16x16x32_bf16 v[32:35], v[224:227], v[208:211], v[32:35]
    ds_read_b128 v[224:227], v4 offset:24576
    buffer_load_dwordx4 v117, s[28:31], s40 offen offset:2048 nt lds
    v_cvt_pk_bf16_f32 v201, v22, v23
    v_add_f32 v18, v18, v22
    v_add_f32 v19, v19, v23
    s_waitcnt lgkmcnt(13)
    v_mfma_f32_16x16x32_bf16 v[36:39], v[228:231], v[204:207], v[36:39]
    v_exp_f32 v24, v180
    v_mfma_f32_16x16x32_bf16 v[40:43], v[228:231], v[208:211], v[40:43]
    ds_read_b128 v[228:231], v5 offset:24576
    v_exp_f32 v25, v181
    s_waitcnt lgkmcnt(12)
    v_mfma_f32_16x16x32_bf16 v[44:47], v[232:235], v[204:207], v[44:47]
    buffer_load_dwordx4 v117, s[28:31], s40 offen offset:3072 nt lds
    v_exp_f32 v26, v182
    v_mfma_f32_16x16x32_bf16 v[48:51], v[232:235], v[208:211], v[48:51]
    ds_read_b128 v[232:235], v6 offset:24576
    v_exp_f32 v27, v183
    s_waitcnt lgkmcnt(11)
    v_mfma_f32_16x16x32_bf16 v[52:55], v[236:239], v[204:207], v[52:55]
    v_cvt_pk_bf16_f32 v198, v24, v25
    v_add_f32 v16, v16, v24
    v_mfma_f32_16x16x32_bf16 v[56:59], v[236:239], v[208:211], v[56:59]
    ds_read_b128 v[236:239], v7 offset:24576
    s_add_u32 m0, s41, 8192
    s_mov_b32 s40, 98304
    buffer_load_dwordx4 v1, s[24:27], s40 offen offset:0 nt lds
    v_add_f32 v17, v17, v25
    v_exp_f32 v22, v184
    s_waitcnt lgkmcnt(10)
    v_mfma_f32_16x16x32_bf16 v[60:63], v[240:243], v[204:207], v[60:63]
    v_exp_f32 v23, v185
    v_mfma_f32_16x16x32_bf16 v[64:67], v[240:243], v[208:211], v[64:67]
    ds_read_b128 v[240:243], v4 offset:25600
    v_cvt_pk_bf16_f32 v199, v26, v27
    v_add_f32 v16, v16, v26
    s_waitcnt lgkmcnt(9)
    v_mfma_f32_16x16x32_bf16 v[68:71], v[244:247], v[204:207], v[68:71]
    buffer_load_dwordx4 v1, s[24:27], s40 offen offset:1024 nt lds
    v_add_f32 v17, v17, v27
    v_exp_f32 v24, v186
    v_mfma_f32_16x16x32_bf16 v[72:75], v[244:247], v[208:211], v[72:75]
    ds_read_b128 v[244:247], v5 offset:25600
    v_exp_f32 v25, v187
    s_waitcnt lgkmcnt(8)
    v_mfma_f32_16x16x32_bf16 v[76:79], v[248:251], v[204:207], v[76:79]
    v_cvt_pk_bf16_f32 v202, v22, v23
    v_add_f32 v18, v18, v22
    v_mfma_f32_16x16x32_bf16 v[80:83], v[248:251], v[208:211], v[80:83]
    ds_read_b128 v[248:251], v6 offset:25600
    buffer_load_dwordx4 v117, s[24:27], s40 offen offset:2048 nt lds
    v_add_f32 v19, v19, v23
    v_cvt_pk_bf16_f32 v203, v24, v25
    s_waitcnt lgkmcnt(7)
    v_mfma_f32_16x16x32_bf16 v[84:87], v[252:255], v[204:207], v[84:87]
    v_add_f32 v18, v18, v24
    v_mfma_f32_16x16x32_bf16 v[88:91], v[252:255], v[208:211], v[88:91]
    ds_read_b128 v[252:255], v7 offset:25600
    v_add_f32 v19, v19, v25
    s_cmp_eq_u32 s43, 0
    s_cbranch_scc1 attn_kernel_b_skip8
    s_call_b64 s[54:55], attn_kernel_b_rare0
attn_kernel_b_skip8:
    s_waitcnt lgkmcnt(7)
    v_mfma_f32_16x16x32_bf16 v[172:175], v[224:227], v[124:127], 0
    buffer_load_dwordx4 v117, s[24:27], s40 offen offset:3072 nt lds
    v_mfma_f32_16x16x32_bf16 v[176:179], v[224:227], v[128:131], 0
    s_waitcnt lgkmcnt(6)
    v_mfma_f32_16x16x32_bf16 v[172:175], v[228:231], v[132:135], v[172:175]
    v_mfma_f32_16x16x32_bf16 v[176:179], v[228:231], v[136:139], v[176:179]
    s_waitcnt lgkmcnt(5)
    v_mfma_f32_16x16x32_bf16 v[172:175], v[232:235], v[140:143], v[172:175]
    v_mfma_f32_16x16x32_bf16 v[176:179], v[232:235], v[144:147], v[176:179]
    s_waitcnt lgkmcnt(4)
    v_mfma_f32_16x16x32_bf16 v[172:175], v[236:239], v[148:151], v[172:175]
    v_mfma_f32_16x16x32_bf16 v[176:179], v[236:239], v[152:155], v[176:179]
    s_waitcnt lgkmcnt(3)
    v_mfma_f32_16x16x32_bf16 v[180:183], v[240:243], v[124:127], 0
    v_mfma_f32_16x16x32_bf16 v[184:187], v[240:243], v[128:131], 0
    s_waitcnt vmcnt(16) lgkmcnt(0)
    s_barrier
    ds_read_b64_tr_b16 v[224:225], v8 offset:32768
    ds_read_b64_tr_b16 v[226:227], v8 offset:33792
    s_add_u32 m0, s41, 16384
    s_mov_b32 s40, 90112
    buffer_load_dwordx4 v1, s[28:31], s40 offen offset:0 nt lds
    v_mfma_f32_16x16x32_bf16 v[180:183], v[244:247], v[132:135], v[180:183]
    ds_read_b64_tr_b16 v[228:229], v9 offset:32768
    ds_read_b64_tr_b16 v[230:231], v9 offset:33792
    v_exp_f32 v22, v172
    v_exp_f32 v23, v173
    v_mfma_f32_16x16x32_bf16 v[184:187], v[244:247], v[136:139], v[184:187]
    ds_read_b64_tr_b16 v[232:233], v10 offset:32768
    ds_read_b64_tr_b16 v[234:235], v10 offset:33792
    v_exp_f32 v24, v174
    v_exp_f32 v25, v175
    v_mfma_f32_16x16x32_bf16 v[180:183], v[248:251], v[140:143], v[180:183]
    ds_read_b64_tr_b16 v[236:237], v11 offset:32768
    ds_read_b64_tr_b16 v[238:239], v11 offset:33792
    buffer_load_dwordx4 v1, s[28:31], s40 offen offset:1024 nt lds
    v_cvt_pk_bf16_f32 v204, v22, v23
    v_add_f32 v16, v16, v22
    v_add_f32 v17, v17, v23
    v_mfma_f32_16x16x32_bf16 v[184:187], v[248:251], v[144:147], v[184:187]
    ds_read_b64_tr_b16 v[240:241], v12 offset:32768
    ds_read_b64_tr_b16 v[242:243], v12 offset:33792
    v_exp_f32 v26, v176
    v_exp_f32 v27, v177
    v_mfma_f32_16x16x32_bf16 v[180:183], v[252:255], v[148:151], v[180:183]
    ds_read_b64_tr_b16 v[244:245], v13 offset:32768
    ds_read_b64_tr_b16 v[246:247], v13 offset:33792
    v_cvt_pk_bf16_f32 v205, v24, v25
    v_add_f32 v16, v16, v24
    v_add_f32 v17, v17, v25
    v_mfma_f32_16x16x32_bf16 v[184:187], v[252:255], v[152:155], v[184:187]
    ds_read_b64_tr_b16 v[248:249], v14 offset:32768
    ds_read_b64_tr_b16 v[250:251], v14 offset:33792
    buffer_load_dwordx4 v117, s[28:31], s40 offen offset:2048 nt lds
    v_exp_f32 v22, v178
    v_exp_f32 v23, v179
    s_waitcnt lgkmcnt(12)
    v_mfma_f32_16x16x32_bf16 v[28:31], v[224:227], v[196:199], v[28:31]
    ds_read_b64_tr_b16 v[252:253], v15 offset:32768
    ds_read_b64_tr_b16 v[254:255], v15 offset:33792
    v_cvt_pk_bf16_f32 v208, v26, v27
    v_add_f32 v18, v18, v26
    v_add_f32 v19, v19, v27
    v_mfma_f32_16x16x32_bf16 v[32:35], v[224:227], v[200:203], v[32:35]
    ds_read_b128 v[224:227], v4 offset:40960
    v_cvt_pk_bf16_f32 v209, v22, v23
    v_add_f32 v18, v18, v22
    v_add_f32 v19, v19, v23
    s_waitcnt lgkmcnt(13)
    v_mfma_f32_16x16x32_bf16 v[36:39], v[228:231], v[196:199], v[36:39]
    buffer_load_dwordx4 v117, s[28:31], s40 offen offset:3072 nt lds
    v_exp_f32 v24, v180
    v_mfma_f32_16x16x32_bf16 v[40:43], v[228:231], v[200:203], v[40:43]
    ds_read_b128 v[228:231], v5 offset:40960
    v_exp_f32 v25, v181
    s_waitcnt lgkmcnt(12)
    v_mfma_f32_16x16x32_bf16 v[44:47], v[232:235], v[196:199], v[44:47]
    v_exp_f32 v26, v182
    v_mfma_f32_16x16x32_bf16 v[48:51], v[232:235], v[200:203], v[48:51]
    ds_read_b128 v[232:235], v6 offset:40960
    s_add_u32 m0, s41, 24576
    s_mov_b32 s40, 106496
    buffer_load_dwordx4 v1, s[24:27], s40 offen offset:0 nt lds
    v_exp_f32 v27, v183
    s_waitcnt lgkmcnt(11)
    v_mfma_f32_16x16x32_bf16 v[52:55], v[236:239], v[196:199], v[52:55]
    v_cvt_pk_bf16_f32 v206, v24, v25
    v_add_f32 v16, v16, v24
    v_mfma_f32_16x16x32_bf16 v[56:59], v[236:239], v[200:203], v[56:59]
    ds_read_b128 v[236:239], v7 offset:40960
    v_add_f32 v17, v17, v25
    v_exp_f32 v22, v184
    s_waitcnt lgkmcnt(10)
    v_mfma_f32_16x16x32_bf16 v[60:63], v[240:243], v[196:199], v[60:63]
    buffer_load_dwordx4 v1, s[24:27], s40 offen offset:1024 nt lds
    v_exp_f32 v23, v185
    v_mfma_f32_16x16x32_bf16 v[64:67], v[240:243], v[200:203], v[64:67]
    ds_read_b128 v[240:243], v4 offset:41984
    v_cvt_pk_bf16_f32 v207, v26, v27
    v_add_f32 v16, v16, v26
    s_waitcnt lgkmcnt(9)
    v_mfma_f32_16x16x32_bf16 v[68:71], v[244:247], v[196:199], v[68:71]
    v_add_f32 v17, v17, v27
    v_exp_f32 v24, v186
    v_mfma_f32_16x16x32_bf16 v[72:75], v[244:247], v[200:203], v[72:75]
    ds_read_b128 v[244:247], v5 offset:41984
    buffer_load_dwordx4 v117, s[24:27], s40 offen offset:2048 nt lds
    v_exp_f32 v25, v187
    s_waitcnt lgkmcnt(8)
    v_mfma_f32_16x16x32_bf16 v[76:79], v[248:251], v[196:199], v[76:79]
    v_cvt_pk_bf16_f32 v210, v22, v23
    v_add_f32 v18, v18, v22
    v_mfma_f32_16x16x32_bf16 v[80:83], v[248:251], v[200:203], v[80:83]
    ds_read_b128 v[248:251], v6 offset:41984
    v_add_f32 v19, v19, v23
    v_cvt_pk_bf16_f32 v211, v24, v25
    s_waitcnt lgkmcnt(7)
    v_mfma_f32_16x16x32_bf16 v[84:87], v[252:255], v[196:199], v[84:87]
    buffer_load_dwordx4 v117, s[24:27], s40 offen offset:3072 nt lds
    v_add_f32 v18, v18, v24
    v_mfma_f32_16x16x32_bf16 v[88:91], v[252:255], v[200:203], v[88:91]
    ds_read_b128 v[252:255], v7 offset:41984
    v_add_f32 v19, v19, v25
    s_cmp_eq_u32 s43, 0
    s_cbranch_scc1 attn_kernel_b_skip9
    s_call_b64 s[54:55], attn_kernel_b_rare1
attn_kernel_b_skip9:
    s_waitcnt lgkmcnt(7)
    v_mfma_f32_16x16x32_bf16 v[172:175], v[224:227], v[124:127], 0
    v_mfma_f32_16x16x32_bf16 v[176:179], v[224:227], v[128:131], 0
    s_waitcnt lgkmcnt(6)
    v_mfma_f32_16x16x32_bf16 v[172:175], v[228:231], v[132:135], v[172:175]
    v_mfma_f32_16x16x32_bf16 v[176:179], v[228:231], v[136:139], v[176:179]
    s_waitcnt lgkmcnt(5)
    v_mfma_f32_16x16x32_bf16 v[172:175], v[232:235], v[140:143], v[172:175]
    v_mfma_f32_16x16x32_bf16 v[176:179], v[232:235], v[144:147], v[176:179]
    s_waitcnt lgkmcnt(4)
    v_mfma_f32_16x16x32_bf16 v[172:175], v[236:239], v[148:151], v[172:175]
    v_mfma_f32_16x16x32_bf16 v[176:179], v[236:239], v[152:155], v[176:179]
    s_waitcnt lgkmcnt(3)
    v_mfma_f32_16x16x32_bf16 v[180:183], v[240:243], v[124:127], 0
    v_mfma_f32_16x16x32_bf16 v[184:187], v[240:243], v[128:131], 0
    s_waitcnt vmcnt(16) lgkmcnt(0)
    s_barrier
    ds_read_b64_tr_b16 v[224:225], v8 offset:49152
    ds_read_b64_tr_b16 v[226:227], v8 offset:50176
    v_mfma_f32_16x16x32_bf16 v[180:183], v[244:247], v[132:135], v[180:183]
    ds_read_b64_tr_b16 v[228:229], v9 offset:49152
    ds_read_b64_tr_b16 v[230:231], v9 offset:50176
    s_add_u32 m0, s41, 32768
    s_mov_b32 s40, 98304
    buffer_load_dwordx4 v1, s[28:31], s40 offen offset:0 nt lds
    v_exp_f32 v22, v172
    v_exp_f32 v23, v173
    v_mfma_f32_16x16x32_bf16 v[184:187], v[244:247], v[136:139], v[184:187]
    ds_read_b64_tr_b16 v[232:233], v10 offset:49152
    ds_read_b64_tr_b16 v[234:235], v10 offset:50176
    v_exp_f32 v24, v174
    v_exp_f32 v25, v175
    v_mfma_f32_16x16x32_bf16 v[180:183], v[248:251], v[140:143], v[180:183]
    ds_read_b64_tr_b16 v[236:237], v11 offset:49152
    ds_read_b64_tr_b16 v[238:239], v11 offset:50176
    v_cvt_pk_bf16_f32 v196, v22, v23
    v_add_f32 v16, v16, v22
    v_add_f32 v17, v17, v23
    v_mfma_f32_16x16x32_bf16 v[184:187], v[248:251], v[144:147], v[184:187]
    ds_read_b64_tr_b16 v[240:241], v12 offset:49152
    ds_read_b64_tr_b16 v[242:243], v12 offset:50176
    buffer_load_dwordx4 v1, s[28:31], s40 offen offset:1024 nt lds
    v_exp_f32 v26, v176
    v_exp_f32 v27, v177
    v_mfma_f32_16x16x32_bf16 v[180:183], v[252:255], v[148:151], v[180:183]
    ds_read_b64_tr_b16 v[244:245], v13 offset:49152
    ds_read_b64_tr_b16 v[246:247], v13 offset:50176
    v_cvt_pk_bf16_f32 v197, v24, v25
    v_add_f32 v16, v16, v24
    v_add_f32 v17, v17, v25
    v_mfma_f32_16x16x32_bf16 v[184:187], v[252:255], v[152:155], v[184:187]
    ds_read_b64_tr_b16 v[248:249], v14 offset:49152
    ds_read_b64_tr_b16 v[250:251], v14 offset:50176
    v_exp_f32 v22, v178
    v_exp_f32 v23, v179
    s_waitcnt lgkmcnt(12)
    v_mfma_f32_16x16x32_bf16 v[28:31], v[224:227], v[204:207], v[28:31]
    ds_read_b64_tr_b16 v[252:253], v15 offset:49152
    ds_read_b64_tr_b16 v[254:255], v15 offset:50176
    buffer_load_dwordx4 v117, s[28:31], s40 offen offset:2048 nt lds
    v_cvt_pk_bf16_f32 v200, v26, v27
    v_add_f32 v18, v18, v26
    v_add_f32 v19, v19, v27
    v_mfma_f32_16x16x32_bf16 v[32:35], v[224:227], v[208:211], v[32:35]
    ds_read_b128 v[224:227], v4 offset:57344
    v_cvt_pk_bf16_f32 v201, v22, v23
    v_add_f32 v18, v18, v22
    v_add_f32 v19, v19, v23
    s_waitcnt lgkmcnt(13)
    v_mfma_f32_16x16x32_bf16 v[36:39], v[228:231], v[204:207], v[36:39]
    v_exp_f32 v24, v180
    v_mfma_f32_16x16x32_bf16 v[40:43], v[228:231], v[208:211], v[40:43]
    ds_read_b128 v[228:231], v5 offset:57344
    buffer_load_dwordx4 v117, s[28:31], s40 offen offset:3072 nt lds
    v_exp_f32 v25, v181
    s_waitcnt lgkmcnt(12)
    v_mfma_f32_16x16x32_bf16 v[44:47], v[232:235], v[204:207], v[44:47]
    v_exp_f32 v26, v182
    v_mfma_f32_16x16x32_bf16 v[48:51], v[232:235], v[208:211], v[48:51]
    ds_read_b128 v[232:235], v6 offset:57344
    v_exp_f32 v27, v183
    s_waitcnt lgkmcnt(11)
    v_mfma_f32_16x16x32_bf16 v[52:55], v[236:239], v[204:207], v[52:55]
    s_add_u32 m0, s41, 40960
    s_mov_b32 s40, 114688
    buffer_load_dwordx4 v1, s[24:27], s40 offen offset:0 nt lds
    v_cvt_pk_bf16_f32 v198, v24, v25
    v_add_f32 v16, v16, v24
    v_mfma_f32_16x16x32_bf16 v[56:59], v[236:239], v[208:211], v[56:59]
    ds_read_b128 v[236:239], v7 offset:57344
    v_add_f32 v17, v17, v25
    v_exp_f32 v22, v184
    s_waitcnt lgkmcnt(10)
    v_mfma_f32_16x16x32_bf16 v[60:63], v[240:243], v[204:207], v[60:63]
    v_exp_f32 v23, v185
    v_mfma_f32_16x16x32_bf16 v[64:67], v[240:243], v[208:211], v[64:67]
    ds_read_b128 v[240:243], v4 offset:58368
    buffer_load_dwordx4 v1, s[24:27], s40 offen offset:1024 nt lds
    v_cvt_pk_bf16_f32 v199, v26, v27
    v_add_f32 v16, v16, v26
    s_waitcnt lgkmcnt(9)
    v_mfma_f32_16x16x32_bf16 v[68:71], v[244:247], v[204:207], v[68:71]
    v_add_f32 v17, v17, v27
    v_exp_f32 v24, v186
    v_mfma_f32_16x16x32_bf16 v[72:75], v[244:247], v[208:211], v[72:75]
    ds_read_b128 v[244:247], v5 offset:58368
    v_exp_f32 v25, v187
    s_waitcnt lgkmcnt(8)
    v_mfma_f32_16x16x32_bf16 v[76:79], v[248:251], v[204:207], v[76:79]
    buffer_load_dwordx4 v117, s[24:27], s40 offen offset:2048 nt lds
    v_cvt_pk_bf16_f32 v202, v22, v23
    v_add_f32 v18, v18, v22
    v_mfma_f32_16x16x32_bf16 v[80:83], v[248:251], v[208:211], v[80:83]
    ds_read_b128 v[248:251], v6 offset:58368
    v_add_f32 v19, v19, v23
    v_cvt_pk_bf16_f32 v203, v24, v25
    s_waitcnt lgkmcnt(7)
    v_mfma_f32_16x16x32_bf16 v[84:87], v[252:255], v[204:207], v[84:87]
    v_add_f32 v18, v18, v24
    v_mfma_f32_16x16x32_bf16 v[88:91], v[252:255], v[208:211], v[88:91]
    ds_read_b128 v[252:255], v7 offset:58368
    buffer_load_dwordx4 v117, s[24:27], s40 offen offset:3072 nt lds
    v_add_f32 v19, v19, v25
    s_cmp_eq_u32 s43, 0
    s_cbranch_scc1 attn_kernel_b_skip10
    s_call_b64 s[54:55], attn_kernel_b_rare0
attn_kernel_b_skip10:
    s_waitcnt lgkmcnt(7)
    v_mfma_f32_16x16x32_bf16 v[172:175], v[224:227], v[124:127], 0
    v_mfma_f32_16x16x32_bf16 v[176:179], v[224:227], v[128:131], 0
    s_waitcnt lgkmcnt(6)
    v_mfma_f32_16x16x32_bf16 v[172:175], v[228:231], v[132:135], v[172:175]
    v_mfma_f32_16x16x32_bf16 v[176:179], v[228:231], v[136:139], v[176:179]
    s_waitcnt lgkmcnt(5)
    v_mfma_f32_16x16x32_bf16 v[172:175], v[232:235], v[140:143], v[172:175]
    v_mfma_f32_16x16x32_bf16 v[176:179], v[232:235], v[144:147], v[176:179]
    s_waitcnt lgkmcnt(4)
    v_mfma_f32_16x16x32_bf16 v[172:175], v[236:239], v[148:151], v[172:175]
    v_mfma_f32_16x16x32_bf16 v[176:179], v[236:239], v[152:155], v[176:179]
    s_waitcnt lgkmcnt(3)
    v_mfma_f32_16x16x32_bf16 v[180:183], v[240:243], v[124:127], 0
    v_mfma_f32_16x16x32_bf16 v[184:187], v[240:243], v[128:131], 0
    s_waitcnt vmcnt(16) lgkmcnt(0)
    s_barrier
    ds_read_b64_tr_b16 v[224:225], v8 offset:0
    ds_read_b64_tr_b16 v[226:227], v8 offset:1024
    v_mfma_f32_16x16x32_bf16 v[180:183], v[244:247], v[132:135], v[180:183]
    ds_read_b64_tr_b16 v[228:229], v9 offset:0
    ds_read_b64_tr_b16 v[230:231], v9 offset:1024
    v_exp_f32 v22, v172
    v_exp_f32 v23, v173
    v_mfma_f32_16x16x32_bf16 v[184:187], v[244:247], v[136:139], v[184:187]
    ds_read_b64_tr_b16 v[232:233], v10 offset:0
    ds_read_b64_tr_b16 v[234:235], v10 offset:1024
    s_add_u32 m0, s41, 49152
    s_mov_b32 s40, 106496
    buffer_load_dwordx4 v1, s[28:31], s40 offen offset:0 nt lds
    v_exp_f32 v24, v174
    v_exp_f32 v25, v175
    v_mfma_f32_16x16x32_bf16 v[180:183], v[248:251], v[140:143], v[180:183]
    ds_read_b64_tr_b16 v[236:237], v11 offset:0
    ds_read_b64_tr_b16 v[238:239], v11 offset:1024
    v_cvt_pk_bf16_f32 v204, v22, v23
    v_add_f32 v16, v16, v22
    v_add_f32 v17, v17, v23
    v_mfma_f32_16x16x32_bf16 v[184:187], v[248:251], v[144:147], v[184:187]
    ds_read_b64_tr_b16 v[240:241], v12 offset:0
    ds_read_b64_tr_b16 v[242:243], v12 offset:1024
    v_exp_f32 v26, v176
    v_exp_f32 v27, v177
    v_mfma_f32_16x16x32_bf16 v[180:183], v[252:255], v[148:151], v[180:183]
    ds_read_b64_tr_b16 v[244:245], v13 offset:0
    ds_read_b64_tr_b16 v[246:247], v13 offset:1024
    buffer_load_dwordx4 v1, s[28:31], s40 offen offset:1024 nt lds
    v_cvt_pk_bf16_f32 v205, v24, v25
    v_add_f32 v16, v16, v24
    v_add_f32 v17, v17, v25
    v_mfma_f32_16x16x32_bf16 v[184:187], v[252:255], v[152:155], v[184:187]
    ds_read_b64_tr_b16 v[248:249], v14 offset:0
    ds_read_b64_tr_b16 v[250:251], v14 offset:1024
    v_exp_f32 v22, v178
    v_exp_f32 v23, v179
    s_waitcnt lgkmcnt(12)
    v_mfma_f32_16x16x32_bf16 v[28:31], v[224:227], v[196:199], v[28:31]
    ds_read_b64_tr_b16 v[252:253], v15 offset:0
    ds_read_b64_tr_b16 v[254:255], v15 offset:1024
    v_cvt_pk_bf16_f32 v208, v26, v27
    v_add_f32 v18, v18, v26
    v_add_f32 v19, v19, v27
    v_mfma_f32_16x16x32_bf16 v[32:35], v[224:227], v[200:203], v[32:35]
    ds_read_b128 v[224:227], v4 offset:8192
    buffer_load_dwordx4 v117, s[28:31], s40 offen offset:2048 nt lds
    v_cvt_pk_bf16_f32 v209, v22, v23
    v_add_f32 v18, v18, v22
    v_add_f32 v19, v19, v23
    s_waitcnt lgkmcnt(13)
    v_mfma_f32_16x16x32_bf16 v[36:39], v[228:231], v[196:199], v[36:39]
    v_exp_f32 v24, v180
    v_mfma_f32_16x16x32_bf16 v[40:43], v[228:231], v[200:203], v[40:43]
    ds_read_b128 v[228:231], v5 offset:8192
    v_exp_f32 v25, v181
    s_waitcnt lgkmcnt(12)
    v_mfma_f32_16x16x32_bf16 v[44:47], v[232:235], v[196:199], v[44:47]
    buffer_load_dwordx4 v117, s[28:31], s40 offen offset:3072 nt lds
    v_exp_f32 v26, v182
    v_mfma_f32_16x16x32_bf16 v[48:51], v[232:235], v[200:203], v[48:51]
    ds_read_b128 v[232:235], v6 offset:8192
    v_exp_f32 v27, v183
    s_waitcnt lgkmcnt(11)
    v_mfma_f32_16x16x32_bf16 v[52:55], v[236:239], v[196:199], v[52:55]
    v_cvt_pk_bf16_f32 v206, v24, v25
    v_add_f32 v16, v16, v24
    v_mfma_f32_16x16x32_bf16 v[56:59], v[236:239], v[200:203], v[56:59]
    ds_read_b128 v[236:239], v7 offset:8192
    s_add_u32 m0, s41, 57344
    s_mov_b32 s40, 122880
    buffer_load_dwordx4 v1, s[24:27], s40 offen offset:0 nt lds
    v_add_f32 v17, v17, v25
    v_exp_f32 v22, v184
    s_waitcnt lgkmcnt(10)
    v_mfma_f32_16x16x32_bf16 v[60:63], v[240:243], v[196:199], v[60:63]
    v_exp_f32 v23, v185
    v_mfma_f32_16x16x32_bf16 v[64:67], v[240:243], v[200:203], v[64:67]
    ds_read_b128 v[240:243], v4 offset:9216
    v_cvt_pk_bf16_f32 v207, v26, v27
    v_add_f32 v16, v16, v26
    s_waitcnt lgkmcnt(9)
    v_mfma_f32_16x16x32_bf16 v[68:71], v[244:247], v[196:199], v[68:71]
    buffer_load_dwordx4 v1, s[24:27], s40 offen offset:1024 nt lds
    v_add_f32 v17, v17, v27
    v_exp_f32 v24, v186
    v_mfma_f32_16x16x32_bf16 v[72:75], v[244:247], v[200:203], v[72:75]
    ds_read_b128 v[244:247], v5 offset:9216
    v_exp_f32 v25, v187
    s_waitcnt lgkmcnt(8)
    v_mfma_f32_16x16x32_bf16 v[76:79], v[248:251], v[196:199], v[76:79]
    v_cvt_pk_bf16_f32 v210, v22, v23
    v_add_f32 v18, v18, v22
    v_mfma_f32_16x16x32_bf16 v[80:83], v[248:251], v[200:203], v[80:83]
    ds_read_b128 v[248:251], v6 offset:9216
    buffer_load_dwordx4 v117, s[24:27], s40 offen offset:2048 nt lds
    v_add_f32 v19, v19, v23
    v_cvt_pk_bf16_f32 v211, v24, v25
    s_waitcnt lgkmcnt(7)
    v_mfma_f32_16x16x32_bf16 v[84:87], v[252:255], v[196:199], v[84:87]
    v_add_f32 v18, v18, v24
    v_mfma_f32_16x16x32_bf16 v[88:91], v[252:255], v[200:203], v[88:91]
    ds_read_b128 v[252:255], v7 offset:9216
    v_add_f32 v19, v19, v25
    s_cmp_eq_u32 s43, 0
    s_cbranch_scc1 attn_kernel_b_skip11
    s_call_b64 s[54:55], attn_kernel_b_rare1
attn_kernel_b_skip11:
    s_waitcnt lgkmcnt(7)
    v_mfma_f32_16x16x32_bf16 v[172:175], v[224:227], v[124:127], 0
    buffer_load_dwordx4 v117, s[24:27], s40 offen offset:3072 nt lds
    v_mfma_f32_16x16x32_bf16 v[176:179], v[224:227], v[128:131], 0
    s_waitcnt lgkmcnt(6)
    v_mfma_f32_16x16x32_bf16 v[172:175], v[228:231], v[132:135], v[172:175]
    v_mfma_f32_16x16x32_bf16 v[176:179], v[228:231], v[136:139], v[176:179]
    s_waitcnt lgkmcnt(5)
    v_mfma_f32_16x16x32_bf16 v[172:175], v[232:235], v[140:143], v[172:175]
    v_mfma_f32_16x16x32_bf16 v[176:179], v[232:235], v[144:147], v[176:179]
    s_waitcnt lgkmcnt(4)
    v_mfma_f32_16x16x32_bf16 v[172:175], v[236:239], v[148:151], v[172:175]
    v_mfma_f32_16x16x32_bf16 v[176:179], v[236:239], v[152:155], v[176:179]
    s_waitcnt lgkmcnt(3)
    v_mfma_f32_16x16x32_bf16 v[180:183], v[240:243], v[124:127], 0
    v_mfma_f32_16x16x32_bf16 v[184:187], v[240:243], v[128:131], 0
    s_waitcnt vmcnt(16) lgkmcnt(0)
    s_barrier
    ds_read_b64_tr_b16 v[224:225], v8 offset:16384
    ds_read_b64_tr_b16 v[226:227], v8 offset:17408
    s_add_u32 m0, s41, 0
    s_mov_b32 s40, 114688
    buffer_load_dwordx4 v1, s[28:31], s40 offen offset:0 nt lds
    v_mfma_f32_16x16x32_bf16 v[180:183], v[244:247], v[132:135], v[180:183]
    ds_read_b64_tr_b16 v[228:229], v9 offset:16384
    ds_read_b64_tr_b16 v[230:231], v9 offset:17408
    v_exp_f32 v22, v172
    v_exp_f32 v23, v173
    v_mfma_f32_16x16x32_bf16 v[184:187], v[244:247], v[136:139], v[184:187]
    ds_read_b64_tr_b16 v[232:233], v10 offset:16384
    ds_read_b64_tr_b16 v[234:235], v10 offset:17408
    v_exp_f32 v24, v174
    v_exp_f32 v25, v175
    v_mfma_f32_16x16x32_bf16 v[180:183], v[248:251], v[140:143], v[180:183]
    ds_read_b64_tr_b16 v[236:237], v11 offset:16384
    ds_read_b64_tr_b16 v[238:239], v11 offset:17408
    buffer_load_dwordx4 v1, s[28:31], s40 offen offset:1024 nt lds
    v_cvt_pk_bf16_f32 v196, v22, v23
    v_add_f32 v16, v16, v22
    v_add_f32 v17, v17, v23
    v_mfma_f32_16x16x32_bf16 v[184:187], v[248:251], v[144:147], v[184:187]
    ds_read_b64_tr_b16 v[240:241], v12 offset:16384
    ds_read_b64_tr_b16 v[242:243], v12 offset:17408
    v_exp_f32 v26, v176
    v_exp_f32 v27, v177
    v_mfma_f32_16x16x32_bf16 v[180:183], v[252:255], v[148:151], v[180:183]
    ds_read_b64_tr_b16 v[244:245], v13 offset:16384
    ds_read_b64_tr_b16 v[246:247], v13 offset:17408
    v_cvt_pk_bf16_f32 v197, v24, v25
    v_add_f32 v16, v16, v24
    v_add_f32 v17, v17, v25
    v_mfma_f32_16x16x32_bf16 v[184:187], v[252:255], v[152:155], v[184:187]
    ds_read_b64_tr_b16 v[248:249], v14 offset:16384
    ds_read_b64_tr_b16 v[250:251], v14 offset:17408
    buffer_load_dwordx4 v117, s[28:31], s40 offen offset:2048 nt lds
    v_exp_f32 v22, v178
    v_exp_f32 v23, v179
    s_waitcnt lgkmcnt(12)
    v_mfma_f32_16x16x32_bf16 v[28:31], v[224:227], v[204:207], v[28:31]
    ds_read_b64_tr_b16 v[252:253], v15 offset:16384
    ds_read_b64_tr_b16 v[254:255], v15 offset:17408
    v_cvt_pk_bf16_f32 v200, v26, v27
    v_add_f32 v18, v18, v26
    v_add_f32 v19, v19, v27
    v_mfma_f32_16x16x32_bf16 v[32:35], v[224:227], v[208:211], v[32:35]
    ds_read_b128 v[224:227], v4 offset:24576
    v_cvt_pk_bf16_f32 v201, v22, v23
    v_add_f32 v18, v18, v22
    v_add_f32 v19, v19, v23
    s_waitcnt lgkmcnt(13)
    v_mfma_f32_16x16x32_bf16 v[36:39], v[228:231], v[204:207], v[36:39]
    buffer_load_dwordx4 v117, s[28:31], s40 offen offset:3072 nt lds
    v_exp_f32 v24, v180
    v_mfma_f32_16x16x32_bf16 v[40:43], v[228:231], v[208:211], v[40:43]
    ds_read_b128 v[228:231], v5 offset:24576
    v_exp_f32 v25, v181
    s_waitcnt lgkmcnt(12)
    v_mfma_f32_16x16x32_bf16 v[44:47], v[232:235], v[204:207], v[44:47]
    v_exp_f32 v26, v182
    v_mfma_f32_16x16x32_bf16 v[48:51], v[232:235], v[208:211], v[48:51]
    ds_read_b128 v[232:235], v6 offset:24576
    s_add_u32 m0, s41, 8192
    s_mov_b32 s40, 122880
    buffer_load_dwordx4 v1, s[28:31], s40 offen offset:0 nt lds
    v_exp_f32 v27, v183
    s_waitcnt lgkmcnt(11)
    v_mfma_f32_16x16x32_bf16 v[52:55], v[236:239], v[204:207], v[52:55]
    v_cvt_pk_bf16_f32 v198, v24, v25
    v_add_f32 v16, v16, v24
    v_mfma_f32_16x16x32_bf16 v[56:59], v[236:239], v[208:211], v[56:59]
    ds_read_b128 v[236:239], v7 offset:24576
    v_add_f32 v17, v17, v25
    v_exp_f32 v22, v184
    s_waitcnt lgkmcnt(10)
    v_mfma_f32_16x16x32_bf16 v[60:63], v[240:243], v[204:207], v[60:63]
    buffer_load_dwordx4 v1, s[28:31], s40 offen offset:1024 nt lds
    v_exp_f32 v23, v185
    v_mfma_f32_16x16x32_bf16 v[64:67], v[240:243], v[208:211], v[64:67]
    ds_read_b128 v[240:243], v4 offset:25600
    v_cvt_pk_bf16_f32 v199, v26, v27
    v_add_f32 v16, v16, v26
    s_waitcnt lgkmcnt(9)
    v_mfma_f32_16x16x32_bf16 v[68:71], v[244:247], v[204:207], v[68:71]
    v_add_f32 v17, v17, v27
    v_exp_f32 v24, v186
    v_mfma_f32_16x16x32_bf16 v[72:75], v[244:247], v[208:211], v[72:75]
    ds_read_b128 v[244:247], v5 offset:25600
    buffer_load_dwordx4 v117, s[28:31], s40 offen offset:2048 nt lds
    v_exp_f32 v25, v187
    s_waitcnt lgkmcnt(8)
    v_mfma_f32_16x16x32_bf16 v[76:79], v[248:251], v[204:207], v[76:79]
    v_cvt_pk_bf16_f32 v202, v22, v23
    v_add_f32 v18, v18, v22
    v_mfma_f32_16x16x32_bf16 v[80:83], v[248:251], v[208:211], v[80:83]
    ds_read_b128 v[248:251], v6 offset:25600
    v_add_f32 v19, v19, v23
    v_cvt_pk_bf16_f32 v203, v24, v25
    s_waitcnt lgkmcnt(7)
    v_mfma_f32_16x16x32_bf16 v[84:87], v[252:255], v[204:207], v[84:87]
    buffer_load_dwordx4 v117, s[28:31], s40 offen offset:3072 nt lds
    v_add_f32 v18, v18, v24
    v_mfma_f32_16x16x32_bf16 v[88:91], v[252:255], v[208:211], v[88:91]
    ds_read_b128 v[252:255], v7 offset:25600
    v_add_f32 v19, v19, v25
    s_cmp_eq_u32 s43, 0
    s_cbranch_scc1 attn_kernel_b_skip12
    s_call_b64 s[54:55], attn_kernel_b_rare0
attn_kernel_b_skip12:
    s_waitcnt lgkmcnt(7)
    v_mfma_f32_16x16x32_bf16 v[172:175], v[224:227], v[124:127], 0
    v_mfma_f32_16x16x32_bf16 v[176:179], v[224:227], v[128:131], 0
    s_waitcnt lgkmcnt(6)
    v_mfma_f32_16x16x32_bf16 v[172:175], v[228:231], v[132:135], v[172:175]
    v_mfma_f32_16x16x32_bf16 v[176:179], v[228:231], v[136:139], v[176:179]
    s_waitcnt lgkmcnt(5)
    v_mfma_f32_16x16x32_bf16 v[172:175], v[232:235], v[140:143], v[172:175]
    v_mfma_f32_16x16x32_bf16 v[176:179], v[232:235], v[144:147], v[176:179]
    s_waitcnt lgkmcnt(4)
    v_mfma_f32_16x16x32_bf16 v[172:175], v[236:239], v[148:151], v[172:175]
    v_mfma_f32_16x16x32_bf16 v[176:179], v[236:239], v[152:155], v[176:179]
    s_waitcnt lgkmcnt(3)
    v_mfma_f32_16x16x32_bf16 v[180:183], v[240:243], v[124:127], 0
    v_mfma_f32_16x16x32_bf16 v[184:187], v[240:243], v[128:131], 0
    s_waitcnt vmcnt(16) lgkmcnt(0)
    s_barrier
    ds_read_b64_tr_b16 v[224:225], v8 offset:32768
    ds_read_b64_tr_b16 v[226:227], v8 offset:33792
    v_mfma_f32_16x16x32_bf16 v[180:183], v[244:247], v[132:135], v[180:183]
    ds_read_b64_tr_b16 v[228:229], v9 offset:32768
    ds_read_b64_tr_b16 v[230:231], v9 offset:33792
    v_exp_f32 v22, v172
    v_exp_f32 v23, v173
    v_mfma_f32_16x16x32_bf16 v[184:187], v[244:247], v[136:139], v[184:187]
    ds_read_b64_tr_b16 v[232:233], v10 offset:32768
    ds_read_b64_tr_b16 v[234:235], v10 offset:33792
    v_exp_f32 v24, v174
    v_exp_f32 v25, v175
    v_mfma_f32_16x16x32_bf16 v[180:183], v[248:251], v[140:143], v[180:183]
    ds_read_b64_tr_b16 v[236:237], v11 offset:32768
    ds_read_b64_tr_b16 v[238:239], v11 offset:33792
    v_cvt_pk_bf16_f32 v204, v22, v23
    v_add_f32 v16, v16, v22
    v_add_f32 v17, v17, v23
    v_mfma_f32_16x16x32_bf16 v[184:187], v[248:251], v[144:147], v[184:187]
    ds_read_b64_tr_b16 v[240:241], v12 offset:32768
    ds_read_b64_tr_b16 v[242:243], v12 offset:33792
    v_exp_f32 v26, v176
    v_exp_f32 v27, v177
    v_mfma_f32_16x16x32_bf16 v[180:183], v[252:255], v[148:151], v[180:183]
    ds_read_b64_tr_b16 v[244:245], v13 offset:32768
    ds_read_b64_tr_b16 v[246:247], v13 offset:33792
    v_cvt_pk_bf16_f32 v205, v24, v25
    v_add_f32 v16, v16, v24
    v_add_f32 v17, v17, v25
    v_mfma_f32_16x16x32_bf16 v[184:187], v[252:255], v[152:155], v[184:187]
    ds_read_b64_tr_b16 v[248:249], v14 offset:32768
    ds_read_b64_tr_b16 v[250:251], v14 offset:33792
    v_exp_f32 v22, v178
    v_exp_f32 v23, v179
    s_waitcnt lgkmcnt(12)
    v_mfma_f32_16x16x32_bf16 v[28:31], v[224:227], v[196:199], v[28:31]
    ds_read_b64_tr_b16 v[252:253], v15 offset:32768
    ds_read_b64_tr_b16 v[254:255], v15 offset:33792
    v_cvt_pk_bf16_f32 v208, v26, v27
    v_add_f32 v18, v18, v26
    v_add_f32 v19, v19, v27
    v_mfma_f32_16x16x32_bf16 v[32:35], v[224:227], v[200:203], v[32:35]
    ds_read_b128 v[224:227], v4 offset:40960
    v_cvt_pk_bf16_f32 v209, v22, v23
    v_add_f32 v18, v18, v22
    v_add_f32 v19, v19, v23
    s_waitcnt lgkmcnt(13)
    v_mfma_f32_16x16x32_bf16 v[36:39], v[228:231], v[196:199], v[36:39]
    v_exp_f32 v24, v180
    v_mfma_f32_16x16x32_bf16 v[40:43], v[228:231], v[200:203], v[40:43]
    ds_read_b128 v[228:231], v5 offset:40960
    v_exp_f32 v25, v181
    s_waitcnt lgkmcnt(12)
    v_mfma_f32_16x16x32_bf16 v[44:47], v[232:235], v[196:199], v[44:47]
    v_exp_f32 v26, v182
    v_mfma_f32_16x16x32_bf16 v[48:51], v[232:235], v[200:203], v[48:51]
    ds_read_b128 v[232:235], v6 offset:40960
    v_exp_f32 v27, v183
    s_waitcnt lgkmcnt(11)
    v_mfma_f32_16x16x32_bf16 v[52:55], v[236:239], v[196:199], v[52:55]
    v_cvt_pk_bf16_f32 v206, v24, v25
    v_add_f32 v16, v16, v24
    v_mfma_f32_16x16x32_bf16 v[56:59], v[236:239], v[200:203], v[56:59]
    ds_read_b128 v[236:239], v7 offset:40960
    v_add_f32 v17, v17, v25
    v_exp_f32 v22, v184
    s_waitcnt lgkmcnt(10)
    v_mfma_f32_16x16x32_bf16 v[60:63], v[240:243], v[196:199], v[60:63]
    v_exp_f32 v23, v185
    v_mfma_f32_16x16x32_bf16 v[64:67], v[240:243], v[200:203], v[64:67]
    ds_read_b128 v[240:243], v4 offset:41984
    v_cvt_pk_bf16_f32 v207, v26, v27
    v_add_f32 v16, v16, v26
    s_waitcnt lgkmcnt(9)
    v_mfma_f32_16x16x32_bf16 v[68:71], v[244:247], v[196:199], v[68:71]
    v_add_f32 v17, v17, v27
    v_exp_f32 v24, v186
    v_mfma_f32_16x16x32_bf16 v[72:75], v[244:247], v[200:203], v[72:75]
    ds_read_b128 v[244:247], v5 offset:41984
    v_exp_f32 v25, v187
    s_waitcnt lgkmcnt(8)
    v_mfma_f32_16x16x32_bf16 v[76:79], v[248:251], v[196:199], v[76:79]
    v_cvt_pk_bf16_f32 v210, v22, v23
    v_add_f32 v18, v18, v22
    v_mfma_f32_16x16x32_bf16 v[80:83], v[248:251], v[200:203], v[80:83]
    ds_read_b128 v[248:251], v6 offset:41984
    v_add_f32 v19, v19, v23
    v_cvt_pk_bf16_f32 v211, v24, v25
    s_waitcnt lgkmcnt(7)
    v_mfma_f32_16x16x32_bf16 v[84:87], v[252:255], v[196:199], v[84:87]
    v_add_f32 v18, v18, v24
    v_mfma_f32_16x16x32_bf16 v[88:91], v[252:255], v[200:203], v[88:91]
    ds_read_b128 v[252:255], v7 offset:41984
    v_add_f32 v19, v19, v25
    s_cmp_eq_u32 s43, 0
    s_cbranch_scc1 attn_kernel_b_skip13
    s_call_b64 s[54:55], attn_kernel_b_rare1
attn_kernel_b_skip13:
    s_waitcnt lgkmcnt(7)
    v_mfma_f32_16x16x32_bf16 v[172:175], v[224:227], v[124:127], 0
    v_mfma_f32_16x16x32_bf16 v[176:179], v[224:227], v[128:131], 0
    s_waitcnt lgkmcnt(6)
    v_mfma_f32_16x16x32_bf16 v[172:175], v[228:231], v[132:135], v[172:175]
    v_mfma_f32_16x16x32_bf16 v[176:179], v[228:231], v[136:139], v[176:179]
    s_waitcnt lgkmcnt(5)
    v_mfma_f32_16x16x32_bf16 v[172:175], v[232:235], v[140:143], v[172:175]
    v_mfma_f32_16x16x32_bf16 v[176:179], v[232:235], v[144:147], v[176:179]
    s_waitcnt lgkmcnt(4)
    v_mfma_f32_16x16x32_bf16 v[172:175], v[236:239], v[148:151], v[172:175]
    v_mfma_f32_16x16x32_bf16 v[176:179], v[236:239], v[152:155], v[176:179]
    s_waitcnt lgkmcnt(3)
    v_mfma_f32_16x16x32_bf16 v[180:183], v[240:243], v[124:127], 0
    v_mfma_f32_16x16x32_bf16 v[184:187], v[240:243], v[128:131], 0
    s_waitcnt vmcnt(8) lgkmcnt(0)
    s_barrier
    ds_read_b64_tr_b16 v[224:225], v8 offset:49152
    ds_read_b64_tr_b16 v[226:227], v8 offset:50176
    v_mfma_f32_16x16x32_bf16 v[180:183], v[244:247], v[132:135], v[180:183]
    ds_read_b64_tr_b16 v[228:229], v9 offset:49152
    ds_read_b64_tr_b16 v[230:231], v9 offset:50176
    v_exp_f32 v22, v172
    v_exp_f32 v23, v173
    v_mfma_f32_16x16x32_bf16 v[184:187], v[244:247], v[136:139], v[184:187]
    ds_read_b64_tr_b16 v[232:233], v10 offset:49152
    ds_read_b64_tr_b16 v[234:235], v10 offset:50176
    v_exp_f32 v24, v174
    v_exp_f32 v25, v175
    v_mfma_f32_16x16x32_bf16 v[180:183], v[248:251], v[140:143], v[180:183]
    ds_read_b64_tr_b16 v[236:237], v11 offset:49152
    ds_read_b64_tr_b16 v[238:239], v11 offset:50176
    v_cvt_pk_bf16_f32 v196, v22, v23
    v_add_f32 v16, v16, v22
    v_add_f32 v17, v17, v23
    v_mfma_f32_16x16x32_bf16 v[184:187], v[248:251], v[144:147], v[184:187]
    ds_read_b64_tr_b16 v[240:241], v12 offset:49152
    ds_read_b64_tr_b16 v[242:243], v12 offset:50176
    v_exp_f32 v26, v176
    v_exp_f32 v27, v177
    v_mfma_f32_16x16x32_bf16 v[180:183], v[252:255], v[148:151], v[180:183]
    ds_read_b64_tr_b16 v[244:245], v13 offset:49152
    ds_read_b64_tr_b16 v[246:247], v13 offset:50176
    v_cvt_pk_bf16_f32 v197, v24, v25
    v_add_f32 v16, v16, v24
    v_add_f32 v17, v17, v25
    v_mfma_f32_16x16x32_bf16 v[184:187], v[252:255], v[152:155], v[184:187]
    ds_read_b64_tr_b16 v[248:249], v14 offset:49152
    ds_read_b64_tr_b16 v[250:251], v14 offset:50176
    v_exp_f32 v22, v178
    v_exp_f32 v23, v179
    s_waitcnt lgkmcnt(12)
    v_mfma_f32_16x16x32_bf16 v[28:31], v[224:227], v[204:207], v[28:31]
    ds_read_b64_tr_b16 v[252:253], v15 offset:49152
    ds_read_b64_tr_b16 v[254:255], v15 offset:50176
    v_cvt_pk_bf16_f32 v200, v26, v27
    v_add_f32 v18, v18, v26
    v_add_f32 v19, v19, v27
    v_mfma_f32_16x16x32_bf16 v[32:35], v[224:227], v[208:211], v[32:35]
    ds_read_b128 v[224:227], v4 offset:57344
    v_cvt_pk_bf16_f32 v201, v22, v23
    v_add_f32 v18, v18, v22
    v_add_f32 v19, v19, v23
    s_waitcnt lgkmcnt(13)
    v_mfma_f32_16x16x32_bf16 v[36:39], v[228:231], v[204:207], v[36:39]
    v_exp_f32 v24, v180
    v_mfma_f32_16x16x32_bf16 v[40:43], v[228:231], v[208:211], v[40:43]
    ds_read_b128 v[228:231], v5 offset:57344
    v_exp_f32 v25, v181
    s_waitcnt lgkmcnt(12)
    v_mfma_f32_16x16x32_bf16 v[44:47], v[232:235], v[204:207], v[44:47]
    v_exp_f32 v26, v182
    v_mfma_f32_16x16x32_bf16 v[48:51], v[232:235], v[208:211], v[48:51]
    ds_read_b128 v[232:235], v6 offset:57344
    v_exp_f32 v27, v183
    s_waitcnt lgkmcnt(11)
    v_mfma_f32_16x16x32_bf16 v[52:55], v[236:239], v[204:207], v[52:55]
    v_cvt_pk_bf16_f32 v198, v24, v25
    v_add_f32 v16, v16, v24
    v_mfma_f32_16x16x32_bf16 v[56:59], v[236:239], v[208:211], v[56:59]
    ds_read_b128 v[236:239], v7 offset:57344
    v_add_f32 v17, v17, v25
    v_exp_f32 v22, v184
    s_waitcnt lgkmcnt(10)
    v_mfma_f32_16x16x32_bf16 v[60:63], v[240:243], v[204:207], v[60:63]
    v_exp_f32 v23, v185
    v_mfma_f32_16x16x32_bf16 v[64:67], v[240:243], v[208:211], v[64:67]
    ds_read_b128 v[240:243], v4 offset:58368
    v_cvt_pk_bf16_f32 v199, v26, v27
    v_add_f32 v16, v16, v26
    s_waitcnt lgkmcnt(9)
    v_mfma_f32_16x16x32_bf16 v[68:71], v[244:247], v[204:207], v[68:71]
    v_add_f32 v17, v17, v27
    v_exp_f32 v24, v186
    v_mfma_f32_16x16x32_bf16 v[72:75], v[244:247], v[208:211], v[72:75]
    ds_read_b128 v[244:247], v5 offset:58368
    v_exp_f32 v25, v187
    s_waitcnt lgkmcnt(8)
    v_mfma_f32_16x16x32_bf16 v[76:79], v[248:251], v[204:207], v[76:79]
    v_cvt_pk_bf16_f32 v202, v22, v23
    v_add_f32 v18, v18, v22
    v_mfma_f32_16x16x32_bf16 v[80:83], v[248:251], v[208:211], v[80:83]
    ds_read_b128 v[248:251], v6 offset:58368
    v_add_f32 v19, v19, v23
    v_cvt_pk_bf16_f32 v203, v24, v25
    s_waitcnt lgkmcnt(7)
    v_mfma_f32_16x16x32_bf16 v[84:87], v[252:255], v[204:207], v[84:87]
    v_add_f32 v18, v18, v24
    v_mfma_f32_16x16x32_bf16 v[88:91], v[252:255], v[208:211], v[88:91]
    ds_read_b128 v[252:255], v7 offset:58368
    v_add_f32 v19, v19, v25
    s_cmp_eq_u32 s43, 0
    s_cbranch_scc1 attn_kernel_b_skip14
    s_call_b64 s[54:55], attn_kernel_b_rare0
attn_kernel_b_skip14:
    s_waitcnt lgkmcnt(7)
    v_mfma_f32_16x16x32_bf16 v[172:175], v[224:227], v[124:127], 0
    v_mfma_f32_16x16x32_bf16 v[176:179], v[224:227], v[128:131], 0
    s_waitcnt lgkmcnt(6)
    v_mfma_f32_16x16x32_bf16 v[172:175], v[228:231], v[132:135], v[172:175]
    v_mfma_f32_16x16x32_bf16 v[176:179], v[228:231], v[136:139], v[176:179]
    s_waitcnt lgkmcnt(5)
    v_mfma_f32_16x16x32_bf16 v[172:175], v[232:235], v[140:143], v[172:175]
    v_mfma_f32_16x16x32_bf16 v[176:179], v[232:235], v[144:147], v[176:179]
    s_waitcnt lgkmcnt(4)
    v_mfma_f32_16x16x32_bf16 v[172:175], v[236:239], v[148:151], v[172:175]
    v_mfma_f32_16x16x32_bf16 v[176:179], v[236:239], v[152:155], v[176:179]
    s_waitcnt lgkmcnt(3)
    v_mfma_f32_16x16x32_bf16 v[180:183], v[240:243], v[124:127], 0
    v_mfma_f32_16x16x32_bf16 v[184:187], v[240:243], v[128:131], 0
    s_waitcnt vmcnt(0) lgkmcnt(0)
    s_barrier
    ds_read_b64_tr_b16 v[224:225], v8 offset:0
    ds_read_b64_tr_b16 v[226:227], v8 offset:1024
    v_mfma_f32_16x16x32_bf16 v[180:183], v[244:247], v[132:135], v[180:183]
    ds_read_b64_tr_b16 v[228:229], v9 offset:0
    ds_read_b64_tr_b16 v[230:231], v9 offset:1024
    v_exp_f32 v22, v172
    v_exp_f32 v23, v173
    v_mfma_f32_16x16x32_bf16 v[184:187], v[244:247], v[136:139], v[184:187]
    ds_read_b64_tr_b16 v[232:233], v10 offset:0
    ds_read_b64_tr_b16 v[234:235], v10 offset:1024
    v_exp_f32 v24, v174
    v_exp_f32 v25, v175
    v_mfma_f32_16x16x32_bf16 v[180:183], v[248:251], v[140:143], v[180:183]
    ds_read_b64_tr_b16 v[236:237], v11 offset:0
    ds_read_b64_tr_b16 v[238:239], v11 offset:1024
    v_cvt_pk_bf16_f32 v204, v22, v23
    v_add_f32 v16, v16, v22
    v_add_f32 v17, v17, v23
    v_mfma_f32_16x16x32_bf16 v[184:187], v[248:251], v[144:147], v[184:187]
    ds_read_b64_tr_b16 v[240:241], v12 offset:0
    ds_read_b64_tr_b16 v[242:243], v12 offset:1024
    v_exp_f32 v26, v176
    v_exp_f32 v27, v177
    v_mfma_f32_16x16x32_bf16 v[180:183], v[252:255], v[148:151], v[180:183]
    ds_read_b64_tr_b16 v[244:245], v13 offset:0
    ds_read_b64_tr_b16 v[246:247], v13 offset:1024
    v_cvt_pk_bf16_f32 v205, v24, v25
    v_add_f32 v16, v16, v24
    v_add_f32 v17, v17, v25
    v_mfma_f32_16x16x32_bf16 v[184:187], v[252:255], v[152:155], v[184:187]
    ds_read_b64_tr_b16 v[248:249], v14 offset:0
    ds_read_b64_tr_b16 v[250:251], v14 offset:1024
    v_exp_f32 v22, v178
    v_exp_f32 v23, v179
    s_waitcnt lgkmcnt(12)
    v_mfma_f32_16x16x32_bf16 v[28:31], v[224:227], v[196:199], v[28:31]
    ds_read_b64_tr_b16 v[252:253], v15 offset:0
    ds_read_b64_tr_b16 v[254:255], v15 offset:1024
    v_cvt_pk_bf16_f32 v208, v26, v27
    v_add_f32 v18, v18, v26
    v_add_f32 v19, v19, v27
    v_mfma_f32_16x16x32_bf16 v[32:35], v[224:227], v[200:203], v[32:35]
    ds_read_b64_tr_b16 v[224:225], v8 offset:8192
    ds_read_b64_tr_b16 v[226:227], v8 offset:9216
    v_cvt_pk_bf16_f32 v209, v22, v23
    v_add_f32 v18, v18, v22
    v_add_f32 v19, v19, v23
    s_waitcnt lgkmcnt(14)
    v_mfma_f32_16x16x32_bf16 v[36:39], v[228:231], v[196:199], v[36:39]
    v_exp_f32 v24, v180
    v_mfma_f32_16x16x32_bf16 v[40:43], v[228:231], v[200:203], v[40:43]
    ds_read_b64_tr_b16 v[228:229], v9 offset:8192
    ds_read_b64_tr_b16 v[230:231], v9 offset:9216
    v_exp_f32 v25, v181
    s_waitcnt lgkmcnt(14)
    v_mfma_f32_16x16x32_bf16 v[44:47], v[232:235], v[196:199], v[44:47]
    v_exp_f32 v26, v182
    v_mfma_f32_16x16x32_bf16 v[48:51], v[232:235], v[200:203], v[48:51]
    ds_read_b64_tr_b16 v[232:233], v10 offset:8192
    ds_read_b64_tr_b16 v[234:235], v10 offset:9216
    v_exp_f32 v27, v183
    s_waitcnt lgkmcnt(14)
    v_mfma_f32_16x16x32_bf16 v[52:55], v[236:239], v[196:199], v[52:55]
    v_cvt_pk_bf16_f32 v206, v24, v25
    v_add_f32 v16, v16, v24
    v_mfma_f32_16x16x32_bf16 v[56:59], v[236:239], v[200:203], v[56:59]
    ds_read_b64_tr_b16 v[236:237], v11 offset:8192
    ds_read_b64_tr_b16 v[238:239], v11 offset:9216
    v_add_f32 v17, v17, v25
    v_exp_f32 v22, v184
    s_waitcnt lgkmcnt(14)
    v_mfma_f32_16x16x32_bf16 v[60:63], v[240:243], v[196:199], v[60:63]
    v_exp_f32 v23, v185
    v_mfma_f32_16x16x32_bf16 v[64:67], v[240:243], v[200:203], v[64:67]
    ds_read_b64_tr_b16 v[240:241], v12 offset:8192
    ds_read_b64_tr_b16 v[242:243], v12 offset:9216
    v_cvt_pk_bf16_f32 v207, v26, v27
    v_add_f32 v16, v16, v26
    s_waitcnt lgkmcnt(14)
    v_mfma_f32_16x16x32_bf16 v[68:71], v[244:247], v[196:199], v[68:71]
    v_add_f32 v17, v17, v27
    v_exp_f32 v24, v186
    v_mfma_f32_16x16x32_bf16 v[72:75], v[244:247], v[200:203], v[72:75]
    ds_read_b64_tr_b16 v[244:245], v13 offset:8192
    ds_read_b64_tr_b16 v[246:247], v13 offset:9216
    v_exp_f32 v25, v187
    s_waitcnt lgkmcnt(14)
    v_mfma_f32_16x16x32_bf16 v[76:79], v[248:251], v[196:199], v[76:79]
    v_cvt_pk_bf16_f32 v210, v22, v23
    v_add_f32 v18, v18, v22
    v_mfma_f32_16x16x32_bf16 v[80:83], v[248:251], v[200:203], v[80:83]
    ds_read_b64_tr_b16 v[248:249], v14 offset:8192
    ds_read_b64_tr_b16 v[250:251], v14 offset:9216
    v_add_f32 v19, v19, v23
    v_cvt_pk_bf16_f32 v211, v24, v25
    s_waitcnt lgkmcnt(14)
    v_mfma_f32_16x16x32_bf16 v[84:87], v[252:255], v[196:199], v[84:87]
    v_add_f32 v18, v18, v24
    v_mfma_f32_16x16x32_bf16 v[88:91], v[252:255], v[200:203], v[88:91]
    ds_read_b64_tr_b16 v[252:253], v15 offset:8192
    ds_read_b64_tr_b16 v[254:255], v15 offset:9216
    v_add_f32 v19, v19, v25
    s_cmp_eq_u32 s43, 0
    s_cbranch_scc1 attn_kernel_b_skip15
    s_call_b64 s[54:55], attn_kernel_b_rare1
attn_kernel_b_skip15:
    s_waitcnt lgkmcnt(14)
    v_mfma_f32_16x16x32_bf16 v[28:31], v[224:227], v[204:207], v[28:31]
    v_mfma_f32_16x16x32_bf16 v[32:35], v[224:227], v[208:211], v[32:35]
    s_waitcnt lgkmcnt(12)
    v_mfma_f32_16x16x32_bf16 v[36:39], v[228:231], v[204:207], v[36:39]
    v_mfma_f32_16x16x32_bf16 v[40:43], v[228:231], v[208:211], v[40:43]
    s_waitcnt lgkmcnt(10)
    v_mfma_f32_16x16x32_bf16 v[44:47], v[232:235], v[204:207], v[44:47]
    v_mfma_f32_16x16x32_bf16 v[48:51], v[232:235], v[208:211], v[48:51]
    s_waitcnt lgkmcnt(8)
    v_mfma_f32_16x16x32_bf16 v[52:55], v[236:239], v[204:207], v[52:55]
    v_mfma_f32_16x16x32_bf16 v[56:59], v[236:239], v[208:211], v[56:59]
    s_waitcnt lgkmcnt(6)
    v_mfma_f32_16x16x32_bf16 v[60:63], v[240:243], v[204:207], v[60:63]
    v_mfma_f32_16x16x32_bf16 v[64:67], v[240:243], v[208:211], v[64:67]
    s_waitcnt lgkmcnt(4)
    v_mfma_f32_16x16x32_bf16 v[68:71], v[244:247], v[204:207], v[68:71]
    v_mfma_f32_16x16x32_bf16 v[72:75], v[244:247], v[208:211], v[72:75]
    s_waitcnt lgkmcnt(2)
    v_mfma_f32_16x16x32_bf16 v[76:79], v[248:251], v[204:207], v[76:79]
    v_mfma_f32_16x16x32_bf16 v[80:83], v[248:251], v[208:211], v[80:83]
    s_waitcnt lgkmcnt(0)
    v_mfma_f32_16x16x32_bf16 v[84:87], v[252:255], v[204:207], v[84:87]
    v_mfma_f32_16x16x32_bf16 v[88:91], v[252:255], v[208:211], v[88:91]
    v_add_f32 v16, v16, v17
    v_add_f32 v18, v18, v19
    v_mov_b32 v22, v16
    v_mov_b32 v23, v18
    s_nop 0
    v_permlane32_swap_b32 v16, v22
    v_permlane32_swap_b32 v18, v23
    v_add_f32 v16, v16, v22
    v_add_f32 v18, v18, v23
    v_mov_b32 v22, v16
    v_mov_b32 v23, v18
    s_nop 0
    v_permlane16_swap_b32 v16, v22
    v_permlane16_swap_b32 v18, v23
    v_add_f32 v16, v16, v22
    v_add_f32 v18, v18, v23
    v_add_f32 v22, v16, v18
    v_min_f32 v23, v16, v18
    v_cmp_nge_f32 vcc, s42, v22
    v_cmp_nle_f32 s[54:55], s49, v23
    s_nop 1
    s_or_b64 vcc, vcc, s[54:55]
    v_mov_b32 v24, s79
    v_mov_b32 v25, 0
    s_nop 1
    s_cmp_lg_u64 vcc, 0
    s_cselect_b32 s40, 1, 0
    v_mov_b32 v23, s40
    ds_write_b32 v24, v23 offset:49152
    v_rcp_f32 v16, v16
    v_rcp_f32 v18, v18
    v_mbcnt_lo_u32_b32 v1, -1, 0
    v_mbcnt_hi_u32_b32 v1, -1, v1
    s_waitcnt lgkmcnt(0)
    s_barrier
    ds_read_b128 v[224:227], v25 offset:49152
    v_mov_b32 v0, v1
    v_lshlrev_b32 v2, 4, v1
    s_waitcnt lgkmcnt(0)
    v_or3_b32 v224, v224, v225, v226
    v_or_b32 v224, v224, v227
    s_nop 0
    v_readfirstlane_b32 s40, v224
    s_nop 1
    s_andn2_b32 s40, s40, s43
    s_cbranch_scc0 attn_kernel_b_fin
    s_mov_b32 s43, 1
    s_waitcnt vmcnt(0) lgkmcnt(0)
    s_barrier
    s_branch attn_kernel_restart
attn_kernel_b_fin:
    v_mul_f32 v28, v28, v16
    v_mul_f32 v29, v29, v16
    v_mul_f32 v30, v30, v16
    v_mul_f32 v31, v31, v16
    v_mul_f32 v36, v36, v16
    v_mul_f32 v37, v37, v16
    v_mul_f32 v38, v38, v16
    v_mul_f32 v39, v39, v16
    v_cvt_pk_bf16_f32 v124, v28, v29
    v_cvt_pk_bf16_f32 v125, v30, v31
    v_cvt_pk_bf16_f32 v126, v36, v37
    v_cvt_pk_bf16_f32 v127, v38, v39
    buffer_store_dwordx4 v[124:127], v2, s[36:39], s50 offen offset:0 sc1
    v_mul_f32 v32, v32, v18
    v_mul_f32 v33, v33, v18
    v_mul_f32 v34, v34, v18
    v_mul_f32 v35, v35, v18
    v_mul_f32 v40, v40, v18
    v_mul_f32 v41, v41, v18
    v_mul_f32 v42, v42, v18
    v_mul_f32 v43, v43, v18
    v_cvt_pk_bf16_f32 v128, v32, v33
    v_cvt_pk_bf16_f32 v129, v34, v35
    v_cvt_pk_bf16_f32 v130, v40, v41
    v_cvt_pk_bf16_f32 v131, v42, v43
    buffer_store_dwordx4 v[128:131], v2, s[36:39], s51 offen offset:0 sc1
    v_mul_f32 v44, v44, v16
    v_mul_f32 v45, v45, v16
    v_mul_f32 v46, v46, v16
    v_mul_f32 v47, v47, v16
    v_mul_f32 v52, v52, v16
    v_mul_f32 v53, v53, v16
    v_mul_f32 v54, v54, v16
    v_mul_f32 v55, v55, v16
    v_cvt_pk_bf16_f32 v132, v44, v45
    v_cvt_pk_bf16_f32 v133, v46, v47
    v_cvt_pk_bf16_f32 v134, v52, v53
    v_cvt_pk_bf16_f32 v135, v54, v55
    buffer_store_dwordx4 v[132:135], v2, s[36:39], s50 offen offset:1024 sc1
    v_mul_f32 v48, v48, v18
    v_mul_f32 v49, v49, v18
    v_mul_f32 v50, v50, v18
    v_mul_f32 v51, v51, v18
    v_mul_f32 v56, v56, v18
    v_mul_f32 v57, v57, v18
    v_mul_f32 v58, v58, v18
    v_mul_f32 v59, v59, v18
    v_cvt_pk_bf16_f32 v136, v48, v49
    v_cvt_pk_bf16_f32 v137, v50, v51
    v_cvt_pk_bf16_f32 v138, v56, v57
    v_cvt_pk_bf16_f32 v139, v58, v59
    buffer_store_dwordx4 v[136:139], v2, s[36:39], s51 offen offset:1024 sc1
    v_mul_f32 v60, v60, v16
    v_mul_f32 v61, v61, v16
    v_mul_f32 v62, v62, v16
    v_mul_f32 v63, v63, v16
    v_mul_f32 v68, v68, v16
    v_mul_f32 v69, v69, v16
    v_mul_f32 v70, v70, v16
    v_mul_f32 v71, v71, v16
    v_cvt_pk_bf16_f32 v140, v60, v61
    v_cvt_pk_bf16_f32 v141, v62, v63
    v_cvt_pk_bf16_f32 v142, v68, v69
    v_cvt_pk_bf16_f32 v143, v70, v71
    buffer_store_dwordx4 v[140:143], v2, s[36:39], s50 offen offset:2048 sc1
    v_mul_f32 v64, v64, v18
    v_mul_f32 v65, v65, v18
    v_mul_f32 v66, v66, v18
    v_mul_f32 v67, v67, v18
    v_mul_f32 v72, v72, v18
    v_mul_f32 v73, v73, v18
    v_mul_f32 v74, v74, v18
    v_mul_f32 v75, v75, v18
    v_cvt_pk_bf16_f32 v144, v64, v65
    v_cvt_pk_bf16_f32 v145, v66, v67
    v_cvt_pk_bf16_f32 v146, v72, v73
    v_cvt_pk_bf16_f32 v147, v74, v75
    buffer_store_dwordx4 v[144:147], v2, s[36:39], s51 offen offset:2048 sc1
    v_mul_f32 v76, v76, v16
    v_mul_f32 v77, v77, v16
    v_mul_f32 v78, v78, v16
    v_mul_f32 v79, v79, v16
    v_mul_f32 v84, v84, v16
    v_mul_f32 v85, v85, v16
    v_mul_f32 v86, v86, v16
    v_mul_f32 v87, v87, v16
    v_cvt_pk_bf16_f32 v148, v76, v77
    v_cvt_pk_bf16_f32 v149, v78, v79
    v_cvt_pk_bf16_f32 v150, v84, v85
    v_cvt_pk_bf16_f32 v151, v86, v87
    buffer_store_dwordx4 v[148:151], v2, s[36:39], s50 offen offset:3072 sc1
    v_mul_f32 v80, v80, v18
    v_mul_f32 v81, v81, v18
    v_mul_f32 v82, v82, v18
    v_mul_f32 v83, v83, v18
    v_mul_f32 v88, v88, v18
    v_mul_f32 v89, v89, v18
    v_mul_f32 v90, v90, v18
    v_mul_f32 v91, v91, v18
    v_cvt_pk_bf16_f32 v152, v80, v81
    v_cvt_pk_bf16_f32 v153, v82, v83
    v_cvt_pk_bf16_f32 v154, v88, v89
    v_cvt_pk_bf16_f32 v155, v90, v91
    buffer_store_dwordx4 v[152:155], v2, s[36:39], s51 offen offset:3072 sc1
    s_add_u32 s40, s77, 0
    v_lshl_or_b32 v92, v93, 16, v92
    v_lshl_or_b32 v93, v95, 16, v94
    v_lshl_or_b32 v94, v97, 16, v96
    v_lshl_or_b32 v95, v99, 16, v98
    buffer_store_dwordx4 v[92:95], v2, s[72:75], s40 offen offset:0 sc1
    s_nop 1
    s_add_u32 s40, s77, 2097152
    v_lshl_or_b32 v100, v101, 16, v100
    v_lshl_or_b32 v101, v103, 16, v102
    v_lshl_or_b32 v102, v105, 16, v104
    v_lshl_or_b32 v103, v107, 16, v106
    buffer_store_dwordx4 v[100:103], v2, s[72:75], s40 offen offset:0 sc1
    s_nop 1
    s_add_u32 s40, s77, 4194304
    v_lshl_or_b32 v108, v109, 16, v108
    v_lshl_or_b32 v109, v111, 16, v110
    v_lshl_or_b32 v110, v113, 16, v112
    v_lshl_or_b32 v111, v115, 16, v114
    buffer_store_dwordx4 v[108:111], v2, s[72:75], s40 offen offset:0 sc1
    s_endpgm
attn_kernel_b_rare0:
    s_nop 11
    v_max3_f32 v22, v172, v173, v174
    v_max3_f32 v23, v175, v180, v181
    v_max3_f32 v22, v22, v182, v183
    v_max_f32 v22, v22, v23
    v_mov_b32 v23, v22
    s_nop 1
    v_permlane32_swap_b32 v22, v23
    v_max_f32 v22, v22, v23
    v_mov_b32 v23, v22
    s_nop 1
    v_permlane16_swap_b32 v22, v23
    v_max_f32 v22, v22, v23
    v_max_f32 v22, v220, v22
    v_sub_f32 v23, v220, v22
    v_exp_f32 v23, v23
    v_mov_b32 v220, v22
    v_sub_f32 v172, v172, v22
    v_sub_f32 v173, v173, v22
    v_sub_f32 v174, v174, v22
    v_sub_f32 v175, v175, v22
    v_sub_f32 v180, v180, v22
    v_sub_f32 v181, v181, v22
    v_sub_f32 v182, v182, v22
    v_sub_f32 v183, v183, v22
    v_mul_f32 v16, v0, v23
    v_mov_b32 v17, 0
    v_mul_f32 v28, v28, v23
    v_mul_f32 v29, v29, v23
    v_mul_f32 v30, v30, v23
    v_mul_f32 v31, v31, v23
    v_mul_f32 v36, v36, v23
    v_mul_f32 v37, v37, v23
    v_mul_f32 v38, v38, v23
    v_mul_f32 v39, v39, v23
    v_mul_f32 v44, v44, v23
    v_mul_f32 v45, v45, v23
    v_mul_f32 v46, v46, v23
    v_mul_f32 v47, v47, v23
    v_mul_f32 v52, v52, v23
    v_mul_f32 v53, v53, v23
    v_mul_f32 v54, v54, v23
    v_mul_f32 v55, v55, v23
    v_mul_f32 v60, v60, v23
    v_mul_f32 v61, v61, v23
    v_mul_f32 v62, v62, v23
    v_mul_f32 v63, v63, v23
    v_mul_f32 v68, v68, v23
    v_mul_f32 v69, v69, v23
    v_mul_f32 v70, v70, v23
    v_mul_f32 v71, v71, v23
    v_mul_f32 v76, v76, v23
    v_mul_f32 v77, v77, v23
    v_mul_f32 v78, v78, v23
    v_mul_f32 v79, v79, v23
    v_mul_f32 v84, v84, v23
    v_mul_f32 v85, v85, v23
    v_mul_f32 v86, v86, v23
    v_mul_f32 v87, v87, v23
    v_max3_f32 v22, v176, v177, v178
    v_max3_f32 v23, v179, v184, v185
    v_max3_f32 v22, v22, v186, v187
    v_max_f32 v22, v22, v23
    v_mov_b32 v23, v22
    s_nop 1
    v_permlane32_swap_b32 v22, v23
    v_max_f32 v22, v22, v23
    v_mov_b32 v23, v22
    s_nop 1
    v_permlane16_swap_b32 v22, v23
    v_max_f32 v22, v22, v23
    v_max_f32 v22, v221, v22
    v_sub_f32 v23, v221, v22
    v_exp_f32 v23, v23
    v_mov_b32 v221, v22
    v_sub_f32 v176, v176, v22
    v_sub_f32 v177, v177, v22
    v_sub_f32 v178, v178, v22
    v_sub_f32 v179, v179, v22
    v_sub_f32 v184, v184, v22
    v_sub_f32 v185, v185, v22
    v_sub_f32 v186, v186, v22
    v_sub_f32 v187, v187, v22
    v_mul_f32 v18, v2, v23
    v_mov_b32 v19, 0
    v_mul_f32 v32, v32, v23
    v_mul_f32 v33, v33, v23
    v_mul_f32 v34, v34, v23
    v_mul_f32 v35, v35, v23
    v_mul_f32 v40, v40, v23
    v_mul_f32 v41, v41, v23
    v_mul_f32 v42, v42, v23
    v_mul_f32 v43, v43, v23
    v_mul_f32 v48, v48, v23
    v_mul_f32 v49, v49, v23
    v_mul_f32 v50, v50, v23
    v_mul_f32 v51, v51, v23
    v_mul_f32 v56, v56, v23
    v_mul_f32 v57, v57, v23
    v_mul_f32 v58, v58, v23
    v_mul_f32 v59, v59, v23
    v_mul_f32 v64, v64, v23
    v_mul_f32 v65, v65, v23
    v_mul_f32 v66, v66, v23
    v_mul_f32 v67, v67, v23
    v_mul_f32 v72, v72, v23
    v_mul_f32 v73, v73, v23
    v_mul_f32 v74, v74, v23
    v_mul_f32 v75, v75, v23
    v_mul_f32 v80, v80, v23
    v_mul_f32 v81, v81, v23
    v_mul_f32 v82, v82, v23
    v_mul_f32 v83, v83, v23
    v_mul_f32 v88, v88, v23
    v_mul_f32 v89, v89, v23
    v_mul_f32 v90, v90, v23
    v_mul_f32 v91, v91, v23
    v_exp_f32 v22, v172
    v_exp_f32 v23, v173
    v_exp_f32 v24, v174
    v_exp_f32 v25, v175
    v_cvt_pk_bf16_f32 v196, v22, v23
    v_add_f32 v16, v16, v22
    v_add_f32 v17, v17, v23
    v_exp_f32 v26, v176
    v_exp_f32 v27, v177
    v_cvt_pk_bf16_f32 v197, v24, v25
    v_add_f32 v16, v16, v24
    v_add_f32 v17, v17, v25
    v_exp_f32 v22, v178
    v_exp_f32 v23, v179
    v_cvt_pk_bf16_f32 v200, v26, v27
    v_add_f32 v18, v18, v26
    v_add_f32 v19, v19, v27
    v_cvt_pk_bf16_f32 v201, v22, v23
    v_add_f32 v18, v18, v22
    v_add_f32 v19, v19, v23
    v_exp_f32 v24, v180
    v_exp_f32 v25, v181
    v_exp_f32 v26, v182
    v_exp_f32 v27, v183
    v_cvt_pk_bf16_f32 v198, v24, v25
    v_add_f32 v16, v16, v24
    v_add_f32 v17, v17, v25
    v_exp_f32 v22, v184
    v_exp_f32 v23, v185
    v_cvt_pk_bf16_f32 v199, v26, v27
    v_add_f32 v16, v16, v26
    v_add_f32 v17, v17, v27
    v_exp_f32 v24, v186
    v_exp_f32 v25, v187
    v_cvt_pk_bf16_f32 v202, v22, v23
    v_add_f32 v18, v18, v22
    v_add_f32 v19, v19, v23
    v_cvt_pk_bf16_f32 v203, v24, v25
    v_add_f32 v18, v18, v24
    v_add_f32 v19, v19, v25
    v_add_f32 v0, v16, v17
    v_add_f32 v2, v18, v19
    s_nop 3
    s_setpc_b64 s[54:55]
attn_kernel_b_rare1:
    s_nop 11
    v_max3_f32 v22, v172, v173, v174
    v_max3_f32 v23, v175, v180, v181
    v_max3_f32 v22, v22, v182, v183
    v_max_f32 v22, v22, v23
    v_mov_b32 v23, v22
    s_nop 1
    v_permlane32_swap_b32 v22, v23
    v_max_f32 v22, v22, v23
    v_mov_b32 v23, v22
    s_nop 1
    v_permlane16_swap_b32 v22, v23
    v_max_f32 v22, v22, v23
    v_max_f32 v22, v220, v22
    v_sub_f32 v23, v220, v22
    v_exp_f32 v23, v23
    v_mov_b32 v220, v22
    v_sub_f32 v172, v172, v22
    v_sub_f32 v173, v173, v22
    v_sub_f32 v174, v174, v22
    v_sub_f32 v175, v175, v22
    v_sub_f32 v180, v180, v22
    v_sub_f32 v181, v181, v22
    v_sub_f32 v182, v182, v22
    v_sub_f32 v183, v183, v22
    v_mul_f32 v16, v0, v23
    v_mov_b32 v17, 0
    v_mul_f32 v28, v28, v23
    v_mul_f32 v29, v29, v23
    v_mul_f32 v30, v30, v23
    v_mul_f32 v31, v31, v23
    v_mul_f32 v36, v36, v23
    v_mul_f32 v37, v37, v23
    v_mul_f32 v38, v38, v23
    v_mul_f32 v39, v39, v23
    v_mul_f32 v44, v44, v23
    v_mul_f32 v45, v45, v23
    v_mul_f32 v46, v46, v23
    v_mul_f32 v47, v47, v23
    v_mul_f32 v52, v52, v23
    v_mul_f32 v53, v53, v23
    v_mul_f32 v54, v54, v23
    v_mul_f32 v55, v55, v23
    v_mul_f32 v60, v60, v23
    v_mul_f32 v61, v61, v23
    v_mul_f32 v62, v62, v23
    v_mul_f32 v63, v63, v23
    v_mul_f32 v68, v68, v23
    v_mul_f32 v69, v69, v23
    v_mul_f32 v70, v70, v23
    v_mul_f32 v71, v71, v23
    v_mul_f32 v76, v76, v23
    v_mul_f32 v77, v77, v23
    v_mul_f32 v78, v78, v23
    v_mul_f32 v79, v79, v23
    v_mul_f32 v84, v84, v23
    v_mul_f32 v85, v85, v23
    v_mul_f32 v86, v86, v23
    v_mul_f32 v87, v87, v23
    v_max3_f32 v22, v176, v177, v178
    v_max3_f32 v23, v179, v184, v185
    v_max3_f32 v22, v22, v186, v187
    v_max_f32 v22, v22, v23
    v_mov_b32 v23, v22
    s_nop 1
    v_permlane32_swap_b32 v22, v23
    v_max_f32 v22, v22, v23
    v_mov_b32 v23, v22
    s_nop 1
    v_permlane16_swap_b32 v22, v23
    v_max_f32 v22, v22, v23
    v_max_f32 v22, v221, v22
    v_sub_f32 v23, v221, v22
    v_exp_f32 v23, v23
    v_mov_b32 v221, v22
    v_sub_f32 v176, v176, v22
    v_sub_f32 v177, v177, v22
    v_sub_f32 v178, v178, v22
    v_sub_f32 v179, v179, v22
    v_sub_f32 v184, v184, v22
    v_sub_f32 v185, v185, v22
    v_sub_f32 v186, v186, v22
    v_sub_f32 v187, v187, v22
    v_mul_f32 v18, v2, v23
    v_mov_b32 v19, 0
    v_mul_f32 v32, v32, v23
    v_mul_f32 v33, v33, v23
    v_mul_f32 v34, v34, v23
    v_mul_f32 v35, v35, v23
    v_mul_f32 v40, v40, v23
    v_mul_f32 v41, v41, v23
    v_mul_f32 v42, v42, v23
    v_mul_f32 v43, v43, v23
    v_mul_f32 v48, v48, v23
    v_mul_f32 v49, v49, v23
    v_mul_f32 v50, v50, v23
    v_mul_f32 v51, v51, v23
    v_mul_f32 v56, v56, v23
    v_mul_f32 v57, v57, v23
    v_mul_f32 v58, v58, v23
    v_mul_f32 v59, v59, v23
    v_mul_f32 v64, v64, v23
    v_mul_f32 v65, v65, v23
    v_mul_f32 v66, v66, v23
    v_mul_f32 v67, v67, v23
    v_mul_f32 v72, v72, v23
    v_mul_f32 v73, v73, v23
    v_mul_f32 v74, v74, v23
    v_mul_f32 v75, v75, v23
    v_mul_f32 v80, v80, v23
    v_mul_f32 v81, v81, v23
    v_mul_f32 v82, v82, v23
    v_mul_f32 v83, v83, v23
    v_mul_f32 v88, v88, v23
    v_mul_f32 v89, v89, v23
    v_mul_f32 v90, v90, v23
    v_mul_f32 v91, v91, v23
    v_exp_f32 v22, v172
    v_exp_f32 v23, v173
    v_exp_f32 v24, v174
    v_exp_f32 v25, v175
    v_cvt_pk_bf16_f32 v204, v22, v23
    v_add_f32 v16, v16, v22
    v_add_f32 v17, v17, v23
    v_exp_f32 v26, v176
    v_exp_f32 v27, v177
    v_cvt_pk_bf16_f32 v205, v24, v25
    v_add_f32 v16, v16, v24
    v_add_f32 v17, v17, v25
    v_exp_f32 v22, v178
    v_exp_f32 v23, v179
    v_cvt_pk_bf16_f32 v208, v26, v27
    v_add_f32 v18, v18, v26
    v_add_f32 v19, v19, v27
    v_cvt_pk_bf16_f32 v209, v22, v23
    v_add_f32 v18, v18, v22
    v_add_f32 v19, v19, v23
    v_exp_f32 v24, v180
    v_exp_f32 v25, v181
    v_exp_f32 v26, v182
    v_exp_f32 v27, v183
    v_cvt_pk_bf16_f32 v206, v24, v25
    v_add_f32 v16, v16, v24
    v_add_f32 v17, v17, v25
    v_exp_f32 v22, v184
    v_exp_f32 v23, v185
    v_cvt_pk_bf16_f32 v207, v26, v27
    v_add_f32 v16, v16, v26
    v_add_f32 v17, v17, v27
    v_exp_f32 v24, v186
    v_exp_f32 v25, v187
    v_cvt_pk_bf16_f32 v210, v22, v23
    v_add_f32 v18, v18, v22
    v_add_f32 v19, v19, v23
    v_cvt_pk_bf16_f32 v211, v24, v25
    v_add_f32 v18, v18, v24
    v_add_f32 v19, v19, v25
    v_add_f32 v0, v16, v17
    v_add_f32 v2, v18, v19
    s_nop 3
    s_setpc_b64 s[54:55]
attn_kernel_done:
    s_endpgm
.globl oproj_kernel
.p2align 8
.type oproj_kernel,@function
oproj_kernel:
    s_cmp_ge_u32 s2, 256
    s_cbranch_scc1 oproj_kernel_done
    s_load_dwordx4 s[4:7], s[0:1], 40
    s_load_dwordx2 s[8:9], s[0:1], 56
    v_lshrrev_b32 v1, 6, v0
    v_and_b32 v0, 63, v0
    s_nop 0
    v_readfirstlane_b32 s60, v1
    s_and_b32 s61, s2, 7
    s_xor_b32 s61, s61, 0
    s_lshr_b32 s62, s2, 3
    s_and_b32 s63, s62, 3
    s_lshr_b32 s62, s62, 2
    s_lshl_b32 s61, s61, 3
    s_add_u32 s61, s61, s62
    s_lshl_b32 s64, s60, 15
    s_mov_b32 s32, s64
    s_add_u32 s33, s32, 131072
    s_add_u32 s34, s32, 262144
    s_add_u32 s35, s32, 393216
    s_add_u32 s36, s32, 524288
    s_lshl_b32 s65, s60, 1
    s_add_u32 s65, s65, 0
    s_and_b32 s65, s65, 7
    s_lshl_b32 s65, s65, 17
    s_add_u32 s40, s65, s64
    s_lshl_b32 s65, s60, 1
    s_add_u32 s65, s65, 1
    s_and_b32 s65, s65, 7
    s_lshl_b32 s65, s65, 17
    s_add_u32 s41, s65, s64
    s_lshl_b32 s65, s60, 1
    s_add_u32 s65, s65, 2
    s_and_b32 s65, s65, 7
    s_lshl_b32 s65, s65, 17
    s_add_u32 s42, s65, s64
    s_lshl_b32 s65, s60, 1
    s_add_u32 s65, s65, 3
    s_and_b32 s65, s65, 7
    s_lshl_b32 s65, s65, 17
    s_add_u32 s43, s65, s64
    s_lshl_b32 s65, s60, 1
    s_add_u32 s65, s65, 4
    s_and_b32 s65, s65, 7
    s_lshl_b32 s65, s65, 17
    s_add_u32 s44, s65, s64
    s_lshl_b32 s65, s60, 1
    s_add_u32 s65, s65, 5
    s_and_b32 s65, s65, 7
    s_lshl_b32 s65, s65, 17
    s_add_u32 s45, s65, s64
    s_lshl_b32 s65, s60, 1
    s_add_u32 s65, s65, 6
    s_and_b32 s65, s65, 7
    s_lshl_b32 s65, s65, 17
    s_add_u32 s46, s65, s64
    s_lshl_b32 s65, s60, 1
    s_add_u32 s65, s65, 7
    s_and_b32 s65, s65, 7
    s_lshl_b32 s65, s65, 17
    s_add_u32 s47, s65, s64
    s_add_u32 s48, s64, 1048576
    s_mov_b32 s50, 0
    s_mov_b32 s51, 18432
    s_mov_b32 s52, 36864
    s_mov_b32 s53, 55296
    s_mov_b32 s54, 73728
    v_lshlrev_b32 v1, 4, v0
    v_and_b32 v8, 15, v0
    v_lshrrev_b32 v9, 4, v0
    v_mul_u32_u24 v2, 1152, v8
    v_lshl_add_u32 v10, v9, 3, v2
    v_lshl_add_u32 v2, v9, 4, v2
    s_lshl_b32 s65, s60, 6
    v_add_u32 v2, s65, v2
    s_mul_i32 s65, s60, 30720
    v_add_u32 v3, s65, v1
    s_add_u32 s65, s60, 1
    s_and_b32 s65, s65, 3
    s_mul_i32 s65, s65, 30720
    s_add_u32 s65, s65, 20480
    v_add_u32 v4, s65, v1
    s_add_u32 s65, s60, 2
    s_and_b32 s65, s65, 3
    s_mul_i32 s65, s65, 30720
    s_add_u32 s65, s65, 10240
    v_add_u32 v5, s65, v1
    s_add_u32 s65, s60, 3
    s_and_b32 s65, s65, 3
    s_mul_i32 s65, s65, 30720
    s_add_u32 s65, s65, 0
    v_add_u32 v6, s65, v1
    s_mul_i32 s65, s60, 5120
    s_add_u32 s65, s65, 122880
    v_add_u32 v7, s65, v1
    v_mov_b32 v232, v10
    s_lshl_b32 s65, s60, 10
    s_add_u32 s65, s65, 122880
    v_add_u32 v233, s65, v1
    s_mul_i32 s66, s60, 18432
    s_waitcnt lgkmcnt(0)
    s_and_b32 s65, s61, 255
    s_mul_i32 s65, s65, 655360
    s_add_u32 s20, s8, s65
    s_addc_u32 s21, s9, 0
    s_mov_b32 s22, 655360
    s_mov_b32 s23, 0x20000
    s_mul_i32 s65, s63, 1179648
    s_add_u32 s65, s65, 50331648
    s_add_u32 s24, s8, s65
    s_addc_u32 s25, s9, 0
    s_mov_b32 s26, 1179648
    s_mov_b32 s27, 0x20000
    s_mul_i32 s65, s61, 92160
    s_mul_i32 s67, s63, 288
    s_add_u32 s65, s65, s67
    s_add_u32 s28, s4, s65
    s_addc_u32 s29, s5, 0
    s_mov_b32 s30, 91296
    s_mov_b32 s31, 0x20000
    buffer_load_dwordx4 v[8:11], v1, s[20:23], s32 offen offset:0
    buffer_load_dwordx4 v[12:15], v1, s[20:23], s33 offen offset:0
    buffer_load_dwordx4 v[16:19], v1, s[20:23], s34 offen offset:0
    buffer_load_dwordx4 v[20:23], v1, s[20:23], s35 offen offset:0
    buffer_load_dwordx4 v[24:27], v1, s[20:23], s36 offen offset:0
    buffer_load_dwordx4 v[28:31], v1, s[24:27], s40 offen offset:0
    buffer_load_dwordx4 v[32:35], v1, s[24:27], s41 offen offset:0
    buffer_load_dwordx4 v[36:39], v1, s[24:27], s42 offen offset:0
    buffer_load_dwordx4 v[40:43], v1, s[24:27], s43 offen offset:0
    buffer_load_dwordx4 v[44:47], v1, s[24:27], s44 offen offset:0
    buffer_load_dwordx4 v[48:51], v1, s[24:27], s45 offen offset:0
    buffer_load_dwordx4 v[52:55], v1, s[24:27], s46 offen offset:0
    buffer_load_dwordx4 v[56:59], v1, s[24:27], s47 offen offset:0
    buffer_load_dwordx4 v[60:63], v1, s[24:27], s48 offen offset:0
    buffer_load_dwordx4 v[64:67], v1, s[20:23], s32 offen offset:1024
    buffer_load_dwordx4 v[68:71], v1, s[20:23], s33 offen offset:1024
    buffer_load_dwordx4 v[72:75], v1, s[20:23], s34 offen offset:1024
    buffer_load_dwordx4 v[76:79], v1, s[20:23], s35 offen offset:1024
    buffer_load_dwordx4 v[80:83], v1, s[20:23], s36 offen offset:1024
    buffer_load_dwordx4 v[84:87], v1, s[24:27], s40 offen offset:1024
    buffer_load_dwordx4 v[88:91], v1, s[24:27], s41 offen offset:1024
    buffer_load_dwordx4 v[92:95], v1, s[24:27], s42 offen offset:1024
    buffer_load_dwordx4 v[96:99], v1, s[24:27], s43 offen offset:1024
    buffer_load_dwordx4 v[100:103], v1, s[24:27], s44 offen offset:1024
    buffer_load_dwordx4 v[104:107], v1, s[24:27], s45 offen offset:1024
    buffer_load_dwordx4 v[108:111], v1, s[24:27], s46 offen offset:1024
    buffer_load_dwordx4 v[112:115], v1, s[24:27], s47 offen offset:1024
    buffer_load_dwordx4 v[116:119], v1, s[24:27], s48 offen offset:1024
    buffer_load_dwordx4 v[120:123], v1, s[20:23], s32 offen offset:2048
    buffer_load_dwordx4 v[124:127], v1, s[20:23], s33 offen offset:2048
    buffer_load_dwordx4 v[128:131], v1, s[20:23], s34 offen offset:2048
    buffer_load_dwordx4 v[132:135], v1, s[20:23], s35 offen offset:2048
    buffer_load_dwordx4 v[136:139], v1, s[20:23], s36 offen offset:2048
    buffer_load_dwordx4 v[140:143], v1, s[24:27], s40 offen offset:2048
    buffer_load_dwordx4 v[144:147], v1, s[24:27], s41 offen offset:2048
    buffer_load_dwordx4 v[148:151], v1, s[24:27], s42 offen offset:2048
    buffer_load_dwordx4 v[152:155], v1, s[24:27], s43 offen offset:2048
    buffer_load_dwordx4 v[156:159], v1, s[24:27], s44 offen offset:2048
    buffer_load_dwordx4 v[160:163], v1, s[24:27], s45 offen offset:2048
    buffer_load_dwordx4 v[164:167], v1, s[24:27], s46 offen offset:2048
    buffer_load_dwordx4 v[168:171], v1, s[24:27], s47 offen offset:2048
    buffer_load_dwordx4 v[172:175], v1, s[24:27], s48 offen offset:2048
    buffer_load_dwordx4 v[176:179], v1, s[20:23], s32 offen offset:3072
    buffer_load_dwordx4 v[180:183], v1, s[20:23], s33 offen offset:3072
    buffer_load_dwordx4 v[184:187], v1, s[20:23], s34 offen offset:3072
    buffer_load_dwordx4 v[188:191], v1, s[20:23], s35 offen offset:3072
    buffer_load_dwordx4 v[192:195], v1, s[20:23], s36 offen offset:3072
    buffer_load_dwordx4 v[196:199], v1, s[24:27], s40 offen offset:3072
    buffer_load_dwordx4 v[200:203], v1, s[24:27], s41 offen offset:3072
    buffer_load_dwordx4 v[204:207], v1, s[24:27], s42 offen offset:3072
    buffer_load_dwordx4 v[208:211], v1, s[24:27], s43 offen offset:3072
    buffer_load_dwordx4 v[212:215], v1, s[24:27], s44 offen offset:3072
    buffer_load_dwordx4 v[216:219], v1, s[24:27], s45 offen offset:3072
    buffer_load_dwordx4 v[220:223], v1, s[24:27], s46 offen offset:3072
    buffer_load_dwordx4 v[224:227], v1, s[24:27], s47 offen offset:3072
    buffer_load_dwordx4 v[228:231], v1, s[24:27], s48 offen offset:3072
    v_add_u32 v234, 4096, v1
    s_waitcnt vmcnt(50)
    v_mfma_f32_16x16x32_bf16 a[0:3], v[28:31], v[8:11], 0
    v_mfma_f32_16x16x32_bf16 a[4:7], v[28:31], v[12:15], 0
    v_mfma_f32_16x16x32_bf16 a[8:11], v[28:31], v[16:19], 0
    v_mfma_f32_16x16x32_bf16 a[12:15], v[28:31], v[20:23], 0
    v_mfma_f32_16x16x32_bf16 a[16:19], v[28:31], v[24:27], 0
    buffer_load_dwordx4 v[28:31], v234, s[24:27], s40 offen offset:0
    s_waitcnt vmcnt(50)
    v_mfma_f32_16x16x32_bf16 a[20:23], v[32:35], v[8:11], 0
    v_mfma_f32_16x16x32_bf16 a[24:27], v[32:35], v[12:15], 0
    v_mfma_f32_16x16x32_bf16 a[28:31], v[32:35], v[16:19], 0
    v_mfma_f32_16x16x32_bf16 a[32:35], v[32:35], v[20:23], 0
    v_mfma_f32_16x16x32_bf16 a[36:39], v[32:35], v[24:27], 0
    buffer_load_dwordx4 v[32:35], v234, s[24:27], s41 offen offset:0
    s_waitcnt vmcnt(50)
    v_mfma_f32_16x16x32_bf16 a[40:43], v[36:39], v[8:11], 0
    v_mfma_f32_16x16x32_bf16 a[44:47], v[36:39], v[12:15], 0
    v_mfma_f32_16x16x32_bf16 a[48:51], v[36:39], v[16:19], 0
    v_mfma_f32_16x16x32_bf16 a[52:55], v[36:39], v[20:23], 0
    v_mfma_f32_16x16x32_bf16 a[56:59], v[36:39], v[24:27], 0
    buffer_load_dwordx4 v[36:39], v234, s[24:27], s42 offen offset:0
    s_waitcnt vmcnt(50)
    v_mfma_f32_16x16x32_bf16 a[60:63], v[40:43], v[8:11], 0
    v_mfma_f32_16x16x32_bf16 a[64:67], v[40:43], v[12:15], 0
    v_mfma_f32_16x16x32_bf16 a[68:71], v[40:43], v[16:19], 0
    v_mfma_f32_16x16x32_bf16 a[72:75], v[40:43], v[20:23], 0
    v_mfma_f32_16x16x32_bf16 a[76:79], v[40:43], v[24:27], 0
    buffer_load_dwordx4 v[40:43], v234, s[24:27], s43 offen offset:0
    s_waitcnt vmcnt(50)
    v_mfma_f32_16x16x32_bf16 a[80:83], v[44:47], v[8:11], 0
    v_mfma_f32_16x16x32_bf16 a[84:87], v[44:47], v[12:15], 0
    v_mfma_f32_16x16x32_bf16 a[88:91], v[44:47], v[16:19], 0
    v_mfma_f32_16x16x32_bf16 a[92:95], v[44:47], v[20:23], 0
    v_mfma_f32_16x16x32_bf16 a[96:99], v[44:47], v[24:27], 0
    buffer_load_dwordx4 v[44:47], v234, s[24:27], s44 offen offset:0
    s_waitcnt vmcnt(50)
    v_mfma_f32_16x16x32_bf16 a[100:103], v[48:51], v[8:11], 0
    v_mfma_f32_16x16x32_bf16 a[104:107], v[48:51], v[12:15], 0
    v_mfma_f32_16x16x32_bf16 a[108:111], v[48:51], v[16:19], 0
    v_mfma_f32_16x16x32_bf16 a[112:115], v[48:51], v[20:23], 0
    v_mfma_f32_16x16x32_bf16 a[116:119], v[48:51], v[24:27], 0
    buffer_load_dwordx4 v[48:51], v234, s[24:27], s45 offen offset:0
    s_waitcnt vmcnt(50)
    v_mfma_f32_16x16x32_bf16 a[120:123], v[52:55], v[8:11], 0
    v_mfma_f32_16x16x32_bf16 a[124:127], v[52:55], v[12:15], 0
    v_mfma_f32_16x16x32_bf16 a[128:131], v[52:55], v[16:19], 0
    v_mfma_f32_16x16x32_bf16 a[132:135], v[52:55], v[20:23], 0
    v_mfma_f32_16x16x32_bf16 a[136:139], v[52:55], v[24:27], 0
    buffer_load_dwordx4 v[52:55], v234, s[24:27], s46 offen offset:0
    s_waitcnt vmcnt(50)
    v_mfma_f32_16x16x32_bf16 a[140:143], v[56:59], v[8:11], 0
    v_mfma_f32_16x16x32_bf16 a[144:147], v[56:59], v[12:15], 0
    v_mfma_f32_16x16x32_bf16 a[148:151], v[56:59], v[16:19], 0
    v_mfma_f32_16x16x32_bf16 a[152:155], v[56:59], v[20:23], 0
    v_mfma_f32_16x16x32_bf16 a[156:159], v[56:59], v[24:27], 0
    buffer_load_dwordx4 v[56:59], v234, s[24:27], s47 offen offset:0
    s_waitcnt vmcnt(50)
    v_mfma_f32_16x16x32_bf16 a[160:163], v[60:63], v[8:11], 0
    buffer_load_dwordx4 v[8:11], v234, s[20:23], s32 offen offset:0
    v_mfma_f32_16x16x32_bf16 a[164:167], v[60:63], v[12:15], 0
    buffer_load_dwordx4 v[12:15], v234, s[20:23], s33 offen offset:0
    v_mfma_f32_16x16x32_bf16 a[168:171], v[60:63], v[16:19], 0
    buffer_load_dwordx4 v[16:19], v234, s[20:23], s34 offen offset:0
    v_mfma_f32_16x16x32_bf16 a[172:175], v[60:63], v[20:23], 0
    buffer_load_dwordx4 v[20:23], v234, s[20:23], s35 offen offset:0
    v_mfma_f32_16x16x32_bf16 a[176:179], v[60:63], v[24:27], 0
    buffer_load_dwordx4 v[24:27], v234, s[20:23], s36 offen offset:0
    buffer_load_dwordx4 v[60:63], v234, s[24:27], s48 offen offset:0
    s_waitcnt vmcnt(50)
    v_mfma_f32_16x16x32_bf16 a[0:3], v[84:87], v[64:67], a[0:3]
    v_mfma_f32_16x16x32_bf16 a[4:7], v[84:87], v[68:71], a[4:7]
    v_mfma_f32_16x16x32_bf16 a[8:11], v[84:87], v[72:75], a[8:11]
    v_mfma_f32_16x16x32_bf16 a[12:15], v[84:87], v[76:79], a[12:15]
    v_mfma_f32_16x16x32_bf16 a[16:19], v[84:87], v[80:83], a[16:19]
    buffer_load_dwordx4 v[84:87], v234, s[24:27], s40 offen offset:1024
    s_waitcnt vmcnt(50)
    v_mfma_f32_16x16x32_bf16 a[20:23], v[88:91], v[64:67], a[20:23]
    v_mfma_f32_16x16x32_bf16 a[24:27], v[88:91], v[68:71], a[24:27]
    v_mfma_f32_16x16x32_bf16 a[28:31], v[88:91], v[72:75], a[28:31]
    v_mfma_f32_16x16x32_bf16 a[32:35], v[88:91], v[76:79], a[32:35]
    v_mfma_f32_16x16x32_bf16 a[36:39], v[88:91], v[80:83], a[36:39]
    buffer_load_dwordx4 v[88:91], v234, s[24:27], s41 offen offset:1024
    s_waitcnt vmcnt(50)
    v_mfma_f32_16x16x32_bf16 a[40:43], v[92:95], v[64:67], a[40:43]
    v_mfma_f32_16x16x32_bf16 a[44:47], v[92:95], v[68:71], a[44:47]
    v_mfma_f32_16x16x32_bf16 a[48:51], v[92:95], v[72:75], a[48:51]
    v_mfma_f32_16x16x32_bf16 a[52:55], v[92:95], v[76:79], a[52:55]
    v_mfma_f32_16x16x32_bf16 a[56:59], v[92:95], v[80:83], a[56:59]
    buffer_load_dwordx4 v[92:95], v234, s[24:27], s42 offen offset:1024
    s_waitcnt vmcnt(50)
    v_mfma_f32_16x16x32_bf16 a[60:63], v[96:99], v[64:67], a[60:63]
    v_mfma_f32_16x16x32_bf16 a[64:67], v[96:99], v[68:71], a[64:67]
    v_mfma_f32_16x16x32_bf16 a[68:71], v[96:99], v[72:75], a[68:71]
    v_mfma_f32_16x16x32_bf16 a[72:75], v[96:99], v[76:79], a[72:75]
    v_mfma_f32_16x16x32_bf16 a[76:79], v[96:99], v[80:83], a[76:79]
    buffer_load_dwordx4 v[96:99], v234, s[24:27], s43 offen offset:1024
    s_waitcnt vmcnt(50)
    v_mfma_f32_16x16x32_bf16 a[80:83], v[100:103], v[64:67], a[80:83]
    v_mfma_f32_16x16x32_bf16 a[84:87], v[100:103], v[68:71], a[84:87]
    v_mfma_f32_16x16x32_bf16 a[88:91], v[100:103], v[72:75], a[88:91]
    v_mfma_f32_16x16x32_bf16 a[92:95], v[100:103], v[76:79], a[92:95]
    v_mfma_f32_16x16x32_bf16 a[96:99], v[100:103], v[80:83], a[96:99]
    buffer_load_dwordx4 v[100:103], v234, s[24:27], s44 offen offset:1024
    s_waitcnt vmcnt(50)
    v_mfma_f32_16x16x32_bf16 a[100:103], v[104:107], v[64:67], a[100:103]
    v_mfma_f32_16x16x32_bf16 a[104:107], v[104:107], v[68:71], a[104:107]
    v_mfma_f32_16x16x32_bf16 a[108:111], v[104:107], v[72:75], a[108:111]
    v_mfma_f32_16x16x32_bf16 a[112:115], v[104:107], v[76:79], a[112:115]
    v_mfma_f32_16x16x32_bf16 a[116:119], v[104:107], v[80:83], a[116:119]
    buffer_load_dwordx4 v[104:107], v234, s[24:27], s45 offen offset:1024
    s_waitcnt vmcnt(50)
    v_mfma_f32_16x16x32_bf16 a[120:123], v[108:111], v[64:67], a[120:123]
    v_mfma_f32_16x16x32_bf16 a[124:127], v[108:111], v[68:71], a[124:127]
    v_mfma_f32_16x16x32_bf16 a[128:131], v[108:111], v[72:75], a[128:131]
    v_mfma_f32_16x16x32_bf16 a[132:135], v[108:111], v[76:79], a[132:135]
    v_mfma_f32_16x16x32_bf16 a[136:139], v[108:111], v[80:83], a[136:139]
    buffer_load_dwordx4 v[108:111], v234, s[24:27], s46 offen offset:1024
    s_waitcnt vmcnt(50)
    v_mfma_f32_16x16x32_bf16 a[140:143], v[112:115], v[64:67], a[140:143]
    v_mfma_f32_16x16x32_bf16 a[144:147], v[112:115], v[68:71], a[144:147]
    v_mfma_f32_16x16x32_bf16 a[148:151], v[112:115], v[72:75], a[148:151]
    v_mfma_f32_16x16x32_bf16 a[152:155], v[112:115], v[76:79], a[152:155]
    v_mfma_f32_16x16x32_bf16 a[156:159], v[112:115], v[80:83], a[156:159]
    buffer_load_dwordx4 v[112:115], v234, s[24:27], s47 offen offset:1024
    s_waitcnt vmcnt(50)
    v_mfma_f32_16x16x32_bf16 a[160:163], v[116:119], v[64:67], a[160:163]
    buffer_load_dwordx4 v[64:67], v234, s[20:23], s32 offen offset:1024
    v_mfma_f32_16x16x32_bf16 a[164:167], v[116:119], v[68:71], a[164:167]
    buffer_load_dwordx4 v[68:71], v234, s[20:23], s33 offen offset:1024
    v_mfma_f32_16x16x32_bf16 a[168:171], v[116:119], v[72:75], a[168:171]
    buffer_load_dwordx4 v[72:75], v234, s[20:23], s34 offen offset:1024
    v_mfma_f32_16x16x32_bf16 a[172:175], v[116:119], v[76:79], a[172:175]
    buffer_load_dwordx4 v[76:79], v234, s[20:23], s35 offen offset:1024
    v_mfma_f32_16x16x32_bf16 a[176:179], v[116:119], v[80:83], a[176:179]
    buffer_load_dwordx4 v[80:83], v234, s[20:23], s36 offen offset:1024
    buffer_load_dwordx4 v[116:119], v234, s[24:27], s48 offen offset:1024
    s_waitcnt vmcnt(50)
    v_mfma_f32_16x16x32_bf16 a[0:3], v[140:143], v[120:123], a[0:3]
    v_mfma_f32_16x16x32_bf16 a[4:7], v[140:143], v[124:127], a[4:7]
    v_mfma_f32_16x16x32_bf16 a[8:11], v[140:143], v[128:131], a[8:11]
    v_mfma_f32_16x16x32_bf16 a[12:15], v[140:143], v[132:135], a[12:15]
    v_mfma_f32_16x16x32_bf16 a[16:19], v[140:143], v[136:139], a[16:19]
    buffer_load_dwordx4 v[140:143], v234, s[24:27], s40 offen offset:2048
    s_waitcnt vmcnt(50)
    v_mfma_f32_16x16x32_bf16 a[20:23], v[144:147], v[120:123], a[20:23]
    v_mfma_f32_16x16x32_bf16 a[24:27], v[144:147], v[124:127], a[24:27]
    v_mfma_f32_16x16x32_bf16 a[28:31], v[144:147], v[128:131], a[28:31]
    v_mfma_f32_16x16x32_bf16 a[32:35], v[144:147], v[132:135], a[32:35]
    v_mfma_f32_16x16x32_bf16 a[36:39], v[144:147], v[136:139], a[36:39]
    buffer_load_dwordx4 v[144:147], v234, s[24:27], s41 offen offset:2048
    s_waitcnt vmcnt(50)
    v_mfma_f32_16x16x32_bf16 a[40:43], v[148:151], v[120:123], a[40:43]
    v_mfma_f32_16x16x32_bf16 a[44:47], v[148:151], v[124:127], a[44:47]
    v_mfma_f32_16x16x32_bf16 a[48:51], v[148:151], v[128:131], a[48:51]
    v_mfma_f32_16x16x32_bf16 a[52:55], v[148:151], v[132:135], a[52:55]
    v_mfma_f32_16x16x32_bf16 a[56:59], v[148:151], v[136:139], a[56:59]
    buffer_load_dwordx4 v[148:151], v234, s[24:27], s42 offen offset:2048
    s_waitcnt vmcnt(50)
    v_mfma_f32_16x16x32_bf16 a[60:63], v[152:155], v[120:123], a[60:63]
    v_mfma_f32_16x16x32_bf16 a[64:67], v[152:155], v[124:127], a[64:67]
    v_mfma_f32_16x16x32_bf16 a[68:71], v[152:155], v[128:131], a[68:71]
    v_mfma_f32_16x16x32_bf16 a[72:75], v[152:155], v[132:135], a[72:75]
    v_mfma_f32_16x16x32_bf16 a[76:79], v[152:155], v[136:139], a[76:79]
    buffer_load_dwordx4 v[152:155], v234, s[24:27], s43 offen offset:2048
    s_waitcnt vmcnt(50)
    v_mfma_f32_16x16x32_bf16 a[80:83], v[156:159], v[120:123], a[80:83]
    v_mfma_f32_16x16x32_bf16 a[84:87], v[156:159], v[124:127], a[84:87]
    v_mfma_f32_16x16x32_bf16 a[88:91], v[156:159], v[128:131], a[88:91]
    v_mfma_f32_16x16x32_bf16 a[92:95], v[156:159], v[132:135], a[92:95]
    v_mfma_f32_16x16x32_bf16 a[96:99], v[156:159], v[136:139], a[96:99]
    buffer_load_dwordx4 v[156:159], v234, s[24:27], s44 offen offset:2048
    s_waitcnt vmcnt(50)
    v_mfma_f32_16x16x32_bf16 a[100:103], v[160:163], v[120:123], a[100:103]
    v_mfma_f32_16x16x32_bf16 a[104:107], v[160:163], v[124:127], a[104:107]
    v_mfma_f32_16x16x32_bf16 a[108:111], v[160:163], v[128:131], a[108:111]
    v_mfma_f32_16x16x32_bf16 a[112:115], v[160:163], v[132:135], a[112:115]
    v_mfma_f32_16x16x32_bf16 a[116:119], v[160:163], v[136:139], a[116:119]
    buffer_load_dwordx4 v[160:163], v234, s[24:27], s45 offen offset:2048
    s_waitcnt vmcnt(50)
    v_mfma_f32_16x16x32_bf16 a[120:123], v[164:167], v[120:123], a[120:123]
    v_mfma_f32_16x16x32_bf16 a[124:127], v[164:167], v[124:127], a[124:127]
    v_mfma_f32_16x16x32_bf16 a[128:131], v[164:167], v[128:131], a[128:131]
    v_mfma_f32_16x16x32_bf16 a[132:135], v[164:167], v[132:135], a[132:135]
    v_mfma_f32_16x16x32_bf16 a[136:139], v[164:167], v[136:139], a[136:139]
    buffer_load_dwordx4 v[164:167], v234, s[24:27], s46 offen offset:2048
    s_waitcnt vmcnt(50)
    v_mfma_f32_16x16x32_bf16 a[140:143], v[168:171], v[120:123], a[140:143]
    v_mfma_f32_16x16x32_bf16 a[144:147], v[168:171], v[124:127], a[144:147]
    v_mfma_f32_16x16x32_bf16 a[148:151], v[168:171], v[128:131], a[148:151]
    v_mfma_f32_16x16x32_bf16 a[152:155], v[168:171], v[132:135], a[152:155]
    v_mfma_f32_16x16x32_bf16 a[156:159], v[168:171], v[136:139], a[156:159]
    buffer_load_dwordx4 v[168:171], v234, s[24:27], s47 offen offset:2048
    s_waitcnt vmcnt(50)
    v_mfma_f32_16x16x32_bf16 a[160:163], v[172:175], v[120:123], a[160:163]
    buffer_load_dwordx4 v[120:123], v234, s[20:23], s32 offen offset:2048
    v_mfma_f32_16x16x32_bf16 a[164:167], v[172:175], v[124:127], a[164:167]
    buffer_load_dwordx4 v[124:127], v234, s[20:23], s33 offen offset:2048
    v_mfma_f32_16x16x32_bf16 a[168:171], v[172:175], v[128:131], a[168:171]
    buffer_load_dwordx4 v[128:131], v234, s[20:23], s34 offen offset:2048
    v_mfma_f32_16x16x32_bf16 a[172:175], v[172:175], v[132:135], a[172:175]
    buffer_load_dwordx4 v[132:135], v234, s[20:23], s35 offen offset:2048
    v_mfma_f32_16x16x32_bf16 a[176:179], v[172:175], v[136:139], a[176:179]
    buffer_load_dwordx4 v[136:139], v234, s[20:23], s36 offen offset:2048
    buffer_load_dwordx4 v[172:175], v234, s[24:27], s48 offen offset:2048
    s_waitcnt vmcnt(50)
    v_mfma_f32_16x16x32_bf16 a[0:3], v[196:199], v[176:179], a[0:3]
    v_mfma_f32_16x16x32_bf16 a[4:7], v[196:199], v[180:183], a[4:7]
    v_mfma_f32_16x16x32_bf16 a[8:11], v[196:199], v[184:187], a[8:11]
    v_mfma_f32_16x16x32_bf16 a[12:15], v[196:199], v[188:191], a[12:15]
    v_mfma_f32_16x16x32_bf16 a[16:19], v[196:199], v[192:195], a[16:19]
    buffer_load_dwordx4 v[196:199], v234, s[24:27], s40 offen offset:3072
    s_waitcnt vmcnt(50)
    v_mfma_f32_16x16x32_bf16 a[20:23], v[200:203], v[176:179], a[20:23]
    v_mfma_f32_16x16x32_bf16 a[24:27], v[200:203], v[180:183], a[24:27]
    v_mfma_f32_16x16x32_bf16 a[28:31], v[200:203], v[184:187], a[28:31]
    v_mfma_f32_16x16x32_bf16 a[32:35], v[200:203], v[188:191], a[32:35]
    v_mfma_f32_16x16x32_bf16 a[36:39], v[200:203], v[192:195], a[36:39]
    buffer_load_dwordx4 v[200:203], v234, s[24:27], s41 offen offset:3072
    s_waitcnt vmcnt(50)
    v_mfma_f32_16x16x32_bf16 a[40:43], v[204:207], v[176:179], a[40:43]
    v_mfma_f32_16x16x32_bf16 a[44:47], v[204:207], v[180:183], a[44:47]
    v_mfma_f32_16x16x32_bf16 a[48:51], v[204:207], v[184:187], a[48:51]
    v_mfma_f32_16x16x32_bf16 a[52:55], v[204:207], v[188:191], a[52:55]
    v_mfma_f32_16x16x32_bf16 a[56:59], v[204:207], v[192:195], a[56:59]
    buffer_load_dwordx4 v[204:207], v234, s[24:27], s42 offen offset:3072
    s_waitcnt vmcnt(50)
    v_mfma_f32_16x16x32_bf16 a[60:63], v[208:211], v[176:179], a[60:63]
    v_mfma_f32_16x16x32_bf16 a[64:67], v[208:211], v[180:183], a[64:67]
    v_mfma_f32_16x16x32_bf16 a[68:71], v[208:211], v[184:187], a[68:71]
    v_mfma_f32_16x16x32_bf16 a[72:75], v[208:211], v[188:191], a[72:75]
    v_mfma_f32_16x16x32_bf16 a[76:79], v[208:211], v[192:195], a[76:79]
    buffer_load_dwordx4 v[208:211], v234, s[24:27], s43 offen offset:3072
    s_waitcnt vmcnt(50)
    v_mfma_f32_16x16x32_bf16 a[80:83], v[212:215], v[176:179], a[80:83]
    v_mfma_f32_16x16x32_bf16 a[84:87], v[212:215], v[180:183], a[84:87]
    v_mfma_f32_16x16x32_bf16 a[88:91], v[212:215], v[184:187], a[88:91]
    v_mfma_f32_16x16x32_bf16 a[92:95], v[212:215], v[188:191], a[92:95]
    v_mfma_f32_16x16x32_bf16 a[96:99], v[212:215], v[192:195], a[96:99]
    buffer_load_dwordx4 v[212:215], v234, s[24:27], s44 offen offset:3072
    s_waitcnt vmcnt(50)
    v_mfma_f32_16x16x32_bf16 a[100:103], v[216:219], v[176:179], a[100:103]
    v_mfma_f32_16x16x32_bf16 a[104:107], v[216:219], v[180:183], a[104:107]
    v_mfma_f32_16x16x32_bf16 a[108:111], v[216:219], v[184:187], a[108:111]
    v_mfma_f32_16x16x32_bf16 a[112:115], v[216:219], v[188:191], a[112:115]
    v_mfma_f32_16x16x32_bf16 a[116:119], v[216:219], v[192:195], a[116:119]
    buffer_load_dwordx4 v[216:219], v234, s[24:27], s45 offen offset:3072
    s_waitcnt vmcnt(50)
    v_mfma_f32_16x16x32_bf16 a[120:123], v[220:223], v[176:179], a[120:123]
    v_mfma_f32_16x16x32_bf16 a[124:127], v[220:223], v[180:183], a[124:127]
    v_mfma_f32_16x16x32_bf16 a[128:131], v[220:223], v[184:187], a[128:131]
    v_mfma_f32_16x16x32_bf16 a[132:135], v[220:223], v[188:191], a[132:135]
    v_mfma_f32_16x16x32_bf16 a[136:139], v[220:223], v[192:195], a[136:139]
    buffer_load_dwordx4 v[220:223], v234, s[24:27], s46 offen offset:3072
    s_waitcnt vmcnt(50)
    v_mfma_f32_16x16x32_bf16 a[140:143], v[224:227], v[176:179], a[140:143]
    v_mfma_f32_16x16x32_bf16 a[144:147], v[224:227], v[180:183], a[144:147]
    v_mfma_f32_16x16x32_bf16 a[148:151], v[224:227], v[184:187], a[148:151]
    v_mfma_f32_16x16x32_bf16 a[152:155], v[224:227], v[188:191], a[152:155]
    v_mfma_f32_16x16x32_bf16 a[156:159], v[224:227], v[192:195], a[156:159]
    buffer_load_dwordx4 v[224:227], v234, s[24:27], s47 offen offset:3072
    s_waitcnt vmcnt(50)
    v_mfma_f32_16x16x32_bf16 a[160:163], v[228:231], v[176:179], a[160:163]
    buffer_load_dwordx4 v[176:179], v234, s[20:23], s32 offen offset:3072
    v_mfma_f32_16x16x32_bf16 a[164:167], v[228:231], v[180:183], a[164:167]
    buffer_load_dwordx4 v[180:183], v234, s[20:23], s33 offen offset:3072
    v_mfma_f32_16x16x32_bf16 a[168:171], v[228:231], v[184:187], a[168:171]
    buffer_load_dwordx4 v[184:187], v234, s[20:23], s34 offen offset:3072
    v_mfma_f32_16x16x32_bf16 a[172:175], v[228:231], v[188:191], a[172:175]
    buffer_load_dwordx4 v[188:191], v234, s[20:23], s35 offen offset:3072
    v_mfma_f32_16x16x32_bf16 a[176:179], v[228:231], v[192:195], a[176:179]
    buffer_load_dwordx4 v[192:195], v234, s[20:23], s36 offen offset:3072
    buffer_load_dwordx4 v[228:231], v234, s[24:27], s48 offen offset:3072
    v_add_u32 v1, 4096, v234
    s_waitcnt vmcnt(47)
    v_mfma_f32_16x16x32_bf16 a[0:3], v[28:31], v[8:11], a[0:3]
    s_waitcnt vmcnt(46)
    v_mfma_f32_16x16x32_bf16 a[4:7], v[28:31], v[12:15], a[4:7]
    s_waitcnt vmcnt(45)
    v_mfma_f32_16x16x32_bf16 a[8:11], v[28:31], v[16:19], a[8:11]
    s_waitcnt vmcnt(44)
    v_mfma_f32_16x16x32_bf16 a[12:15], v[28:31], v[20:23], a[12:15]
    s_waitcnt vmcnt(43)
    v_mfma_f32_16x16x32_bf16 a[16:19], v[28:31], v[24:27], a[16:19]
    buffer_load_dwordx4 v[28:31], v1, s[24:27], s40 offen offset:0
    v_mfma_f32_16x16x32_bf16 a[20:23], v[32:35], v[8:11], a[20:23]
    v_mfma_f32_16x16x32_bf16 a[24:27], v[32:35], v[12:15], a[24:27]
    v_mfma_f32_16x16x32_bf16 a[28:31], v[32:35], v[16:19], a[28:31]
    v_mfma_f32_16x16x32_bf16 a[32:35], v[32:35], v[20:23], a[32:35]
    v_mfma_f32_16x16x32_bf16 a[36:39], v[32:35], v[24:27], a[36:39]
    buffer_load_dwordx4 v[32:35], v1, s[24:27], s41 offen offset:0
    v_mfma_f32_16x16x32_bf16 a[40:43], v[36:39], v[8:11], a[40:43]
    v_mfma_f32_16x16x32_bf16 a[44:47], v[36:39], v[12:15], a[44:47]
    v_mfma_f32_16x16x32_bf16 a[48:51], v[36:39], v[16:19], a[48:51]
    v_mfma_f32_16x16x32_bf16 a[52:55], v[36:39], v[20:23], a[52:55]
    v_mfma_f32_16x16x32_bf16 a[56:59], v[36:39], v[24:27], a[56:59]
    buffer_load_dwordx4 v[36:39], v1, s[24:27], s42 offen offset:0
    v_mfma_f32_16x16x32_bf16 a[60:63], v[40:43], v[8:11], a[60:63]
    v_mfma_f32_16x16x32_bf16 a[64:67], v[40:43], v[12:15], a[64:67]
    v_mfma_f32_16x16x32_bf16 a[68:71], v[40:43], v[16:19], a[68:71]
    v_mfma_f32_16x16x32_bf16 a[72:75], v[40:43], v[20:23], a[72:75]
    v_mfma_f32_16x16x32_bf16 a[76:79], v[40:43], v[24:27], a[76:79]
    buffer_load_dwordx4 v[40:43], v1, s[24:27], s43 offen offset:0
    v_mfma_f32_16x16x32_bf16 a[80:83], v[44:47], v[8:11], a[80:83]
    v_mfma_f32_16x16x32_bf16 a[84:87], v[44:47], v[12:15], a[84:87]
    v_mfma_f32_16x16x32_bf16 a[88:91], v[44:47], v[16:19], a[88:91]
    v_mfma_f32_16x16x32_bf16 a[92:95], v[44:47], v[20:23], a[92:95]
    v_mfma_f32_16x16x32_bf16 a[96:99], v[44:47], v[24:27], a[96:99]
    buffer_load_dwordx4 v[44:47], v1, s[24:27], s44 offen offset:0
    v_mfma_f32_16x16x32_bf16 a[100:103], v[48:51], v[8:11], a[100:103]
    v_mfma_f32_16x16x32_bf16 a[104:107], v[48:51], v[12:15], a[104:107]
    v_mfma_f32_16x16x32_bf16 a[108:111], v[48:51], v[16:19], a[108:111]
    v_mfma_f32_16x16x32_bf16 a[112:115], v[48:51], v[20:23], a[112:115]
    v_mfma_f32_16x16x32_bf16 a[116:119], v[48:51], v[24:27], a[116:119]
    buffer_load_dwordx4 v[48:51], v1, s[24:27], s45 offen offset:0
    v_mfma_f32_16x16x32_bf16 a[120:123], v[52:55], v[8:11], a[120:123]
    v_mfma_f32_16x16x32_bf16 a[124:127], v[52:55], v[12:15], a[124:127]
    v_mfma_f32_16x16x32_bf16 a[128:131], v[52:55], v[16:19], a[128:131]
    v_mfma_f32_16x16x32_bf16 a[132:135], v[52:55], v[20:23], a[132:135]
    v_mfma_f32_16x16x32_bf16 a[136:139], v[52:55], v[24:27], a[136:139]
    buffer_load_dwordx4 v[52:55], v1, s[24:27], s46 offen offset:0
    v_mfma_f32_16x16x32_bf16 a[140:143], v[56:59], v[8:11], a[140:143]
    v_mfma_f32_16x16x32_bf16 a[144:147], v[56:59], v[12:15], a[144:147]
    v_mfma_f32_16x16x32_bf16 a[148:151], v[56:59], v[16:19], a[148:151]
    v_mfma_f32_16x16x32_bf16 a[152:155], v[56:59], v[20:23], a[152:155]
    v_mfma_f32_16x16x32_bf16 a[156:159], v[56:59], v[24:27], a[156:159]
    buffer_load_dwordx4 v[56:59], v1, s[24:27], s47 offen offset:0
    s_waitcnt vmcnt(50)
    v_mfma_f32_16x16x32_bf16 a[160:163], v[60:63], v[8:11], a[160:163]
    buffer_load_dwordx4 v[8:11], v1, s[20:23], s32 offen offset:0
    v_mfma_f32_16x16x32_bf16 a[164:167], v[60:63], v[12:15], a[164:167]
    buffer_load_dwordx4 v[12:15], v1, s[20:23], s33 offen offset:0
    v_mfma_f32_16x16x32_bf16 a[168:171], v[60:63], v[16:19], a[168:171]
    buffer_load_dwordx4 v[16:19], v1, s[20:23], s34 offen offset:0
    v_mfma_f32_16x16x32_bf16 a[172:175], v[60:63], v[20:23], a[172:175]
    buffer_load_dwordx4 v[20:23], v1, s[20:23], s35 offen offset:0
    v_mfma_f32_16x16x32_bf16 a[176:179], v[60:63], v[24:27], a[176:179]
    buffer_load_dwordx4 v[24:27], v1, s[20:23], s36 offen offset:0
    buffer_load_dwordx4 v[60:63], v1, s[24:27], s48 offen offset:0
    s_waitcnt vmcnt(47)
    v_mfma_f32_16x16x32_bf16 a[0:3], v[84:87], v[64:67], a[0:3]
    s_waitcnt vmcnt(46)
    v_mfma_f32_16x16x32_bf16 a[4:7], v[84:87], v[68:71], a[4:7]
    s_waitcnt vmcnt(45)
    v_mfma_f32_16x16x32_bf16 a[8:11], v[84:87], v[72:75], a[8:11]
    s_waitcnt vmcnt(44)
    v_mfma_f32_16x16x32_bf16 a[12:15], v[84:87], v[76:79], a[12:15]
    s_waitcnt vmcnt(43)
    v_mfma_f32_16x16x32_bf16 a[16:19], v[84:87], v[80:83], a[16:19]
    buffer_load_dwordx4 v[84:87], v1, s[24:27], s40 offen offset:1024
    v_mfma_f32_16x16x32_bf16 a[20:23], v[88:91], v[64:67], a[20:23]
    v_mfma_f32_16x16x32_bf16 a[24:27], v[88:91], v[68:71], a[24:27]
    v_mfma_f32_16x16x32_bf16 a[28:31], v[88:91], v[72:75], a[28:31]
    v_mfma_f32_16x16x32_bf16 a[32:35], v[88:91], v[76:79], a[32:35]
    v_mfma_f32_16x16x32_bf16 a[36:39], v[88:91], v[80:83], a[36:39]
    buffer_load_dwordx4 v[88:91], v1, s[24:27], s41 offen offset:1024
    v_mfma_f32_16x16x32_bf16 a[40:43], v[92:95], v[64:67], a[40:43]
    v_mfma_f32_16x16x32_bf16 a[44:47], v[92:95], v[68:71], a[44:47]
    v_mfma_f32_16x16x32_bf16 a[48:51], v[92:95], v[72:75], a[48:51]
    v_mfma_f32_16x16x32_bf16 a[52:55], v[92:95], v[76:79], a[52:55]
    v_mfma_f32_16x16x32_bf16 a[56:59], v[92:95], v[80:83], a[56:59]
    buffer_load_dwordx4 v[92:95], v1, s[24:27], s42 offen offset:1024
    v_mfma_f32_16x16x32_bf16 a[60:63], v[96:99], v[64:67], a[60:63]
    v_mfma_f32_16x16x32_bf16 a[64:67], v[96:99], v[68:71], a[64:67]
    v_mfma_f32_16x16x32_bf16 a[68:71], v[96:99], v[72:75], a[68:71]
    v_mfma_f32_16x16x32_bf16 a[72:75], v[96:99], v[76:79], a[72:75]
    v_mfma_f32_16x16x32_bf16 a[76:79], v[96:99], v[80:83], a[76:79]
    buffer_load_dwordx4 v[96:99], v1, s[24:27], s43 offen offset:1024
    v_mfma_f32_16x16x32_bf16 a[80:83], v[100:103], v[64:67], a[80:83]
    v_mfma_f32_16x16x32_bf16 a[84:87], v[100:103], v[68:71], a[84:87]
    v_mfma_f32_16x16x32_bf16 a[88:91], v[100:103], v[72:75], a[88:91]
    v_mfma_f32_16x16x32_bf16 a[92:95], v[100:103], v[76:79], a[92:95]
    v_mfma_f32_16x16x32_bf16 a[96:99], v[100:103], v[80:83], a[96:99]
    buffer_load_dwordx4 v[100:103], v1, s[24:27], s44 offen offset:1024
    v_mfma_f32_16x16x32_bf16 a[100:103], v[104:107], v[64:67], a[100:103]
    v_mfma_f32_16x16x32_bf16 a[104:107], v[104:107], v[68:71], a[104:107]
    v_mfma_f32_16x16x32_bf16 a[108:111], v[104:107], v[72:75], a[108:111]
    v_mfma_f32_16x16x32_bf16 a[112:115], v[104:107], v[76:79], a[112:115]
    v_mfma_f32_16x16x32_bf16 a[116:119], v[104:107], v[80:83], a[116:119]
    buffer_load_dwordx4 v[104:107], v1, s[24:27], s45 offen offset:1024
    v_mfma_f32_16x16x32_bf16 a[120:123], v[108:111], v[64:67], a[120:123]
    v_mfma_f32_16x16x32_bf16 a[124:127], v[108:111], v[68:71], a[124:127]
    v_mfma_f32_16x16x32_bf16 a[128:131], v[108:111], v[72:75], a[128:131]
    v_mfma_f32_16x16x32_bf16 a[132:135], v[108:111], v[76:79], a[132:135]
    v_mfma_f32_16x16x32_bf16 a[136:139], v[108:111], v[80:83], a[136:139]
    buffer_load_dwordx4 v[108:111], v1, s[24:27], s46 offen offset:1024
    v_mfma_f32_16x16x32_bf16 a[140:143], v[112:115], v[64:67], a[140:143]
    v_mfma_f32_16x16x32_bf16 a[144:147], v[112:115], v[68:71], a[144:147]
    v_mfma_f32_16x16x32_bf16 a[148:151], v[112:115], v[72:75], a[148:151]
    v_mfma_f32_16x16x32_bf16 a[152:155], v[112:115], v[76:79], a[152:155]
    v_mfma_f32_16x16x32_bf16 a[156:159], v[112:115], v[80:83], a[156:159]
    buffer_load_dwordx4 v[112:115], v1, s[24:27], s47 offen offset:1024
    s_waitcnt vmcnt(50)
    v_mfma_f32_16x16x32_bf16 a[160:163], v[116:119], v[64:67], a[160:163]
    buffer_load_dwordx4 v[64:67], v1, s[20:23], s32 offen offset:1024
    v_mfma_f32_16x16x32_bf16 a[164:167], v[116:119], v[68:71], a[164:167]
    buffer_load_dwordx4 v[68:71], v1, s[20:23], s33 offen offset:1024
    v_mfma_f32_16x16x32_bf16 a[168:171], v[116:119], v[72:75], a[168:171]
    buffer_load_dwordx4 v[72:75], v1, s[20:23], s34 offen offset:1024
    v_mfma_f32_16x16x32_bf16 a[172:175], v[116:119], v[76:79], a[172:175]
    buffer_load_dwordx4 v[76:79], v1, s[20:23], s35 offen offset:1024
    v_mfma_f32_16x16x32_bf16 a[176:179], v[116:119], v[80:83], a[176:179]
    buffer_load_dwordx4 v[80:83], v1, s[20:23], s36 offen offset:1024
    buffer_load_dwordx4 v[116:119], v1, s[24:27], s48 offen offset:1024
    s_waitcnt vmcnt(47)
    v_mfma_f32_16x16x32_bf16 a[0:3], v[140:143], v[120:123], a[0:3]
    s_waitcnt vmcnt(46)
    v_mfma_f32_16x16x32_bf16 a[4:7], v[140:143], v[124:127], a[4:7]
    s_waitcnt vmcnt(45)
    v_mfma_f32_16x16x32_bf16 a[8:11], v[140:143], v[128:131], a[8:11]
    s_waitcnt vmcnt(44)
    v_mfma_f32_16x16x32_bf16 a[12:15], v[140:143], v[132:135], a[12:15]
    s_waitcnt vmcnt(43)
    v_mfma_f32_16x16x32_bf16 a[16:19], v[140:143], v[136:139], a[16:19]
    buffer_load_dwordx4 v[140:143], v1, s[24:27], s40 offen offset:2048
    v_mfma_f32_16x16x32_bf16 a[20:23], v[144:147], v[120:123], a[20:23]
    v_mfma_f32_16x16x32_bf16 a[24:27], v[144:147], v[124:127], a[24:27]
    v_mfma_f32_16x16x32_bf16 a[28:31], v[144:147], v[128:131], a[28:31]
    v_mfma_f32_16x16x32_bf16 a[32:35], v[144:147], v[132:135], a[32:35]
    v_mfma_f32_16x16x32_bf16 a[36:39], v[144:147], v[136:139], a[36:39]
    buffer_load_dwordx4 v[144:147], v1, s[24:27], s41 offen offset:2048
    v_mfma_f32_16x16x32_bf16 a[40:43], v[148:151], v[120:123], a[40:43]
    v_mfma_f32_16x16x32_bf16 a[44:47], v[148:151], v[124:127], a[44:47]
    v_mfma_f32_16x16x32_bf16 a[48:51], v[148:151], v[128:131], a[48:51]
    v_mfma_f32_16x16x32_bf16 a[52:55], v[148:151], v[132:135], a[52:55]
    v_mfma_f32_16x16x32_bf16 a[56:59], v[148:151], v[136:139], a[56:59]
    buffer_load_dwordx4 v[148:151], v1, s[24:27], s42 offen offset:2048
    v_mfma_f32_16x16x32_bf16 a[60:63], v[152:155], v[120:123], a[60:63]
    v_mfma_f32_16x16x32_bf16 a[64:67], v[152:155], v[124:127], a[64:67]
    v_mfma_f32_16x16x32_bf16 a[68:71], v[152:155], v[128:131], a[68:71]
    v_mfma_f32_16x16x32_bf16 a[72:75], v[152:155], v[132:135], a[72:75]
    v_mfma_f32_16x16x32_bf16 a[76:79], v[152:155], v[136:139], a[76:79]
    buffer_load_dwordx4 v[152:155], v1, s[24:27], s43 offen offset:2048
    v_mfma_f32_16x16x32_bf16 a[80:83], v[156:159], v[120:123], a[80:83]
    v_mfma_f32_16x16x32_bf16 a[84:87], v[156:159], v[124:127], a[84:87]
    v_mfma_f32_16x16x32_bf16 a[88:91], v[156:159], v[128:131], a[88:91]
    v_mfma_f32_16x16x32_bf16 a[92:95], v[156:159], v[132:135], a[92:95]
    v_mfma_f32_16x16x32_bf16 a[96:99], v[156:159], v[136:139], a[96:99]
    buffer_load_dwordx4 v[156:159], v1, s[24:27], s44 offen offset:2048
    v_mfma_f32_16x16x32_bf16 a[100:103], v[160:163], v[120:123], a[100:103]
    v_mfma_f32_16x16x32_bf16 a[104:107], v[160:163], v[124:127], a[104:107]
    v_mfma_f32_16x16x32_bf16 a[108:111], v[160:163], v[128:131], a[108:111]
    v_mfma_f32_16x16x32_bf16 a[112:115], v[160:163], v[132:135], a[112:115]
    v_mfma_f32_16x16x32_bf16 a[116:119], v[160:163], v[136:139], a[116:119]
    buffer_load_dwordx4 v[160:163], v1, s[24:27], s45 offen offset:2048
    v_mfma_f32_16x16x32_bf16 a[120:123], v[164:167], v[120:123], a[120:123]
    v_mfma_f32_16x16x32_bf16 a[124:127], v[164:167], v[124:127], a[124:127]
    v_mfma_f32_16x16x32_bf16 a[128:131], v[164:167], v[128:131], a[128:131]
    v_mfma_f32_16x16x32_bf16 a[132:135], v[164:167], v[132:135], a[132:135]
    v_mfma_f32_16x16x32_bf16 a[136:139], v[164:167], v[136:139], a[136:139]
    buffer_load_dwordx4 v[164:167], v1, s[24:27], s46 offen offset:2048
    v_mfma_f32_16x16x32_bf16 a[140:143], v[168:171], v[120:123], a[140:143]
    v_mfma_f32_16x16x32_bf16 a[144:147], v[168:171], v[124:127], a[144:147]
    v_mfma_f32_16x16x32_bf16 a[148:151], v[168:171], v[128:131], a[148:151]
    v_mfma_f32_16x16x32_bf16 a[152:155], v[168:171], v[132:135], a[152:155]
    v_mfma_f32_16x16x32_bf16 a[156:159], v[168:171], v[136:139], a[156:159]
    buffer_load_dwordx4 v[168:171], v1, s[24:27], s47 offen offset:2048
    s_waitcnt vmcnt(50)
    v_mfma_f32_16x16x32_bf16 a[160:163], v[172:175], v[120:123], a[160:163]
    buffer_load_dwordx4 v[120:123], v1, s[20:23], s32 offen offset:2048
    v_mfma_f32_16x16x32_bf16 a[164:167], v[172:175], v[124:127], a[164:167]
    buffer_load_dwordx4 v[124:127], v1, s[20:23], s33 offen offset:2048
    v_mfma_f32_16x16x32_bf16 a[168:171], v[172:175], v[128:131], a[168:171]
    buffer_load_dwordx4 v[128:131], v1, s[20:23], s34 offen offset:2048
    v_mfma_f32_16x16x32_bf16 a[172:175], v[172:175], v[132:135], a[172:175]
    buffer_load_dwordx4 v[132:135], v1, s[20:23], s35 offen offset:2048
    v_mfma_f32_16x16x32_bf16 a[176:179], v[172:175], v[136:139], a[176:179]
    buffer_load_dwordx4 v[136:139], v1, s[20:23], s36 offen offset:2048
    buffer_load_dwordx4 v[172:175], v1, s[24:27], s48 offen offset:2048
    s_waitcnt vmcnt(47)
    v_mfma_f32_16x16x32_bf16 a[0:3], v[196:199], v[176:179], a[0:3]
    s_waitcnt vmcnt(46)
    v_mfma_f32_16x16x32_bf16 a[4:7], v[196:199], v[180:183], a[4:7]
    s_waitcnt vmcnt(45)
    v_mfma_f32_16x16x32_bf16 a[8:11], v[196:199], v[184:187], a[8:11]
    s_waitcnt vmcnt(44)
    v_mfma_f32_16x16x32_bf16 a[12:15], v[196:199], v[188:191], a[12:15]
    s_waitcnt vmcnt(43)
    v_mfma_f32_16x16x32_bf16 a[16:19], v[196:199], v[192:195], a[16:19]
    buffer_load_dwordx4 v[196:199], v1, s[24:27], s40 offen offset:3072
    v_mfma_f32_16x16x32_bf16 a[20:23], v[200:203], v[176:179], a[20:23]
    v_mfma_f32_16x16x32_bf16 a[24:27], v[200:203], v[180:183], a[24:27]
    v_mfma_f32_16x16x32_bf16 a[28:31], v[200:203], v[184:187], a[28:31]
    v_mfma_f32_16x16x32_bf16 a[32:35], v[200:203], v[188:191], a[32:35]
    v_mfma_f32_16x16x32_bf16 a[36:39], v[200:203], v[192:195], a[36:39]
    buffer_load_dwordx4 v[200:203], v1, s[24:27], s41 offen offset:3072
    v_mfma_f32_16x16x32_bf16 a[40:43], v[204:207], v[176:179], a[40:43]
    v_mfma_f32_16x16x32_bf16 a[44:47], v[204:207], v[180:183], a[44:47]
    v_mfma_f32_16x16x32_bf16 a[48:51], v[204:207], v[184:187], a[48:51]
    v_mfma_f32_16x16x32_bf16 a[52:55], v[204:207], v[188:191], a[52:55]
    v_mfma_f32_16x16x32_bf16 a[56:59], v[204:207], v[192:195], a[56:59]
    buffer_load_dwordx4 v[204:207], v1, s[24:27], s42 offen offset:3072
    v_mfma_f32_16x16x32_bf16 a[60:63], v[208:211], v[176:179], a[60:63]
    v_mfma_f32_16x16x32_bf16 a[64:67], v[208:211], v[180:183], a[64:67]
    v_mfma_f32_16x16x32_bf16 a[68:71], v[208:211], v[184:187], a[68:71]
    v_mfma_f32_16x16x32_bf16 a[72:75], v[208:211], v[188:191], a[72:75]
    v_mfma_f32_16x16x32_bf16 a[76:79], v[208:211], v[192:195], a[76:79]
    buffer_load_dwordx4 v[208:211], v1, s[24:27], s43 offen offset:3072
    v_mfma_f32_16x16x32_bf16 a[80:83], v[212:215], v[176:179], a[80:83]
    v_mfma_f32_16x16x32_bf16 a[84:87], v[212:215], v[180:183], a[84:87]
    v_mfma_f32_16x16x32_bf16 a[88:91], v[212:215], v[184:187], a[88:91]
    v_mfma_f32_16x16x32_bf16 a[92:95], v[212:215], v[188:191], a[92:95]
    v_mfma_f32_16x16x32_bf16 a[96:99], v[212:215], v[192:195], a[96:99]
    buffer_load_dwordx4 v[212:215], v1, s[24:27], s44 offen offset:3072
    v_mfma_f32_16x16x32_bf16 a[100:103], v[216:219], v[176:179], a[100:103]
    v_mfma_f32_16x16x32_bf16 a[104:107], v[216:219], v[180:183], a[104:107]
    v_mfma_f32_16x16x32_bf16 a[108:111], v[216:219], v[184:187], a[108:111]
    v_mfma_f32_16x16x32_bf16 a[112:115], v[216:219], v[188:191], a[112:115]
    v_mfma_f32_16x16x32_bf16 a[116:119], v[216:219], v[192:195], a[116:119]
    buffer_load_dwordx4 v[216:219], v1, s[24:27], s45 offen offset:3072
    v_mfma_f32_16x16x32_bf16 a[120:123], v[220:223], v[176:179], a[120:123]
    v_mfma_f32_16x16x32_bf16 a[124:127], v[220:223], v[180:183], a[124:127]
    v_mfma_f32_16x16x32_bf16 a[128:131], v[220:223], v[184:187], a[128:131]
    v_mfma_f32_16x16x32_bf16 a[132:135], v[220:223], v[188:191], a[132:135]
    v_mfma_f32_16x16x32_bf16 a[136:139], v[220:223], v[192:195], a[136:139]
    buffer_load_dwordx4 v[220:223], v1, s[24:27], s46 offen offset:3072
    v_mfma_f32_16x16x32_bf16 a[140:143], v[224:227], v[176:179], a[140:143]
    v_mfma_f32_16x16x32_bf16 a[144:147], v[224:227], v[180:183], a[144:147]
    v_mfma_f32_16x16x32_bf16 a[148:151], v[224:227], v[184:187], a[148:151]
    v_mfma_f32_16x16x32_bf16 a[152:155], v[224:227], v[188:191], a[152:155]
    v_mfma_f32_16x16x32_bf16 a[156:159], v[224:227], v[192:195], a[156:159]
    buffer_load_dwordx4 v[224:227], v1, s[24:27], s47 offen offset:3072
    s_waitcnt vmcnt(50)
    v_mfma_f32_16x16x32_bf16 a[160:163], v[228:231], v[176:179], a[160:163]
    buffer_load_dwordx4 v[176:179], v1, s[20:23], s32 offen offset:3072
    v_mfma_f32_16x16x32_bf16 a[164:167], v[228:231], v[180:183], a[164:167]
    buffer_load_dwordx4 v[180:183], v1, s[20:23], s33 offen offset:3072
    v_mfma_f32_16x16x32_bf16 a[168:171], v[228:231], v[184:187], a[168:171]
    buffer_load_dwordx4 v[184:187], v1, s[20:23], s34 offen offset:3072
    v_mfma_f32_16x16x32_bf16 a[172:175], v[228:231], v[188:191], a[172:175]
    buffer_load_dwordx4 v[188:191], v1, s[20:23], s35 offen offset:3072
    v_mfma_f32_16x16x32_bf16 a[176:179], v[228:231], v[192:195], a[176:179]
    buffer_load_dwordx4 v[192:195], v1, s[20:23], s36 offen offset:3072
    buffer_load_dwordx4 v[228:231], v1, s[24:27], s48 offen offset:3072
    v_add_u32 v234, 4096, v1
    s_waitcnt vmcnt(47)
    v_mfma_f32_16x16x32_bf16 a[0:3], v[28:31], v[8:11], a[0:3]
    s_waitcnt vmcnt(46)
    v_mfma_f32_16x16x32_bf16 a[4:7], v[28:31], v[12:15], a[4:7]
    s_waitcnt vmcnt(45)
    v_mfma_f32_16x16x32_bf16 a[8:11], v[28:31], v[16:19], a[8:11]
    s_waitcnt vmcnt(44)
    v_mfma_f32_16x16x32_bf16 a[12:15], v[28:31], v[20:23], a[12:15]
    s_waitcnt vmcnt(43)
    v_mfma_f32_16x16x32_bf16 a[16:19], v[28:31], v[24:27], a[16:19]
    buffer_load_dwordx4 v[28:31], v234, s[24:27], s40 offen offset:0
    v_mfma_f32_16x16x32_bf16 a[20:23], v[32:35], v[8:11], a[20:23]
    v_mfma_f32_16x16x32_bf16 a[24:27], v[32:35], v[12:15], a[24:27]
    v_mfma_f32_16x16x32_bf16 a[28:31], v[32:35], v[16:19], a[28:31]
    v_mfma_f32_16x16x32_bf16 a[32:35], v[32:35], v[20:23], a[32:35]
    v_mfma_f32_16x16x32_bf16 a[36:39], v[32:35], v[24:27], a[36:39]
    buffer_load_dwordx4 v[32:35], v234, s[24:27], s41 offen offset:0
    v_mfma_f32_16x16x32_bf16 a[40:43], v[36:39], v[8:11], a[40:43]
    v_mfma_f32_16x16x32_bf16 a[44:47], v[36:39], v[12:15], a[44:47]
    v_mfma_f32_16x16x32_bf16 a[48:51], v[36:39], v[16:19], a[48:51]
    v_mfma_f32_16x16x32_bf16 a[52:55], v[36:39], v[20:23], a[52:55]
    v_mfma_f32_16x16x32_bf16 a[56:59], v[36:39], v[24:27], a[56:59]
    buffer_load_dwordx4 v[36:39], v234, s[24:27], s42 offen offset:0
    v_mfma_f32_16x16x32_bf16 a[60:63], v[40:43], v[8:11], a[60:63]
    v_mfma_f32_16x16x32_bf16 a[64:67], v[40:43], v[12:15], a[64:67]
    v_mfma_f32_16x16x32_bf16 a[68:71], v[40:43], v[16:19], a[68:71]
    v_mfma_f32_16x16x32_bf16 a[72:75], v[40:43], v[20:23], a[72:75]
    v_mfma_f32_16x16x32_bf16 a[76:79], v[40:43], v[24:27], a[76:79]
    buffer_load_dwordx4 v[40:43], v234, s[24:27], s43 offen offset:0
    v_mfma_f32_16x16x32_bf16 a[80:83], v[44:47], v[8:11], a[80:83]
    v_mfma_f32_16x16x32_bf16 a[84:87], v[44:47], v[12:15], a[84:87]
    v_mfma_f32_16x16x32_bf16 a[88:91], v[44:47], v[16:19], a[88:91]
    v_mfma_f32_16x16x32_bf16 a[92:95], v[44:47], v[20:23], a[92:95]
    v_mfma_f32_16x16x32_bf16 a[96:99], v[44:47], v[24:27], a[96:99]
    buffer_load_dwordx4 v[44:47], v234, s[24:27], s44 offen offset:0
    v_mfma_f32_16x16x32_bf16 a[100:103], v[48:51], v[8:11], a[100:103]
    v_mfma_f32_16x16x32_bf16 a[104:107], v[48:51], v[12:15], a[104:107]
    v_mfma_f32_16x16x32_bf16 a[108:111], v[48:51], v[16:19], a[108:111]
    v_mfma_f32_16x16x32_bf16 a[112:115], v[48:51], v[20:23], a[112:115]
    v_mfma_f32_16x16x32_bf16 a[116:119], v[48:51], v[24:27], a[116:119]
    buffer_load_dwordx4 v[48:51], v234, s[24:27], s45 offen offset:0
    v_mfma_f32_16x16x32_bf16 a[120:123], v[52:55], v[8:11], a[120:123]
    v_mfma_f32_16x16x32_bf16 a[124:127], v[52:55], v[12:15], a[124:127]
    v_mfma_f32_16x16x32_bf16 a[128:131], v[52:55], v[16:19], a[128:131]
    v_mfma_f32_16x16x32_bf16 a[132:135], v[52:55], v[20:23], a[132:135]
    v_mfma_f32_16x16x32_bf16 a[136:139], v[52:55], v[24:27], a[136:139]
    buffer_load_dwordx4 v[52:55], v234, s[24:27], s46 offen offset:0
    v_mfma_f32_16x16x32_bf16 a[140:143], v[56:59], v[8:11], a[140:143]
    v_mfma_f32_16x16x32_bf16 a[144:147], v[56:59], v[12:15], a[144:147]
    v_mfma_f32_16x16x32_bf16 a[148:151], v[56:59], v[16:19], a[148:151]
    v_mfma_f32_16x16x32_bf16 a[152:155], v[56:59], v[20:23], a[152:155]
    v_mfma_f32_16x16x32_bf16 a[156:159], v[56:59], v[24:27], a[156:159]
    buffer_load_dwordx4 v[56:59], v234, s[24:27], s47 offen offset:0
    s_waitcnt vmcnt(50)
    v_mfma_f32_16x16x32_bf16 a[160:163], v[60:63], v[8:11], a[160:163]
    buffer_load_dwordx4 v[8:11], v234, s[20:23], s32 offen offset:0
    v_mfma_f32_16x16x32_bf16 a[164:167], v[60:63], v[12:15], a[164:167]
    buffer_load_dwordx4 v[12:15], v234, s[20:23], s33 offen offset:0
    v_mfma_f32_16x16x32_bf16 a[168:171], v[60:63], v[16:19], a[168:171]
    buffer_load_dwordx4 v[16:19], v234, s[20:23], s34 offen offset:0
    v_mfma_f32_16x16x32_bf16 a[172:175], v[60:63], v[20:23], a[172:175]
    buffer_load_dwordx4 v[20:23], v234, s[20:23], s35 offen offset:0
    v_mfma_f32_16x16x32_bf16 a[176:179], v[60:63], v[24:27], a[176:179]
    buffer_load_dwordx4 v[24:27], v234, s[20:23], s36 offen offset:0
    buffer_load_dwordx4 v[60:63], v234, s[24:27], s48 offen offset:0
    s_waitcnt vmcnt(47)
    v_mfma_f32_16x16x32_bf16 a[0:3], v[84:87], v[64:67], a[0:3]
    s_waitcnt vmcnt(46)
    v_mfma_f32_16x16x32_bf16 a[4:7], v[84:87], v[68:71], a[4:7]
    s_waitcnt vmcnt(45)
    v_mfma_f32_16x16x32_bf16 a[8:11], v[84:87], v[72:75], a[8:11]
    s_waitcnt vmcnt(44)
    v_mfma_f32_16x16x32_bf16 a[12:15], v[84:87], v[76:79], a[12:15]
    s_waitcnt vmcnt(43)
    v_mfma_f32_16x16x32_bf16 a[16:19], v[84:87], v[80:83], a[16:19]
    buffer_load_dwordx4 v[84:87], v234, s[24:27], s40 offen offset:1024
    v_mfma_f32_16x16x32_bf16 a[20:23], v[88:91], v[64:67], a[20:23]
    v_mfma_f32_16x16x32_bf16 a[24:27], v[88:91], v[68:71], a[24:27]
    v_mfma_f32_16x16x32_bf16 a[28:31], v[88:91], v[72:75], a[28:31]
    v_mfma_f32_16x16x32_bf16 a[32:35], v[88:91], v[76:79], a[32:35]
    v_mfma_f32_16x16x32_bf16 a[36:39], v[88:91], v[80:83], a[36:39]
    buffer_load_dwordx4 v[88:91], v234, s[24:27], s41 offen offset:1024
    v_mfma_f32_16x16x32_bf16 a[40:43], v[92:95], v[64:67], a[40:43]
    v_mfma_f32_16x16x32_bf16 a[44:47], v[92:95], v[68:71], a[44:47]
    v_mfma_f32_16x16x32_bf16 a[48:51], v[92:95], v[72:75], a[48:51]
    v_mfma_f32_16x16x32_bf16 a[52:55], v[92:95], v[76:79], a[52:55]
    v_mfma_f32_16x16x32_bf16 a[56:59], v[92:95], v[80:83], a[56:59]
    buffer_load_dwordx4 v[92:95], v234, s[24:27], s42 offen offset:1024
    v_mfma_f32_16x16x32_bf16 a[60:63], v[96:99], v[64:67], a[60:63]
    v_mfma_f32_16x16x32_bf16 a[64:67], v[96:99], v[68:71], a[64:67]
    v_mfma_f32_16x16x32_bf16 a[68:71], v[96:99], v[72:75], a[68:71]
    v_mfma_f32_16x16x32_bf16 a[72:75], v[96:99], v[76:79], a[72:75]
    v_mfma_f32_16x16x32_bf16 a[76:79], v[96:99], v[80:83], a[76:79]
    buffer_load_dwordx4 v[96:99], v234, s[24:27], s43 offen offset:1024
    v_mfma_f32_16x16x32_bf16 a[80:83], v[100:103], v[64:67], a[80:83]
    v_mfma_f32_16x16x32_bf16 a[84:87], v[100:103], v[68:71], a[84:87]
    v_mfma_f32_16x16x32_bf16 a[88:91], v[100:103], v[72:75], a[88:91]
    v_mfma_f32_16x16x32_bf16 a[92:95], v[100:103], v[76:79], a[92:95]
    v_mfma_f32_16x16x32_bf16 a[96:99], v[100:103], v[80:83], a[96:99]
    buffer_load_dwordx4 v[100:103], v234, s[24:27], s44 offen offset:1024
    v_mfma_f32_16x16x32_bf16 a[100:103], v[104:107], v[64:67], a[100:103]
    v_mfma_f32_16x16x32_bf16 a[104:107], v[104:107], v[68:71], a[104:107]
    v_mfma_f32_16x16x32_bf16 a[108:111], v[104:107], v[72:75], a[108:111]
    v_mfma_f32_16x16x32_bf16 a[112:115], v[104:107], v[76:79], a[112:115]
    v_mfma_f32_16x16x32_bf16 a[116:119], v[104:107], v[80:83], a[116:119]
    buffer_load_dwordx4 v[104:107], v234, s[24:27], s45 offen offset:1024
    v_mfma_f32_16x16x32_bf16 a[120:123], v[108:111], v[64:67], a[120:123]
    v_mfma_f32_16x16x32_bf16 a[124:127], v[108:111], v[68:71], a[124:127]
    v_mfma_f32_16x16x32_bf16 a[128:131], v[108:111], v[72:75], a[128:131]
    v_mfma_f32_16x16x32_bf16 a[132:135], v[108:111], v[76:79], a[132:135]
    v_mfma_f32_16x16x32_bf16 a[136:139], v[108:111], v[80:83], a[136:139]
    buffer_load_dwordx4 v[108:111], v234, s[24:27], s46 offen offset:1024
    v_mfma_f32_16x16x32_bf16 a[140:143], v[112:115], v[64:67], a[140:143]
    v_mfma_f32_16x16x32_bf16 a[144:147], v[112:115], v[68:71], a[144:147]
    v_mfma_f32_16x16x32_bf16 a[148:151], v[112:115], v[72:75], a[148:151]
    v_mfma_f32_16x16x32_bf16 a[152:155], v[112:115], v[76:79], a[152:155]
    v_mfma_f32_16x16x32_bf16 a[156:159], v[112:115], v[80:83], a[156:159]
    buffer_load_dwordx4 v[112:115], v234, s[24:27], s47 offen offset:1024
    s_waitcnt vmcnt(50)
    v_mfma_f32_16x16x32_bf16 a[160:163], v[116:119], v[64:67], a[160:163]
    buffer_load_dwordx4 v[64:67], v234, s[20:23], s32 offen offset:1024
    v_mfma_f32_16x16x32_bf16 a[164:167], v[116:119], v[68:71], a[164:167]
    buffer_load_dwordx4 v[68:71], v234, s[20:23], s33 offen offset:1024
    v_mfma_f32_16x16x32_bf16 a[168:171], v[116:119], v[72:75], a[168:171]
    buffer_load_dwordx4 v[72:75], v234, s[20:23], s34 offen offset:1024
    v_mfma_f32_16x16x32_bf16 a[172:175], v[116:119], v[76:79], a[172:175]
    buffer_load_dwordx4 v[76:79], v234, s[20:23], s35 offen offset:1024
    v_mfma_f32_16x16x32_bf16 a[176:179], v[116:119], v[80:83], a[176:179]
    buffer_load_dwordx4 v[80:83], v234, s[20:23], s36 offen offset:1024
    buffer_load_dwordx4 v[116:119], v234, s[24:27], s48 offen offset:1024
    s_waitcnt vmcnt(47)
    v_mfma_f32_16x16x32_bf16 a[0:3], v[140:143], v[120:123], a[0:3]
    s_waitcnt vmcnt(46)
    v_mfma_f32_16x16x32_bf16 a[4:7], v[140:143], v[124:127], a[4:7]
    s_waitcnt vmcnt(45)
    v_mfma_f32_16x16x32_bf16 a[8:11], v[140:143], v[128:131], a[8:11]
    s_waitcnt vmcnt(44)
    v_mfma_f32_16x16x32_bf16 a[12:15], v[140:143], v[132:135], a[12:15]
    s_waitcnt vmcnt(43)
    v_mfma_f32_16x16x32_bf16 a[16:19], v[140:143], v[136:139], a[16:19]
    buffer_load_dwordx4 v[140:143], v234, s[24:27], s40 offen offset:2048
    v_mfma_f32_16x16x32_bf16 a[20:23], v[144:147], v[120:123], a[20:23]
    v_mfma_f32_16x16x32_bf16 a[24:27], v[144:147], v[124:127], a[24:27]
    v_mfma_f32_16x16x32_bf16 a[28:31], v[144:147], v[128:131], a[28:31]
    v_mfma_f32_16x16x32_bf16 a[32:35], v[144:147], v[132:135], a[32:35]
    v_mfma_f32_16x16x32_bf16 a[36:39], v[144:147], v[136:139], a[36:39]
    buffer_load_dwordx4 v[144:147], v234, s[24:27], s41 offen offset:2048
    v_mfma_f32_16x16x32_bf16 a[40:43], v[148:151], v[120:123], a[40:43]
    v_mfma_f32_16x16x32_bf16 a[44:47], v[148:151], v[124:127], a[44:47]
    v_mfma_f32_16x16x32_bf16 a[48:51], v[148:151], v[128:131], a[48:51]
    v_mfma_f32_16x16x32_bf16 a[52:55], v[148:151], v[132:135], a[52:55]
    v_mfma_f32_16x16x32_bf16 a[56:59], v[148:151], v[136:139], a[56:59]
    buffer_load_dwordx4 v[148:151], v234, s[24:27], s42 offen offset:2048
    v_mfma_f32_16x16x32_bf16 a[60:63], v[152:155], v[120:123], a[60:63]
    v_mfma_f32_16x16x32_bf16 a[64:67], v[152:155], v[124:127], a[64:67]
    v_mfma_f32_16x16x32_bf16 a[68:71], v[152:155], v[128:131], a[68:71]
    v_mfma_f32_16x16x32_bf16 a[72:75], v[152:155], v[132:135], a[72:75]
    v_mfma_f32_16x16x32_bf16 a[76:79], v[152:155], v[136:139], a[76:79]
    buffer_load_dwordx4 v[152:155], v234, s[24:27], s43 offen offset:2048
    v_mfma_f32_16x16x32_bf16 a[80:83], v[156:159], v[120:123], a[80:83]
    v_mfma_f32_16x16x32_bf16 a[84:87], v[156:159], v[124:127], a[84:87]
    v_mfma_f32_16x16x32_bf16 a[88:91], v[156:159], v[128:131], a[88:91]
    v_mfma_f32_16x16x32_bf16 a[92:95], v[156:159], v[132:135], a[92:95]
    v_mfma_f32_16x16x32_bf16 a[96:99], v[156:159], v[136:139], a[96:99]
    buffer_load_dwordx4 v[156:159], v234, s[24:27], s44 offen offset:2048
    v_mfma_f32_16x16x32_bf16 a[100:103], v[160:163], v[120:123], a[100:103]
    v_mfma_f32_16x16x32_bf16 a[104:107], v[160:163], v[124:127], a[104:107]
    v_mfma_f32_16x16x32_bf16 a[108:111], v[160:163], v[128:131], a[108:111]
    v_mfma_f32_16x16x32_bf16 a[112:115], v[160:163], v[132:135], a[112:115]
    v_mfma_f32_16x16x32_bf16 a[116:119], v[160:163], v[136:139], a[116:119]
    buffer_load_dwordx4 v[160:163], v234, s[24:27], s45 offen offset:2048
    v_mfma_f32_16x16x32_bf16 a[120:123], v[164:167], v[120:123], a[120:123]
    v_mfma_f32_16x16x32_bf16 a[124:127], v[164:167], v[124:127], a[124:127]
    v_mfma_f32_16x16x32_bf16 a[128:131], v[164:167], v[128:131], a[128:131]
    v_mfma_f32_16x16x32_bf16 a[132:135], v[164:167], v[132:135], a[132:135]
    v_mfma_f32_16x16x32_bf16 a[136:139], v[164:167], v[136:139], a[136:139]
    buffer_load_dwordx4 v[164:167], v234, s[24:27], s46 offen offset:2048
    v_mfma_f32_16x16x32_bf16 a[140:143], v[168:171], v[120:123], a[140:143]
    v_mfma_f32_16x16x32_bf16 a[144:147], v[168:171], v[124:127], a[144:147]
    v_mfma_f32_16x16x32_bf16 a[148:151], v[168:171], v[128:131], a[148:151]
    v_mfma_f32_16x16x32_bf16 a[152:155], v[168:171], v[132:135], a[152:155]
    v_mfma_f32_16x16x32_bf16 a[156:159], v[168:171], v[136:139], a[156:159]
    buffer_load_dwordx4 v[168:171], v234, s[24:27], s47 offen offset:2048
    s_waitcnt vmcnt(50)
    v_mfma_f32_16x16x32_bf16 a[160:163], v[172:175], v[120:123], a[160:163]
    buffer_load_dwordx4 v[120:123], v234, s[20:23], s32 offen offset:2048
    v_mfma_f32_16x16x32_bf16 a[164:167], v[172:175], v[124:127], a[164:167]
    buffer_load_dwordx4 v[124:127], v234, s[20:23], s33 offen offset:2048
    v_mfma_f32_16x16x32_bf16 a[168:171], v[172:175], v[128:131], a[168:171]
    buffer_load_dwordx4 v[128:131], v234, s[20:23], s34 offen offset:2048
    v_mfma_f32_16x16x32_bf16 a[172:175], v[172:175], v[132:135], a[172:175]
    buffer_load_dwordx4 v[132:135], v234, s[20:23], s35 offen offset:2048
    v_mfma_f32_16x16x32_bf16 a[176:179], v[172:175], v[136:139], a[176:179]
    buffer_load_dwordx4 v[136:139], v234, s[20:23], s36 offen offset:2048
    buffer_load_dwordx4 v[172:175], v234, s[24:27], s48 offen offset:2048
    s_waitcnt vmcnt(47)
    v_mfma_f32_16x16x32_bf16 a[0:3], v[196:199], v[176:179], a[0:3]
    s_waitcnt vmcnt(46)
    v_mfma_f32_16x16x32_bf16 a[4:7], v[196:199], v[180:183], a[4:7]
    s_waitcnt vmcnt(45)
    v_mfma_f32_16x16x32_bf16 a[8:11], v[196:199], v[184:187], a[8:11]
    s_waitcnt vmcnt(44)
    v_mfma_f32_16x16x32_bf16 a[12:15], v[196:199], v[188:191], a[12:15]
    s_waitcnt vmcnt(43)
    v_mfma_f32_16x16x32_bf16 a[16:19], v[196:199], v[192:195], a[16:19]
    buffer_load_dwordx4 v[196:199], v234, s[24:27], s40 offen offset:3072
    v_mfma_f32_16x16x32_bf16 a[20:23], v[200:203], v[176:179], a[20:23]
    v_mfma_f32_16x16x32_bf16 a[24:27], v[200:203], v[180:183], a[24:27]
    v_mfma_f32_16x16x32_bf16 a[28:31], v[200:203], v[184:187], a[28:31]
    v_mfma_f32_16x16x32_bf16 a[32:35], v[200:203], v[188:191], a[32:35]
    v_mfma_f32_16x16x32_bf16 a[36:39], v[200:203], v[192:195], a[36:39]
    buffer_load_dwordx4 v[200:203], v234, s[24:27], s41 offen offset:3072
    v_mfma_f32_16x16x32_bf16 a[40:43], v[204:207], v[176:179], a[40:43]
    v_mfma_f32_16x16x32_bf16 a[44:47], v[204:207], v[180:183], a[44:47]
    v_mfma_f32_16x16x32_bf16 a[48:51], v[204:207], v[184:187], a[48:51]
    v_mfma_f32_16x16x32_bf16 a[52:55], v[204:207], v[188:191], a[52:55]
    v_mfma_f32_16x16x32_bf16 a[56:59], v[204:207], v[192:195], a[56:59]
    buffer_load_dwordx4 v[204:207], v234, s[24:27], s42 offen offset:3072
    v_mfma_f32_16x16x32_bf16 a[60:63], v[208:211], v[176:179], a[60:63]
    v_mfma_f32_16x16x32_bf16 a[64:67], v[208:211], v[180:183], a[64:67]
    v_mfma_f32_16x16x32_bf16 a[68:71], v[208:211], v[184:187], a[68:71]
    v_mfma_f32_16x16x32_bf16 a[72:75], v[208:211], v[188:191], a[72:75]
    v_mfma_f32_16x16x32_bf16 a[76:79], v[208:211], v[192:195], a[76:79]
    buffer_load_dwordx4 v[208:211], v234, s[24:27], s43 offen offset:3072
    v_mfma_f32_16x16x32_bf16 a[80:83], v[212:215], v[176:179], a[80:83]
    v_mfma_f32_16x16x32_bf16 a[84:87], v[212:215], v[180:183], a[84:87]
    v_mfma_f32_16x16x32_bf16 a[88:91], v[212:215], v[184:187], a[88:91]
    v_mfma_f32_16x16x32_bf16 a[92:95], v[212:215], v[188:191], a[92:95]
    v_mfma_f32_16x16x32_bf16 a[96:99], v[212:215], v[192:195], a[96:99]
    buffer_load_dwordx4 v[212:215], v234, s[24:27], s44 offen offset:3072
    v_mfma_f32_16x16x32_bf16 a[100:103], v[216:219], v[176:179], a[100:103]
    v_mfma_f32_16x16x32_bf16 a[104:107], v[216:219], v[180:183], a[104:107]
    v_mfma_f32_16x16x32_bf16 a[108:111], v[216:219], v[184:187], a[108:111]
    v_mfma_f32_16x16x32_bf16 a[112:115], v[216:219], v[188:191], a[112:115]
    v_mfma_f32_16x16x32_bf16 a[116:119], v[216:219], v[192:195], a[116:119]
    buffer_load_dwordx4 v[216:219], v234, s[24:27], s45 offen offset:3072
    v_mfma_f32_16x16x32_bf16 a[120:123], v[220:223], v[176:179], a[120:123]
    v_mfma_f32_16x16x32_bf16 a[124:127], v[220:223], v[180:183], a[124:127]
    v_mfma_f32_16x16x32_bf16 a[128:131], v[220:223], v[184:187], a[128:131]
    v_mfma_f32_16x16x32_bf16 a[132:135], v[220:223], v[188:191], a[132:135]
    v_mfma_f32_16x16x32_bf16 a[136:139], v[220:223], v[192:195], a[136:139]
    buffer_load_dwordx4 v[220:223], v234, s[24:27], s46 offen offset:3072
    v_mfma_f32_16x16x32_bf16 a[140:143], v[224:227], v[176:179], a[140:143]
    v_mfma_f32_16x16x32_bf16 a[144:147], v[224:227], v[180:183], a[144:147]
    v_mfma_f32_16x16x32_bf16 a[148:151], v[224:227], v[184:187], a[148:151]
    v_mfma_f32_16x16x32_bf16 a[152:155], v[224:227], v[188:191], a[152:155]
    v_mfma_f32_16x16x32_bf16 a[156:159], v[224:227], v[192:195], a[156:159]
    buffer_load_dwordx4 v[224:227], v234, s[24:27], s47 offen offset:3072
    s_waitcnt vmcnt(50)
    v_mfma_f32_16x16x32_bf16 a[160:163], v[228:231], v[176:179], a[160:163]
    buffer_load_dwordx4 v[176:179], v234, s[20:23], s32 offen offset:3072
    v_mfma_f32_16x16x32_bf16 a[164:167], v[228:231], v[180:183], a[164:167]
    buffer_load_dwordx4 v[180:183], v234, s[20:23], s33 offen offset:3072
    v_mfma_f32_16x16x32_bf16 a[168:171], v[228:231], v[184:187], a[168:171]
    buffer_load_dwordx4 v[184:187], v234, s[20:23], s34 offen offset:3072
    v_mfma_f32_16x16x32_bf16 a[172:175], v[228:231], v[188:191], a[172:175]
    buffer_load_dwordx4 v[188:191], v234, s[20:23], s35 offen offset:3072
    v_mfma_f32_16x16x32_bf16 a[176:179], v[228:231], v[192:195], a[176:179]
    buffer_load_dwordx4 v[192:195], v234, s[20:23], s36 offen offset:3072
    buffer_load_dwordx4 v[228:231], v234, s[24:27], s48 offen offset:3072
    v_add_u32 v1, 4096, v234
    s_waitcnt vmcnt(47)
    v_mfma_f32_16x16x32_bf16 a[0:3], v[28:31], v[8:11], a[0:3]
    s_waitcnt vmcnt(46)
    v_mfma_f32_16x16x32_bf16 a[4:7], v[28:31], v[12:15], a[4:7]
    s_waitcnt vmcnt(45)
    v_mfma_f32_16x16x32_bf16 a[8:11], v[28:31], v[16:19], a[8:11]
    s_waitcnt vmcnt(44)
    v_mfma_f32_16x16x32_bf16 a[12:15], v[28:31], v[20:23], a[12:15]
    s_waitcnt vmcnt(43)
    v_mfma_f32_16x16x32_bf16 a[16:19], v[28:31], v[24:27], a[16:19]
    buffer_load_dwordx4 v[28:31], v1, s[24:27], s40 offen offset:0
    v_mfma_f32_16x16x32_bf16 a[20:23], v[32:35], v[8:11], a[20:23]
    v_mfma_f32_16x16x32_bf16 a[24:27], v[32:35], v[12:15], a[24:27]
    v_mfma_f32_16x16x32_bf16 a[28:31], v[32:35], v[16:19], a[28:31]
    v_mfma_f32_16x16x32_bf16 a[32:35], v[32:35], v[20:23], a[32:35]
    v_mfma_f32_16x16x32_bf16 a[36:39], v[32:35], v[24:27], a[36:39]
    buffer_load_dwordx4 v[32:35], v1, s[24:27], s41 offen offset:0
    v_mfma_f32_16x16x32_bf16 a[40:43], v[36:39], v[8:11], a[40:43]
    v_mfma_f32_16x16x32_bf16 a[44:47], v[36:39], v[12:15], a[44:47]
    v_mfma_f32_16x16x32_bf16 a[48:51], v[36:39], v[16:19], a[48:51]
    v_mfma_f32_16x16x32_bf16 a[52:55], v[36:39], v[20:23], a[52:55]
    v_mfma_f32_16x16x32_bf16 a[56:59], v[36:39], v[24:27], a[56:59]
    buffer_load_dwordx4 v[36:39], v1, s[24:27], s42 offen offset:0
    v_mfma_f32_16x16x32_bf16 a[60:63], v[40:43], v[8:11], a[60:63]
    v_mfma_f32_16x16x32_bf16 a[64:67], v[40:43], v[12:15], a[64:67]
    v_mfma_f32_16x16x32_bf16 a[68:71], v[40:43], v[16:19], a[68:71]
    v_mfma_f32_16x16x32_bf16 a[72:75], v[40:43], v[20:23], a[72:75]
    v_mfma_f32_16x16x32_bf16 a[76:79], v[40:43], v[24:27], a[76:79]
    buffer_load_dwordx4 v[40:43], v1, s[24:27], s43 offen offset:0
    v_mfma_f32_16x16x32_bf16 a[80:83], v[44:47], v[8:11], a[80:83]
    v_mfma_f32_16x16x32_bf16 a[84:87], v[44:47], v[12:15], a[84:87]
    v_mfma_f32_16x16x32_bf16 a[88:91], v[44:47], v[16:19], a[88:91]
    v_mfma_f32_16x16x32_bf16 a[92:95], v[44:47], v[20:23], a[92:95]
    v_mfma_f32_16x16x32_bf16 a[96:99], v[44:47], v[24:27], a[96:99]
    buffer_load_dwordx4 v[44:47], v1, s[24:27], s44 offen offset:0
    v_mfma_f32_16x16x32_bf16 a[100:103], v[48:51], v[8:11], a[100:103]
    v_mfma_f32_16x16x32_bf16 a[104:107], v[48:51], v[12:15], a[104:107]
    v_mfma_f32_16x16x32_bf16 a[108:111], v[48:51], v[16:19], a[108:111]
    v_mfma_f32_16x16x32_bf16 a[112:115], v[48:51], v[20:23], a[112:115]
    v_mfma_f32_16x16x32_bf16 a[116:119], v[48:51], v[24:27], a[116:119]
    buffer_load_dwordx4 v[48:51], v1, s[24:27], s45 offen offset:0
    v_mfma_f32_16x16x32_bf16 a[120:123], v[52:55], v[8:11], a[120:123]
    v_mfma_f32_16x16x32_bf16 a[124:127], v[52:55], v[12:15], a[124:127]
    v_mfma_f32_16x16x32_bf16 a[128:131], v[52:55], v[16:19], a[128:131]
    v_mfma_f32_16x16x32_bf16 a[132:135], v[52:55], v[20:23], a[132:135]
    v_mfma_f32_16x16x32_bf16 a[136:139], v[52:55], v[24:27], a[136:139]
    buffer_load_dwordx4 v[52:55], v1, s[24:27], s46 offen offset:0
    v_mfma_f32_16x16x32_bf16 a[140:143], v[56:59], v[8:11], a[140:143]
    v_mfma_f32_16x16x32_bf16 a[144:147], v[56:59], v[12:15], a[144:147]
    v_mfma_f32_16x16x32_bf16 a[148:151], v[56:59], v[16:19], a[148:151]
    v_mfma_f32_16x16x32_bf16 a[152:155], v[56:59], v[20:23], a[152:155]
    v_mfma_f32_16x16x32_bf16 a[156:159], v[56:59], v[24:27], a[156:159]
    buffer_load_dwordx4 v[56:59], v1, s[24:27], s47 offen offset:0
    s_waitcnt vmcnt(50)
    v_mfma_f32_16x16x32_bf16 a[160:163], v[60:63], v[8:11], a[160:163]
    buffer_load_dwordx4 v[8:11], v1, s[20:23], s32 offen offset:0
    v_mfma_f32_16x16x32_bf16 a[164:167], v[60:63], v[12:15], a[164:167]
    buffer_load_dwordx4 v[12:15], v1, s[20:23], s33 offen offset:0
    v_mfma_f32_16x16x32_bf16 a[168:171], v[60:63], v[16:19], a[168:171]
    buffer_load_dwordx4 v[16:19], v1, s[20:23], s34 offen offset:0
    v_mfma_f32_16x16x32_bf16 a[172:175], v[60:63], v[20:23], a[172:175]
    buffer_load_dwordx4 v[20:23], v1, s[20:23], s35 offen offset:0
    v_mfma_f32_16x16x32_bf16 a[176:179], v[60:63], v[24:27], a[176:179]
    buffer_load_dwordx4 v[24:27], v1, s[20:23], s36 offen offset:0
    buffer_load_dwordx4 v[60:63], v1, s[24:27], s48 offen offset:0
    s_waitcnt vmcnt(47)
    v_mfma_f32_16x16x32_bf16 a[0:3], v[84:87], v[64:67], a[0:3]
    s_waitcnt vmcnt(46)
    v_mfma_f32_16x16x32_bf16 a[4:7], v[84:87], v[68:71], a[4:7]
    s_waitcnt vmcnt(45)
    v_mfma_f32_16x16x32_bf16 a[8:11], v[84:87], v[72:75], a[8:11]
    s_waitcnt vmcnt(44)
    v_mfma_f32_16x16x32_bf16 a[12:15], v[84:87], v[76:79], a[12:15]
    s_waitcnt vmcnt(43)
    v_mfma_f32_16x16x32_bf16 a[16:19], v[84:87], v[80:83], a[16:19]
    buffer_load_dwordx4 v[84:87], v1, s[24:27], s40 offen offset:1024
    v_mfma_f32_16x16x32_bf16 a[20:23], v[88:91], v[64:67], a[20:23]
    v_mfma_f32_16x16x32_bf16 a[24:27], v[88:91], v[68:71], a[24:27]
    v_mfma_f32_16x16x32_bf16 a[28:31], v[88:91], v[72:75], a[28:31]
    v_mfma_f32_16x16x32_bf16 a[32:35], v[88:91], v[76:79], a[32:35]
    v_mfma_f32_16x16x32_bf16 a[36:39], v[88:91], v[80:83], a[36:39]
    buffer_load_dwordx4 v[88:91], v1, s[24:27], s41 offen offset:1024
    v_mfma_f32_16x16x32_bf16 a[40:43], v[92:95], v[64:67], a[40:43]
    v_mfma_f32_16x16x32_bf16 a[44:47], v[92:95], v[68:71], a[44:47]
    v_mfma_f32_16x16x32_bf16 a[48:51], v[92:95], v[72:75], a[48:51]
    v_mfma_f32_16x16x32_bf16 a[52:55], v[92:95], v[76:79], a[52:55]
    v_mfma_f32_16x16x32_bf16 a[56:59], v[92:95], v[80:83], a[56:59]
    buffer_load_dwordx4 v[92:95], v1, s[24:27], s42 offen offset:1024
    v_mfma_f32_16x16x32_bf16 a[60:63], v[96:99], v[64:67], a[60:63]
    v_mfma_f32_16x16x32_bf16 a[64:67], v[96:99], v[68:71], a[64:67]
    v_mfma_f32_16x16x32_bf16 a[68:71], v[96:99], v[72:75], a[68:71]
    v_mfma_f32_16x16x32_bf16 a[72:75], v[96:99], v[76:79], a[72:75]
    v_mfma_f32_16x16x32_bf16 a[76:79], v[96:99], v[80:83], a[76:79]
    buffer_load_dwordx4 v[96:99], v1, s[24:27], s43 offen offset:1024
    v_mfma_f32_16x16x32_bf16 a[80:83], v[100:103], v[64:67], a[80:83]
    v_mfma_f32_16x16x32_bf16 a[84:87], v[100:103], v[68:71], a[84:87]
    v_mfma_f32_16x16x32_bf16 a[88:91], v[100:103], v[72:75], a[88:91]
    v_mfma_f32_16x16x32_bf16 a[92:95], v[100:103], v[76:79], a[92:95]
    v_mfma_f32_16x16x32_bf16 a[96:99], v[100:103], v[80:83], a[96:99]
    buffer_load_dwordx4 v[100:103], v1, s[24:27], s44 offen offset:1024
    v_mfma_f32_16x16x32_bf16 a[100:103], v[104:107], v[64:67], a[100:103]
    v_mfma_f32_16x16x32_bf16 a[104:107], v[104:107], v[68:71], a[104:107]
    v_mfma_f32_16x16x32_bf16 a[108:111], v[104:107], v[72:75], a[108:111]
    v_mfma_f32_16x16x32_bf16 a[112:115], v[104:107], v[76:79], a[112:115]
    v_mfma_f32_16x16x32_bf16 a[116:119], v[104:107], v[80:83], a[116:119]
    buffer_load_dwordx4 v[104:107], v1, s[24:27], s45 offen offset:1024
    v_mfma_f32_16x16x32_bf16 a[120:123], v[108:111], v[64:67], a[120:123]
    v_mfma_f32_16x16x32_bf16 a[124:127], v[108:111], v[68:71], a[124:127]
    v_mfma_f32_16x16x32_bf16 a[128:131], v[108:111], v[72:75], a[128:131]
    v_mfma_f32_16x16x32_bf16 a[132:135], v[108:111], v[76:79], a[132:135]
    v_mfma_f32_16x16x32_bf16 a[136:139], v[108:111], v[80:83], a[136:139]
    buffer_load_dwordx4 v[108:111], v1, s[24:27], s46 offen offset:1024
    v_mfma_f32_16x16x32_bf16 a[140:143], v[112:115], v[64:67], a[140:143]
    v_mfma_f32_16x16x32_bf16 a[144:147], v[112:115], v[68:71], a[144:147]
    v_mfma_f32_16x16x32_bf16 a[148:151], v[112:115], v[72:75], a[148:151]
    v_mfma_f32_16x16x32_bf16 a[152:155], v[112:115], v[76:79], a[152:155]
    v_mfma_f32_16x16x32_bf16 a[156:159], v[112:115], v[80:83], a[156:159]
    buffer_load_dwordx4 v[112:115], v1, s[24:27], s47 offen offset:1024
    s_waitcnt vmcnt(50)
    v_mfma_f32_16x16x32_bf16 a[160:163], v[116:119], v[64:67], a[160:163]
    buffer_load_dwordx4 v[64:67], v1, s[20:23], s32 offen offset:1024
    v_mfma_f32_16x16x32_bf16 a[164:167], v[116:119], v[68:71], a[164:167]
    buffer_load_dwordx4 v[68:71], v1, s[20:23], s33 offen offset:1024
    v_mfma_f32_16x16x32_bf16 a[168:171], v[116:119], v[72:75], a[168:171]
    buffer_load_dwordx4 v[72:75], v1, s[20:23], s34 offen offset:1024
    v_mfma_f32_16x16x32_bf16 a[172:175], v[116:119], v[76:79], a[172:175]
    buffer_load_dwordx4 v[76:79], v1, s[20:23], s35 offen offset:1024
    v_mfma_f32_16x16x32_bf16 a[176:179], v[116:119], v[80:83], a[176:179]
    buffer_load_dwordx4 v[80:83], v1, s[20:23], s36 offen offset:1024
    buffer_load_dwordx4 v[116:119], v1, s[24:27], s48 offen offset:1024
    s_waitcnt vmcnt(47)
    v_mfma_f32_16x16x32_bf16 a[0:3], v[140:143], v[120:123], a[0:3]
    s_waitcnt vmcnt(46)
    v_mfma_f32_16x16x32_bf16 a[4:7], v[140:143], v[124:127], a[4:7]
    s_waitcnt vmcnt(45)
    v_mfma_f32_16x16x32_bf16 a[8:11], v[140:143], v[128:131], a[8:11]
    s_waitcnt vmcnt(44)
    v_mfma_f32_16x16x32_bf16 a[12:15], v[140:143], v[132:135], a[12:15]
    s_waitcnt vmcnt(43)
    v_mfma_f32_16x16x32_bf16 a[16:19], v[140:143], v[136:139], a[16:19]
    buffer_load_dwordx4 v[140:143], v1, s[24:27], s40 offen offset:2048
    v_mfma_f32_16x16x32_bf16 a[20:23], v[144:147], v[120:123], a[20:23]
    v_mfma_f32_16x16x32_bf16 a[24:27], v[144:147], v[124:127], a[24:27]
    v_mfma_f32_16x16x32_bf16 a[28:31], v[144:147], v[128:131], a[28:31]
    v_mfma_f32_16x16x32_bf16 a[32:35], v[144:147], v[132:135], a[32:35]
    v_mfma_f32_16x16x32_bf16 a[36:39], v[144:147], v[136:139], a[36:39]
    buffer_load_dwordx4 v[144:147], v1, s[24:27], s41 offen offset:2048
    v_mfma_f32_16x16x32_bf16 a[40:43], v[148:151], v[120:123], a[40:43]
    v_mfma_f32_16x16x32_bf16 a[44:47], v[148:151], v[124:127], a[44:47]
    v_mfma_f32_16x16x32_bf16 a[48:51], v[148:151], v[128:131], a[48:51]
    v_mfma_f32_16x16x32_bf16 a[52:55], v[148:151], v[132:135], a[52:55]
    v_mfma_f32_16x16x32_bf16 a[56:59], v[148:151], v[136:139], a[56:59]
    buffer_load_dwordx4 v[148:151], v1, s[24:27], s42 offen offset:2048
    v_mfma_f32_16x16x32_bf16 a[60:63], v[152:155], v[120:123], a[60:63]
    v_mfma_f32_16x16x32_bf16 a[64:67], v[152:155], v[124:127], a[64:67]
    v_mfma_f32_16x16x32_bf16 a[68:71], v[152:155], v[128:131], a[68:71]
    v_mfma_f32_16x16x32_bf16 a[72:75], v[152:155], v[132:135], a[72:75]
    v_mfma_f32_16x16x32_bf16 a[76:79], v[152:155], v[136:139], a[76:79]
    buffer_load_dwordx4 v[152:155], v1, s[24:27], s43 offen offset:2048
    v_mfma_f32_16x16x32_bf16 a[80:83], v[156:159], v[120:123], a[80:83]
    v_mfma_f32_16x16x32_bf16 a[84:87], v[156:159], v[124:127], a[84:87]
    v_mfma_f32_16x16x32_bf16 a[88:91], v[156:159], v[128:131], a[88:91]
    v_mfma_f32_16x16x32_bf16 a[92:95], v[156:159], v[132:135], a[92:95]
    v_mfma_f32_16x16x32_bf16 a[96:99], v[156:159], v[136:139], a[96:99]
    buffer_load_dwordx4 v[156:159], v1, s[24:27], s44 offen offset:2048
    v_mfma_f32_16x16x32_bf16 a[100:103], v[160:163], v[120:123], a[100:103]
    v_mfma_f32_16x16x32_bf16 a[104:107], v[160:163], v[124:127], a[104:107]
    v_mfma_f32_16x16x32_bf16 a[108:111], v[160:163], v[128:131], a[108:111]
    v_mfma_f32_16x16x32_bf16 a[112:115], v[160:163], v[132:135], a[112:115]
    v_mfma_f32_16x16x32_bf16 a[116:119], v[160:163], v[136:139], a[116:119]
    buffer_load_dwordx4 v[160:163], v1, s[24:27], s45 offen offset:2048
    v_mfma_f32_16x16x32_bf16 a[120:123], v[164:167], v[120:123], a[120:123]
    v_mfma_f32_16x16x32_bf16 a[124:127], v[164:167], v[124:127], a[124:127]
    v_mfma_f32_16x16x32_bf16 a[128:131], v[164:167], v[128:131], a[128:131]
    v_mfma_f32_16x16x32_bf16 a[132:135], v[164:167], v[132:135], a[132:135]
    v_mfma_f32_16x16x32_bf16 a[136:139], v[164:167], v[136:139], a[136:139]
    buffer_load_dwordx4 v[164:167], v1, s[24:27], s46 offen offset:2048
    v_mfma_f32_16x16x32_bf16 a[140:143], v[168:171], v[120:123], a[140:143]
    v_mfma_f32_16x16x32_bf16 a[144:147], v[168:171], v[124:127], a[144:147]
    v_mfma_f32_16x16x32_bf16 a[148:151], v[168:171], v[128:131], a[148:151]
    v_mfma_f32_16x16x32_bf16 a[152:155], v[168:171], v[132:135], a[152:155]
    v_mfma_f32_16x16x32_bf16 a[156:159], v[168:171], v[136:139], a[156:159]
    buffer_load_dwordx4 v[168:171], v1, s[24:27], s47 offen offset:2048
    s_waitcnt vmcnt(50)
    v_mfma_f32_16x16x32_bf16 a[160:163], v[172:175], v[120:123], a[160:163]
    buffer_load_dwordx4 v[120:123], v1, s[20:23], s32 offen offset:2048
    v_mfma_f32_16x16x32_bf16 a[164:167], v[172:175], v[124:127], a[164:167]
    buffer_load_dwordx4 v[124:127], v1, s[20:23], s33 offen offset:2048
    v_mfma_f32_16x16x32_bf16 a[168:171], v[172:175], v[128:131], a[168:171]
    buffer_load_dwordx4 v[128:131], v1, s[20:23], s34 offen offset:2048
    v_mfma_f32_16x16x32_bf16 a[172:175], v[172:175], v[132:135], a[172:175]
    buffer_load_dwordx4 v[132:135], v1, s[20:23], s35 offen offset:2048
    v_mfma_f32_16x16x32_bf16 a[176:179], v[172:175], v[136:139], a[176:179]
    buffer_load_dwordx4 v[136:139], v1, s[20:23], s36 offen offset:2048
    buffer_load_dwordx4 v[172:175], v1, s[24:27], s48 offen offset:2048
    s_waitcnt vmcnt(47)
    v_mfma_f32_16x16x32_bf16 a[0:3], v[196:199], v[176:179], a[0:3]
    s_waitcnt vmcnt(46)
    v_mfma_f32_16x16x32_bf16 a[4:7], v[196:199], v[180:183], a[4:7]
    s_waitcnt vmcnt(45)
    v_mfma_f32_16x16x32_bf16 a[8:11], v[196:199], v[184:187], a[8:11]
    s_waitcnt vmcnt(44)
    v_mfma_f32_16x16x32_bf16 a[12:15], v[196:199], v[188:191], a[12:15]
    s_waitcnt vmcnt(43)
    v_mfma_f32_16x16x32_bf16 a[16:19], v[196:199], v[192:195], a[16:19]
    buffer_load_dwordx4 v[196:199], v1, s[24:27], s40 offen offset:3072
    v_mfma_f32_16x16x32_bf16 a[20:23], v[200:203], v[176:179], a[20:23]
    v_mfma_f32_16x16x32_bf16 a[24:27], v[200:203], v[180:183], a[24:27]
    v_mfma_f32_16x16x32_bf16 a[28:31], v[200:203], v[184:187], a[28:31]
    v_mfma_f32_16x16x32_bf16 a[32:35], v[200:203], v[188:191], a[32:35]
    v_mfma_f32_16x16x32_bf16 a[36:39], v[200:203], v[192:195], a[36:39]
    buffer_load_dwordx4 v[200:203], v1, s[24:27], s41 offen offset:3072
    v_mfma_f32_16x16x32_bf16 a[40:43], v[204:207], v[176:179], a[40:43]
    v_mfma_f32_16x16x32_bf16 a[44:47], v[204:207], v[180:183], a[44:47]
    v_mfma_f32_16x16x32_bf16 a[48:51], v[204:207], v[184:187], a[48:51]
    v_mfma_f32_16x16x32_bf16 a[52:55], v[204:207], v[188:191], a[52:55]
    v_mfma_f32_16x16x32_bf16 a[56:59], v[204:207], v[192:195], a[56:59]
    buffer_load_dwordx4 v[204:207], v1, s[24:27], s42 offen offset:3072
    v_mfma_f32_16x16x32_bf16 a[60:63], v[208:211], v[176:179], a[60:63]
    v_mfma_f32_16x16x32_bf16 a[64:67], v[208:211], v[180:183], a[64:67]
    v_mfma_f32_16x16x32_bf16 a[68:71], v[208:211], v[184:187], a[68:71]
    v_mfma_f32_16x16x32_bf16 a[72:75], v[208:211], v[188:191], a[72:75]
    v_mfma_f32_16x16x32_bf16 a[76:79], v[208:211], v[192:195], a[76:79]
    buffer_load_dwordx4 v[208:211], v1, s[24:27], s43 offen offset:3072
    v_mfma_f32_16x16x32_bf16 a[80:83], v[212:215], v[176:179], a[80:83]
    v_mfma_f32_16x16x32_bf16 a[84:87], v[212:215], v[180:183], a[84:87]
    v_mfma_f32_16x16x32_bf16 a[88:91], v[212:215], v[184:187], a[88:91]
    v_mfma_f32_16x16x32_bf16 a[92:95], v[212:215], v[188:191], a[92:95]
    v_mfma_f32_16x16x32_bf16 a[96:99], v[212:215], v[192:195], a[96:99]
    buffer_load_dwordx4 v[212:215], v1, s[24:27], s44 offen offset:3072
    v_mfma_f32_16x16x32_bf16 a[100:103], v[216:219], v[176:179], a[100:103]
    v_mfma_f32_16x16x32_bf16 a[104:107], v[216:219], v[180:183], a[104:107]
    v_mfma_f32_16x16x32_bf16 a[108:111], v[216:219], v[184:187], a[108:111]
    v_mfma_f32_16x16x32_bf16 a[112:115], v[216:219], v[188:191], a[112:115]
    v_mfma_f32_16x16x32_bf16 a[116:119], v[216:219], v[192:195], a[116:119]
    buffer_load_dwordx4 v[216:219], v1, s[24:27], s45 offen offset:3072
    v_mfma_f32_16x16x32_bf16 a[120:123], v[220:223], v[176:179], a[120:123]
    v_mfma_f32_16x16x32_bf16 a[124:127], v[220:223], v[180:183], a[124:127]
    v_mfma_f32_16x16x32_bf16 a[128:131], v[220:223], v[184:187], a[128:131]
    v_mfma_f32_16x16x32_bf16 a[132:135], v[220:223], v[188:191], a[132:135]
    v_mfma_f32_16x16x32_bf16 a[136:139], v[220:223], v[192:195], a[136:139]
    buffer_load_dwordx4 v[220:223], v1, s[24:27], s46 offen offset:3072
    v_mfma_f32_16x16x32_bf16 a[140:143], v[224:227], v[176:179], a[140:143]
    v_mfma_f32_16x16x32_bf16 a[144:147], v[224:227], v[180:183], a[144:147]
    v_mfma_f32_16x16x32_bf16 a[148:151], v[224:227], v[184:187], a[148:151]
    v_mfma_f32_16x16x32_bf16 a[152:155], v[224:227], v[188:191], a[152:155]
    v_mfma_f32_16x16x32_bf16 a[156:159], v[224:227], v[192:195], a[156:159]
    buffer_load_dwordx4 v[224:227], v1, s[24:27], s47 offen offset:3072
    s_waitcnt vmcnt(50)
    v_mfma_f32_16x16x32_bf16 a[160:163], v[228:231], v[176:179], a[160:163]
    buffer_load_dwordx4 v[176:179], v1, s[20:23], s32 offen offset:3072
    v_mfma_f32_16x16x32_bf16 a[164:167], v[228:231], v[180:183], a[164:167]
    buffer_load_dwordx4 v[180:183], v1, s[20:23], s33 offen offset:3072
    v_mfma_f32_16x16x32_bf16 a[168:171], v[228:231], v[184:187], a[168:171]
    buffer_load_dwordx4 v[184:187], v1, s[20:23], s34 offen offset:3072
    v_mfma_f32_16x16x32_bf16 a[172:175], v[228:231], v[188:191], a[172:175]
    buffer_load_dwordx4 v[188:191], v1, s[20:23], s35 offen offset:3072
    v_mfma_f32_16x16x32_bf16 a[176:179], v[228:231], v[192:195], a[176:179]
    buffer_load_dwordx4 v[192:195], v1, s[20:23], s36 offen offset:3072
    buffer_load_dwordx4 v[228:231], v1, s[24:27], s48 offen offset:3072
    v_add_u32 v234, 4096, v1
    s_waitcnt vmcnt(47)
    v_mfma_f32_16x16x32_bf16 a[0:3], v[28:31], v[8:11], a[0:3]
    s_waitcnt vmcnt(46)
    v_mfma_f32_16x16x32_bf16 a[4:7], v[28:31], v[12:15], a[4:7]
    s_waitcnt vmcnt(45)
    v_mfma_f32_16x16x32_bf16 a[8:11], v[28:31], v[16:19], a[8:11]
    s_waitcnt vmcnt(44)
    v_mfma_f32_16x16x32_bf16 a[12:15], v[28:31], v[20:23], a[12:15]
    s_waitcnt vmcnt(43)
    v_mfma_f32_16x16x32_bf16 a[16:19], v[28:31], v[24:27], a[16:19]
    buffer_load_dwordx4 v[28:31], v234, s[24:27], s40 offen offset:0
    v_mfma_f32_16x16x32_bf16 a[20:23], v[32:35], v[8:11], a[20:23]
    v_mfma_f32_16x16x32_bf16 a[24:27], v[32:35], v[12:15], a[24:27]
    v_mfma_f32_16x16x32_bf16 a[28:31], v[32:35], v[16:19], a[28:31]
    v_mfma_f32_16x16x32_bf16 a[32:35], v[32:35], v[20:23], a[32:35]
    v_mfma_f32_16x16x32_bf16 a[36:39], v[32:35], v[24:27], a[36:39]
    buffer_load_dwordx4 v[32:35], v234, s[24:27], s41 offen offset:0
    v_mfma_f32_16x16x32_bf16 a[40:43], v[36:39], v[8:11], a[40:43]
    v_mfma_f32_16x16x32_bf16 a[44:47], v[36:39], v[12:15], a[44:47]
    v_mfma_f32_16x16x32_bf16 a[48:51], v[36:39], v[16:19], a[48:51]
    v_mfma_f32_16x16x32_bf16 a[52:55], v[36:39], v[20:23], a[52:55]
    v_mfma_f32_16x16x32_bf16 a[56:59], v[36:39], v[24:27], a[56:59]
    buffer_load_dwordx4 v[36:39], v234, s[24:27], s42 offen offset:0
    v_mfma_f32_16x16x32_bf16 a[60:63], v[40:43], v[8:11], a[60:63]
    v_mfma_f32_16x16x32_bf16 a[64:67], v[40:43], v[12:15], a[64:67]
    v_mfma_f32_16x16x32_bf16 a[68:71], v[40:43], v[16:19], a[68:71]
    v_mfma_f32_16x16x32_bf16 a[72:75], v[40:43], v[20:23], a[72:75]
    v_mfma_f32_16x16x32_bf16 a[76:79], v[40:43], v[24:27], a[76:79]
    buffer_load_dwordx4 v[40:43], v234, s[24:27], s43 offen offset:0
    v_mfma_f32_16x16x32_bf16 a[80:83], v[44:47], v[8:11], a[80:83]
    v_mfma_f32_16x16x32_bf16 a[84:87], v[44:47], v[12:15], a[84:87]
    v_mfma_f32_16x16x32_bf16 a[88:91], v[44:47], v[16:19], a[88:91]
    v_mfma_f32_16x16x32_bf16 a[92:95], v[44:47], v[20:23], a[92:95]
    v_mfma_f32_16x16x32_bf16 a[96:99], v[44:47], v[24:27], a[96:99]
    buffer_load_dwordx4 v[44:47], v234, s[24:27], s44 offen offset:0
    v_mfma_f32_16x16x32_bf16 a[100:103], v[48:51], v[8:11], a[100:103]
    v_mfma_f32_16x16x32_bf16 a[104:107], v[48:51], v[12:15], a[104:107]
    v_mfma_f32_16x16x32_bf16 a[108:111], v[48:51], v[16:19], a[108:111]
    v_mfma_f32_16x16x32_bf16 a[112:115], v[48:51], v[20:23], a[112:115]
    v_mfma_f32_16x16x32_bf16 a[116:119], v[48:51], v[24:27], a[116:119]
    buffer_load_dwordx4 v[48:51], v234, s[24:27], s45 offen offset:0
    v_mfma_f32_16x16x32_bf16 a[120:123], v[52:55], v[8:11], a[120:123]
    v_mfma_f32_16x16x32_bf16 a[124:127], v[52:55], v[12:15], a[124:127]
    v_mfma_f32_16x16x32_bf16 a[128:131], v[52:55], v[16:19], a[128:131]
    v_mfma_f32_16x16x32_bf16 a[132:135], v[52:55], v[20:23], a[132:135]
    v_mfma_f32_16x16x32_bf16 a[136:139], v[52:55], v[24:27], a[136:139]
    buffer_load_dwordx4 v[52:55], v234, s[24:27], s46 offen offset:0
    v_mfma_f32_16x16x32_bf16 a[140:143], v[56:59], v[8:11], a[140:143]
    v_mfma_f32_16x16x32_bf16 a[144:147], v[56:59], v[12:15], a[144:147]
    v_mfma_f32_16x16x32_bf16 a[148:151], v[56:59], v[16:19], a[148:151]
    v_mfma_f32_16x16x32_bf16 a[152:155], v[56:59], v[20:23], a[152:155]
    v_mfma_f32_16x16x32_bf16 a[156:159], v[56:59], v[24:27], a[156:159]
    buffer_load_dwordx4 v[56:59], v234, s[24:27], s47 offen offset:0
    s_waitcnt vmcnt(50)
    v_mfma_f32_16x16x32_bf16 a[160:163], v[60:63], v[8:11], a[160:163]
    buffer_load_dwordx4 v[8:11], v234, s[20:23], s32 offen offset:0
    v_mfma_f32_16x16x32_bf16 a[164:167], v[60:63], v[12:15], a[164:167]
    buffer_load_dwordx4 v[12:15], v234, s[20:23], s33 offen offset:0
    v_mfma_f32_16x16x32_bf16 a[168:171], v[60:63], v[16:19], a[168:171]
    buffer_load_dwordx4 v[16:19], v234, s[20:23], s34 offen offset:0
    v_mfma_f32_16x16x32_bf16 a[172:175], v[60:63], v[20:23], a[172:175]
    buffer_load_dwordx4 v[20:23], v234, s[20:23], s35 offen offset:0
    v_mfma_f32_16x16x32_bf16 a[176:179], v[60:63], v[24:27], a[176:179]
    buffer_load_dwordx4 v[24:27], v234, s[20:23], s36 offen offset:0
    buffer_load_dwordx4 v[60:63], v234, s[24:27], s48 offen offset:0
    s_waitcnt vmcnt(47)
    v_mfma_f32_16x16x32_bf16 a[0:3], v[84:87], v[64:67], a[0:3]
    s_waitcnt vmcnt(46)
    v_mfma_f32_16x16x32_bf16 a[4:7], v[84:87], v[68:71], a[4:7]
    s_waitcnt vmcnt(45)
    v_mfma_f32_16x16x32_bf16 a[8:11], v[84:87], v[72:75], a[8:11]
    s_waitcnt vmcnt(44)
    v_mfma_f32_16x16x32_bf16 a[12:15], v[84:87], v[76:79], a[12:15]
    s_waitcnt vmcnt(43)
    v_mfma_f32_16x16x32_bf16 a[16:19], v[84:87], v[80:83], a[16:19]
    buffer_load_dwordx4 v[84:87], v234, s[24:27], s40 offen offset:1024
    v_mfma_f32_16x16x32_bf16 a[20:23], v[88:91], v[64:67], a[20:23]
    v_mfma_f32_16x16x32_bf16 a[24:27], v[88:91], v[68:71], a[24:27]
    v_mfma_f32_16x16x32_bf16 a[28:31], v[88:91], v[72:75], a[28:31]
    v_mfma_f32_16x16x32_bf16 a[32:35], v[88:91], v[76:79], a[32:35]
    v_mfma_f32_16x16x32_bf16 a[36:39], v[88:91], v[80:83], a[36:39]
    buffer_load_dwordx4 v[88:91], v234, s[24:27], s41 offen offset:1024
    v_mfma_f32_16x16x32_bf16 a[40:43], v[92:95], v[64:67], a[40:43]
    v_mfma_f32_16x16x32_bf16 a[44:47], v[92:95], v[68:71], a[44:47]
    v_mfma_f32_16x16x32_bf16 a[48:51], v[92:95], v[72:75], a[48:51]
    v_mfma_f32_16x16x32_bf16 a[52:55], v[92:95], v[76:79], a[52:55]
    v_mfma_f32_16x16x32_bf16 a[56:59], v[92:95], v[80:83], a[56:59]
    buffer_load_dwordx4 v[92:95], v234, s[24:27], s42 offen offset:1024
    v_mfma_f32_16x16x32_bf16 a[60:63], v[96:99], v[64:67], a[60:63]
    v_mfma_f32_16x16x32_bf16 a[64:67], v[96:99], v[68:71], a[64:67]
    v_mfma_f32_16x16x32_bf16 a[68:71], v[96:99], v[72:75], a[68:71]
    v_mfma_f32_16x16x32_bf16 a[72:75], v[96:99], v[76:79], a[72:75]
    v_mfma_f32_16x16x32_bf16 a[76:79], v[96:99], v[80:83], a[76:79]
    buffer_load_dwordx4 v[96:99], v234, s[24:27], s43 offen offset:1024
    v_mfma_f32_16x16x32_bf16 a[80:83], v[100:103], v[64:67], a[80:83]
    v_mfma_f32_16x16x32_bf16 a[84:87], v[100:103], v[68:71], a[84:87]
    v_mfma_f32_16x16x32_bf16 a[88:91], v[100:103], v[72:75], a[88:91]
    v_mfma_f32_16x16x32_bf16 a[92:95], v[100:103], v[76:79], a[92:95]
    v_mfma_f32_16x16x32_bf16 a[96:99], v[100:103], v[80:83], a[96:99]
    buffer_load_dwordx4 v[100:103], v234, s[24:27], s44 offen offset:1024
    v_mfma_f32_16x16x32_bf16 a[100:103], v[104:107], v[64:67], a[100:103]
    v_mfma_f32_16x16x32_bf16 a[104:107], v[104:107], v[68:71], a[104:107]
    v_mfma_f32_16x16x32_bf16 a[108:111], v[104:107], v[72:75], a[108:111]
    v_mfma_f32_16x16x32_bf16 a[112:115], v[104:107], v[76:79], a[112:115]
    v_mfma_f32_16x16x32_bf16 a[116:119], v[104:107], v[80:83], a[116:119]
    buffer_load_dwordx4 v[104:107], v234, s[24:27], s45 offen offset:1024
    v_mfma_f32_16x16x32_bf16 a[120:123], v[108:111], v[64:67], a[120:123]
    v_mfma_f32_16x16x32_bf16 a[124:127], v[108:111], v[68:71], a[124:127]
    v_mfma_f32_16x16x32_bf16 a[128:131], v[108:111], v[72:75], a[128:131]
    v_mfma_f32_16x16x32_bf16 a[132:135], v[108:111], v[76:79], a[132:135]
    v_mfma_f32_16x16x32_bf16 a[136:139], v[108:111], v[80:83], a[136:139]
    buffer_load_dwordx4 v[108:111], v234, s[24:27], s46 offen offset:1024
    v_mfma_f32_16x16x32_bf16 a[140:143], v[112:115], v[64:67], a[140:143]
    v_mfma_f32_16x16x32_bf16 a[144:147], v[112:115], v[68:71], a[144:147]
    v_mfma_f32_16x16x32_bf16 a[148:151], v[112:115], v[72:75], a[148:151]
    v_mfma_f32_16x16x32_bf16 a[152:155], v[112:115], v[76:79], a[152:155]
    v_mfma_f32_16x16x32_bf16 a[156:159], v[112:115], v[80:83], a[156:159]
    buffer_load_dwordx4 v[112:115], v234, s[24:27], s47 offen offset:1024
    s_waitcnt vmcnt(50)
    v_mfma_f32_16x16x32_bf16 a[160:163], v[116:119], v[64:67], a[160:163]
    buffer_load_dwordx4 v[64:67], v234, s[20:23], s32 offen offset:1024
    v_mfma_f32_16x16x32_bf16 a[164:167], v[116:119], v[68:71], a[164:167]
    buffer_load_dwordx4 v[68:71], v234, s[20:23], s33 offen offset:1024
    v_mfma_f32_16x16x32_bf16 a[168:171], v[116:119], v[72:75], a[168:171]
    buffer_load_dwordx4 v[72:75], v234, s[20:23], s34 offen offset:1024
    v_mfma_f32_16x16x32_bf16 a[172:175], v[116:119], v[76:79], a[172:175]
    buffer_load_dwordx4 v[76:79], v234, s[20:23], s35 offen offset:1024
    v_mfma_f32_16x16x32_bf16 a[176:179], v[116:119], v[80:83], a[176:179]
    buffer_load_dwordx4 v[80:83], v234, s[20:23], s36 offen offset:1024
    buffer_load_dwordx4 v[116:119], v234, s[24:27], s48 offen offset:1024
    s_waitcnt vmcnt(47)
    v_mfma_f32_16x16x32_bf16 a[0:3], v[140:143], v[120:123], a[0:3]
    s_waitcnt vmcnt(46)
    v_mfma_f32_16x16x32_bf16 a[4:7], v[140:143], v[124:127], a[4:7]
    s_waitcnt vmcnt(45)
    v_mfma_f32_16x16x32_bf16 a[8:11], v[140:143], v[128:131], a[8:11]
    s_waitcnt vmcnt(44)
    v_mfma_f32_16x16x32_bf16 a[12:15], v[140:143], v[132:135], a[12:15]
    s_waitcnt vmcnt(43)
    v_mfma_f32_16x16x32_bf16 a[16:19], v[140:143], v[136:139], a[16:19]
    buffer_load_dwordx4 v[140:143], v234, s[24:27], s40 offen offset:2048
    v_mfma_f32_16x16x32_bf16 a[20:23], v[144:147], v[120:123], a[20:23]
    v_mfma_f32_16x16x32_bf16 a[24:27], v[144:147], v[124:127], a[24:27]
    v_mfma_f32_16x16x32_bf16 a[28:31], v[144:147], v[128:131], a[28:31]
    v_mfma_f32_16x16x32_bf16 a[32:35], v[144:147], v[132:135], a[32:35]
    v_mfma_f32_16x16x32_bf16 a[36:39], v[144:147], v[136:139], a[36:39]
    buffer_load_dwordx4 v[144:147], v234, s[24:27], s41 offen offset:2048
    v_mfma_f32_16x16x32_bf16 a[40:43], v[148:151], v[120:123], a[40:43]
    v_mfma_f32_16x16x32_bf16 a[44:47], v[148:151], v[124:127], a[44:47]
    v_mfma_f32_16x16x32_bf16 a[48:51], v[148:151], v[128:131], a[48:51]
    v_mfma_f32_16x16x32_bf16 a[52:55], v[148:151], v[132:135], a[52:55]
    v_mfma_f32_16x16x32_bf16 a[56:59], v[148:151], v[136:139], a[56:59]
    buffer_load_dwordx4 v[148:151], v234, s[24:27], s42 offen offset:2048
    v_mfma_f32_16x16x32_bf16 a[60:63], v[152:155], v[120:123], a[60:63]
    v_mfma_f32_16x16x32_bf16 a[64:67], v[152:155], v[124:127], a[64:67]
    v_mfma_f32_16x16x32_bf16 a[68:71], v[152:155], v[128:131], a[68:71]
    v_mfma_f32_16x16x32_bf16 a[72:75], v[152:155], v[132:135], a[72:75]
    v_mfma_f32_16x16x32_bf16 a[76:79], v[152:155], v[136:139], a[76:79]
    buffer_load_dwordx4 v[152:155], v234, s[24:27], s43 offen offset:2048
    v_mfma_f32_16x16x32_bf16 a[80:83], v[156:159], v[120:123], a[80:83]
    v_mfma_f32_16x16x32_bf16 a[84:87], v[156:159], v[124:127], a[84:87]
    v_mfma_f32_16x16x32_bf16 a[88:91], v[156:159], v[128:131], a[88:91]
    v_mfma_f32_16x16x32_bf16 a[92:95], v[156:159], v[132:135], a[92:95]
    v_mfma_f32_16x16x32_bf16 a[96:99], v[156:159], v[136:139], a[96:99]
    buffer_load_dwordx4 v[156:159], v234, s[24:27], s44 offen offset:2048
    v_mfma_f32_16x16x32_bf16 a[100:103], v[160:163], v[120:123], a[100:103]
    v_mfma_f32_16x16x32_bf16 a[104:107], v[160:163], v[124:127], a[104:107]
    v_mfma_f32_16x16x32_bf16 a[108:111], v[160:163], v[128:131], a[108:111]
    v_mfma_f32_16x16x32_bf16 a[112:115], v[160:163], v[132:135], a[112:115]
    v_mfma_f32_16x16x32_bf16 a[116:119], v[160:163], v[136:139], a[116:119]
    buffer_load_dwordx4 v[160:163], v234, s[24:27], s45 offen offset:2048
    v_mfma_f32_16x16x32_bf16 a[120:123], v[164:167], v[120:123], a[120:123]
    v_mfma_f32_16x16x32_bf16 a[124:127], v[164:167], v[124:127], a[124:127]
    v_mfma_f32_16x16x32_bf16 a[128:131], v[164:167], v[128:131], a[128:131]
    v_mfma_f32_16x16x32_bf16 a[132:135], v[164:167], v[132:135], a[132:135]
    v_mfma_f32_16x16x32_bf16 a[136:139], v[164:167], v[136:139], a[136:139]
    buffer_load_dwordx4 v[164:167], v234, s[24:27], s46 offen offset:2048
    v_mfma_f32_16x16x32_bf16 a[140:143], v[168:171], v[120:123], a[140:143]
    v_mfma_f32_16x16x32_bf16 a[144:147], v[168:171], v[124:127], a[144:147]
    v_mfma_f32_16x16x32_bf16 a[148:151], v[168:171], v[128:131], a[148:151]
    v_mfma_f32_16x16x32_bf16 a[152:155], v[168:171], v[132:135], a[152:155]
    v_mfma_f32_16x16x32_bf16 a[156:159], v[168:171], v[136:139], a[156:159]
    buffer_load_dwordx4 v[168:171], v234, s[24:27], s47 offen offset:2048
    s_waitcnt vmcnt(50)
    v_mfma_f32_16x16x32_bf16 a[160:163], v[172:175], v[120:123], a[160:163]
    buffer_load_dwordx4 v[120:123], v234, s[20:23], s32 offen offset:2048
    v_mfma_f32_16x16x32_bf16 a[164:167], v[172:175], v[124:127], a[164:167]
    buffer_load_dwordx4 v[124:127], v234, s[20:23], s33 offen offset:2048
    v_mfma_f32_16x16x32_bf16 a[168:171], v[172:175], v[128:131], a[168:171]
    buffer_load_dwordx4 v[128:131], v234, s[20:23], s34 offen offset:2048
    v_mfma_f32_16x16x32_bf16 a[172:175], v[172:175], v[132:135], a[172:175]
    buffer_load_dwordx4 v[132:135], v234, s[20:23], s35 offen offset:2048
    v_mfma_f32_16x16x32_bf16 a[176:179], v[172:175], v[136:139], a[176:179]
    buffer_load_dwordx4 v[136:139], v234, s[20:23], s36 offen offset:2048
    buffer_load_dwordx4 v[172:175], v234, s[24:27], s48 offen offset:2048
    s_waitcnt vmcnt(47)
    v_mfma_f32_16x16x32_bf16 a[0:3], v[196:199], v[176:179], a[0:3]
    s_waitcnt vmcnt(46)
    v_mfma_f32_16x16x32_bf16 a[4:7], v[196:199], v[180:183], a[4:7]
    s_waitcnt vmcnt(45)
    v_mfma_f32_16x16x32_bf16 a[8:11], v[196:199], v[184:187], a[8:11]
    s_waitcnt vmcnt(44)
    v_mfma_f32_16x16x32_bf16 a[12:15], v[196:199], v[188:191], a[12:15]
    s_waitcnt vmcnt(43)
    v_mfma_f32_16x16x32_bf16 a[16:19], v[196:199], v[192:195], a[16:19]
    buffer_load_dwordx4 v[196:199], v234, s[24:27], s40 offen offset:3072
    v_mfma_f32_16x16x32_bf16 a[20:23], v[200:203], v[176:179], a[20:23]
    v_mfma_f32_16x16x32_bf16 a[24:27], v[200:203], v[180:183], a[24:27]
    v_mfma_f32_16x16x32_bf16 a[28:31], v[200:203], v[184:187], a[28:31]
    v_mfma_f32_16x16x32_bf16 a[32:35], v[200:203], v[188:191], a[32:35]
    v_mfma_f32_16x16x32_bf16 a[36:39], v[200:203], v[192:195], a[36:39]
    buffer_load_dwordx4 v[200:203], v234, s[24:27], s41 offen offset:3072
    v_mfma_f32_16x16x32_bf16 a[40:43], v[204:207], v[176:179], a[40:43]
    v_mfma_f32_16x16x32_bf16 a[44:47], v[204:207], v[180:183], a[44:47]
    v_mfma_f32_16x16x32_bf16 a[48:51], v[204:207], v[184:187], a[48:51]
    v_mfma_f32_16x16x32_bf16 a[52:55], v[204:207], v[188:191], a[52:55]
    v_mfma_f32_16x16x32_bf16 a[56:59], v[204:207], v[192:195], a[56:59]
    buffer_load_dwordx4 v[204:207], v234, s[24:27], s42 offen offset:3072
    v_mfma_f32_16x16x32_bf16 a[60:63], v[208:211], v[176:179], a[60:63]
    v_mfma_f32_16x16x32_bf16 a[64:67], v[208:211], v[180:183], a[64:67]
    v_mfma_f32_16x16x32_bf16 a[68:71], v[208:211], v[184:187], a[68:71]
    v_mfma_f32_16x16x32_bf16 a[72:75], v[208:211], v[188:191], a[72:75]
    v_mfma_f32_16x16x32_bf16 a[76:79], v[208:211], v[192:195], a[76:79]
    buffer_load_dwordx4 v[208:211], v234, s[24:27], s43 offen offset:3072
    v_mfma_f32_16x16x32_bf16 a[80:83], v[212:215], v[176:179], a[80:83]
    v_mfma_f32_16x16x32_bf16 a[84:87], v[212:215], v[180:183], a[84:87]
    v_mfma_f32_16x16x32_bf16 a[88:91], v[212:215], v[184:187], a[88:91]
    v_mfma_f32_16x16x32_bf16 a[92:95], v[212:215], v[188:191], a[92:95]
    v_mfma_f32_16x16x32_bf16 a[96:99], v[212:215], v[192:195], a[96:99]
    buffer_load_dwordx4 v[212:215], v234, s[24:27], s44 offen offset:3072
    v_mfma_f32_16x16x32_bf16 a[100:103], v[216:219], v[176:179], a[100:103]
    v_mfma_f32_16x16x32_bf16 a[104:107], v[216:219], v[180:183], a[104:107]
    v_mfma_f32_16x16x32_bf16 a[108:111], v[216:219], v[184:187], a[108:111]
    v_mfma_f32_16x16x32_bf16 a[112:115], v[216:219], v[188:191], a[112:115]
    v_mfma_f32_16x16x32_bf16 a[116:119], v[216:219], v[192:195], a[116:119]
    buffer_load_dwordx4 v[216:219], v234, s[24:27], s45 offen offset:3072
    v_mfma_f32_16x16x32_bf16 a[120:123], v[220:223], v[176:179], a[120:123]
    v_mfma_f32_16x16x32_bf16 a[124:127], v[220:223], v[180:183], a[124:127]
    v_mfma_f32_16x16x32_bf16 a[128:131], v[220:223], v[184:187], a[128:131]
    v_mfma_f32_16x16x32_bf16 a[132:135], v[220:223], v[188:191], a[132:135]
    v_mfma_f32_16x16x32_bf16 a[136:139], v[220:223], v[192:195], a[136:139]
    buffer_load_dwordx4 v[220:223], v234, s[24:27], s46 offen offset:3072
    v_mfma_f32_16x16x32_bf16 a[140:143], v[224:227], v[176:179], a[140:143]
    v_mfma_f32_16x16x32_bf16 a[144:147], v[224:227], v[180:183], a[144:147]
    v_mfma_f32_16x16x32_bf16 a[148:151], v[224:227], v[184:187], a[148:151]
    v_mfma_f32_16x16x32_bf16 a[152:155], v[224:227], v[188:191], a[152:155]
    v_mfma_f32_16x16x32_bf16 a[156:159], v[224:227], v[192:195], a[156:159]
    buffer_load_dwordx4 v[224:227], v234, s[24:27], s47 offen offset:3072
    s_waitcnt vmcnt(50)
    v_mfma_f32_16x16x32_bf16 a[160:163], v[228:231], v[176:179], a[160:163]
    buffer_load_dwordx4 v[176:179], v234, s[20:23], s32 offen offset:3072
    v_mfma_f32_16x16x32_bf16 a[164:167], v[228:231], v[180:183], a[164:167]
    buffer_load_dwordx4 v[180:183], v234, s[20:23], s33 offen offset:3072
    v_mfma_f32_16x16x32_bf16 a[168:171], v[228:231], v[184:187], a[168:171]
    buffer_load_dwordx4 v[184:187], v234, s[20:23], s34 offen offset:3072
    v_mfma_f32_16x16x32_bf16 a[172:175], v[228:231], v[188:191], a[172:175]
    buffer_load_dwordx4 v[188:191], v234, s[20:23], s35 offen offset:3072
    v_mfma_f32_16x16x32_bf16 a[176:179], v[228:231], v[192:195], a[176:179]
    buffer_load_dwordx4 v[192:195], v234, s[20:23], s36 offen offset:3072
    buffer_load_dwordx4 v[228:231], v234, s[24:27], s48 offen offset:3072
    v_add_u32 v1, 4096, v234
    s_waitcnt vmcnt(47)
    v_mfma_f32_16x16x32_bf16 a[0:3], v[28:31], v[8:11], a[0:3]
    s_waitcnt vmcnt(46)
    v_mfma_f32_16x16x32_bf16 a[4:7], v[28:31], v[12:15], a[4:7]
    s_waitcnt vmcnt(45)
    v_mfma_f32_16x16x32_bf16 a[8:11], v[28:31], v[16:19], a[8:11]
    s_waitcnt vmcnt(44)
    v_mfma_f32_16x16x32_bf16 a[12:15], v[28:31], v[20:23], a[12:15]
    s_waitcnt vmcnt(43)
    v_mfma_f32_16x16x32_bf16 a[16:19], v[28:31], v[24:27], a[16:19]
    buffer_load_dwordx4 v[28:31], v1, s[24:27], s40 offen offset:0
    v_mfma_f32_16x16x32_bf16 a[20:23], v[32:35], v[8:11], a[20:23]
    v_mfma_f32_16x16x32_bf16 a[24:27], v[32:35], v[12:15], a[24:27]
    v_mfma_f32_16x16x32_bf16 a[28:31], v[32:35], v[16:19], a[28:31]
    v_mfma_f32_16x16x32_bf16 a[32:35], v[32:35], v[20:23], a[32:35]
    v_mfma_f32_16x16x32_bf16 a[36:39], v[32:35], v[24:27], a[36:39]
    buffer_load_dwordx4 v[32:35], v1, s[24:27], s41 offen offset:0
    v_mfma_f32_16x16x32_bf16 a[40:43], v[36:39], v[8:11], a[40:43]
    v_mfma_f32_16x16x32_bf16 a[44:47], v[36:39], v[12:15], a[44:47]
    v_mfma_f32_16x16x32_bf16 a[48:51], v[36:39], v[16:19], a[48:51]
    v_mfma_f32_16x16x32_bf16 a[52:55], v[36:39], v[20:23], a[52:55]
    v_mfma_f32_16x16x32_bf16 a[56:59], v[36:39], v[24:27], a[56:59]
    buffer_load_dwordx4 v[36:39], v1, s[24:27], s42 offen offset:0
    v_mfma_f32_16x16x32_bf16 a[60:63], v[40:43], v[8:11], a[60:63]
    v_mfma_f32_16x16x32_bf16 a[64:67], v[40:43], v[12:15], a[64:67]
    v_mfma_f32_16x16x32_bf16 a[68:71], v[40:43], v[16:19], a[68:71]
    v_mfma_f32_16x16x32_bf16 a[72:75], v[40:43], v[20:23], a[72:75]
    v_mfma_f32_16x16x32_bf16 a[76:79], v[40:43], v[24:27], a[76:79]
    buffer_load_dwordx4 v[40:43], v1, s[24:27], s43 offen offset:0
    v_mfma_f32_16x16x32_bf16 a[80:83], v[44:47], v[8:11], a[80:83]
    v_mfma_f32_16x16x32_bf16 a[84:87], v[44:47], v[12:15], a[84:87]
    v_mfma_f32_16x16x32_bf16 a[88:91], v[44:47], v[16:19], a[88:91]
    v_mfma_f32_16x16x32_bf16 a[92:95], v[44:47], v[20:23], a[92:95]
    v_mfma_f32_16x16x32_bf16 a[96:99], v[44:47], v[24:27], a[96:99]
    buffer_load_dwordx4 v[44:47], v1, s[24:27], s44 offen offset:0
    v_mfma_f32_16x16x32_bf16 a[100:103], v[48:51], v[8:11], a[100:103]
    v_mfma_f32_16x16x32_bf16 a[104:107], v[48:51], v[12:15], a[104:107]
    v_mfma_f32_16x16x32_bf16 a[108:111], v[48:51], v[16:19], a[108:111]
    v_mfma_f32_16x16x32_bf16 a[112:115], v[48:51], v[20:23], a[112:115]
    v_mfma_f32_16x16x32_bf16 a[116:119], v[48:51], v[24:27], a[116:119]
    buffer_load_dwordx4 v[48:51], v1, s[24:27], s45 offen offset:0
    v_mfma_f32_16x16x32_bf16 a[120:123], v[52:55], v[8:11], a[120:123]
    v_mfma_f32_16x16x32_bf16 a[124:127], v[52:55], v[12:15], a[124:127]
    v_mfma_f32_16x16x32_bf16 a[128:131], v[52:55], v[16:19], a[128:131]
    v_mfma_f32_16x16x32_bf16 a[132:135], v[52:55], v[20:23], a[132:135]
    v_mfma_f32_16x16x32_bf16 a[136:139], v[52:55], v[24:27], a[136:139]
    buffer_load_dwordx4 v[52:55], v1, s[24:27], s46 offen offset:0
    v_mfma_f32_16x16x32_bf16 a[140:143], v[56:59], v[8:11], a[140:143]
    v_mfma_f32_16x16x32_bf16 a[144:147], v[56:59], v[12:15], a[144:147]
    v_mfma_f32_16x16x32_bf16 a[148:151], v[56:59], v[16:19], a[148:151]
    v_mfma_f32_16x16x32_bf16 a[152:155], v[56:59], v[20:23], a[152:155]
    v_mfma_f32_16x16x32_bf16 a[156:159], v[56:59], v[24:27], a[156:159]
    buffer_load_dwordx4 v[56:59], v1, s[24:27], s47 offen offset:0
    s_waitcnt vmcnt(50)
    v_mfma_f32_16x16x32_bf16 a[160:163], v[60:63], v[8:11], a[160:163]
    buffer_load_dwordx4 v[8:11], v1, s[20:23], s32 offen offset:0
    v_mfma_f32_16x16x32_bf16 a[164:167], v[60:63], v[12:15], a[164:167]
    buffer_load_dwordx4 v[12:15], v1, s[20:23], s33 offen offset:0
    v_mfma_f32_16x16x32_bf16 a[168:171], v[60:63], v[16:19], a[168:171]
    buffer_load_dwordx4 v[16:19], v1, s[20:23], s34 offen offset:0
    v_mfma_f32_16x16x32_bf16 a[172:175], v[60:63], v[20:23], a[172:175]
    buffer_load_dwordx4 v[20:23], v1, s[20:23], s35 offen offset:0
    v_mfma_f32_16x16x32_bf16 a[176:179], v[60:63], v[24:27], a[176:179]
    buffer_load_dwordx4 v[24:27], v1, s[20:23], s36 offen offset:0
    buffer_load_dwordx4 v[60:63], v1, s[24:27], s48 offen offset:0
    s_waitcnt vmcnt(47)
    v_mfma_f32_16x16x32_bf16 a[0:3], v[84:87], v[64:67], a[0:3]
    s_waitcnt vmcnt(46)
    v_mfma_f32_16x16x32_bf16 a[4:7], v[84:87], v[68:71], a[4:7]
    s_waitcnt vmcnt(45)
    v_mfma_f32_16x16x32_bf16 a[8:11], v[84:87], v[72:75], a[8:11]
    s_waitcnt vmcnt(44)
    v_mfma_f32_16x16x32_bf16 a[12:15], v[84:87], v[76:79], a[12:15]
    s_waitcnt vmcnt(43)
    v_mfma_f32_16x16x32_bf16 a[16:19], v[84:87], v[80:83], a[16:19]
    buffer_load_dwordx4 v[84:87], v1, s[24:27], s40 offen offset:1024
    v_mfma_f32_16x16x32_bf16 a[20:23], v[88:91], v[64:67], a[20:23]
    v_mfma_f32_16x16x32_bf16 a[24:27], v[88:91], v[68:71], a[24:27]
    v_mfma_f32_16x16x32_bf16 a[28:31], v[88:91], v[72:75], a[28:31]
    v_mfma_f32_16x16x32_bf16 a[32:35], v[88:91], v[76:79], a[32:35]
    v_mfma_f32_16x16x32_bf16 a[36:39], v[88:91], v[80:83], a[36:39]
    buffer_load_dwordx4 v[88:91], v1, s[24:27], s41 offen offset:1024
    v_mfma_f32_16x16x32_bf16 a[40:43], v[92:95], v[64:67], a[40:43]
    v_mfma_f32_16x16x32_bf16 a[44:47], v[92:95], v[68:71], a[44:47]
    v_mfma_f32_16x16x32_bf16 a[48:51], v[92:95], v[72:75], a[48:51]
    v_mfma_f32_16x16x32_bf16 a[52:55], v[92:95], v[76:79], a[52:55]
    v_mfma_f32_16x16x32_bf16 a[56:59], v[92:95], v[80:83], a[56:59]
    buffer_load_dwordx4 v[92:95], v1, s[24:27], s42 offen offset:1024
    v_mfma_f32_16x16x32_bf16 a[60:63], v[96:99], v[64:67], a[60:63]
    v_mfma_f32_16x16x32_bf16 a[64:67], v[96:99], v[68:71], a[64:67]
    v_mfma_f32_16x16x32_bf16 a[68:71], v[96:99], v[72:75], a[68:71]
    v_mfma_f32_16x16x32_bf16 a[72:75], v[96:99], v[76:79], a[72:75]
    v_mfma_f32_16x16x32_bf16 a[76:79], v[96:99], v[80:83], a[76:79]
    buffer_load_dwordx4 v[96:99], v1, s[24:27], s43 offen offset:1024
    v_mfma_f32_16x16x32_bf16 a[80:83], v[100:103], v[64:67], a[80:83]
    v_mfma_f32_16x16x32_bf16 a[84:87], v[100:103], v[68:71], a[84:87]
    v_mfma_f32_16x16x32_bf16 a[88:91], v[100:103], v[72:75], a[88:91]
    v_mfma_f32_16x16x32_bf16 a[92:95], v[100:103], v[76:79], a[92:95]
    v_mfma_f32_16x16x32_bf16 a[96:99], v[100:103], v[80:83], a[96:99]
    buffer_load_dwordx4 v[100:103], v1, s[24:27], s44 offen offset:1024
    v_mfma_f32_16x16x32_bf16 a[100:103], v[104:107], v[64:67], a[100:103]
    v_mfma_f32_16x16x32_bf16 a[104:107], v[104:107], v[68:71], a[104:107]
    v_mfma_f32_16x16x32_bf16 a[108:111], v[104:107], v[72:75], a[108:111]
    v_mfma_f32_16x16x32_bf16 a[112:115], v[104:107], v[76:79], a[112:115]
    v_mfma_f32_16x16x32_bf16 a[116:119], v[104:107], v[80:83], a[116:119]
    buffer_load_dwordx4 v[104:107], v1, s[24:27], s45 offen offset:1024
    v_mfma_f32_16x16x32_bf16 a[120:123], v[108:111], v[64:67], a[120:123]
    v_mfma_f32_16x16x32_bf16 a[124:127], v[108:111], v[68:71], a[124:127]
    v_mfma_f32_16x16x32_bf16 a[128:131], v[108:111], v[72:75], a[128:131]
    v_mfma_f32_16x16x32_bf16 a[132:135], v[108:111], v[76:79], a[132:135]
    v_mfma_f32_16x16x32_bf16 a[136:139], v[108:111], v[80:83], a[136:139]
    buffer_load_dwordx4 v[108:111], v1, s[24:27], s46 offen offset:1024
    v_mfma_f32_16x16x32_bf16 a[140:143], v[112:115], v[64:67], a[140:143]
    v_mfma_f32_16x16x32_bf16 a[144:147], v[112:115], v[68:71], a[144:147]
    v_mfma_f32_16x16x32_bf16 a[148:151], v[112:115], v[72:75], a[148:151]
    v_mfma_f32_16x16x32_bf16 a[152:155], v[112:115], v[76:79], a[152:155]
    v_mfma_f32_16x16x32_bf16 a[156:159], v[112:115], v[80:83], a[156:159]
    buffer_load_dwordx4 v[112:115], v1, s[24:27], s47 offen offset:1024
    s_waitcnt vmcnt(50)
    v_mfma_f32_16x16x32_bf16 a[160:163], v[116:119], v[64:67], a[160:163]
    buffer_load_dwordx4 v[64:67], v1, s[20:23], s32 offen offset:1024
    v_mfma_f32_16x16x32_bf16 a[164:167], v[116:119], v[68:71], a[164:167]
    buffer_load_dwordx4 v[68:71], v1, s[20:23], s33 offen offset:1024
    v_mfma_f32_16x16x32_bf16 a[168:171], v[116:119], v[72:75], a[168:171]
    buffer_load_dwordx4 v[72:75], v1, s[20:23], s34 offen offset:1024
    v_mfma_f32_16x16x32_bf16 a[172:175], v[116:119], v[76:79], a[172:175]
    buffer_load_dwordx4 v[76:79], v1, s[20:23], s35 offen offset:1024
    v_mfma_f32_16x16x32_bf16 a[176:179], v[116:119], v[80:83], a[176:179]
    buffer_load_dwordx4 v[80:83], v1, s[20:23], s36 offen offset:1024
    buffer_load_dwordx4 v[116:119], v1, s[24:27], s48 offen offset:1024
    s_waitcnt vmcnt(47)
    v_mfma_f32_16x16x32_bf16 a[0:3], v[140:143], v[120:123], a[0:3]
    s_waitcnt vmcnt(46)
    v_mfma_f32_16x16x32_bf16 a[4:7], v[140:143], v[124:127], a[4:7]
    s_waitcnt vmcnt(45)
    v_mfma_f32_16x16x32_bf16 a[8:11], v[140:143], v[128:131], a[8:11]
    s_waitcnt vmcnt(44)
    v_mfma_f32_16x16x32_bf16 a[12:15], v[140:143], v[132:135], a[12:15]
    s_waitcnt vmcnt(43)
    v_mfma_f32_16x16x32_bf16 a[16:19], v[140:143], v[136:139], a[16:19]
    buffer_load_dwordx4 v[140:143], v1, s[24:27], s40 offen offset:2048
    v_mfma_f32_16x16x32_bf16 a[20:23], v[144:147], v[120:123], a[20:23]
    v_mfma_f32_16x16x32_bf16 a[24:27], v[144:147], v[124:127], a[24:27]
    v_mfma_f32_16x16x32_bf16 a[28:31], v[144:147], v[128:131], a[28:31]
    v_mfma_f32_16x16x32_bf16 a[32:35], v[144:147], v[132:135], a[32:35]
    v_mfma_f32_16x16x32_bf16 a[36:39], v[144:147], v[136:139], a[36:39]
    buffer_load_dwordx4 v[144:147], v1, s[24:27], s41 offen offset:2048
    v_mfma_f32_16x16x32_bf16 a[40:43], v[148:151], v[120:123], a[40:43]
    v_mfma_f32_16x16x32_bf16 a[44:47], v[148:151], v[124:127], a[44:47]
    v_mfma_f32_16x16x32_bf16 a[48:51], v[148:151], v[128:131], a[48:51]
    v_mfma_f32_16x16x32_bf16 a[52:55], v[148:151], v[132:135], a[52:55]
    v_mfma_f32_16x16x32_bf16 a[56:59], v[148:151], v[136:139], a[56:59]
    buffer_load_dwordx4 v[148:151], v1, s[24:27], s42 offen offset:2048
    v_mfma_f32_16x16x32_bf16 a[60:63], v[152:155], v[120:123], a[60:63]
    v_mfma_f32_16x16x32_bf16 a[64:67], v[152:155], v[124:127], a[64:67]
    v_mfma_f32_16x16x32_bf16 a[68:71], v[152:155], v[128:131], a[68:71]
    v_mfma_f32_16x16x32_bf16 a[72:75], v[152:155], v[132:135], a[72:75]
    v_mfma_f32_16x16x32_bf16 a[76:79], v[152:155], v[136:139], a[76:79]
    buffer_load_dwordx4 v[152:155], v1, s[24:27], s43 offen offset:2048
    v_mfma_f32_16x16x32_bf16 a[80:83], v[156:159], v[120:123], a[80:83]
    v_mfma_f32_16x16x32_bf16 a[84:87], v[156:159], v[124:127], a[84:87]
    v_mfma_f32_16x16x32_bf16 a[88:91], v[156:159], v[128:131], a[88:91]
    v_mfma_f32_16x16x32_bf16 a[92:95], v[156:159], v[132:135], a[92:95]
    v_mfma_f32_16x16x32_bf16 a[96:99], v[156:159], v[136:139], a[96:99]
    buffer_load_dwordx4 v[156:159], v1, s[24:27], s44 offen offset:2048
    v_mfma_f32_16x16x32_bf16 a[100:103], v[160:163], v[120:123], a[100:103]
    v_mfma_f32_16x16x32_bf16 a[104:107], v[160:163], v[124:127], a[104:107]
    v_mfma_f32_16x16x32_bf16 a[108:111], v[160:163], v[128:131], a[108:111]
    v_mfma_f32_16x16x32_bf16 a[112:115], v[160:163], v[132:135], a[112:115]
    v_mfma_f32_16x16x32_bf16 a[116:119], v[160:163], v[136:139], a[116:119]
    buffer_load_dwordx4 v[160:163], v1, s[24:27], s45 offen offset:2048
    v_mfma_f32_16x16x32_bf16 a[120:123], v[164:167], v[120:123], a[120:123]
    v_mfma_f32_16x16x32_bf16 a[124:127], v[164:167], v[124:127], a[124:127]
    v_mfma_f32_16x16x32_bf16 a[128:131], v[164:167], v[128:131], a[128:131]
    v_mfma_f32_16x16x32_bf16 a[132:135], v[164:167], v[132:135], a[132:135]
    v_mfma_f32_16x16x32_bf16 a[136:139], v[164:167], v[136:139], a[136:139]
    buffer_load_dwordx4 v[164:167], v1, s[24:27], s46 offen offset:2048
    v_mfma_f32_16x16x32_bf16 a[140:143], v[168:171], v[120:123], a[140:143]
    v_mfma_f32_16x16x32_bf16 a[144:147], v[168:171], v[124:127], a[144:147]
    v_mfma_f32_16x16x32_bf16 a[148:151], v[168:171], v[128:131], a[148:151]
    v_mfma_f32_16x16x32_bf16 a[152:155], v[168:171], v[132:135], a[152:155]
    v_mfma_f32_16x16x32_bf16 a[156:159], v[168:171], v[136:139], a[156:159]
    buffer_load_dwordx4 v[168:171], v1, s[24:27], s47 offen offset:2048
    s_waitcnt vmcnt(50)
    v_mfma_f32_16x16x32_bf16 a[160:163], v[172:175], v[120:123], a[160:163]
    buffer_load_dwordx4 v[120:123], v1, s[20:23], s32 offen offset:2048
    v_mfma_f32_16x16x32_bf16 a[164:167], v[172:175], v[124:127], a[164:167]
    buffer_load_dwordx4 v[124:127], v1, s[20:23], s33 offen offset:2048
    v_mfma_f32_16x16x32_bf16 a[168:171], v[172:175], v[128:131], a[168:171]
    buffer_load_dwordx4 v[128:131], v1, s[20:23], s34 offen offset:2048
    v_mfma_f32_16x16x32_bf16 a[172:175], v[172:175], v[132:135], a[172:175]
    buffer_load_dwordx4 v[132:135], v1, s[20:23], s35 offen offset:2048
    v_mfma_f32_16x16x32_bf16 a[176:179], v[172:175], v[136:139], a[176:179]
    buffer_load_dwordx4 v[136:139], v1, s[20:23], s36 offen offset:2048
    buffer_load_dwordx4 v[172:175], v1, s[24:27], s48 offen offset:2048
    s_waitcnt vmcnt(47)
    v_mfma_f32_16x16x32_bf16 a[0:3], v[196:199], v[176:179], a[0:3]
    s_waitcnt vmcnt(46)
    v_mfma_f32_16x16x32_bf16 a[4:7], v[196:199], v[180:183], a[4:7]
    s_waitcnt vmcnt(45)
    v_mfma_f32_16x16x32_bf16 a[8:11], v[196:199], v[184:187], a[8:11]
    s_waitcnt vmcnt(44)
    v_mfma_f32_16x16x32_bf16 a[12:15], v[196:199], v[188:191], a[12:15]
    s_waitcnt vmcnt(43)
    v_mfma_f32_16x16x32_bf16 a[16:19], v[196:199], v[192:195], a[16:19]
    buffer_load_dwordx4 v[196:199], v1, s[24:27], s40 offen offset:3072
    v_mfma_f32_16x16x32_bf16 a[20:23], v[200:203], v[176:179], a[20:23]
    v_mfma_f32_16x16x32_bf16 a[24:27], v[200:203], v[180:183], a[24:27]
    v_mfma_f32_16x16x32_bf16 a[28:31], v[200:203], v[184:187], a[28:31]
    v_mfma_f32_16x16x32_bf16 a[32:35], v[200:203], v[188:191], a[32:35]
    v_mfma_f32_16x16x32_bf16 a[36:39], v[200:203], v[192:195], a[36:39]
    buffer_load_dwordx4 v[200:203], v1, s[24:27], s41 offen offset:3072
    v_mfma_f32_16x16x32_bf16 a[40:43], v[204:207], v[176:179], a[40:43]
    v_mfma_f32_16x16x32_bf16 a[44:47], v[204:207], v[180:183], a[44:47]
    v_mfma_f32_16x16x32_bf16 a[48:51], v[204:207], v[184:187], a[48:51]
    v_mfma_f32_16x16x32_bf16 a[52:55], v[204:207], v[188:191], a[52:55]
    v_mfma_f32_16x16x32_bf16 a[56:59], v[204:207], v[192:195], a[56:59]
    buffer_load_dwordx4 v[204:207], v1, s[24:27], s42 offen offset:3072
    v_mfma_f32_16x16x32_bf16 a[60:63], v[208:211], v[176:179], a[60:63]
    v_mfma_f32_16x16x32_bf16 a[64:67], v[208:211], v[180:183], a[64:67]
    v_mfma_f32_16x16x32_bf16 a[68:71], v[208:211], v[184:187], a[68:71]
    v_mfma_f32_16x16x32_bf16 a[72:75], v[208:211], v[188:191], a[72:75]
    v_mfma_f32_16x16x32_bf16 a[76:79], v[208:211], v[192:195], a[76:79]
    buffer_load_dwordx4 v[208:211], v1, s[24:27], s43 offen offset:3072
    v_mfma_f32_16x16x32_bf16 a[80:83], v[212:215], v[176:179], a[80:83]
    v_mfma_f32_16x16x32_bf16 a[84:87], v[212:215], v[180:183], a[84:87]
    v_mfma_f32_16x16x32_bf16 a[88:91], v[212:215], v[184:187], a[88:91]
    v_mfma_f32_16x16x32_bf16 a[92:95], v[212:215], v[188:191], a[92:95]
    v_mfma_f32_16x16x32_bf16 a[96:99], v[212:215], v[192:195], a[96:99]
    buffer_load_dwordx4 v[212:215], v1, s[24:27], s44 offen offset:3072
    v_mfma_f32_16x16x32_bf16 a[100:103], v[216:219], v[176:179], a[100:103]
    v_mfma_f32_16x16x32_bf16 a[104:107], v[216:219], v[180:183], a[104:107]
    v_mfma_f32_16x16x32_bf16 a[108:111], v[216:219], v[184:187], a[108:111]
    v_mfma_f32_16x16x32_bf16 a[112:115], v[216:219], v[188:191], a[112:115]
    v_mfma_f32_16x16x32_bf16 a[116:119], v[216:219], v[192:195], a[116:119]
    buffer_load_dwordx4 v[216:219], v1, s[24:27], s45 offen offset:3072
    v_mfma_f32_16x16x32_bf16 a[120:123], v[220:223], v[176:179], a[120:123]
    v_mfma_f32_16x16x32_bf16 a[124:127], v[220:223], v[180:183], a[124:127]
    v_mfma_f32_16x16x32_bf16 a[128:131], v[220:223], v[184:187], a[128:131]
    v_mfma_f32_16x16x32_bf16 a[132:135], v[220:223], v[188:191], a[132:135]
    v_mfma_f32_16x16x32_bf16 a[136:139], v[220:223], v[192:195], a[136:139]
    buffer_load_dwordx4 v[220:223], v1, s[24:27], s46 offen offset:3072
    v_mfma_f32_16x16x32_bf16 a[140:143], v[224:227], v[176:179], a[140:143]
    v_mfma_f32_16x16x32_bf16 a[144:147], v[224:227], v[180:183], a[144:147]
    v_mfma_f32_16x16x32_bf16 a[148:151], v[224:227], v[184:187], a[148:151]
    v_mfma_f32_16x16x32_bf16 a[152:155], v[224:227], v[188:191], a[152:155]
    v_mfma_f32_16x16x32_bf16 a[156:159], v[224:227], v[192:195], a[156:159]
    buffer_load_dwordx4 v[224:227], v1, s[24:27], s47 offen offset:3072
    s_waitcnt vmcnt(50)
    v_mfma_f32_16x16x32_bf16 a[160:163], v[228:231], v[176:179], a[160:163]
    buffer_load_dwordx4 v[176:179], v1, s[20:23], s32 offen offset:3072
    v_mfma_f32_16x16x32_bf16 a[164:167], v[228:231], v[180:183], a[164:167]
    buffer_load_dwordx4 v[180:183], v1, s[20:23], s33 offen offset:3072
    v_mfma_f32_16x16x32_bf16 a[168:171], v[228:231], v[184:187], a[168:171]
    buffer_load_dwordx4 v[184:187], v1, s[20:23], s34 offen offset:3072
    v_mfma_f32_16x16x32_bf16 a[172:175], v[228:231], v[188:191], a[172:175]
    buffer_load_dwordx4 v[188:191], v1, s[20:23], s35 offen offset:3072
    v_mfma_f32_16x16x32_bf16 a[176:179], v[228:231], v[192:195], a[176:179]
    buffer_load_dwordx4 v[192:195], v1, s[20:23], s36 offen offset:3072
    buffer_load_dwordx4 v[228:231], v1, s[24:27], s48 offen offset:3072
    v_add_u32 v234, 4096, v1
    s_waitcnt vmcnt(47)
    v_mfma_f32_16x16x32_bf16 a[0:3], v[28:31], v[8:11], a[0:3]
    s_waitcnt vmcnt(46)
    v_mfma_f32_16x16x32_bf16 a[4:7], v[28:31], v[12:15], a[4:7]
    s_waitcnt vmcnt(45)
    v_mfma_f32_16x16x32_bf16 a[8:11], v[28:31], v[16:19], a[8:11]
    s_waitcnt vmcnt(44)
    v_mfma_f32_16x16x32_bf16 a[12:15], v[28:31], v[20:23], a[12:15]
    s_waitcnt vmcnt(43)
    v_mfma_f32_16x16x32_bf16 a[16:19], v[28:31], v[24:27], a[16:19]
    buffer_load_dwordx4 v[28:31], v234, s[24:27], s40 offen offset:0
    v_mfma_f32_16x16x32_bf16 a[20:23], v[32:35], v[8:11], a[20:23]
    v_mfma_f32_16x16x32_bf16 a[24:27], v[32:35], v[12:15], a[24:27]
    v_mfma_f32_16x16x32_bf16 a[28:31], v[32:35], v[16:19], a[28:31]
    v_mfma_f32_16x16x32_bf16 a[32:35], v[32:35], v[20:23], a[32:35]
    v_mfma_f32_16x16x32_bf16 a[36:39], v[32:35], v[24:27], a[36:39]
    buffer_load_dwordx4 v[32:35], v234, s[24:27], s41 offen offset:0
    v_mfma_f32_16x16x32_bf16 a[40:43], v[36:39], v[8:11], a[40:43]
    v_mfma_f32_16x16x32_bf16 a[44:47], v[36:39], v[12:15], a[44:47]
    v_mfma_f32_16x16x32_bf16 a[48:51], v[36:39], v[16:19], a[48:51]
    v_mfma_f32_16x16x32_bf16 a[52:55], v[36:39], v[20:23], a[52:55]
    v_mfma_f32_16x16x32_bf16 a[56:59], v[36:39], v[24:27], a[56:59]
    buffer_load_dwordx4 v[36:39], v234, s[24:27], s42 offen offset:0
    v_mfma_f32_16x16x32_bf16 a[60:63], v[40:43], v[8:11], a[60:63]
    v_mfma_f32_16x16x32_bf16 a[64:67], v[40:43], v[12:15], a[64:67]
    v_mfma_f32_16x16x32_bf16 a[68:71], v[40:43], v[16:19], a[68:71]
    v_mfma_f32_16x16x32_bf16 a[72:75], v[40:43], v[20:23], a[72:75]
    v_mfma_f32_16x16x32_bf16 a[76:79], v[40:43], v[24:27], a[76:79]
    buffer_load_dwordx4 v[40:43], v234, s[24:27], s43 offen offset:0
    v_mfma_f32_16x16x32_bf16 a[80:83], v[44:47], v[8:11], a[80:83]
    v_mfma_f32_16x16x32_bf16 a[84:87], v[44:47], v[12:15], a[84:87]
    v_mfma_f32_16x16x32_bf16 a[88:91], v[44:47], v[16:19], a[88:91]
    v_mfma_f32_16x16x32_bf16 a[92:95], v[44:47], v[20:23], a[92:95]
    v_mfma_f32_16x16x32_bf16 a[96:99], v[44:47], v[24:27], a[96:99]
    buffer_load_dwordx4 v[44:47], v234, s[24:27], s44 offen offset:0
    v_mfma_f32_16x16x32_bf16 a[100:103], v[48:51], v[8:11], a[100:103]
    v_mfma_f32_16x16x32_bf16 a[104:107], v[48:51], v[12:15], a[104:107]
    v_mfma_f32_16x16x32_bf16 a[108:111], v[48:51], v[16:19], a[108:111]
    v_mfma_f32_16x16x32_bf16 a[112:115], v[48:51], v[20:23], a[112:115]
    v_mfma_f32_16x16x32_bf16 a[116:119], v[48:51], v[24:27], a[116:119]
    buffer_load_dwordx4 v[48:51], v234, s[24:27], s45 offen offset:0
    v_mfma_f32_16x16x32_bf16 a[120:123], v[52:55], v[8:11], a[120:123]
    v_mfma_f32_16x16x32_bf16 a[124:127], v[52:55], v[12:15], a[124:127]
    v_mfma_f32_16x16x32_bf16 a[128:131], v[52:55], v[16:19], a[128:131]
    v_mfma_f32_16x16x32_bf16 a[132:135], v[52:55], v[20:23], a[132:135]
    v_mfma_f32_16x16x32_bf16 a[136:139], v[52:55], v[24:27], a[136:139]
    buffer_load_dwordx4 v[52:55], v234, s[24:27], s46 offen offset:0
    v_mfma_f32_16x16x32_bf16 a[140:143], v[56:59], v[8:11], a[140:143]
    v_mfma_f32_16x16x32_bf16 a[144:147], v[56:59], v[12:15], a[144:147]
    v_mfma_f32_16x16x32_bf16 a[148:151], v[56:59], v[16:19], a[148:151]
    v_mfma_f32_16x16x32_bf16 a[152:155], v[56:59], v[20:23], a[152:155]
    v_mfma_f32_16x16x32_bf16 a[156:159], v[56:59], v[24:27], a[156:159]
    buffer_load_dwordx4 v[56:59], v234, s[24:27], s47 offen offset:0
    s_waitcnt vmcnt(50)
    v_mfma_f32_16x16x32_bf16 a[160:163], v[60:63], v[8:11], a[160:163]
    buffer_load_dwordx4 v[8:11], v234, s[20:23], s32 offen offset:0
    v_mfma_f32_16x16x32_bf16 a[164:167], v[60:63], v[12:15], a[164:167]
    buffer_load_dwordx4 v[12:15], v234, s[20:23], s33 offen offset:0
    v_mfma_f32_16x16x32_bf16 a[168:171], v[60:63], v[16:19], a[168:171]
    buffer_load_dwordx4 v[16:19], v234, s[20:23], s34 offen offset:0
    v_mfma_f32_16x16x32_bf16 a[172:175], v[60:63], v[20:23], a[172:175]
    buffer_load_dwordx4 v[20:23], v234, s[20:23], s35 offen offset:0
    v_mfma_f32_16x16x32_bf16 a[176:179], v[60:63], v[24:27], a[176:179]
    buffer_load_dwordx4 v[24:27], v234, s[20:23], s36 offen offset:0
    buffer_load_dwordx4 v[60:63], v234, s[24:27], s48 offen offset:0
    s_waitcnt vmcnt(47)
    v_mfma_f32_16x16x32_bf16 a[0:3], v[84:87], v[64:67], a[0:3]
    s_waitcnt vmcnt(46)
    v_mfma_f32_16x16x32_bf16 a[4:7], v[84:87], v[68:71], a[4:7]
    s_waitcnt vmcnt(45)
    v_mfma_f32_16x16x32_bf16 a[8:11], v[84:87], v[72:75], a[8:11]
    s_waitcnt vmcnt(44)
    v_mfma_f32_16x16x32_bf16 a[12:15], v[84:87], v[76:79], a[12:15]
    s_waitcnt vmcnt(43)
    v_mfma_f32_16x16x32_bf16 a[16:19], v[84:87], v[80:83], a[16:19]
    buffer_load_dwordx4 v[84:87], v234, s[24:27], s40 offen offset:1024
    v_mfma_f32_16x16x32_bf16 a[20:23], v[88:91], v[64:67], a[20:23]
    v_mfma_f32_16x16x32_bf16 a[24:27], v[88:91], v[68:71], a[24:27]
    v_mfma_f32_16x16x32_bf16 a[28:31], v[88:91], v[72:75], a[28:31]
    v_mfma_f32_16x16x32_bf16 a[32:35], v[88:91], v[76:79], a[32:35]
    v_mfma_f32_16x16x32_bf16 a[36:39], v[88:91], v[80:83], a[36:39]
    buffer_load_dwordx4 v[88:91], v234, s[24:27], s41 offen offset:1024
    v_mfma_f32_16x16x32_bf16 a[40:43], v[92:95], v[64:67], a[40:43]
    v_mfma_f32_16x16x32_bf16 a[44:47], v[92:95], v[68:71], a[44:47]
    v_mfma_f32_16x16x32_bf16 a[48:51], v[92:95], v[72:75], a[48:51]
    v_mfma_f32_16x16x32_bf16 a[52:55], v[92:95], v[76:79], a[52:55]
    v_mfma_f32_16x16x32_bf16 a[56:59], v[92:95], v[80:83], a[56:59]
    buffer_load_dwordx4 v[92:95], v234, s[24:27], s42 offen offset:1024
    v_mfma_f32_16x16x32_bf16 a[60:63], v[96:99], v[64:67], a[60:63]
    v_mfma_f32_16x16x32_bf16 a[64:67], v[96:99], v[68:71], a[64:67]
    v_mfma_f32_16x16x32_bf16 a[68:71], v[96:99], v[72:75], a[68:71]
    v_mfma_f32_16x16x32_bf16 a[72:75], v[96:99], v[76:79], a[72:75]
    v_mfma_f32_16x16x32_bf16 a[76:79], v[96:99], v[80:83], a[76:79]
    buffer_load_dwordx4 v[96:99], v234, s[24:27], s43 offen offset:1024
    v_mfma_f32_16x16x32_bf16 a[80:83], v[100:103], v[64:67], a[80:83]
    v_mfma_f32_16x16x32_bf16 a[84:87], v[100:103], v[68:71], a[84:87]
    v_mfma_f32_16x16x32_bf16 a[88:91], v[100:103], v[72:75], a[88:91]
    v_mfma_f32_16x16x32_bf16 a[92:95], v[100:103], v[76:79], a[92:95]
    v_mfma_f32_16x16x32_bf16 a[96:99], v[100:103], v[80:83], a[96:99]
    buffer_load_dwordx4 v[100:103], v234, s[24:27], s44 offen offset:1024
    v_mfma_f32_16x16x32_bf16 a[100:103], v[104:107], v[64:67], a[100:103]
    v_mfma_f32_16x16x32_bf16 a[104:107], v[104:107], v[68:71], a[104:107]
    v_mfma_f32_16x16x32_bf16 a[108:111], v[104:107], v[72:75], a[108:111]
    v_mfma_f32_16x16x32_bf16 a[112:115], v[104:107], v[76:79], a[112:115]
    v_mfma_f32_16x16x32_bf16 a[116:119], v[104:107], v[80:83], a[116:119]
    buffer_load_dwordx4 v[104:107], v234, s[24:27], s45 offen offset:1024
    v_mfma_f32_16x16x32_bf16 a[120:123], v[108:111], v[64:67], a[120:123]
    v_mfma_f32_16x16x32_bf16 a[124:127], v[108:111], v[68:71], a[124:127]
    v_mfma_f32_16x16x32_bf16 a[128:131], v[108:111], v[72:75], a[128:131]
    v_mfma_f32_16x16x32_bf16 a[132:135], v[108:111], v[76:79], a[132:135]
    v_mfma_f32_16x16x32_bf16 a[136:139], v[108:111], v[80:83], a[136:139]
    buffer_load_dwordx4 v[108:111], v234, s[24:27], s46 offen offset:1024
    v_mfma_f32_16x16x32_bf16 a[140:143], v[112:115], v[64:67], a[140:143]
    v_mfma_f32_16x16x32_bf16 a[144:147], v[112:115], v[68:71], a[144:147]
    v_mfma_f32_16x16x32_bf16 a[148:151], v[112:115], v[72:75], a[148:151]
    v_mfma_f32_16x16x32_bf16 a[152:155], v[112:115], v[76:79], a[152:155]
    v_mfma_f32_16x16x32_bf16 a[156:159], v[112:115], v[80:83], a[156:159]
    buffer_load_dwordx4 v[112:115], v234, s[24:27], s47 offen offset:1024
    s_waitcnt vmcnt(50)
    v_mfma_f32_16x16x32_bf16 a[160:163], v[116:119], v[64:67], a[160:163]
    buffer_load_dwordx4 v[64:67], v234, s[20:23], s32 offen offset:1024
    v_mfma_f32_16x16x32_bf16 a[164:167], v[116:119], v[68:71], a[164:167]
    buffer_load_dwordx4 v[68:71], v234, s[20:23], s33 offen offset:1024
    v_mfma_f32_16x16x32_bf16 a[168:171], v[116:119], v[72:75], a[168:171]
    buffer_load_dwordx4 v[72:75], v234, s[20:23], s34 offen offset:1024
    v_mfma_f32_16x16x32_bf16 a[172:175], v[116:119], v[76:79], a[172:175]
    buffer_load_dwordx4 v[76:79], v234, s[20:23], s35 offen offset:1024
    v_mfma_f32_16x16x32_bf16 a[176:179], v[116:119], v[80:83], a[176:179]
    buffer_load_dwordx4 v[80:83], v234, s[20:23], s36 offen offset:1024
    buffer_load_dwordx4 v[116:119], v234, s[24:27], s48 offen offset:1024
    s_waitcnt vmcnt(47)
    v_mfma_f32_16x16x32_bf16 a[0:3], v[140:143], v[120:123], a[0:3]
    s_waitcnt vmcnt(46)
    v_mfma_f32_16x16x32_bf16 a[4:7], v[140:143], v[124:127], a[4:7]
    s_waitcnt vmcnt(45)
    v_mfma_f32_16x16x32_bf16 a[8:11], v[140:143], v[128:131], a[8:11]
    s_waitcnt vmcnt(44)
    v_mfma_f32_16x16x32_bf16 a[12:15], v[140:143], v[132:135], a[12:15]
    s_waitcnt vmcnt(43)
    v_mfma_f32_16x16x32_bf16 a[16:19], v[140:143], v[136:139], a[16:19]
    buffer_load_dwordx4 v[140:143], v234, s[24:27], s40 offen offset:2048
    v_mfma_f32_16x16x32_bf16 a[20:23], v[144:147], v[120:123], a[20:23]
    v_mfma_f32_16x16x32_bf16 a[24:27], v[144:147], v[124:127], a[24:27]
    v_mfma_f32_16x16x32_bf16 a[28:31], v[144:147], v[128:131], a[28:31]
    v_mfma_f32_16x16x32_bf16 a[32:35], v[144:147], v[132:135], a[32:35]
    v_mfma_f32_16x16x32_bf16 a[36:39], v[144:147], v[136:139], a[36:39]
    buffer_load_dwordx4 v[144:147], v234, s[24:27], s41 offen offset:2048
    v_mfma_f32_16x16x32_bf16 a[40:43], v[148:151], v[120:123], a[40:43]
    v_mfma_f32_16x16x32_bf16 a[44:47], v[148:151], v[124:127], a[44:47]
    v_mfma_f32_16x16x32_bf16 a[48:51], v[148:151], v[128:131], a[48:51]
    v_mfma_f32_16x16x32_bf16 a[52:55], v[148:151], v[132:135], a[52:55]
    v_mfma_f32_16x16x32_bf16 a[56:59], v[148:151], v[136:139], a[56:59]
    buffer_load_dwordx4 v[148:151], v234, s[24:27], s42 offen offset:2048
    v_mfma_f32_16x16x32_bf16 a[60:63], v[152:155], v[120:123], a[60:63]
    v_mfma_f32_16x16x32_bf16 a[64:67], v[152:155], v[124:127], a[64:67]
    v_mfma_f32_16x16x32_bf16 a[68:71], v[152:155], v[128:131], a[68:71]
    v_mfma_f32_16x16x32_bf16 a[72:75], v[152:155], v[132:135], a[72:75]
    v_mfma_f32_16x16x32_bf16 a[76:79], v[152:155], v[136:139], a[76:79]
    buffer_load_dwordx4 v[152:155], v234, s[24:27], s43 offen offset:2048
    v_mfma_f32_16x16x32_bf16 a[80:83], v[156:159], v[120:123], a[80:83]
    v_mfma_f32_16x16x32_bf16 a[84:87], v[156:159], v[124:127], a[84:87]
    v_mfma_f32_16x16x32_bf16 a[88:91], v[156:159], v[128:131], a[88:91]
    v_mfma_f32_16x16x32_bf16 a[92:95], v[156:159], v[132:135], a[92:95]
    v_mfma_f32_16x16x32_bf16 a[96:99], v[156:159], v[136:139], a[96:99]
    buffer_load_dwordx4 v[156:159], v234, s[24:27], s44 offen offset:2048
    v_mfma_f32_16x16x32_bf16 a[100:103], v[160:163], v[120:123], a[100:103]
    v_mfma_f32_16x16x32_bf16 a[104:107], v[160:163], v[124:127], a[104:107]
    v_mfma_f32_16x16x32_bf16 a[108:111], v[160:163], v[128:131], a[108:111]
    v_mfma_f32_16x16x32_bf16 a[112:115], v[160:163], v[132:135], a[112:115]
    v_mfma_f32_16x16x32_bf16 a[116:119], v[160:163], v[136:139], a[116:119]
    buffer_load_dwordx4 v[160:163], v234, s[24:27], s45 offen offset:2048
    v_mfma_f32_16x16x32_bf16 a[120:123], v[164:167], v[120:123], a[120:123]
    v_mfma_f32_16x16x32_bf16 a[124:127], v[164:167], v[124:127], a[124:127]
    v_mfma_f32_16x16x32_bf16 a[128:131], v[164:167], v[128:131], a[128:131]
    v_mfma_f32_16x16x32_bf16 a[132:135], v[164:167], v[132:135], a[132:135]
    v_mfma_f32_16x16x32_bf16 a[136:139], v[164:167], v[136:139], a[136:139]
    buffer_load_dwordx4 v[164:167], v234, s[24:27], s46 offen offset:2048
    v_mfma_f32_16x16x32_bf16 a[140:143], v[168:171], v[120:123], a[140:143]
    v_mfma_f32_16x16x32_bf16 a[144:147], v[168:171], v[124:127], a[144:147]
    v_mfma_f32_16x16x32_bf16 a[148:151], v[168:171], v[128:131], a[148:151]
    v_mfma_f32_16x16x32_bf16 a[152:155], v[168:171], v[132:135], a[152:155]
    v_mfma_f32_16x16x32_bf16 a[156:159], v[168:171], v[136:139], a[156:159]
    buffer_load_dwordx4 v[168:171], v234, s[24:27], s47 offen offset:2048
    s_waitcnt vmcnt(50)
    v_mfma_f32_16x16x32_bf16 a[160:163], v[172:175], v[120:123], a[160:163]
    buffer_load_dwordx4 v[120:123], v234, s[20:23], s32 offen offset:2048
    v_mfma_f32_16x16x32_bf16 a[164:167], v[172:175], v[124:127], a[164:167]
    buffer_load_dwordx4 v[124:127], v234, s[20:23], s33 offen offset:2048
    v_mfma_f32_16x16x32_bf16 a[168:171], v[172:175], v[128:131], a[168:171]
    buffer_load_dwordx4 v[128:131], v234, s[20:23], s34 offen offset:2048
    v_mfma_f32_16x16x32_bf16 a[172:175], v[172:175], v[132:135], a[172:175]
    buffer_load_dwordx4 v[132:135], v234, s[20:23], s35 offen offset:2048
    v_mfma_f32_16x16x32_bf16 a[176:179], v[172:175], v[136:139], a[176:179]
    buffer_load_dwordx4 v[136:139], v234, s[20:23], s36 offen offset:2048
    buffer_load_dwordx4 v[172:175], v234, s[24:27], s48 offen offset:2048
    s_waitcnt vmcnt(47)
    v_mfma_f32_16x16x32_bf16 a[0:3], v[196:199], v[176:179], a[0:3]
    s_waitcnt vmcnt(46)
    v_mfma_f32_16x16x32_bf16 a[4:7], v[196:199], v[180:183], a[4:7]
    s_waitcnt vmcnt(45)
    v_mfma_f32_16x16x32_bf16 a[8:11], v[196:199], v[184:187], a[8:11]
    s_waitcnt vmcnt(44)
    v_mfma_f32_16x16x32_bf16 a[12:15], v[196:199], v[188:191], a[12:15]
    s_waitcnt vmcnt(43)
    v_mfma_f32_16x16x32_bf16 a[16:19], v[196:199], v[192:195], a[16:19]
    buffer_load_dwordx4 v[196:199], v234, s[24:27], s40 offen offset:3072
    v_mfma_f32_16x16x32_bf16 a[20:23], v[200:203], v[176:179], a[20:23]
    v_mfma_f32_16x16x32_bf16 a[24:27], v[200:203], v[180:183], a[24:27]
    v_mfma_f32_16x16x32_bf16 a[28:31], v[200:203], v[184:187], a[28:31]
    v_mfma_f32_16x16x32_bf16 a[32:35], v[200:203], v[188:191], a[32:35]
    v_mfma_f32_16x16x32_bf16 a[36:39], v[200:203], v[192:195], a[36:39]
    buffer_load_dwordx4 v[200:203], v234, s[24:27], s41 offen offset:3072
    v_mfma_f32_16x16x32_bf16 a[40:43], v[204:207], v[176:179], a[40:43]
    v_mfma_f32_16x16x32_bf16 a[44:47], v[204:207], v[180:183], a[44:47]
    v_mfma_f32_16x16x32_bf16 a[48:51], v[204:207], v[184:187], a[48:51]
    v_mfma_f32_16x16x32_bf16 a[52:55], v[204:207], v[188:191], a[52:55]
    v_mfma_f32_16x16x32_bf16 a[56:59], v[204:207], v[192:195], a[56:59]
    buffer_load_dwordx4 v[204:207], v234, s[24:27], s42 offen offset:3072
    v_mfma_f32_16x16x32_bf16 a[60:63], v[208:211], v[176:179], a[60:63]
    v_mfma_f32_16x16x32_bf16 a[64:67], v[208:211], v[180:183], a[64:67]
    v_mfma_f32_16x16x32_bf16 a[68:71], v[208:211], v[184:187], a[68:71]
    v_mfma_f32_16x16x32_bf16 a[72:75], v[208:211], v[188:191], a[72:75]
    v_mfma_f32_16x16x32_bf16 a[76:79], v[208:211], v[192:195], a[76:79]
    buffer_load_dwordx4 v[208:211], v234, s[24:27], s43 offen offset:3072
    v_mfma_f32_16x16x32_bf16 a[80:83], v[212:215], v[176:179], a[80:83]
    v_mfma_f32_16x16x32_bf16 a[84:87], v[212:215], v[180:183], a[84:87]
    v_mfma_f32_16x16x32_bf16 a[88:91], v[212:215], v[184:187], a[88:91]
    v_mfma_f32_16x16x32_bf16 a[92:95], v[212:215], v[188:191], a[92:95]
    v_mfma_f32_16x16x32_bf16 a[96:99], v[212:215], v[192:195], a[96:99]
    buffer_load_dwordx4 v[212:215], v234, s[24:27], s44 offen offset:3072
    v_mfma_f32_16x16x32_bf16 a[100:103], v[216:219], v[176:179], a[100:103]
    v_mfma_f32_16x16x32_bf16 a[104:107], v[216:219], v[180:183], a[104:107]
    v_mfma_f32_16x16x32_bf16 a[108:111], v[216:219], v[184:187], a[108:111]
    v_mfma_f32_16x16x32_bf16 a[112:115], v[216:219], v[188:191], a[112:115]
    v_mfma_f32_16x16x32_bf16 a[116:119], v[216:219], v[192:195], a[116:119]
    buffer_load_dwordx4 v[216:219], v234, s[24:27], s45 offen offset:3072
    v_mfma_f32_16x16x32_bf16 a[120:123], v[220:223], v[176:179], a[120:123]
    v_mfma_f32_16x16x32_bf16 a[124:127], v[220:223], v[180:183], a[124:127]
    v_mfma_f32_16x16x32_bf16 a[128:131], v[220:223], v[184:187], a[128:131]
    v_mfma_f32_16x16x32_bf16 a[132:135], v[220:223], v[188:191], a[132:135]
    v_mfma_f32_16x16x32_bf16 a[136:139], v[220:223], v[192:195], a[136:139]
    buffer_load_dwordx4 v[220:223], v234, s[24:27], s46 offen offset:3072
    v_mfma_f32_16x16x32_bf16 a[140:143], v[224:227], v[176:179], a[140:143]
    v_mfma_f32_16x16x32_bf16 a[144:147], v[224:227], v[180:183], a[144:147]
    v_mfma_f32_16x16x32_bf16 a[148:151], v[224:227], v[184:187], a[148:151]
    v_mfma_f32_16x16x32_bf16 a[152:155], v[224:227], v[188:191], a[152:155]
    v_mfma_f32_16x16x32_bf16 a[156:159], v[224:227], v[192:195], a[156:159]
    buffer_load_dwordx4 v[224:227], v234, s[24:27], s47 offen offset:3072
    s_waitcnt vmcnt(50)
    v_mfma_f32_16x16x32_bf16 a[160:163], v[228:231], v[176:179], a[160:163]
    buffer_load_dwordx4 v[176:179], v234, s[20:23], s32 offen offset:3072
    v_mfma_f32_16x16x32_bf16 a[164:167], v[228:231], v[180:183], a[164:167]
    buffer_load_dwordx4 v[180:183], v234, s[20:23], s33 offen offset:3072
    v_mfma_f32_16x16x32_bf16 a[168:171], v[228:231], v[184:187], a[168:171]
    buffer_load_dwordx4 v[184:187], v234, s[20:23], s34 offen offset:3072
    v_mfma_f32_16x16x32_bf16 a[172:175], v[228:231], v[188:191], a[172:175]
    buffer_load_dwordx4 v[188:191], v234, s[20:23], s35 offen offset:3072
    v_mfma_f32_16x16x32_bf16 a[176:179], v[228:231], v[192:195], a[176:179]
    buffer_load_dwordx4 v[192:195], v234, s[20:23], s36 offen offset:3072
    buffer_load_dwordx4 v[228:231], v234, s[24:27], s48 offen offset:3072
    s_waitcnt vmcnt(47)
    v_mfma_f32_16x16x32_bf16 a[0:3], v[28:31], v[8:11], a[0:3]
    s_waitcnt vmcnt(46)
    v_mfma_f32_16x16x32_bf16 a[4:7], v[28:31], v[12:15], a[4:7]
    s_waitcnt vmcnt(45)
    v_mfma_f32_16x16x32_bf16 a[8:11], v[28:31], v[16:19], a[8:11]
    s_waitcnt vmcnt(44)
    v_mfma_f32_16x16x32_bf16 a[12:15], v[28:31], v[20:23], a[12:15]
    s_waitcnt vmcnt(43)
    v_mfma_f32_16x16x32_bf16 a[16:19], v[28:31], v[24:27], a[16:19]
    v_mfma_f32_16x16x32_bf16 a[20:23], v[32:35], v[8:11], a[20:23]
    v_mfma_f32_16x16x32_bf16 a[24:27], v[32:35], v[12:15], a[24:27]
    v_mfma_f32_16x16x32_bf16 a[28:31], v[32:35], v[16:19], a[28:31]
    v_mfma_f32_16x16x32_bf16 a[32:35], v[32:35], v[20:23], a[32:35]
    v_mfma_f32_16x16x32_bf16 a[36:39], v[32:35], v[24:27], a[36:39]
    v_mfma_f32_16x16x32_bf16 a[40:43], v[36:39], v[8:11], a[40:43]
    v_mfma_f32_16x16x32_bf16 a[44:47], v[36:39], v[12:15], a[44:47]
    v_mfma_f32_16x16x32_bf16 a[48:51], v[36:39], v[16:19], a[48:51]
    v_mfma_f32_16x16x32_bf16 a[52:55], v[36:39], v[20:23], a[52:55]
    v_mfma_f32_16x16x32_bf16 a[56:59], v[36:39], v[24:27], a[56:59]
    v_mfma_f32_16x16x32_bf16 a[60:63], v[40:43], v[8:11], a[60:63]
    v_mfma_f32_16x16x32_bf16 a[64:67], v[40:43], v[12:15], a[64:67]
    v_mfma_f32_16x16x32_bf16 a[68:71], v[40:43], v[16:19], a[68:71]
    v_mfma_f32_16x16x32_bf16 a[72:75], v[40:43], v[20:23], a[72:75]
    v_mfma_f32_16x16x32_bf16 a[76:79], v[40:43], v[24:27], a[76:79]
    v_mfma_f32_16x16x32_bf16 a[80:83], v[44:47], v[8:11], a[80:83]
    v_mfma_f32_16x16x32_bf16 a[84:87], v[44:47], v[12:15], a[84:87]
    v_mfma_f32_16x16x32_bf16 a[88:91], v[44:47], v[16:19], a[88:91]
    v_mfma_f32_16x16x32_bf16 a[92:95], v[44:47], v[20:23], a[92:95]
    v_mfma_f32_16x16x32_bf16 a[96:99], v[44:47], v[24:27], a[96:99]
    v_mfma_f32_16x16x32_bf16 a[100:103], v[48:51], v[8:11], a[100:103]
    v_mfma_f32_16x16x32_bf16 a[104:107], v[48:51], v[12:15], a[104:107]
    v_mfma_f32_16x16x32_bf16 a[108:111], v[48:51], v[16:19], a[108:111]
    v_mfma_f32_16x16x32_bf16 a[112:115], v[48:51], v[20:23], a[112:115]
    v_mfma_f32_16x16x32_bf16 a[116:119], v[48:51], v[24:27], a[116:119]
    v_mfma_f32_16x16x32_bf16 a[120:123], v[52:55], v[8:11], a[120:123]
    v_mfma_f32_16x16x32_bf16 a[124:127], v[52:55], v[12:15], a[124:127]
    v_mfma_f32_16x16x32_bf16 a[128:131], v[52:55], v[16:19], a[128:131]
    v_mfma_f32_16x16x32_bf16 a[132:135], v[52:55], v[20:23], a[132:135]
    v_mfma_f32_16x16x32_bf16 a[136:139], v[52:55], v[24:27], a[136:139]
    v_mfma_f32_16x16x32_bf16 a[140:143], v[56:59], v[8:11], a[140:143]
    v_mfma_f32_16x16x32_bf16 a[144:147], v[56:59], v[12:15], a[144:147]
    v_mfma_f32_16x16x32_bf16 a[148:151], v[56:59], v[16:19], a[148:151]
    v_mfma_f32_16x16x32_bf16 a[152:155], v[56:59], v[20:23], a[152:155]
    v_mfma_f32_16x16x32_bf16 a[156:159], v[56:59], v[24:27], a[156:159]
    s_waitcnt vmcnt(42)
    v_mfma_f32_16x16x32_bf16 a[160:163], v[60:63], v[8:11], a[160:163]
    v_mfma_f32_16x16x32_bf16 a[164:167], v[60:63], v[12:15], a[164:167]
    v_mfma_f32_16x16x32_bf16 a[168:171], v[60:63], v[16:19], a[168:171]
    v_mfma_f32_16x16x32_bf16 a[172:175], v[60:63], v[20:23], a[172:175]
    v_mfma_f32_16x16x32_bf16 a[176:179], v[60:63], v[24:27], a[176:179]
    s_waitcnt vmcnt(33)
    v_mfma_f32_16x16x32_bf16 a[0:3], v[84:87], v[64:67], a[0:3]
    s_waitcnt vmcnt(32)
    v_mfma_f32_16x16x32_bf16 a[4:7], v[84:87], v[68:71], a[4:7]
    s_waitcnt vmcnt(31)
    v_mfma_f32_16x16x32_bf16 a[8:11], v[84:87], v[72:75], a[8:11]
    s_waitcnt vmcnt(30)
    v_mfma_f32_16x16x32_bf16 a[12:15], v[84:87], v[76:79], a[12:15]
    s_waitcnt vmcnt(29)
    v_mfma_f32_16x16x32_bf16 a[16:19], v[84:87], v[80:83], a[16:19]
    v_mfma_f32_16x16x32_bf16 a[20:23], v[88:91], v[64:67], a[20:23]
    v_mfma_f32_16x16x32_bf16 a[24:27], v[88:91], v[68:71], a[24:27]
    v_mfma_f32_16x16x32_bf16 a[28:31], v[88:91], v[72:75], a[28:31]
    v_mfma_f32_16x16x32_bf16 a[32:35], v[88:91], v[76:79], a[32:35]
    v_mfma_f32_16x16x32_bf16 a[36:39], v[88:91], v[80:83], a[36:39]
    v_mfma_f32_16x16x32_bf16 a[40:43], v[92:95], v[64:67], a[40:43]
    v_mfma_f32_16x16x32_bf16 a[44:47], v[92:95], v[68:71], a[44:47]
    v_mfma_f32_16x16x32_bf16 a[48:51], v[92:95], v[72:75], a[48:51]
    v_mfma_f32_16x16x32_bf16 a[52:55], v[92:95], v[76:79], a[52:55]
    v_mfma_f32_16x16x32_bf16 a[56:59], v[92:95], v[80:83], a[56:59]
    v_mfma_f32_16x16x32_bf16 a[60:63], v[96:99], v[64:67], a[60:63]
    v_mfma_f32_16x16x32_bf16 a[64:67], v[96:99], v[68:71], a[64:67]
    v_mfma_f32_16x16x32_bf16 a[68:71], v[96:99], v[72:75], a[68:71]
    v_mfma_f32_16x16x32_bf16 a[72:75], v[96:99], v[76:79], a[72:75]
    v_mfma_f32_16x16x32_bf16 a[76:79], v[96:99], v[80:83], a[76:79]
    v_mfma_f32_16x16x32_bf16 a[80:83], v[100:103], v[64:67], a[80:83]
    v_mfma_f32_16x16x32_bf16 a[84:87], v[100:103], v[68:71], a[84:87]
    v_mfma_f32_16x16x32_bf16 a[88:91], v[100:103], v[72:75], a[88:91]
    v_mfma_f32_16x16x32_bf16 a[92:95], v[100:103], v[76:79], a[92:95]
    v_mfma_f32_16x16x32_bf16 a[96:99], v[100:103], v[80:83], a[96:99]
    v_mfma_f32_16x16x32_bf16 a[100:103], v[104:107], v[64:67], a[100:103]
    v_mfma_f32_16x16x32_bf16 a[104:107], v[104:107], v[68:71], a[104:107]
    v_mfma_f32_16x16x32_bf16 a[108:111], v[104:107], v[72:75], a[108:111]
    v_mfma_f32_16x16x32_bf16 a[112:115], v[104:107], v[76:79], a[112:115]
    v_mfma_f32_16x16x32_bf16 a[116:119], v[104:107], v[80:83], a[116:119]
    v_mfma_f32_16x16x32_bf16 a[120:123], v[108:111], v[64:67], a[120:123]
    v_mfma_f32_16x16x32_bf16 a[124:127], v[108:111], v[68:71], a[124:127]
    v_mfma_f32_16x16x32_bf16 a[128:131], v[108:111], v[72:75], a[128:131]
    v_mfma_f32_16x16x32_bf16 a[132:135], v[108:111], v[76:79], a[132:135]
    v_mfma_f32_16x16x32_bf16 a[136:139], v[108:111], v[80:83], a[136:139]
    v_mfma_f32_16x16x32_bf16 a[140:143], v[112:115], v[64:67], a[140:143]
    v_mfma_f32_16x16x32_bf16 a[144:147], v[112:115], v[68:71], a[144:147]
    v_mfma_f32_16x16x32_bf16 a[148:151], v[112:115], v[72:75], a[148:151]
    v_mfma_f32_16x16x32_bf16 a[152:155], v[112:115], v[76:79], a[152:155]
    v_mfma_f32_16x16x32_bf16 a[156:159], v[112:115], v[80:83], a[156:159]
    s_waitcnt vmcnt(28)
    v_mfma_f32_16x16x32_bf16 a[160:163], v[116:119], v[64:67], a[160:163]
    v_mfma_f32_16x16x32_bf16 a[164:167], v[116:119], v[68:71], a[164:167]
    v_mfma_f32_16x16x32_bf16 a[168:171], v[116:119], v[72:75], a[168:171]
    v_mfma_f32_16x16x32_bf16 a[172:175], v[116:119], v[76:79], a[172:175]
    v_mfma_f32_16x16x32_bf16 a[176:179], v[116:119], v[80:83], a[176:179]
    s_waitcnt vmcnt(19)
    v_mfma_f32_16x16x32_bf16 a[0:3], v[140:143], v[120:123], a[0:3]
    s_waitcnt vmcnt(18)
    v_mfma_f32_16x16x32_bf16 a[4:7], v[140:143], v[124:127], a[4:7]
    s_waitcnt vmcnt(17)
    v_mfma_f32_16x16x32_bf16 a[8:11], v[140:143], v[128:131], a[8:11]
    s_waitcnt vmcnt(16)
    v_mfma_f32_16x16x32_bf16 a[12:15], v[140:143], v[132:135], a[12:15]
    s_waitcnt vmcnt(15)
    v_mfma_f32_16x16x32_bf16 a[16:19], v[140:143], v[136:139], a[16:19]
    v_mfma_f32_16x16x32_bf16 a[20:23], v[144:147], v[120:123], a[20:23]
    v_mfma_f32_16x16x32_bf16 a[24:27], v[144:147], v[124:127], a[24:27]
    v_mfma_f32_16x16x32_bf16 a[28:31], v[144:147], v[128:131], a[28:31]
    v_mfma_f32_16x16x32_bf16 a[32:35], v[144:147], v[132:135], a[32:35]
    v_mfma_f32_16x16x32_bf16 a[36:39], v[144:147], v[136:139], a[36:39]
    v_mfma_f32_16x16x32_bf16 a[40:43], v[148:151], v[120:123], a[40:43]
    v_mfma_f32_16x16x32_bf16 a[44:47], v[148:151], v[124:127], a[44:47]
    v_mfma_f32_16x16x32_bf16 a[48:51], v[148:151], v[128:131], a[48:51]
    v_mfma_f32_16x16x32_bf16 a[52:55], v[148:151], v[132:135], a[52:55]
    v_mfma_f32_16x16x32_bf16 a[56:59], v[148:151], v[136:139], a[56:59]
    v_mfma_f32_16x16x32_bf16 a[60:63], v[152:155], v[120:123], a[60:63]
    v_mfma_f32_16x16x32_bf16 a[64:67], v[152:155], v[124:127], a[64:67]
    v_mfma_f32_16x16x32_bf16 a[68:71], v[152:155], v[128:131], a[68:71]
    v_mfma_f32_16x16x32_bf16 a[72:75], v[152:155], v[132:135], a[72:75]
    v_mfma_f32_16x16x32_bf16 a[76:79], v[152:155], v[136:139], a[76:79]
    v_mfma_f32_16x16x32_bf16 a[80:83], v[156:159], v[120:123], a[80:83]
    v_mfma_f32_16x16x32_bf16 a[84:87], v[156:159], v[124:127], a[84:87]
    v_mfma_f32_16x16x32_bf16 a[88:91], v[156:159], v[128:131], a[88:91]
    v_mfma_f32_16x16x32_bf16 a[92:95], v[156:159], v[132:135], a[92:95]
    v_mfma_f32_16x16x32_bf16 a[96:99], v[156:159], v[136:139], a[96:99]
    v_mfma_f32_16x16x32_bf16 a[100:103], v[160:163], v[120:123], a[100:103]
    v_mfma_f32_16x16x32_bf16 a[104:107], v[160:163], v[124:127], a[104:107]
    v_mfma_f32_16x16x32_bf16 a[108:111], v[160:163], v[128:131], a[108:111]
    v_mfma_f32_16x16x32_bf16 a[112:115], v[160:163], v[132:135], a[112:115]
    v_mfma_f32_16x16x32_bf16 a[116:119], v[160:163], v[136:139], a[116:119]
    v_mfma_f32_16x16x32_bf16 a[120:123], v[164:167], v[120:123], a[120:123]
    v_mfma_f32_16x16x32_bf16 a[124:127], v[164:167], v[124:127], a[124:127]
    v_mfma_f32_16x16x32_bf16 a[128:131], v[164:167], v[128:131], a[128:131]
    v_mfma_f32_16x16x32_bf16 a[132:135], v[164:167], v[132:135], a[132:135]
    v_mfma_f32_16x16x32_bf16 a[136:139], v[164:167], v[136:139], a[136:139]
    v_mfma_f32_16x16x32_bf16 a[140:143], v[168:171], v[120:123], a[140:143]
    v_mfma_f32_16x16x32_bf16 a[144:147], v[168:171], v[124:127], a[144:147]
    v_mfma_f32_16x16x32_bf16 a[148:151], v[168:171], v[128:131], a[148:151]
    v_mfma_f32_16x16x32_bf16 a[152:155], v[168:171], v[132:135], a[152:155]
    v_mfma_f32_16x16x32_bf16 a[156:159], v[168:171], v[136:139], a[156:159]
    s_waitcnt vmcnt(14)
    v_mfma_f32_16x16x32_bf16 a[160:163], v[172:175], v[120:123], a[160:163]
    v_mfma_f32_16x16x32_bf16 a[164:167], v[172:175], v[124:127], a[164:167]
    v_mfma_f32_16x16x32_bf16 a[168:171], v[172:175], v[128:131], a[168:171]
    v_mfma_f32_16x16x32_bf16 a[172:175], v[172:175], v[132:135], a[172:175]
    v_mfma_f32_16x16x32_bf16 a[176:179], v[172:175], v[136:139], a[176:179]
    s_waitcnt vmcnt(5)
    v_mfma_f32_16x16x32_bf16 a[0:3], v[196:199], v[176:179], a[0:3]
    s_waitcnt vmcnt(4)
    v_mfma_f32_16x16x32_bf16 a[4:7], v[196:199], v[180:183], a[4:7]
    s_waitcnt vmcnt(3)
    v_mfma_f32_16x16x32_bf16 a[8:11], v[196:199], v[184:187], a[8:11]
    s_waitcnt vmcnt(2)
    v_mfma_f32_16x16x32_bf16 a[12:15], v[196:199], v[188:191], a[12:15]
    s_waitcnt vmcnt(1)
    v_mfma_f32_16x16x32_bf16 a[16:19], v[196:199], v[192:195], a[16:19]
    v_mfma_f32_16x16x32_bf16 a[20:23], v[200:203], v[176:179], a[20:23]
    v_mfma_f32_16x16x32_bf16 a[24:27], v[200:203], v[180:183], a[24:27]
    v_mfma_f32_16x16x32_bf16 a[28:31], v[200:203], v[184:187], a[28:31]
    v_mfma_f32_16x16x32_bf16 a[32:35], v[200:203], v[188:191], a[32:35]
    v_mfma_f32_16x16x32_bf16 a[36:39], v[200:203], v[192:195], a[36:39]
    v_mfma_f32_16x16x32_bf16 a[40:43], v[204:207], v[176:179], a[40:43]
    v_mfma_f32_16x16x32_bf16 a[44:47], v[204:207], v[180:183], a[44:47]
    v_mfma_f32_16x16x32_bf16 a[48:51], v[204:207], v[184:187], a[48:51]
    v_mfma_f32_16x16x32_bf16 a[52:55], v[204:207], v[188:191], a[52:55]
    v_mfma_f32_16x16x32_bf16 a[56:59], v[204:207], v[192:195], a[56:59]
    v_mfma_f32_16x16x32_bf16 a[60:63], v[208:211], v[176:179], a[60:63]
    v_mfma_f32_16x16x32_bf16 a[64:67], v[208:211], v[180:183], a[64:67]
    v_mfma_f32_16x16x32_bf16 a[68:71], v[208:211], v[184:187], a[68:71]
    v_mfma_f32_16x16x32_bf16 a[72:75], v[208:211], v[188:191], a[72:75]
    v_mfma_f32_16x16x32_bf16 a[76:79], v[208:211], v[192:195], a[76:79]
    v_mfma_f32_16x16x32_bf16 a[80:83], v[212:215], v[176:179], a[80:83]
    v_mfma_f32_16x16x32_bf16 a[84:87], v[212:215], v[180:183], a[84:87]
    v_mfma_f32_16x16x32_bf16 a[88:91], v[212:215], v[184:187], a[88:91]
    v_mfma_f32_16x16x32_bf16 a[92:95], v[212:215], v[188:191], a[92:95]
    v_mfma_f32_16x16x32_bf16 a[96:99], v[212:215], v[192:195], a[96:99]
    v_mfma_f32_16x16x32_bf16 a[100:103], v[216:219], v[176:179], a[100:103]
    v_mfma_f32_16x16x32_bf16 a[104:107], v[216:219], v[180:183], a[104:107]
    v_mfma_f32_16x16x32_bf16 a[108:111], v[216:219], v[184:187], a[108:111]
    v_mfma_f32_16x16x32_bf16 a[112:115], v[216:219], v[188:191], a[112:115]
    v_mfma_f32_16x16x32_bf16 a[116:119], v[216:219], v[192:195], a[116:119]
    v_mfma_f32_16x16x32_bf16 a[120:123], v[220:223], v[176:179], a[120:123]
    v_mfma_f32_16x16x32_bf16 a[124:127], v[220:223], v[180:183], a[124:127]
    v_mfma_f32_16x16x32_bf16 a[128:131], v[220:223], v[184:187], a[128:131]
    v_mfma_f32_16x16x32_bf16 a[132:135], v[220:223], v[188:191], a[132:135]
    v_mfma_f32_16x16x32_bf16 a[136:139], v[220:223], v[192:195], a[136:139]
    v_mfma_f32_16x16x32_bf16 a[140:143], v[224:227], v[176:179], a[140:143]
    v_mfma_f32_16x16x32_bf16 a[144:147], v[224:227], v[180:183], a[144:147]
    v_mfma_f32_16x16x32_bf16 a[148:151], v[224:227], v[184:187], a[148:151]
    v_mfma_f32_16x16x32_bf16 a[152:155], v[224:227], v[188:191], a[152:155]
    v_mfma_f32_16x16x32_bf16 a[156:159], v[224:227], v[192:195], a[156:159]
    s_waitcnt vmcnt(0)
    v_mfma_f32_16x16x32_bf16 a[160:163], v[228:231], v[176:179], a[160:163]
    v_mfma_f32_16x16x32_bf16 a[164:167], v[228:231], v[180:183], a[164:167]
    v_mfma_f32_16x16x32_bf16 a[168:171], v[228:231], v[184:187], a[168:171]
    v_mfma_f32_16x16x32_bf16 a[172:175], v[228:231], v[188:191], a[172:175]
    v_mfma_f32_16x16x32_bf16 a[176:179], v[228:231], v[192:195], a[176:179]
    ds_write_b128 v4, a[40:43] offset:0
    ds_write_b128 v4, a[44:47] offset:1024
    ds_write_b128 v4, a[48:51] offset:2048
    ds_write_b128 v4, a[52:55] offset:3072
    ds_write_b128 v4, a[56:59] offset:4096
    ds_write_b128 v4, a[60:63] offset:5120
    ds_write_b128 v4, a[64:67] offset:6144
    ds_write_b128 v4, a[68:71] offset:7168
    ds_write_b128 v4, a[72:75] offset:8192
    ds_write_b128 v4, a[76:79] offset:9216
    ds_write_b128 v5, a[80:83] offset:0
    ds_write_b128 v5, a[84:87] offset:1024
    ds_write_b128 v5, a[88:91] offset:2048
    ds_write_b128 v5, a[92:95] offset:3072
    ds_write_b128 v5, a[96:99] offset:4096
    ds_write_b128 v5, a[100:103] offset:5120
    ds_write_b128 v5, a[104:107] offset:6144
    ds_write_b128 v5, a[108:111] offset:7168
    ds_write_b128 v5, a[112:115] offset:8192
    ds_write_b128 v5, a[116:119] offset:9216
    ds_write_b128 v6, a[120:123] offset:0
    ds_write_b128 v6, a[124:127] offset:1024
    ds_write_b128 v6, a[128:131] offset:2048
    ds_write_b128 v6, a[132:135] offset:3072
    ds_write_b128 v6, a[136:139] offset:4096
    ds_write_b128 v6, a[140:143] offset:5120
    ds_write_b128 v6, a[144:147] offset:6144
    ds_write_b128 v6, a[148:151] offset:7168
    ds_write_b128 v6, a[152:155] offset:8192
    ds_write_b128 v6, a[156:159] offset:9216
    ds_write_b128 v7, a[160:163] offset:0
    ds_write_b128 v7, a[164:167] offset:1024
    ds_write_b128 v7, a[168:171] offset:2048
    ds_write_b128 v7, a[172:175] offset:3072
    ds_write_b128 v7, a[176:179] offset:4096
    v_accvgpr_read_b32 v8, a0
    v_accvgpr_read_b32 v9, a1
    v_accvgpr_read_b32 v10, a2
    v_accvgpr_read_b32 v11, a3
    v_accvgpr_read_b32 v12, a4
    v_accvgpr_read_b32 v13, a5
    v_accvgpr_read_b32 v14, a6
    v_accvgpr_read_b32 v15, a7
    v_accvgpr_read_b32 v16, a8
    v_accvgpr_read_b32 v17, a9
    v_accvgpr_read_b32 v18, a10
    v_accvgpr_read_b32 v19, a11
    v_accvgpr_read_b32 v20, a12
    v_accvgpr_read_b32 v21, a13
    v_accvgpr_read_b32 v22, a14
    v_accvgpr_read_b32 v23, a15
    v_accvgpr_read_b32 v24, a16
    v_accvgpr_read_b32 v25, a17
    v_accvgpr_read_b32 v26, a18
    v_accvgpr_read_b32 v27, a19
    v_accvgpr_read_b32 v28, a20
    v_accvgpr_read_b32 v29, a21
    v_accvgpr_read_b32 v30, a22
    v_accvgpr_read_b32 v31, a23
    v_accvgpr_read_b32 v32, a24
    v_accvgpr_read_b32 v33, a25
    v_accvgpr_read_b32 v34, a26
    v_accvgpr_read_b32 v35, a27
    v_accvgpr_read_b32 v36, a28
    v_accvgpr_read_b32 v37, a29
    v_accvgpr_read_b32 v38, a30
    v_accvgpr_read_b32 v39, a31
    v_accvgpr_read_b32 v40, a32
    v_accvgpr_read_b32 v41, a33
    v_accvgpr_read_b32 v42, a34
    v_accvgpr_read_b32 v43, a35
    v_accvgpr_read_b32 v44, a36
    v_accvgpr_read_b32 v45, a37
    v_accvgpr_read_b32 v46, a38
    v_accvgpr_read_b32 v47, a39
    s_waitcnt lgkmcnt(0)
    s_barrier
    ds_read_b128 v[48:51], v3 offset:0
    ds_read_b128 v[52:55], v3 offset:10240
    ds_read_b128 v[56:59], v3 offset:20480
    ds_read_b128 v[60:63], v3 offset:5120
    ds_read_b128 v[64:67], v3 offset:15360
    ds_read_b128 v[68:71], v3 offset:25600
    ds_read_b128 v[72:75], v3 offset:1024
    ds_read_b128 v[76:79], v3 offset:11264
    ds_read_b128 v[80:83], v3 offset:21504
    ds_read_b128 v[84:87], v3 offset:6144
    ds_read_b128 v[88:91], v3 offset:16384
    ds_read_b128 v[92:95], v3 offset:26624
    ds_read_b128 v[168:171], v233 offset:0
    ds_read_b128 v[172:175], v233 offset:5120
    ds_read_b128 v[176:179], v233 offset:10240
    ds_read_b128 v[180:183], v233 offset:15360
    ds_read_b128 v[96:99], v3 offset:2048
    ds_read_b128 v[100:103], v3 offset:12288
    ds_read_b128 v[104:107], v3 offset:22528
    ds_read_b128 v[108:111], v3 offset:7168
    ds_read_b128 v[112:115], v3 offset:17408
    ds_read_b128 v[116:119], v3 offset:27648
    ds_read_b128 v[120:123], v3 offset:3072
    ds_read_b128 v[124:127], v3 offset:13312
    ds_read_b128 v[128:131], v3 offset:23552
    ds_read_b128 v[132:135], v3 offset:8192
    ds_read_b128 v[136:139], v3 offset:18432
    ds_read_b128 v[140:143], v3 offset:28672
    ds_read_b128 v[144:147], v3 offset:4096
    ds_read_b128 v[148:151], v3 offset:14336
    ds_read_b128 v[152:155], v3 offset:24576
    ds_read_b128 v[156:159], v3 offset:9216
    ds_read_b128 v[160:163], v3 offset:19456
    ds_read_b128 v[164:167], v3 offset:29696
    s_waitcnt lgkmcnt(15)
    v_pk_add_f32 v[8:9], v[8:9], v[48:49]
    v_pk_add_f32 v[10:11], v[10:11], v[50:51]
    v_pk_add_f32 v[8:9], v[8:9], v[52:53]
    v_pk_add_f32 v[10:11], v[10:11], v[54:55]
    v_pk_add_f32 v[8:9], v[8:9], v[56:57]
    v_pk_add_f32 v[10:11], v[10:11], v[58:59]
    v_pk_add_f32 v[28:29], v[28:29], v[60:61]
    v_pk_add_f32 v[30:31], v[30:31], v[62:63]
    v_pk_add_f32 v[28:29], v[28:29], v[64:65]
    v_pk_add_f32 v[30:31], v[30:31], v[66:67]
    v_pk_add_f32 v[28:29], v[28:29], v[68:69]
    v_pk_add_f32 v[30:31], v[30:31], v[70:71]
    v_cvt_pk_bf16_f32 v200, v8, v9
    v_cvt_pk_bf16_f32 v201, v10, v11
    v_cvt_pk_bf16_f32 v202, v28, v29
    v_cvt_pk_bf16_f32 v203, v30, v31
    s_nop 0
    v_permlane32_swap_b32 v200, v202
    v_permlane32_swap_b32 v201, v203
    s_nop 0
    v_permlane16_swap_b32 v200, v202
    v_permlane16_swap_b32 v201, v203
    buffer_store_dwordx4 v[200:203], v2, s[28:31], s50 offen offset:0
    v_pk_add_f32 v[12:13], v[12:13], v[72:73]
    v_pk_add_f32 v[14:15], v[14:15], v[74:75]
    v_pk_add_f32 v[12:13], v[12:13], v[76:77]
    v_pk_add_f32 v[14:15], v[14:15], v[78:79]
    v_pk_add_f32 v[12:13], v[12:13], v[80:81]
    v_pk_add_f32 v[14:15], v[14:15], v[82:83]
    v_pk_add_f32 v[32:33], v[32:33], v[84:85]
    v_pk_add_f32 v[34:35], v[34:35], v[86:87]
    v_pk_add_f32 v[32:33], v[32:33], v[88:89]
    v_pk_add_f32 v[34:35], v[34:35], v[90:91]
    v_pk_add_f32 v[32:33], v[32:33], v[92:93]
    v_pk_add_f32 v[34:35], v[34:35], v[94:95]
    v_cvt_pk_bf16_f32 v204, v12, v13
    v_cvt_pk_bf16_f32 v205, v14, v15
    v_cvt_pk_bf16_f32 v206, v32, v33
    v_cvt_pk_bf16_f32 v207, v34, v35
    s_nop 0
    v_permlane32_swap_b32 v204, v206
    v_permlane32_swap_b32 v205, v207
    s_nop 0
    v_permlane16_swap_b32 v204, v206
    v_permlane16_swap_b32 v205, v207
    buffer_store_dwordx4 v[204:207], v2, s[28:31], s51 offen offset:0
    v_pk_add_f32 v[168:169], v[168:169], v[172:173]
    v_pk_add_f32 v[176:177], v[176:177], v[180:181]
    v_pk_add_f32 v[168:169], v[168:169], v[176:177]
    v_pk_add_f32 v[170:171], v[170:171], v[174:175]
    v_pk_add_f32 v[178:179], v[178:179], v[182:183]
    v_pk_add_f32 v[170:171], v[170:171], v[178:179]
    v_cvt_pk_bf16_f32 v168, v168, v169
    v_cvt_pk_bf16_f32 v169, v170, v171
    buffer_store_dwordx2 v[168:169], v232, s[28:31], s66 offen offset:256
    v_pk_add_f32 v[16:17], v[16:17], v[96:97]
    v_pk_add_f32 v[18:19], v[18:19], v[98:99]
    v_pk_add_f32 v[16:17], v[16:17], v[100:101]
    v_pk_add_f32 v[18:19], v[18:19], v[102:103]
    v_pk_add_f32 v[16:17], v[16:17], v[104:105]
    v_pk_add_f32 v[18:19], v[18:19], v[106:107]
    s_waitcnt lgkmcnt(14)
    v_pk_add_f32 v[36:37], v[36:37], v[108:109]
    v_pk_add_f32 v[38:39], v[38:39], v[110:111]
    s_waitcnt lgkmcnt(13)
    v_pk_add_f32 v[36:37], v[36:37], v[112:113]
    v_pk_add_f32 v[38:39], v[38:39], v[114:115]
    s_waitcnt lgkmcnt(12)
    v_pk_add_f32 v[36:37], v[36:37], v[116:117]
    v_pk_add_f32 v[38:39], v[38:39], v[118:119]
    v_cvt_pk_bf16_f32 v208, v16, v17
    v_cvt_pk_bf16_f32 v209, v18, v19
    v_cvt_pk_bf16_f32 v210, v36, v37
    v_cvt_pk_bf16_f32 v211, v38, v39
    s_nop 0
    v_permlane32_swap_b32 v208, v210
    v_permlane32_swap_b32 v209, v211
    s_nop 0
    v_permlane16_swap_b32 v208, v210
    v_permlane16_swap_b32 v209, v211
    buffer_store_dwordx4 v[208:211], v2, s[28:31], s52 offen offset:0
    s_waitcnt lgkmcnt(11)
    v_pk_add_f32 v[20:21], v[20:21], v[120:121]
    v_pk_add_f32 v[22:23], v[22:23], v[122:123]
    s_waitcnt lgkmcnt(10)
    v_pk_add_f32 v[20:21], v[20:21], v[124:125]
    v_pk_add_f32 v[22:23], v[22:23], v[126:127]
    s_waitcnt lgkmcnt(9)
    v_pk_add_f32 v[20:21], v[20:21], v[128:129]
    v_pk_add_f32 v[22:23], v[22:23], v[130:131]
    s_waitcnt lgkmcnt(8)
    v_pk_add_f32 v[40:41], v[40:41], v[132:133]
    v_pk_add_f32 v[42:43], v[42:43], v[134:135]
    s_waitcnt lgkmcnt(7)
    v_pk_add_f32 v[40:41], v[40:41], v[136:137]
    v_pk_add_f32 v[42:43], v[42:43], v[138:139]
    s_waitcnt lgkmcnt(6)
    v_pk_add_f32 v[40:41], v[40:41], v[140:141]
    v_pk_add_f32 v[42:43], v[42:43], v[142:143]
    v_cvt_pk_bf16_f32 v212, v20, v21
    v_cvt_pk_bf16_f32 v213, v22, v23
    v_cvt_pk_bf16_f32 v214, v40, v41
    v_cvt_pk_bf16_f32 v215, v42, v43
    s_nop 0
    v_permlane32_swap_b32 v212, v214
    v_permlane32_swap_b32 v213, v215
    s_nop 0
    v_permlane16_swap_b32 v212, v214
    v_permlane16_swap_b32 v213, v215
    buffer_store_dwordx4 v[212:215], v2, s[28:31], s53 offen offset:0
    s_waitcnt lgkmcnt(5)
    v_pk_add_f32 v[24:25], v[24:25], v[144:145]
    v_pk_add_f32 v[26:27], v[26:27], v[146:147]
    s_waitcnt lgkmcnt(4)
    v_pk_add_f32 v[24:25], v[24:25], v[148:149]
    v_pk_add_f32 v[26:27], v[26:27], v[150:151]
    s_waitcnt lgkmcnt(3)
    v_pk_add_f32 v[24:25], v[24:25], v[152:153]
    v_pk_add_f32 v[26:27], v[26:27], v[154:155]
    s_waitcnt lgkmcnt(2)
    v_pk_add_f32 v[44:45], v[44:45], v[156:157]
    v_pk_add_f32 v[46:47], v[46:47], v[158:159]
    s_waitcnt lgkmcnt(1)
    v_pk_add_f32 v[44:45], v[44:45], v[160:161]
    v_pk_add_f32 v[46:47], v[46:47], v[162:163]
    s_waitcnt lgkmcnt(0)
    v_pk_add_f32 v[44:45], v[44:45], v[164:165]
    v_pk_add_f32 v[46:47], v[46:47], v[166:167]
    v_cvt_pk_bf16_f32 v216, v24, v25
    v_cvt_pk_bf16_f32 v217, v26, v27
    v_cvt_pk_bf16_f32 v218, v44, v45
    v_cvt_pk_bf16_f32 v219, v46, v47
    s_nop 0
    v_permlane32_swap_b32 v216, v218
    v_permlane32_swap_b32 v217, v219
    s_nop 0
    v_permlane16_swap_b32 v216, v218
    v_permlane16_swap_b32 v217, v219
    buffer_store_dwordx4 v[216:219], v2, s[28:31], s54 offen offset:0
    s_cmp_lg_u32 s60, 0
    s_cbranch_scc1 oproj_kernel_done
    ds_read_b128 v[184:187], v233 offset:4096
    ds_read_b128 v[188:191], v233 offset:9216
    ds_read_b128 v[192:195], v233 offset:14336
    ds_read_b128 v[196:199], v233 offset:19456
    s_waitcnt lgkmcnt(2)
    v_pk_add_f32 v[184:185], v[184:185], v[188:189]
    s_waitcnt lgkmcnt(0)
    v_pk_add_f32 v[192:193], v[192:193], v[196:197]
    v_pk_add_f32 v[184:185], v[184:185], v[192:193]
    v_pk_add_f32 v[186:187], v[186:187], v[190:191]
    v_pk_add_f32 v[194:195], v[194:195], v[198:199]
    v_pk_add_f32 v[186:187], v[186:187], v[194:195]
    v_cvt_pk_bf16_f32 v184, v184, v185
    v_cvt_pk_bf16_f32 v185, v186, v187
    buffer_store_dwordx2 v[184:185], v232, s[28:31], s54 offen offset:256
oproj_kernel_done:
    s_endpgm
.section .rodata,"a"
.p2align 6
.amdhsa_kernel attn_kernel
  .amdhsa_next_free_vgpr 256
  .amdhsa_next_free_sgpr 102
  .amdhsa_accum_offset 256
  .amdhsa_group_segment_fixed_size 0
  .amdhsa_kernarg_size 64
  .amdhsa_user_sgpr_count 2
  .amdhsa_user_sgpr_kernarg_segment_ptr 1
  .amdhsa_system_sgpr_workgroup_id_x 1
.end_amdhsa_kernel
.p2align 6
.amdhsa_kernel oproj_kernel
  .amdhsa_next_free_vgpr 512
  .amdhsa_next_free_sgpr 96
  .amdhsa_accum_offset 256
  .amdhsa_group_segment_fixed_size 0
  .amdhsa_kernarg_size 64
  .amdhsa_user_sgpr_count 2
  .amdhsa_user_sgpr_kernarg_segment_ptr 1
  .amdhsa_system_sgpr_workgroup_id_x 1
.end_amdhsa_kernel
```
